```python
import torch

def _softmax(x, axis=-1):
    return torch.softmax(x, dim=axis)

def _gelu(x):
    return torch.nn.functional.gelu(x, approximate='tanh')

def _silu(x):
    return torch.nn.functional.silu(x)

def _sigmoid(x):
    return torch.sigmoid(x)

def _layernorm(x, axis=-1, eps=1e-05):
    m = x.mean(dim=axis, keepdim=True)
    v = x.var(dim=axis, keepdim=True, unbiased=False)
    return (x - m) / torch.sqrt(v + eps)

def _scatter_add(tgt, idx, src, axis=0):
    return tgt.clone().index_add_(axis, idx, src)

def _segment_sum(src, seg, n):
    out = torch.zeros((n,) + src.shape[1:], dtype=src.dtype)
    return out.index_add_(0, seg, src)

def _pad(x, pw):
    flat = tuple((v for pair in reversed(pw) for v in pair))
    return torch.nn.functional.pad(x, flat)
kernel_name = 'parallel_sum__memory_aug_recurrent_mem_tr__glu_gated_bilinear__prompt'

def setup_inputs():

    _w = lambda a: (lambda t: t.to(torch.bfloat16) if t.is_floating_point() else t)(torch.as_tensor(a))

    def _A_setup():
        B, S, Dm = (1, 2048, 448)
        H, Dh = (16, 256)
        M, seg = (8, 32)
        seg = min(seg, S)
        S = S // seg * seg
        return {'x': _w((lambda *s: torch.randn(*s, dtype=torch.bfloat16) * 0.05)(B, S, Dm)), 'mem0': _w((lambda *s: torch.randn(*s, dtype=torch.bfloat16) * 0.2)(B, M, Dm)), 'Wq': _w((lambda *s: torch.randn(*s, dtype=torch.bfloat16) * 1.6)(Dm, H, Dh) * Dm ** (-0.5)), 'Wk': _w((lambda *s: torch.randn(*s, dtype=torch.bfloat16) * 1.6)(Dm, H, Dh) * Dm ** (-0.5)), 'Wv': _w((lambda *s: torch.randn(*s, dtype=torch.bfloat16) * 0.2)(Dm, H, Dh) * Dm ** (-0.5)), 'Wo': _w((lambda *s: torch.randn(*s, dtype=torch.bfloat16) * 0.2)(H, Dh, Dm) * (H * Dh) ** (-0.5)), 'seg_len': seg}
    _A_in = _A_setup()

    def _B_setup():
        B, S, D, F = (1, 2048, 448, 1792)
        return {'x': _w((lambda *s: torch.randn(*s, dtype=torch.bfloat16) * 0.05)(B, S, D)), 'w_gate': _w((lambda *s: torch.randn(*s, dtype=torch.bfloat16) * 0.2)(D, F) * D ** (-0.5)), 'w_up': _w((lambda *s: torch.randn(*s, dtype=torch.bfloat16) * 0.2)(D, F) * D ** (-0.5)), 'w_down': _w((lambda *s: torch.randn(*s, dtype=torch.bfloat16) * 0.2)(F, D) * F ** (-0.5))}
    _B_in = _B_setup()
    return {'A_x': _A_in['x'], 'A_mem0': _A_in['mem0'], 'A_Wq': _A_in['Wq'], 'A_Wk': _A_in['Wk'], 'A_Wv': _A_in['Wv'], 'A_Wo': _A_in['Wo'], 'A_seg_len': _A_in['seg_len'], 'B_x': _B_in['x'], 'B_w_gate': _B_in['w_gate'], 'B_w_up': _B_in['w_up'], 'B_w_down': _B_in['w_down']}

def reference(A_x, A_mem0, A_Wq, A_Wk, A_Wv, A_Wo, A_seg_len, B_x, B_w_gate, B_w_up, B_w_down):

    def _A_ref(x, mem0, Wq, Wk, Wv, Wo, seg_len):
        B, S, Dm = x.shape
        H, Dh = (Wq.shape[1], Wq.shape[2])
        M = mem0.shape[1]
        scale = Dh ** (-0.5)
        n_seg = S // seg_len
        L = M + seg_len
        idx = torch.arange(L)
        mask = (idx[:, None] < M) | (idx[:, None] >= idx[None, :])
        mem = mem0
        outs = []
        for s in range(n_seg):
            xs = x[:, s * seg_len:(s + 1) * seg_len, :].clone()
            h = torch.concatenate([mem, xs], axis=1)
            q = torch.einsum('btd,dhe->bhte', h, Wq)
            k = torch.einsum('btd,dhe->bhte', h, Wk)
            v = torch.einsum('btd,dhe->bhte', h, Wv)
            scores = torch.einsum('bhqe,bhke->bhqk', q, k) * scale
            scores = torch.where(mask[None, None], scores, -1000000000.0)
            p = _softmax(scores, axis=-1)
            o = torch.einsum('bhqk,bhke->bhqe', p, v)
            o = torch.einsum('bhte,hed->btd', o, Wo)
            mem = o[:, :M, :].clone()
            outs.append(o[:, M:, :])
        return torch.concatenate(outs, axis=1)

    def _B_ref(x, w_gate, w_up, w_down):
        g = torch.einsum('bsd,df->bsf', x, w_gate)
        u = torch.einsum('bsd,df->bsf', x, w_up)
        h = g * u
        return torch.einsum('bsf,fd->bsd', h, w_down)
    x = A_x
    xn = _layernorm(x, axis=-1)
    return x + _A_ref(xn, A_mem0, A_Wq, A_Wk, A_Wv, A_Wo, A_seg_len) + _B_ref(xn, B_w_gate, B_w_up, B_w_down)
```

```asm
; @launch kernel=parallel_sum__memory_aug_recurrent_mem_tr__glu_gated_bilinear__prompt_kernel grid=(256,1,1) block=(256,1,1) lds=163840
.amdgcn_target "amdgcn-amd-amdhsa--gfx950"
.text
.p2align 8
.type parallel_sum__memory_aug_recurrent_mem_tr__glu_gated_bilinear__prompt_kernel,@function
parallel_sum__memory_aug_recurrent_mem_tr__glu_gated_bilinear__prompt_kernel:
    s_cmp_ge_u32 s2, 256
    s_cbranch_scc1 CH_DONE
    s_nop 0
    s_load_dwordx2 s[4:5], s[0:1], 96
    s_load_dwordx2 s[6:7], s[0:1], 104
    s_load_dwordx8 s[40:47], s[0:1], 0
    s_load_dwordx4 s[48:51], s[0:1], 32
    v_lshrrev_b32_e64 v1, 6, v0
    s_nop 0
    v_readfirstlane_b32 s16, v1
    s_waitcnt lgkmcnt(0)
    s_mov_b32 s8, s6
    s_and_b32 s9, s7, 0xffff
    s_mov_b32 s10, 268435456
    s_mov_b32 s11, 0x00020000
    s_mov_b32 s12, s4
    s_nop 0
    s_and_b32 s13, s5, 0xffff
    s_mov_b32 s14, 256
    s_mov_b32 s15, 0x00020000
    s_mov_b32 s17, 255
    s_mov_b32 s97, 0
    s_cmp_lg_u32 s16, 0
    s_cbranch_scc1 EL_MID
    s_getreg_b32 s29, hwreg(HW_REG_XCC_ID)
    s_and_b32 s29, s29, 15
    s_cmp_lg_u32 s29, 0
    s_cbranch_scc1 EL_MID
    s_mov_b64 exec, 1
    v_mov_b32_e64 v250, 1
    v_mov_b32 v4, 192
    buffer_atomic_add v250, v4, s[12:15], 0 offen sc0
    s_mov_b32 s97, 1
    s_nop 0
EL_MID:
    s_mov_b64 exec, -1
    v_and_b32 v1, 63, v0
    v_and_b32 v3, 15, v1
    v_lshrrev_b32 v4, 4, v1
    v_lshlrev_b32_e64 v5, 4, v1
    s_cmp_ge_u32 s2, 224
    s_cbranch_scc1 PP_LN
    s_and_b32 s28, s2, 1
    s_lshr_b32 s23, s2, 5
    s_nop 0
    s_bfe_u32 s20, s2, 0x20001
    s_lshl_b32 s20, s20, 2
    s_nop 0
    s_bfe_u32 s4, s2, 0x20003
    s_add_u32 s20, s20, s4
    s_cmp_eq_u32 s28, 1
    s_cselect_b32 s24, s44, s48
    s_cselect_b32 s25, s45, s49
    s_cselect_b32 s26, s46, s50
    s_cselect_b32 s27, s47, s51
    s_mov_b32 s32, s24
    s_nop 0
    s_and_b32 s33, s25, 0xffff
    s_mov_b32 s34, 3670016
    s_mov_b32 s35, 0x00020000
    s_mov_b32 s36, s26
    s_nop 0
    s_and_b32 s37, s27, 0xffff
    s_mov_b32 s38, 3670016
    s_mov_b32 s39, 0x00020000
    v_lshrrev_b32 v6, 5, v1
    v_and_b32 v7, 31, v1
    s_lshl_b32 s4, s16, 2
    v_or_b32 v8, s4, v6
    v_xor_b32 v7, v7, v8
    v_lshlrev_b32 v8, 13, v6
    v_lshl_add_u32 v8, v7, 4, v8
    v_xor_b32_e64 v9, 32, v8
    s_lshl_b32 s21, s20, 9
    s_lshl_b32 s4, s16, 16
    s_add_u32 s21, s21, s4
    s_lshl_b32 s29, s16, 12
    s_lshl_b32 s4, s23, 19
    s_add_u32 s64, s21, s4
    s_add_u32 m0, s29, 32768
    s_add_u32 s5, s64, 0
    s_nop 0
    buffer_load_dwordx4 v8, s[32:35], s5 offen lds
    s_add_u32 m0, s29, 33792
    s_add_u32 s5, s64, 16384
    buffer_load_dwordx4 v9, s[32:35], s5 offen lds
    s_add_u32 m0, s29, 34816
    s_add_u32 s5, s64, 32768
    buffer_load_dwordx4 v8, s[32:35], s5 offen lds
    s_add_u32 m0, s29, 35840
    s_add_u32 s5, s64, 49152
    buffer_load_dwordx4 v9, s[32:35], s5 offen lds
    s_add_u32 m0, s29, 49152
    s_add_u32 s5, s64, 262144
    buffer_load_dwordx4 v8, s[32:35], s5 offen lds
    s_add_u32 m0, s29, 50176
    s_add_u32 s5, s64, 278528
    buffer_load_dwordx4 v9, s[32:35], s5 offen lds
    s_add_u32 m0, s29, 51200
    s_add_u32 s5, s64, 294912
    buffer_load_dwordx4 v8, s[32:35], s5 offen lds
    s_add_u32 m0, s29, 52224
    s_add_u32 s5, s64, 311296
    buffer_load_dwordx4 v9, s[32:35], s5 offen lds
    s_cmp_eq_u32 s28, 1
    s_cbranch_scc1 PP_BA
    v_lshrrev_b32 v6, 3, v1
    v_and_b32 v7, 7, v1
    v_bfe_u32 v10, v1, 4, 1
    s_lshl_b32 s4, s16, 1
    v_or_b32 v10, s4, v10
    v_xor_b32_e64 v7, v7, v10
    v_mul_u32_u24 v10, 896, v6
    v_lshl_add_u32 v10, v7, 4, v10
    s_mul_i32 s22, s20, 229376
    s_lshl_b32 s5, s23, 7
    s_add_u32 s22, s22, s5
    s_mul_i32 s5, s16, 7168
    s_add_u32 s22, s22, s5
    s_lshl_b32 s4, s16, 10
    s_add_u32 m0, s4, 0
    s_add_u32 s5, s22, 0
    buffer_load_dwordx4 v10, s[36:39], s5 offen lds
    s_add_u32 m0, s4, 4096
    s_add_u32 s5, s22, 28672
    buffer_load_dwordx4 v10, s[36:39], s5 offen lds
    s_add_u32 m0, s4, 8192
    s_add_u32 s5, s22, 57344
    buffer_load_dwordx4 v10, s[36:39], s5 offen lds
    s_add_u32 m0, s4, 12288
    s_add_u32 s5, s22, 86016
    buffer_load_dwordx4 v10, s[36:39], s5 offen lds
    s_add_u32 m0, s4, 16384
    s_add_u32 s5, s22, 114688
    buffer_load_dwordx4 v10, s[36:39], s5 offen lds
    s_add_u32 m0, s4, 20480
    s_add_u32 s5, s22, 143360
    buffer_load_dwordx4 v10, s[36:39], s5 offen lds
    s_add_u32 m0, s4, 24576
    s_add_u32 s5, s22, 172032
    buffer_load_dwordx4 v10, s[36:39], s5 offen lds
    s_add_u32 m0, s4, 28672
    s_add_u32 s5, s22, 200704
    buffer_load_dwordx4 v10, s[36:39], s5 offen lds
    s_branch PP_BD
    s_nop 0
PP_BA:
    s_lshl_b32 s22, s23, 19
    s_add_u32 s22, s22, s21
    s_add_u32 m0, s29, 0
    s_add_u32 s5, s22, 0
    buffer_load_dwordx4 v8, s[36:39], s5 offen lds
    s_add_u32 m0, s29, 1024
    s_add_u32 s5, s22, 16384
    buffer_load_dwordx4 v9, s[36:39], s5 offen lds
    s_add_u32 m0, s29, 2048
    s_add_u32 s5, s22, 32768
    buffer_load_dwordx4 v8, s[36:39], s5 offen lds
    s_add_u32 m0, s29, 3072
    s_add_u32 s5, s22, 49152
    buffer_load_dwordx4 v9, s[36:39], s5 offen lds
    s_add_u32 m0, s29, 16384
    s_add_u32 s5, s22, 262144
    buffer_load_dwordx4 v8, s[36:39], s5 offen lds
    s_add_u32 m0, s29, 17408
    s_add_u32 s5, s22, 278528
    buffer_load_dwordx4 v9, s[36:39], s5 offen lds
    s_add_u32 m0, s29, 18432
    s_add_u32 s5, s22, 294912
    buffer_load_dwordx4 v8, s[36:39], s5 offen lds
    s_add_u32 m0, s29, 19456
    s_add_u32 s5, s22, 311296
    buffer_load_dwordx4 v9, s[36:39], s5 offen lds
PP_BD:
    s_add_u32 s4, s23, 0
    s_sub_u32 s5, s4, 7
    s_cmp_ge_u32 s4, 7
    s_cselect_b32 s4, s5, s4
    s_lshl_b32 s84, s4, 11
    s_lshl_b32 s4, s4, 19
    s_add_u32 s64, s21, s4
    s_add_u32 s4, s23, 1
    s_sub_u32 s5, s4, 7
    s_cmp_ge_u32 s4, 7
    s_cselect_b32 s4, s5, s4
    s_lshl_b32 s85, s4, 11
    s_lshl_b32 s4, s4, 19
    s_add_u32 s65, s21, s4
    s_add_u32 s4, s23, 2
    s_sub_u32 s5, s4, 7
    s_cmp_ge_u32 s4, 7
    s_cselect_b32 s4, s5, s4
    s_lshl_b32 s86, s4, 11
    s_lshl_b32 s4, s4, 19
    s_add_u32 s66, s21, s4
    s_add_u32 s4, s23, 3
    s_sub_u32 s5, s4, 7
    s_cmp_ge_u32 s4, 7
    s_cselect_b32 s4, s5, s4
    s_lshl_b32 s87, s4, 11
    s_lshl_b32 s4, s4, 19
    s_add_u32 s67, s21, s4
    s_add_u32 s4, s23, 4
    s_sub_u32 s5, s4, 7
    s_cmp_ge_u32 s4, 7
    s_cselect_b32 s4, s5, s4
    s_lshl_b32 s88, s4, 11
    s_lshl_b32 s4, s4, 19
    s_add_u32 s68, s21, s4
    s_add_u32 s4, s23, 5
    s_sub_u32 s5, s4, 7
    s_cmp_ge_u32 s4, 7
    s_cselect_b32 s4, s5, s4
    s_lshl_b32 s89, s4, 11
    s_lshl_b32 s4, s4, 19
    s_add_u32 s69, s21, s4
    s_add_u32 s4, s23, 6
    s_sub_u32 s5, s4, 7
    s_cmp_ge_u32 s4, 7
    s_cselect_b32 s4, s5, s4
    s_lshl_b32 s90, s4, 11
    s_lshl_b32 s4, s4, 19
    s_add_u32 s70, s21, s4
    s_nop 0
    s_add_u32 m0, s29, 65536
    s_add_u32 s5, s65, 0
    s_nop 0
    buffer_load_dwordx4 v8, s[32:35], s5 offen lds
    s_add_u32 m0, s29, 66560
    s_add_u32 s5, s65, 16384
    buffer_load_dwordx4 v9, s[32:35], s5 offen lds
    s_add_u32 m0, s29, 67584
    s_add_u32 s5, s65, 32768
    buffer_load_dwordx4 v8, s[32:35], s5 offen lds
    s_add_u32 m0, s29, 68608
    s_add_u32 s5, s65, 49152
    buffer_load_dwordx4 v9, s[32:35], s5 offen lds
    s_add_u32 m0, s29, 81920
    s_add_u32 s5, s65, 262144
    buffer_load_dwordx4 v8, s[32:35], s5 offen lds
    s_add_u32 m0, s29, 82944
    s_add_u32 s5, s65, 278528
    buffer_load_dwordx4 v9, s[32:35], s5 offen lds
    s_add_u32 m0, s29, 83968
    s_add_u32 s5, s65, 294912
    buffer_load_dwordx4 v8, s[32:35], s5 offen lds
    s_add_u32 m0, s29, 84992
    s_add_u32 s5, s65, 311296
    buffer_load_dwordx4 v9, s[32:35], s5 offen lds
    v_lshrrev_b32 v6, 2, v3
    v_lshlrev_b32 v6, 3, v6
    v_and_b32 v7, 3, v3
    v_add_u32 v6, v6, v7
    v_lshlrev_b32 v6, 9, v6
    v_xor_b32 v7, v3, v4
    v_lshl_add_u32 v12, v7, 4, v6
    s_and_b32 s30, s16, 1
    s_lshr_b32 s31, s16, 1
    s_lshl_b32 s4, s30, 14
    v_add_u32 v16, s4, v12
    s_lshl_b32 s4, s31, 14
    v_add_u32 v12, s4, v12
    v_xor_b32 v13, 64, v12
    v_xor_b32 v17, 64, v16
    v_xor_b32 v14, 128, v12
    v_xor_b32 v18, 128, v16
    v_xor_b32 v15, 192, v12
    v_xor_b32 v19, 192, v16
    v_add_u32 v20, 0x10000, v12
    v_add_u32 v21, 0x10000, v13
    v_add_u32 v22, 0x10000, v14
    v_add_u32 v23, 0x10000, v15
    v_bfe_u32 v6, v1, 2, 2
    v_lshl_add_u32 v7, v4, 3, v6
    v_lshlrev_b32_e64 v7, 7, v7
    v_bfe_u32 v6, v1, 3, 1
    v_lshl_or_b32 v6, v4, 1, v6
    v_bfe_u32 v10, v1, 1, 1
    v_xor_b32_e64 v6, v6, v10
    v_lshl_add_u32 v7, v6, 4, v7
    v_and_b32_e64 v6, 1, v1
    v_lshl_add_u32 v7, v6, 3, v7
    s_lshl_b32 s4, s30, 6
    v_xor_b32 v24, s4, v7
    v_xor_b32_e64 v25, 32, v24
    s_mul_i32 s26, s20, 28
    s_lshl_b32 s5, s23, 2
    s_add_u32 s26, s26, s5
    s_lshl_b32 s5, s30, 1
    s_add_u32 s26, s26, s5
    s_mul_i32 s26, s26, 14
    s_add_u32 s26, s26, s31
    s_lshl_b32 s26, s26, 10
    s_mov_b32 s4, 9437184
    s_mov_b32 s27, 1.0
    s_cmp_eq_u32 s28, 1
    s_cselect_b32 s4, 2097152, s4
    s_cselect_b32 s27, 0x3db8aa3b, s27
    s_add_u32 s26, s26, s4
    v_mov_b32 v26, s27
    v_mov_b32 v27, s27
    s_waitcnt vmcnt(8)
    s_barrier
    s_cmp_eq_u32 s97, 0
    s_cbranch_scc1 ELE_1
    v_readfirstlane_b32 s17, v250
    s_nop 3
    s_cmp_ge_u32 s17, 32
    s_cbranch_scc1 ELE_1
    s_mov_b64 exec, 1
    s_lshl_b32 s98, s17, 2
    v_mov_b32 v251, s98
    s_add_u32 s98, s2, 1
    v_mov_b32 v252, s98
    v_mov_b32_e64 v253, 0
    buffer_atomic_cmpswap v[252:253], v251, s[12:15], 0 offen
    s_nop 0
    s_nop 0
ELE_1:
    s_mov_b64 exec, -1
    s_cmp_eq_u32 s28, 1
    s_cbranch_scc1 PP_RA
    s_nop 0
    ds_read_b64_tr_b16 v[32:33], v24 offset:0
    ds_read_b64_tr_b16 v[34:35], v24 offset:512
    ds_read_b64_tr_b16 v[36:37], v24 offset:4096
    ds_read_b64_tr_b16 v[38:39], v24 offset:4608
    ds_read_b64_tr_b16 v[40:41], v24 offset:8192
    ds_read_b64_tr_b16 v[42:43], v24 offset:8704
    ds_read_b64_tr_b16 v[44:45], v24 offset:12288
    ds_read_b64_tr_b16 v[46:47], v24 offset:12800
    ds_read_b64_tr_b16 v[48:49], v24 offset:16384
    ds_read_b64_tr_b16 v[50:51], v24 offset:16896
    ds_read_b64_tr_b16 v[52:53], v24 offset:20480
    ds_read_b64_tr_b16 v[54:55], v24 offset:20992
    ds_read_b64_tr_b16 v[56:57], v24 offset:24576
    ds_read_b64_tr_b16 v[58:59], v24 offset:25088
    ds_read_b64_tr_b16 v[60:61], v24 offset:28672
    ds_read_b64_tr_b16 v[62:63], v24 offset:29184
    ds_read_b64_tr_b16 v[64:65], v25 offset:0
    ds_read_b64_tr_b16 v[66:67], v25 offset:512
    ds_read_b64_tr_b16 v[68:69], v25 offset:4096
    ds_read_b64_tr_b16 v[70:71], v25 offset:4608
    ds_read_b64_tr_b16 v[72:73], v25 offset:8192
    ds_read_b64_tr_b16 v[74:75], v25 offset:8704
    ds_read_b64_tr_b16 v[76:77], v25 offset:12288
    ds_read_b64_tr_b16 v[78:79], v25 offset:12800
    ds_read_b64_tr_b16 v[80:81], v25 offset:16384
    ds_read_b64_tr_b16 v[82:83], v25 offset:16896
    ds_read_b64_tr_b16 v[84:85], v25 offset:20480
    ds_read_b64_tr_b16 v[86:87], v25 offset:20992
    ds_read_b64_tr_b16 v[88:89], v25 offset:24576
    ds_read_b64_tr_b16 v[90:91], v25 offset:25088
    ds_read_b64_tr_b16 v[92:93], v25 offset:28672
    ds_read_b64_tr_b16 v[94:95], v25 offset:29184
    s_branch PP_RD
    s_nop 0
PP_RA:
    ds_read_b128 v[32:35], v16 offset:0
    ds_read_b128 v[36:39], v17 offset:0
    ds_read_b128 v[40:43], v18 offset:0
    ds_read_b128 v[44:47], v19 offset:0
    ds_read_b128 v[48:51], v16 offset:256
    ds_read_b128 v[52:55], v17 offset:256
    ds_read_b128 v[56:59], v18 offset:256
    ds_read_b128 v[60:63], v19 offset:256
    ds_read_b128 v[64:67], v16 offset:2048
    ds_read_b128 v[68:71], v17 offset:2048
    ds_read_b128 v[72:75], v18 offset:2048
    ds_read_b128 v[76:79], v19 offset:2048
    ds_read_b128 v[80:83], v16 offset:2304
    ds_read_b128 v[84:87], v17 offset:2304
    ds_read_b128 v[88:91], v18 offset:2304
    ds_read_b128 v[92:95], v19 offset:2304
PP_RD:
    ds_read_b128 v[96:99], v12 offset:32768
    ds_read_b128 v[100:103], v12 offset:34816
    ds_read_b128 v[104:107], v13 offset:32768
    ds_read_b128 v[108:111], v13 offset:34816
    ds_read_b128 v[112:115], v14 offset:32768
    ds_read_b128 v[116:119], v14 offset:34816
    ds_read_b128 v[120:123], v15 offset:32768
    ds_read_b128 v[124:127], v15 offset:34816
    ds_read_b128 v[128:131], v12 offset:33024
    ds_read_b128 v[132:135], v12 offset:35072
    ds_read_b128 v[136:139], v13 offset:33024
    ds_read_b128 v[140:143], v13 offset:35072
    ds_read_b128 v[144:147], v14 offset:33024
    ds_read_b128 v[148:151], v14 offset:35072
    ds_read_b128 v[152:155], v15 offset:33024
    ds_read_b128 v[156:159], v15 offset:35072
    s_add_u32 m0, s29, 98304
    s_add_u32 s5, s66, 0
    s_nop 0
    buffer_load_dwordx4 v8, s[32:35], s5 offen lds
    s_add_u32 m0, s29, 99328
    s_add_u32 s5, s66, 16384
    buffer_load_dwordx4 v9, s[32:35], s5 offen lds
    s_add_u32 m0, s29, 100352
    s_add_u32 s5, s66, 32768
    buffer_load_dwordx4 v8, s[32:35], s5 offen lds
    s_add_u32 m0, s29, 101376
    s_add_u32 s5, s66, 49152
    buffer_load_dwordx4 v9, s[32:35], s5 offen lds
    s_add_u32 m0, s29, 114688
    s_add_u32 s5, s66, 262144
    buffer_load_dwordx4 v8, s[32:35], s5 offen lds
    s_add_u32 m0, s29, 115712
    s_add_u32 s5, s66, 278528
    buffer_load_dwordx4 v9, s[32:35], s5 offen lds
    s_add_u32 m0, s29, 116736
    s_add_u32 s5, s66, 294912
    buffer_load_dwordx4 v8, s[32:35], s5 offen lds
    s_add_u32 m0, s29, 117760
    s_add_u32 s5, s66, 311296
    buffer_load_dwordx4 v9, s[32:35], s5 offen lds
    s_waitcnt vmcnt(8) lgkmcnt(0)
    s_barrier
    ds_read_b128 v[160:163], v20 offset:0
    ds_read_b128 v[164:167], v20 offset:2048
    ds_read_b128 v[168:171], v21 offset:0
    ds_read_b128 v[172:175], v21 offset:2048
    ds_read_b128 v[176:179], v22 offset:0
    ds_read_b128 v[180:183], v22 offset:2048
    ds_read_b128 v[184:187], v23 offset:0
    ds_read_b128 v[188:191], v23 offset:2048
    ds_read_b128 v[192:195], v20 offset:256
    ds_read_b128 v[196:199], v20 offset:2304
    ds_read_b128 v[200:203], v21 offset:256
    ds_read_b128 v[204:207], v21 offset:2304
    ds_read_b128 v[208:211], v22 offset:256
    ds_read_b128 v[212:215], v22 offset:2304
    ds_read_b128 v[216:219], v23 offset:256
    ds_read_b128 v[220:223], v23 offset:2304
    s_add_u32 m0, s29, 32768
    s_add_u32 s5, s67, 0
    s_nop 0
    buffer_load_dwordx4 v8, s[32:35], s5 offen lds
    s_add_u32 m0, s29, 33792
    s_add_u32 s5, s67, 16384
    buffer_load_dwordx4 v9, s[32:35], s5 offen lds
    s_add_u32 m0, s29, 34816
    s_add_u32 s5, s67, 32768
    buffer_load_dwordx4 v8, s[32:35], s5 offen lds
    s_add_u32 m0, s29, 35840
    s_add_u32 s5, s67, 49152
    buffer_load_dwordx4 v9, s[32:35], s5 offen lds
    s_add_u32 m0, s29, 49152
    s_add_u32 s5, s67, 262144
    buffer_load_dwordx4 v8, s[32:35], s5 offen lds
    s_add_u32 m0, s29, 50176
    s_add_u32 s5, s67, 278528
    buffer_load_dwordx4 v9, s[32:35], s5 offen lds
    s_add_u32 m0, s29, 51200
    s_add_u32 s5, s67, 294912
    buffer_load_dwordx4 v8, s[32:35], s5 offen lds
    s_add_u32 m0, s29, 52224
    s_add_u32 s5, s67, 311296
    buffer_load_dwordx4 v9, s[32:35], s5 offen lds
    v_mfma_f32_16x16x32_bf16 v[224:227], v[96:99], v[32:35], 0
    v_mfma_f32_16x16x32_bf16 v[228:231], v[96:99], v[64:67], 0
    v_mfma_f32_16x16x32_bf16 v[232:235], v[100:103], v[32:35], 0
    v_mfma_f32_16x16x32_bf16 v[236:239], v[100:103], v[64:67], 0
    v_mfma_f32_16x16x32_bf16 v[224:227], v[104:107], v[36:39], v[224:227]
    v_mfma_f32_16x16x32_bf16 v[228:231], v[104:107], v[68:71], v[228:231]
    v_mfma_f32_16x16x32_bf16 v[232:235], v[108:111], v[36:39], v[232:235]
    v_mfma_f32_16x16x32_bf16 v[236:239], v[108:111], v[68:71], v[236:239]
    v_mfma_f32_16x16x32_bf16 v[224:227], v[112:115], v[40:43], v[224:227]
    v_mfma_f32_16x16x32_bf16 v[228:231], v[112:115], v[72:75], v[228:231]
    v_mfma_f32_16x16x32_bf16 v[232:235], v[116:119], v[40:43], v[232:235]
    v_mfma_f32_16x16x32_bf16 v[236:239], v[116:119], v[72:75], v[236:239]
    v_mfma_f32_16x16x32_bf16 v[224:227], v[120:123], v[44:47], v[224:227]
    v_mfma_f32_16x16x32_bf16 v[228:231], v[120:123], v[76:79], v[228:231]
    v_mfma_f32_16x16x32_bf16 v[232:235], v[124:127], v[44:47], v[232:235]
    v_mfma_f32_16x16x32_bf16 v[236:239], v[124:127], v[76:79], v[236:239]
    v_mfma_f32_16x16x32_bf16 v[224:227], v[128:131], v[48:51], v[224:227]
    v_mfma_f32_16x16x32_bf16 v[228:231], v[128:131], v[80:83], v[228:231]
    v_mfma_f32_16x16x32_bf16 v[232:235], v[132:135], v[48:51], v[232:235]
    v_mfma_f32_16x16x32_bf16 v[236:239], v[132:135], v[80:83], v[236:239]
    v_mfma_f32_16x16x32_bf16 v[224:227], v[136:139], v[52:55], v[224:227]
    v_mfma_f32_16x16x32_bf16 v[228:231], v[136:139], v[84:87], v[228:231]
    v_mfma_f32_16x16x32_bf16 v[232:235], v[140:143], v[52:55], v[232:235]
    v_mfma_f32_16x16x32_bf16 v[236:239], v[140:143], v[84:87], v[236:239]
    v_mfma_f32_16x16x32_bf16 v[224:227], v[144:147], v[56:59], v[224:227]
    v_mfma_f32_16x16x32_bf16 v[228:231], v[144:147], v[88:91], v[228:231]
    v_mfma_f32_16x16x32_bf16 v[232:235], v[148:151], v[56:59], v[232:235]
    v_mfma_f32_16x16x32_bf16 v[236:239], v[148:151], v[88:91], v[236:239]
    v_mfma_f32_16x16x32_bf16 v[224:227], v[152:155], v[60:63], v[224:227]
    v_mfma_f32_16x16x32_bf16 v[228:231], v[152:155], v[92:95], v[228:231]
    v_mfma_f32_16x16x32_bf16 v[232:235], v[156:159], v[60:63], v[232:235]
    v_mfma_f32_16x16x32_bf16 v[236:239], v[156:159], v[92:95], v[236:239]
    s_waitcnt vmcnt(8) lgkmcnt(0)
    s_barrier
    ds_read_b128 v[96:99], v20 offset:32768
    ds_read_b128 v[100:103], v20 offset:34816
    ds_read_b128 v[104:107], v21 offset:32768
    ds_read_b128 v[108:111], v21 offset:34816
    ds_read_b128 v[112:115], v22 offset:32768
    ds_read_b128 v[116:119], v22 offset:34816
    ds_read_b128 v[120:123], v23 offset:32768
    ds_read_b128 v[124:127], v23 offset:34816
    ds_read_b128 v[128:131], v20 offset:33024
    ds_read_b128 v[132:135], v20 offset:35072
    ds_read_b128 v[136:139], v21 offset:33024
    ds_read_b128 v[140:143], v21 offset:35072
    ds_read_b128 v[144:147], v22 offset:33024
    ds_read_b128 v[148:151], v22 offset:35072
    ds_read_b128 v[152:155], v23 offset:33024
    ds_read_b128 v[156:159], v23 offset:35072
    s_add_u32 m0, s29, 65536
    s_add_u32 s5, s68, 0
    s_nop 0
    buffer_load_dwordx4 v8, s[32:35], s5 offen lds
    s_add_u32 m0, s29, 66560
    s_add_u32 s5, s68, 16384
    buffer_load_dwordx4 v9, s[32:35], s5 offen lds
    s_add_u32 m0, s29, 67584
    s_add_u32 s5, s68, 32768
    buffer_load_dwordx4 v8, s[32:35], s5 offen lds
    s_add_u32 m0, s29, 68608
    s_add_u32 s5, s68, 49152
    buffer_load_dwordx4 v9, s[32:35], s5 offen lds
    s_add_u32 m0, s29, 81920
    s_add_u32 s5, s68, 262144
    buffer_load_dwordx4 v8, s[32:35], s5 offen lds
    s_add_u32 m0, s29, 82944
    s_add_u32 s5, s68, 278528
    buffer_load_dwordx4 v9, s[32:35], s5 offen lds
    s_add_u32 m0, s29, 83968
    s_add_u32 s5, s68, 294912
    buffer_load_dwordx4 v8, s[32:35], s5 offen lds
    s_add_u32 m0, s29, 84992
    s_add_u32 s5, s68, 311296
    buffer_load_dwordx4 v9, s[32:35], s5 offen lds
    v_mfma_f32_16x16x32_bf16 v[240:243], v[160:163], v[32:35], 0
    v_pk_mul_f32 v[224:225], v[224:225], v[26:27]
    v_mfma_f32_16x16x32_bf16 v[244:247], v[160:163], v[64:67], 0
    v_pk_mul_f32 v[232:233], v[232:233], v[26:27]
    v_mfma_f32_16x16x32_bf16 v[248:251], v[164:167], v[32:35], 0
    v_pk_mul_f32 v[226:227], v[226:227], v[26:27]
    v_mfma_f32_16x16x32_bf16 v[252:255], v[164:167], v[64:67], 0
    v_pk_mul_f32 v[234:235], v[234:235], v[26:27]
    v_mfma_f32_16x16x32_bf16 v[240:243], v[168:171], v[36:39], v[240:243]
    v_cvt_pk_bf16_f32 v224, v224, v225
    v_mfma_f32_16x16x32_bf16 v[244:247], v[168:171], v[68:71], v[244:247]
    v_cvt_pk_bf16_f32 v225, v226, v227
    v_mfma_f32_16x16x32_bf16 v[248:251], v[172:175], v[36:39], v[248:251]
    v_cvt_pk_bf16_f32 v226, v232, v233
    v_mfma_f32_16x16x32_bf16 v[252:255], v[172:175], v[68:71], v[252:255]
    v_cvt_pk_bf16_f32 v227, v234, v235
    v_mfma_f32_16x16x32_bf16 v[240:243], v[176:179], v[40:43], v[240:243]
    s_add_u32 s5, s26, s84
    s_nop 0
    v_mfma_f32_16x16x32_bf16 v[244:247], v[176:179], v[72:75], v[244:247]
    buffer_store_dwordx4 v[224:227], v5, s[8:11], s5 offen sc1
    v_mfma_f32_16x16x32_bf16 v[248:251], v[180:183], v[40:43], v[248:251]
    v_pk_mul_f32 v[228:229], v[228:229], v[26:27]
    v_mfma_f32_16x16x32_bf16 v[252:255], v[180:183], v[72:75], v[252:255]
    v_pk_mul_f32 v[236:237], v[236:237], v[26:27]
    v_mfma_f32_16x16x32_bf16 v[240:243], v[184:187], v[44:47], v[240:243]
    v_pk_mul_f32 v[230:231], v[230:231], v[26:27]
    v_mfma_f32_16x16x32_bf16 v[244:247], v[184:187], v[76:79], v[244:247]
    v_pk_mul_f32 v[238:239], v[238:239], v[26:27]
    v_mfma_f32_16x16x32_bf16 v[248:251], v[188:191], v[44:47], v[248:251]
    v_cvt_pk_bf16_f32 v228, v228, v229
    v_mfma_f32_16x16x32_bf16 v[252:255], v[188:191], v[76:79], v[252:255]
    v_cvt_pk_bf16_f32 v229, v230, v231
    v_mfma_f32_16x16x32_bf16 v[240:243], v[192:195], v[48:51], v[240:243]
    v_cvt_pk_bf16_f32 v230, v236, v237
    v_mfma_f32_16x16x32_bf16 v[244:247], v[192:195], v[80:83], v[244:247]
    v_cvt_pk_bf16_f32 v231, v238, v239
    v_mfma_f32_16x16x32_bf16 v[248:251], v[196:199], v[48:51], v[248:251]
    s_add_u32 s5, s5, 14336
    v_mfma_f32_16x16x32_bf16 v[252:255], v[196:199], v[80:83], v[252:255]
    buffer_store_dwordx4 v[228:231], v5, s[8:11], s5 offen sc1
    v_mfma_f32_16x16x32_bf16 v[240:243], v[200:203], v[52:55], v[240:243]
    v_mfma_f32_16x16x32_bf16 v[244:247], v[200:203], v[84:87], v[244:247]
    v_mfma_f32_16x16x32_bf16 v[248:251], v[204:207], v[52:55], v[248:251]
    v_mfma_f32_16x16x32_bf16 v[252:255], v[204:207], v[84:87], v[252:255]
    v_mfma_f32_16x16x32_bf16 v[240:243], v[208:211], v[56:59], v[240:243]
    v_mfma_f32_16x16x32_bf16 v[244:247], v[208:211], v[88:91], v[244:247]
    v_mfma_f32_16x16x32_bf16 v[248:251], v[212:215], v[56:59], v[248:251]
    v_mfma_f32_16x16x32_bf16 v[252:255], v[212:215], v[88:91], v[252:255]
    v_mfma_f32_16x16x32_bf16 v[240:243], v[216:219], v[60:63], v[240:243]
    v_mfma_f32_16x16x32_bf16 v[244:247], v[216:219], v[92:95], v[244:247]
    v_mfma_f32_16x16x32_bf16 v[248:251], v[220:223], v[60:63], v[248:251]
    v_mfma_f32_16x16x32_bf16 v[252:255], v[220:223], v[92:95], v[252:255]
    s_waitcnt vmcnt(10) lgkmcnt(0)
    s_barrier
    ds_read_b128 v[160:163], v12 offset:32768
    ds_read_b128 v[164:167], v12 offset:34816
    ds_read_b128 v[168:171], v13 offset:32768
    ds_read_b128 v[172:175], v13 offset:34816
    ds_read_b128 v[176:179], v14 offset:32768
    ds_read_b128 v[180:183], v14 offset:34816
    ds_read_b128 v[184:187], v15 offset:32768
    ds_read_b128 v[188:191], v15 offset:34816
    ds_read_b128 v[192:195], v12 offset:33024
    ds_read_b128 v[196:199], v12 offset:35072
    ds_read_b128 v[200:203], v13 offset:33024
    ds_read_b128 v[204:207], v13 offset:35072
    ds_read_b128 v[208:211], v14 offset:33024
    ds_read_b128 v[212:215], v14 offset:35072
    ds_read_b128 v[216:219], v15 offset:33024
    ds_read_b128 v[220:223], v15 offset:35072
    s_add_u32 m0, s29, 98304
    s_add_u32 s5, s69, 0
    s_nop 0
    buffer_load_dwordx4 v8, s[32:35], s5 offen lds
    s_add_u32 m0, s29, 99328
    s_add_u32 s5, s69, 16384
    buffer_load_dwordx4 v9, s[32:35], s5 offen lds
    s_add_u32 m0, s29, 100352
    s_add_u32 s5, s69, 32768
    buffer_load_dwordx4 v8, s[32:35], s5 offen lds
    s_add_u32 m0, s29, 101376
    s_add_u32 s5, s69, 49152
    buffer_load_dwordx4 v9, s[32:35], s5 offen lds
    s_add_u32 m0, s29, 114688
    s_add_u32 s5, s69, 262144
    buffer_load_dwordx4 v8, s[32:35], s5 offen lds
    s_add_u32 m0, s29, 115712
    s_add_u32 s5, s69, 278528
    buffer_load_dwordx4 v9, s[32:35], s5 offen lds
    s_add_u32 m0, s29, 116736
    s_add_u32 s5, s69, 294912
    buffer_load_dwordx4 v8, s[32:35], s5 offen lds
    s_add_u32 m0, s29, 117760
    s_add_u32 s5, s69, 311296
    buffer_load_dwordx4 v9, s[32:35], s5 offen lds
    v_mfma_f32_16x16x32_bf16 v[224:227], v[96:99], v[32:35], 0
    v_pk_mul_f32 v[240:241], v[240:241], v[26:27]
    v_mfma_f32_16x16x32_bf16 v[228:231], v[96:99], v[64:67], 0
    v_pk_mul_f32 v[248:249], v[248:249], v[26:27]
    v_mfma_f32_16x16x32_bf16 v[232:235], v[100:103], v[32:35], 0
    v_pk_mul_f32 v[242:243], v[242:243], v[26:27]
    v_mfma_f32_16x16x32_bf16 v[236:239], v[100:103], v[64:67], 0
    v_pk_mul_f32 v[250:251], v[250:251], v[26:27]
    v_mfma_f32_16x16x32_bf16 v[224:227], v[104:107], v[36:39], v[224:227]
    v_cvt_pk_bf16_f32 v240, v240, v241
    v_mfma_f32_16x16x32_bf16 v[228:231], v[104:107], v[68:71], v[228:231]
    v_cvt_pk_bf16_f32 v241, v242, v243
    v_mfma_f32_16x16x32_bf16 v[232:235], v[108:111], v[36:39], v[232:235]
    v_cvt_pk_bf16_f32 v242, v248, v249
    v_mfma_f32_16x16x32_bf16 v[236:239], v[108:111], v[68:71], v[236:239]
    v_cvt_pk_bf16_f32 v243, v250, v251
    v_mfma_f32_16x16x32_bf16 v[224:227], v[112:115], v[40:43], v[224:227]
    s_add_u32 s5, s26, s85
    s_nop 0
    v_mfma_f32_16x16x32_bf16 v[228:231], v[112:115], v[72:75], v[228:231]
    buffer_store_dwordx4 v[240:243], v5, s[8:11], s5 offen sc1
    v_mfma_f32_16x16x32_bf16 v[232:235], v[116:119], v[40:43], v[232:235]
    v_pk_mul_f32 v[244:245], v[244:245], v[26:27]
    v_mfma_f32_16x16x32_bf16 v[236:239], v[116:119], v[72:75], v[236:239]
    v_pk_mul_f32 v[252:253], v[252:253], v[26:27]
    v_mfma_f32_16x16x32_bf16 v[224:227], v[120:123], v[44:47], v[224:227]
    v_pk_mul_f32 v[246:247], v[246:247], v[26:27]
    v_mfma_f32_16x16x32_bf16 v[228:231], v[120:123], v[76:79], v[228:231]
    v_pk_mul_f32 v[254:255], v[254:255], v[26:27]
    v_mfma_f32_16x16x32_bf16 v[232:235], v[124:127], v[44:47], v[232:235]
    v_cvt_pk_bf16_f32 v244, v244, v245
    v_mfma_f32_16x16x32_bf16 v[236:239], v[124:127], v[76:79], v[236:239]
    v_cvt_pk_bf16_f32 v245, v246, v247
    v_mfma_f32_16x16x32_bf16 v[224:227], v[128:131], v[48:51], v[224:227]
    v_cvt_pk_bf16_f32 v246, v252, v253
    v_mfma_f32_16x16x32_bf16 v[228:231], v[128:131], v[80:83], v[228:231]
    v_cvt_pk_bf16_f32 v247, v254, v255
    v_mfma_f32_16x16x32_bf16 v[232:235], v[132:135], v[48:51], v[232:235]
    s_add_u32 s5, s5, 14336
    v_mfma_f32_16x16x32_bf16 v[236:239], v[132:135], v[80:83], v[236:239]
    buffer_store_dwordx4 v[244:247], v5, s[8:11], s5 offen sc1
    v_mfma_f32_16x16x32_bf16 v[224:227], v[136:139], v[52:55], v[224:227]
    v_mfma_f32_16x16x32_bf16 v[228:231], v[136:139], v[84:87], v[228:231]
    v_mfma_f32_16x16x32_bf16 v[232:235], v[140:143], v[52:55], v[232:235]
    v_mfma_f32_16x16x32_bf16 v[236:239], v[140:143], v[84:87], v[236:239]
    v_mfma_f32_16x16x32_bf16 v[224:227], v[144:147], v[56:59], v[224:227]
    v_mfma_f32_16x16x32_bf16 v[228:231], v[144:147], v[88:91], v[228:231]
    v_mfma_f32_16x16x32_bf16 v[232:235], v[148:151], v[56:59], v[232:235]
    v_mfma_f32_16x16x32_bf16 v[236:239], v[148:151], v[88:91], v[236:239]
    v_mfma_f32_16x16x32_bf16 v[224:227], v[152:155], v[60:63], v[224:227]
    v_mfma_f32_16x16x32_bf16 v[228:231], v[152:155], v[92:95], v[228:231]
    v_mfma_f32_16x16x32_bf16 v[232:235], v[156:159], v[60:63], v[232:235]
    v_mfma_f32_16x16x32_bf16 v[236:239], v[156:159], v[92:95], v[236:239]
    s_waitcnt vmcnt(12) lgkmcnt(0)
    s_barrier
    ds_read_b128 v[96:99], v20 offset:0
    ds_read_b128 v[100:103], v20 offset:2048
    ds_read_b128 v[104:107], v21 offset:0
    ds_read_b128 v[108:111], v21 offset:2048
    ds_read_b128 v[112:115], v22 offset:0
    ds_read_b128 v[116:119], v22 offset:2048
    ds_read_b128 v[120:123], v23 offset:0
    ds_read_b128 v[124:127], v23 offset:2048
    ds_read_b128 v[128:131], v20 offset:256
    ds_read_b128 v[132:135], v20 offset:2304
    ds_read_b128 v[136:139], v21 offset:256
    ds_read_b128 v[140:143], v21 offset:2304
    ds_read_b128 v[144:147], v22 offset:256
    ds_read_b128 v[148:151], v22 offset:2304
    ds_read_b128 v[152:155], v23 offset:256
    ds_read_b128 v[156:159], v23 offset:2304
    s_add_u32 m0, s29, 32768
    s_add_u32 s5, s70, 0
    s_nop 0
    buffer_load_dwordx4 v8, s[32:35], s5 offen lds
    s_add_u32 m0, s29, 33792
    s_add_u32 s5, s70, 16384
    buffer_load_dwordx4 v9, s[32:35], s5 offen lds
    s_add_u32 m0, s29, 34816
    s_add_u32 s5, s70, 32768
    buffer_load_dwordx4 v8, s[32:35], s5 offen lds
    s_add_u32 m0, s29, 35840
    s_add_u32 s5, s70, 49152
    buffer_load_dwordx4 v9, s[32:35], s5 offen lds
    s_add_u32 m0, s29, 49152
    s_add_u32 s5, s70, 262144
    buffer_load_dwordx4 v8, s[32:35], s5 offen lds
    s_add_u32 m0, s29, 50176
    s_add_u32 s5, s70, 278528
    buffer_load_dwordx4 v9, s[32:35], s5 offen lds
    s_add_u32 m0, s29, 51200
    s_add_u32 s5, s70, 294912
    buffer_load_dwordx4 v8, s[32:35], s5 offen lds
    s_add_u32 m0, s29, 52224
    s_add_u32 s5, s70, 311296
    buffer_load_dwordx4 v9, s[32:35], s5 offen lds
    v_mfma_f32_16x16x32_bf16 v[240:243], v[160:163], v[32:35], 0
    v_pk_mul_f32 v[224:225], v[224:225], v[26:27]
    v_mfma_f32_16x16x32_bf16 v[244:247], v[160:163], v[64:67], 0
    v_pk_mul_f32 v[232:233], v[232:233], v[26:27]
    v_mfma_f32_16x16x32_bf16 v[248:251], v[164:167], v[32:35], 0
    v_pk_mul_f32 v[226:227], v[226:227], v[26:27]
    v_mfma_f32_16x16x32_bf16 v[252:255], v[164:167], v[64:67], 0
    v_pk_mul_f32 v[234:235], v[234:235], v[26:27]
    v_mfma_f32_16x16x32_bf16 v[240:243], v[168:171], v[36:39], v[240:243]
    v_cvt_pk_bf16_f32 v224, v224, v225
    v_mfma_f32_16x16x32_bf16 v[244:247], v[168:171], v[68:71], v[244:247]
    v_cvt_pk_bf16_f32 v225, v226, v227
    v_mfma_f32_16x16x32_bf16 v[248:251], v[172:175], v[36:39], v[248:251]
    v_cvt_pk_bf16_f32 v226, v232, v233
    v_mfma_f32_16x16x32_bf16 v[252:255], v[172:175], v[68:71], v[252:255]
    v_cvt_pk_bf16_f32 v227, v234, v235
    v_mfma_f32_16x16x32_bf16 v[240:243], v[176:179], v[40:43], v[240:243]
    s_add_u32 s5, s26, s86
    s_nop 0
    v_mfma_f32_16x16x32_bf16 v[244:247], v[176:179], v[72:75], v[244:247]
    buffer_store_dwordx4 v[224:227], v5, s[8:11], s5 offen sc1
    v_mfma_f32_16x16x32_bf16 v[248:251], v[180:183], v[40:43], v[248:251]
    v_pk_mul_f32 v[228:229], v[228:229], v[26:27]
    v_mfma_f32_16x16x32_bf16 v[252:255], v[180:183], v[72:75], v[252:255]
    v_pk_mul_f32 v[236:237], v[236:237], v[26:27]
    v_mfma_f32_16x16x32_bf16 v[240:243], v[184:187], v[44:47], v[240:243]
    v_pk_mul_f32 v[230:231], v[230:231], v[26:27]
    v_mfma_f32_16x16x32_bf16 v[244:247], v[184:187], v[76:79], v[244:247]
    v_pk_mul_f32 v[238:239], v[238:239], v[26:27]
    v_mfma_f32_16x16x32_bf16 v[248:251], v[188:191], v[44:47], v[248:251]
    v_cvt_pk_bf16_f32 v228, v228, v229
    v_mfma_f32_16x16x32_bf16 v[252:255], v[188:191], v[76:79], v[252:255]
    v_cvt_pk_bf16_f32 v229, v230, v231
    v_mfma_f32_16x16x32_bf16 v[240:243], v[192:195], v[48:51], v[240:243]
    v_cvt_pk_bf16_f32 v230, v236, v237
    v_mfma_f32_16x16x32_bf16 v[244:247], v[192:195], v[80:83], v[244:247]
    v_cvt_pk_bf16_f32 v231, v238, v239
    v_mfma_f32_16x16x32_bf16 v[248:251], v[196:199], v[48:51], v[248:251]
    s_add_u32 s5, s5, 14336
    v_mfma_f32_16x16x32_bf16 v[252:255], v[196:199], v[80:83], v[252:255]
    buffer_store_dwordx4 v[228:231], v5, s[8:11], s5 offen sc1
    v_mfma_f32_16x16x32_bf16 v[240:243], v[200:203], v[52:55], v[240:243]
    v_mfma_f32_16x16x32_bf16 v[244:247], v[200:203], v[84:87], v[244:247]
    v_mfma_f32_16x16x32_bf16 v[248:251], v[204:207], v[52:55], v[248:251]
    v_mfma_f32_16x16x32_bf16 v[252:255], v[204:207], v[84:87], v[252:255]
    v_mfma_f32_16x16x32_bf16 v[240:243], v[208:211], v[56:59], v[240:243]
    v_mfma_f32_16x16x32_bf16 v[244:247], v[208:211], v[88:91], v[244:247]
    v_mfma_f32_16x16x32_bf16 v[248:251], v[212:215], v[56:59], v[248:251]
    v_mfma_f32_16x16x32_bf16 v[252:255], v[212:215], v[88:91], v[252:255]
    v_mfma_f32_16x16x32_bf16 v[240:243], v[216:219], v[60:63], v[240:243]
    v_mfma_f32_16x16x32_bf16 v[244:247], v[216:219], v[92:95], v[244:247]
    v_mfma_f32_16x16x32_bf16 v[248:251], v[220:223], v[60:63], v[248:251]
    v_mfma_f32_16x16x32_bf16 v[252:255], v[220:223], v[92:95], v[252:255]
    s_waitcnt vmcnt(12) lgkmcnt(0)
    s_barrier
    ds_read_b128 v[160:163], v20 offset:32768
    ds_read_b128 v[164:167], v20 offset:34816
    ds_read_b128 v[168:171], v21 offset:32768
    ds_read_b128 v[172:175], v21 offset:34816
    ds_read_b128 v[176:179], v22 offset:32768
    ds_read_b128 v[180:183], v22 offset:34816
    ds_read_b128 v[184:187], v23 offset:32768
    ds_read_b128 v[188:191], v23 offset:34816
    ds_read_b128 v[192:195], v20 offset:33024
    ds_read_b128 v[196:199], v20 offset:35072
    ds_read_b128 v[200:203], v21 offset:33024
    ds_read_b128 v[204:207], v21 offset:35072
    ds_read_b128 v[208:211], v22 offset:33024
    ds_read_b128 v[212:215], v22 offset:35072
    ds_read_b128 v[216:219], v23 offset:33024
    ds_read_b128 v[220:223], v23 offset:35072
    v_mfma_f32_16x16x32_bf16 v[224:227], v[96:99], v[32:35], 0
    v_pk_mul_f32 v[240:241], v[240:241], v[26:27]
    v_mfma_f32_16x16x32_bf16 v[228:231], v[96:99], v[64:67], 0
    v_pk_mul_f32 v[248:249], v[248:249], v[26:27]
    v_mfma_f32_16x16x32_bf16 v[232:235], v[100:103], v[32:35], 0
    v_pk_mul_f32 v[242:243], v[242:243], v[26:27]
    v_mfma_f32_16x16x32_bf16 v[236:239], v[100:103], v[64:67], 0
    v_pk_mul_f32 v[250:251], v[250:251], v[26:27]
    v_mfma_f32_16x16x32_bf16 v[224:227], v[104:107], v[36:39], v[224:227]
    v_cvt_pk_bf16_f32 v240, v240, v241
    v_mfma_f32_16x16x32_bf16 v[228:231], v[104:107], v[68:71], v[228:231]
    v_cvt_pk_bf16_f32 v241, v242, v243
    v_mfma_f32_16x16x32_bf16 v[232:235], v[108:111], v[36:39], v[232:235]
    v_cvt_pk_bf16_f32 v242, v248, v249
    v_mfma_f32_16x16x32_bf16 v[236:239], v[108:111], v[68:71], v[236:239]
    v_cvt_pk_bf16_f32 v243, v250, v251
    v_mfma_f32_16x16x32_bf16 v[224:227], v[112:115], v[40:43], v[224:227]
    s_add_u32 s5, s26, s87
    s_nop 0
    v_mfma_f32_16x16x32_bf16 v[228:231], v[112:115], v[72:75], v[228:231]
    buffer_store_dwordx4 v[240:243], v5, s[8:11], s5 offen sc1
    v_mfma_f32_16x16x32_bf16 v[232:235], v[116:119], v[40:43], v[232:235]
    v_pk_mul_f32 v[244:245], v[244:245], v[26:27]
    v_mfma_f32_16x16x32_bf16 v[236:239], v[116:119], v[72:75], v[236:239]
    v_pk_mul_f32 v[252:253], v[252:253], v[26:27]
    v_mfma_f32_16x16x32_bf16 v[224:227], v[120:123], v[44:47], v[224:227]
    v_pk_mul_f32 v[246:247], v[246:247], v[26:27]
    v_mfma_f32_16x16x32_bf16 v[228:231], v[120:123], v[76:79], v[228:231]
    v_pk_mul_f32 v[254:255], v[254:255], v[26:27]
    v_mfma_f32_16x16x32_bf16 v[232:235], v[124:127], v[44:47], v[232:235]
    v_cvt_pk_bf16_f32 v244, v244, v245
    v_mfma_f32_16x16x32_bf16 v[236:239], v[124:127], v[76:79], v[236:239]
    v_cvt_pk_bf16_f32 v245, v246, v247
    v_mfma_f32_16x16x32_bf16 v[224:227], v[128:131], v[48:51], v[224:227]
    v_cvt_pk_bf16_f32 v246, v252, v253
    v_mfma_f32_16x16x32_bf16 v[228:231], v[128:131], v[80:83], v[228:231]
    v_cvt_pk_bf16_f32 v247, v254, v255
    v_mfma_f32_16x16x32_bf16 v[232:235], v[132:135], v[48:51], v[232:235]
    s_add_u32 s5, s5, 14336
    v_mfma_f32_16x16x32_bf16 v[236:239], v[132:135], v[80:83], v[236:239]
    buffer_store_dwordx4 v[244:247], v5, s[8:11], s5 offen sc1
    v_mfma_f32_16x16x32_bf16 v[224:227], v[136:139], v[52:55], v[224:227]
    v_mfma_f32_16x16x32_bf16 v[228:231], v[136:139], v[84:87], v[228:231]
    v_mfma_f32_16x16x32_bf16 v[232:235], v[140:143], v[52:55], v[232:235]
    v_mfma_f32_16x16x32_bf16 v[236:239], v[140:143], v[84:87], v[236:239]
    v_mfma_f32_16x16x32_bf16 v[224:227], v[144:147], v[56:59], v[224:227]
    v_mfma_f32_16x16x32_bf16 v[228:231], v[144:147], v[88:91], v[228:231]
    v_mfma_f32_16x16x32_bf16 v[232:235], v[148:151], v[56:59], v[232:235]
    v_mfma_f32_16x16x32_bf16 v[236:239], v[148:151], v[88:91], v[236:239]
    v_mfma_f32_16x16x32_bf16 v[224:227], v[152:155], v[60:63], v[224:227]
    v_mfma_f32_16x16x32_bf16 v[228:231], v[152:155], v[92:95], v[228:231]
    v_mfma_f32_16x16x32_bf16 v[232:235], v[156:159], v[60:63], v[232:235]
    v_mfma_f32_16x16x32_bf16 v[236:239], v[156:159], v[92:95], v[236:239]
    s_waitcnt vmcnt(4) lgkmcnt(0)
    s_barrier
    ds_read_b128 v[96:99], v12 offset:32768
    ds_read_b128 v[100:103], v12 offset:34816
    ds_read_b128 v[104:107], v13 offset:32768
    ds_read_b128 v[108:111], v13 offset:34816
    ds_read_b128 v[112:115], v14 offset:32768
    ds_read_b128 v[116:119], v14 offset:34816
    ds_read_b128 v[120:123], v15 offset:32768
    ds_read_b128 v[124:127], v15 offset:34816
    ds_read_b128 v[128:131], v12 offset:33024
    ds_read_b128 v[132:135], v12 offset:35072
    ds_read_b128 v[136:139], v13 offset:33024
    ds_read_b128 v[140:143], v13 offset:35072
    ds_read_b128 v[144:147], v14 offset:33024
    ds_read_b128 v[148:151], v14 offset:35072
    ds_read_b128 v[152:155], v15 offset:33024
    ds_read_b128 v[156:159], v15 offset:35072
    v_mfma_f32_16x16x32_bf16 v[240:243], v[160:163], v[32:35], 0
    v_pk_mul_f32 v[224:225], v[224:225], v[26:27]
    v_mfma_f32_16x16x32_bf16 v[244:247], v[160:163], v[64:67], 0
    v_pk_mul_f32 v[232:233], v[232:233], v[26:27]
    v_mfma_f32_16x16x32_bf16 v[248:251], v[164:167], v[32:35], 0
    v_pk_mul_f32 v[226:227], v[226:227], v[26:27]
    v_mfma_f32_16x16x32_bf16 v[252:255], v[164:167], v[64:67], 0
    v_pk_mul_f32 v[234:235], v[234:235], v[26:27]
    v_mfma_f32_16x16x32_bf16 v[240:243], v[168:171], v[36:39], v[240:243]
    v_cvt_pk_bf16_f32 v224, v224, v225
    v_mfma_f32_16x16x32_bf16 v[244:247], v[168:171], v[68:71], v[244:247]
    v_cvt_pk_bf16_f32 v225, v226, v227
    v_mfma_f32_16x16x32_bf16 v[248:251], v[172:175], v[36:39], v[248:251]
    v_cvt_pk_bf16_f32 v226, v232, v233
    v_mfma_f32_16x16x32_bf16 v[252:255], v[172:175], v[68:71], v[252:255]
    v_cvt_pk_bf16_f32 v227, v234, v235
    v_mfma_f32_16x16x32_bf16 v[240:243], v[176:179], v[40:43], v[240:243]
    s_add_u32 s5, s26, s88
    s_nop 0
    v_mfma_f32_16x16x32_bf16 v[244:247], v[176:179], v[72:75], v[244:247]
    buffer_store_dwordx4 v[224:227], v5, s[8:11], s5 offen sc1
    v_mfma_f32_16x16x32_bf16 v[248:251], v[180:183], v[40:43], v[248:251]
    v_pk_mul_f32 v[228:229], v[228:229], v[26:27]
    v_mfma_f32_16x16x32_bf16 v[252:255], v[180:183], v[72:75], v[252:255]
    v_pk_mul_f32 v[236:237], v[236:237], v[26:27]
    v_mfma_f32_16x16x32_bf16 v[240:243], v[184:187], v[44:47], v[240:243]
    v_pk_mul_f32 v[230:231], v[230:231], v[26:27]
    v_mfma_f32_16x16x32_bf16 v[244:247], v[184:187], v[76:79], v[244:247]
    v_pk_mul_f32 v[238:239], v[238:239], v[26:27]
    v_mfma_f32_16x16x32_bf16 v[248:251], v[188:191], v[44:47], v[248:251]
    v_cvt_pk_bf16_f32 v228, v228, v229
    v_mfma_f32_16x16x32_bf16 v[252:255], v[188:191], v[76:79], v[252:255]
    v_cvt_pk_bf16_f32 v229, v230, v231
    v_mfma_f32_16x16x32_bf16 v[240:243], v[192:195], v[48:51], v[240:243]
    v_cvt_pk_bf16_f32 v230, v236, v237
    v_mfma_f32_16x16x32_bf16 v[244:247], v[192:195], v[80:83], v[244:247]
    v_cvt_pk_bf16_f32 v231, v238, v239
    v_mfma_f32_16x16x32_bf16 v[248:251], v[196:199], v[48:51], v[248:251]
    s_add_u32 s5, s5, 14336
    v_mfma_f32_16x16x32_bf16 v[252:255], v[196:199], v[80:83], v[252:255]
    buffer_store_dwordx4 v[228:231], v5, s[8:11], s5 offen sc1
    v_mfma_f32_16x16x32_bf16 v[240:243], v[200:203], v[52:55], v[240:243]
    v_mfma_f32_16x16x32_bf16 v[244:247], v[200:203], v[84:87], v[244:247]
    v_mfma_f32_16x16x32_bf16 v[248:251], v[204:207], v[52:55], v[248:251]
    v_mfma_f32_16x16x32_bf16 v[252:255], v[204:207], v[84:87], v[252:255]
    v_mfma_f32_16x16x32_bf16 v[240:243], v[208:211], v[56:59], v[240:243]
    v_mfma_f32_16x16x32_bf16 v[244:247], v[208:211], v[88:91], v[244:247]
    v_mfma_f32_16x16x32_bf16 v[248:251], v[212:215], v[56:59], v[248:251]
    v_mfma_f32_16x16x32_bf16 v[252:255], v[212:215], v[88:91], v[252:255]
    v_mfma_f32_16x16x32_bf16 v[240:243], v[216:219], v[60:63], v[240:243]
    v_mfma_f32_16x16x32_bf16 v[244:247], v[216:219], v[92:95], v[244:247]
    v_mfma_f32_16x16x32_bf16 v[248:251], v[220:223], v[60:63], v[248:251]
    v_mfma_f32_16x16x32_bf16 v[252:255], v[220:223], v[92:95], v[252:255]
    s_nop 0
    s_waitcnt lgkmcnt(0)
    v_mov_b32 v29, 196
    buffer_load_dword v28, v29, s[12:15], 0 offen sc1
    v_mfma_f32_16x16x32_bf16 v[224:227], v[96:99], v[32:35], 0
    v_pk_mul_f32 v[240:241], v[240:241], v[26:27]
    v_mfma_f32_16x16x32_bf16 v[228:231], v[96:99], v[64:67], 0
    v_pk_mul_f32 v[248:249], v[248:249], v[26:27]
    v_mfma_f32_16x16x32_bf16 v[232:235], v[100:103], v[32:35], 0
    v_pk_mul_f32 v[242:243], v[242:243], v[26:27]
    v_mfma_f32_16x16x32_bf16 v[236:239], v[100:103], v[64:67], 0
    v_pk_mul_f32 v[250:251], v[250:251], v[26:27]
    v_mfma_f32_16x16x32_bf16 v[224:227], v[104:107], v[36:39], v[224:227]
    v_cvt_pk_bf16_f32 v240, v240, v241
    v_mfma_f32_16x16x32_bf16 v[228:231], v[104:107], v[68:71], v[228:231]
    v_cvt_pk_bf16_f32 v241, v242, v243
    v_mfma_f32_16x16x32_bf16 v[232:235], v[108:111], v[36:39], v[232:235]
    v_cvt_pk_bf16_f32 v242, v248, v249
    v_mfma_f32_16x16x32_bf16 v[236:239], v[108:111], v[68:71], v[236:239]
    v_cvt_pk_bf16_f32 v243, v250, v251
    v_mfma_f32_16x16x32_bf16 v[224:227], v[112:115], v[40:43], v[224:227]
    s_add_u32 s5, s26, s89
    s_nop 0
    v_mfma_f32_16x16x32_bf16 v[228:231], v[112:115], v[72:75], v[228:231]
    buffer_store_dwordx4 v[240:243], v5, s[8:11], s5 offen sc1
    v_mfma_f32_16x16x32_bf16 v[232:235], v[116:119], v[40:43], v[232:235]
    v_pk_mul_f32 v[244:245], v[244:245], v[26:27]
    v_mfma_f32_16x16x32_bf16 v[236:239], v[116:119], v[72:75], v[236:239]
    v_pk_mul_f32 v[252:253], v[252:253], v[26:27]
    v_mfma_f32_16x16x32_bf16 v[224:227], v[120:123], v[44:47], v[224:227]
    v_pk_mul_f32 v[246:247], v[246:247], v[26:27]
    v_mfma_f32_16x16x32_bf16 v[228:231], v[120:123], v[76:79], v[228:231]
    v_pk_mul_f32 v[254:255], v[254:255], v[26:27]
    v_mfma_f32_16x16x32_bf16 v[232:235], v[124:127], v[44:47], v[232:235]
    v_cvt_pk_bf16_f32 v244, v244, v245
    v_mfma_f32_16x16x32_bf16 v[236:239], v[124:127], v[76:79], v[236:239]
    v_cvt_pk_bf16_f32 v245, v246, v247
    v_mfma_f32_16x16x32_bf16 v[224:227], v[128:131], v[48:51], v[224:227]
    v_cvt_pk_bf16_f32 v246, v252, v253
    v_mfma_f32_16x16x32_bf16 v[228:231], v[128:131], v[80:83], v[228:231]
    v_cvt_pk_bf16_f32 v247, v254, v255
    v_mfma_f32_16x16x32_bf16 v[232:235], v[132:135], v[48:51], v[232:235]
    s_add_u32 s5, s5, 14336
    v_mfma_f32_16x16x32_bf16 v[236:239], v[132:135], v[80:83], v[236:239]
    buffer_store_dwordx4 v[244:247], v5, s[8:11], s5 offen sc1
    v_mfma_f32_16x16x32_bf16 v[224:227], v[136:139], v[52:55], v[224:227]
    v_mfma_f32_16x16x32_bf16 v[228:231], v[136:139], v[84:87], v[228:231]
    v_mfma_f32_16x16x32_bf16 v[232:235], v[140:143], v[52:55], v[232:235]
    v_mfma_f32_16x16x32_bf16 v[236:239], v[140:143], v[84:87], v[236:239]
    v_mfma_f32_16x16x32_bf16 v[224:227], v[144:147], v[56:59], v[224:227]
    v_mfma_f32_16x16x32_bf16 v[228:231], v[144:147], v[88:91], v[228:231]
    v_mfma_f32_16x16x32_bf16 v[232:235], v[148:151], v[56:59], v[232:235]
    v_mfma_f32_16x16x32_bf16 v[236:239], v[148:151], v[88:91], v[236:239]
    v_mfma_f32_16x16x32_bf16 v[224:227], v[152:155], v[60:63], v[224:227]
    v_mfma_f32_16x16x32_bf16 v[228:231], v[152:155], v[92:95], v[228:231]
    v_mfma_f32_16x16x32_bf16 v[232:235], v[156:159], v[60:63], v[232:235]
    v_mfma_f32_16x16x32_bf16 v[236:239], v[156:159], v[92:95], v[236:239]
    s_nop 6
    s_nop 0
    v_pk_mul_f32 v[224:225], v[224:225], v[26:27]
    v_pk_mul_f32 v[232:233], v[232:233], v[26:27]
    v_pk_mul_f32 v[226:227], v[226:227], v[26:27]
    v_pk_mul_f32 v[234:235], v[234:235], v[26:27]
    v_cvt_pk_bf16_f32 v224, v224, v225
    v_cvt_pk_bf16_f32 v225, v226, v227
    v_cvt_pk_bf16_f32 v226, v232, v233
    v_cvt_pk_bf16_f32 v227, v234, v235
    s_add_u32 s5, s26, s90
    s_nop 0
    buffer_store_dwordx4 v[224:227], v5, s[8:11], s5 offen sc1
    v_pk_mul_f32 v[228:229], v[228:229], v[26:27]
    v_pk_mul_f32 v[236:237], v[236:237], v[26:27]
    v_pk_mul_f32 v[230:231], v[230:231], v[26:27]
    v_pk_mul_f32 v[238:239], v[238:239], v[26:27]
    v_cvt_pk_bf16_f32 v228, v228, v229
    v_cvt_pk_bf16_f32 v229, v230, v231
    v_cvt_pk_bf16_f32 v230, v236, v237
    v_cvt_pk_bf16_f32 v231, v238, v239
    s_add_u32 s5, s5, 14336
    buffer_store_dwordx4 v[228:231], v5, s[8:11], s5 offen sc1
PP_SIG:
    s_lshl_b32 s4, s28, 4
    s_add_u32 s4, s4, s20
    s_add_u32 s4, s4, 32
    s_lshl_b32 s31, s4, 7
    s_branch PP_DONE
    s_nop 0
PP_LN:
    s_sub_u32 s3, s2, 224
    s_mov_b32 s32, s40
    s_nop 0
    s_and_b32 s33, s41, 0xffff
    s_mov_b32 s34, 1835008
    s_mov_b32 s35, 0x00020000
    v_and_b32 v6, 7, v1
    v_lshrrev_b32 v7, 3, v1
    v_mul_u32_u24 v8, 896, v6
    v_lshl_add_u32 v8, v7, 4, v8
    s_lshl_b32 s4, s3, 2
    s_add_u32 s4, s4, s16
    s_mul_i32 s20, s4, 7168
    v_lshlrev_b32 v11, 4, v0
    s_cmp_lg_u32 s3, 0
    s_cbranch_scc1 PP_LN0
    v_mov_b32 v12, 0
    v_mov_b32 v13, 0
    v_mov_b32 v14, 0
    v_mov_b32_e64 v15, 0
    s_mov_b32 s5, 85131264
    buffer_store_dwordx4 v[12:15], v11, s[8:11], s5 offen sc1
    s_mov_b32 s5, 85135360
    buffer_store_dwordx4 v[12:15], v11, s[8:11], s5 offen sc1
PP_LN0:
    s_add_u32 s5, s20, 0
    s_nop 0
    buffer_load_dwordx4 v[64:67], v8, s[32:35], s5 offen offset:0
    buffer_load_dwordx4 v[68:71], v8, s[32:35], s5 offen offset:128
    buffer_load_dwordx4 v[72:75], v8, s[32:35], s5 offen offset:256
    buffer_load_dwordx4 v[76:79], v8, s[32:35], s5 offen offset:384
    buffer_load_dwordx4 v[80:83], v8, s[32:35], s5 offen offset:512
    buffer_load_dwordx4 v[84:87], v8, s[32:35], s5 offen offset:640
    buffer_load_dwordx4 v[88:91], v8, s[32:35], s5 offen offset:768
    s_add_u32 s5, s20, 917504
    buffer_load_dwordx4 v[92:95], v8, s[32:35], s5 offen offset:0
    buffer_load_dwordx4 v[96:99], v8, s[32:35], s5 offen offset:128
    buffer_load_dwordx4 v[100:103], v8, s[32:35], s5 offen offset:256
    buffer_load_dwordx4 v[104:107], v8, s[32:35], s5 offen offset:384
    buffer_load_dwordx4 v[108:111], v8, s[32:35], s5 offen offset:512
    buffer_load_dwordx4 v[112:115], v8, s[32:35], s5 offen offset:640
    buffer_load_dwordx4 v[116:119], v8, s[32:35], s5 offen offset:768
    v_lshrrev_b32 v9, 2, v7
    v_lshlrev_b32 v9, 10, v9
    v_and_b32_e64 v10, 3, v7
    v_lshl_add_u32 v9, v10, 8, v9
    v_lshl_add_u32 v9, v6, 4, v9
    s_lshr_b32 s22, s4, 1
    s_nop 0
    s_mul_i32 s22, s22, 14336
    s_and_b32 s4, s4, 1
    s_lshl_b32 s4, s4, 7
    s_add_u32 s22, s22, s4
    s_cmp_lg_u32 s3, 0
    s_cbranch_scc1 PP_LNA
    s_waitcnt vmcnt(14)
    s_barrier
    v_mov_b32 v12, 1
    v_mov_b32 v13, 196
    buffer_store_dword v12, v13, s[12:15], 0 offen sc1
PP_LNA:
    s_cmp_lg_u32 s3, 1
    s_cbranch_scc1 PP_LN1
    s_mov_b32 s36, s42
    s_nop 0
    s_and_b32 s37, s43, 0xffff
    s_mov_b32 s38, 7168
    s_mov_b32 s39, 0x00020000
    v_lshrrev_b32 v12, 6, v0
    v_lshlrev_b32 v12, 4, v12
    v_and_b32_e64 v13, 3, v0
    v_lshl_add_u32 v12, v13, 2, v12
    v_bfe_u32 v13, v0, 5, 1
    v_lshl_add_u32 v12, v13, 1, v12
    v_bfe_u32 v13, v0, 2, 3
    v_mul_u32_u24 v13, 448, v13
    v_add_lshl_u32 v12, v12, v13, 1
    v_lshlrev_b32_e64 v14, 2, v0
    buffer_load_dword v48, v12, s[36:39], 0 offen offset:0
    buffer_load_dword v49, v12, s[36:39], 0 offen offset:128
    buffer_load_dword v50, v12, s[36:39], 0 offen offset:256
    buffer_load_dword v51, v12, s[36:39], 0 offen offset:384
    buffer_load_dword v52, v12, s[36:39], 0 offen offset:512
    buffer_load_dword v53, v12, s[36:39], 0 offen offset:640
    buffer_load_dword v54, v12, s[36:39], 0 offen offset:768
    s_nop 0
    s_waitcnt vmcnt(0)
    s_mov_b32 s5, 83886080
    v_min_u32_e64 v48, 0xfffffffe, v48
    buffer_store_dword v48, v14, s[8:11], s5 offen offset:0 sc1
    v_min_u32_e64 v49, 0xfffffffe, v49
    buffer_store_dword v49, v14, s[8:11], s5 offen offset:1024 sc1
    v_min_u32_e64 v50, 0xfffffffe, v50
    buffer_store_dword v50, v14, s[8:11], s5 offen offset:2048 sc1
    v_min_u32_e64 v51, 0xfffffffe, v51
    buffer_store_dword v51, v14, s[8:11], s5 offen offset:3072 sc1
    s_mov_b32 s5, 83890176
    v_min_u32_e64 v52, 0xfffffffe, v52
    buffer_store_dword v52, v14, s[8:11], s5 offen offset:0 sc1
    v_min_u32_e64 v53, 0xfffffffe, v53
    buffer_store_dword v53, v14, s[8:11], s5 offen offset:1024 sc1
    v_min_u32_e64 v54, 0xfffffffe, v54
    buffer_store_dword v54, v14, s[8:11], s5 offen offset:2048 sc1
PP_LN1:
    v_mov_b32 v56, -1
    v_mov_b32 v57, -1
    v_mov_b32_e64 v58, -1
    v_mov_b32 v59, -1
    s_add_u32 s21, s3, 2
    s_min_u32 s21, s21, 303
    s_lshl_b32 s21, s21, 12
    s_nop 0
    s_add_u32 s21, s21, 83886080
    buffer_store_dwordx4 v[56:59], v11, s[8:11], s21 offen sc1
    s_add_u32 s21, s3, 34
    s_nop 0
    s_min_u32 s21, s21, 303
    s_lshl_b32 s21, s21, 12
    s_nop 0
    s_add_u32 s21, s21, 83886080
    buffer_store_dwordx4 v[56:59], v11, s[8:11], s21 offen sc1
    s_add_u32 s21, s3, 66
    s_min_u32 s21, s21, 303
    s_lshl_b32 s21, s21, 12
    s_nop 0
    s_add_u32 s21, s21, 83886080
    buffer_store_dwordx4 v[56:59], v11, s[8:11], s21 offen sc1
    s_add_u32 s21, s3, 98
    s_min_u32 s21, s21, 303
    s_lshl_b32 s21, s21, 12
    s_nop 0
    s_add_u32 s21, s21, 83886080
    buffer_store_dwordx4 v[56:59], v11, s[8:11], s21 offen sc1
    s_add_u32 s21, s3, 130
    s_min_u32 s21, s21, 303
    s_lshl_b32 s21, s21, 12
    s_nop 0
    s_add_u32 s21, s21, 83886080
    buffer_store_dwordx4 v[56:59], v11, s[8:11], s21 offen sc1
    s_add_u32 s21, s3, 162
    s_min_u32 s21, s21, 303
    s_lshl_b32 s21, s21, 12
    s_nop 0
    s_add_u32 s21, s21, 83886080
    buffer_store_dwordx4 v[56:59], v11, s[8:11], s21 offen sc1
    s_add_u32 s21, s3, 194
    s_min_u32 s21, s21, 303
    s_lshl_b32 s21, s21, 12
    s_nop 0
    s_add_u32 s21, s21, 83886080
    buffer_store_dwordx4 v[56:59], v11, s[8:11], s21 offen sc1
    s_add_u32 s21, s3, 226
    s_min_u32 s21, s21, 303
    s_lshl_b32 s21, s21, 12
    s_nop 0
    s_add_u32 s21, s21, 83886080
    buffer_store_dwordx4 v[56:59], v11, s[8:11], s21 offen sc1
    s_add_u32 s21, s3, 258
    s_min_u32 s21, s21, 303
    s_lshl_b32 s21, s21, 12
    s_nop 0
    s_add_u32 s21, s21, 83886080
    buffer_store_dwordx4 v[56:59], v11, s[8:11], s21 offen sc1
    s_add_u32 s21, s3, 290
    s_min_u32 s21, s21, 303
    s_lshl_b32 s21, s21, 12
    s_nop 0
    s_add_u32 s21, s21, 83886080
    buffer_store_dwordx4 v[56:59], v11, s[8:11], s21 offen sc1
    s_waitcnt vmcnt(17)
    s_cmp_eq_u32 s97, 0
    s_cbranch_scc1 ELE_2
    v_readfirstlane_b32 s17, v250
    s_nop 3
    s_cmp_ge_u32 s17, 32
    s_cbranch_scc1 ELE_2
    s_mov_b64 exec, 1
    s_lshl_b32 s98, s17, 2
    v_mov_b32 v251, s98
    s_add_u32 s98, s2, 1
    v_mov_b32 v252, s98
    v_mov_b32_e64 v253, 0
    buffer_atomic_cmpswap v[252:253], v251, s[12:15], 0 offen
    s_nop 0
    s_nop 0
ELE_2:
    s_mov_b64 exec, -1
    v_lshlrev_b32 v120, 16, v64
    v_and_b32 v121, 0xffff0000, v64
    v_lshlrev_b32_e64 v122, 16, v65
    v_and_b32 v123, 0xffff0000, v65
    v_lshlrev_b32_e64 v124, 16, v66
    v_and_b32 v125, 0xffff0000, v66
    v_lshlrev_b32_e64 v126, 16, v67
    v_and_b32 v127, 0xffff0000, v67
    v_lshlrev_b32_e64 v128, 16, v68
    v_and_b32 v129, 0xffff0000, v68
    v_lshlrev_b32_e64 v130, 16, v69
    v_and_b32 v131, 0xffff0000, v69
    v_lshlrev_b32_e64 v132, 16, v70
    v_and_b32 v133, 0xffff0000, v70
    v_lshlrev_b32_e64 v134, 16, v71
    v_and_b32 v135, 0xffff0000, v71
    v_lshlrev_b32_e64 v136, 16, v72
    v_and_b32 v137, 0xffff0000, v72
    v_lshlrev_b32_e64 v138, 16, v73
    v_and_b32 v139, 0xffff0000, v73
    v_lshlrev_b32_e64 v140, 16, v74
    v_and_b32 v141, 0xffff0000, v74
    v_lshlrev_b32_e64 v142, 16, v75
    v_and_b32 v143, 0xffff0000, v75
    v_lshlrev_b32_e64 v144, 16, v76
    v_and_b32 v145, 0xffff0000, v76
    v_lshlrev_b32_e64 v146, 16, v77
    v_and_b32 v147, 0xffff0000, v77
    v_lshlrev_b32_e64 v148, 16, v78
    v_and_b32 v149, 0xffff0000, v78
    v_lshlrev_b32_e64 v150, 16, v79
    v_and_b32 v151, 0xffff0000, v79
    v_lshlrev_b32_e64 v152, 16, v80
    v_and_b32 v153, 0xffff0000, v80
    v_lshlrev_b32_e64 v154, 16, v81
    v_and_b32 v155, 0xffff0000, v81
    v_lshlrev_b32_e64 v156, 16, v82
    v_and_b32 v157, 0xffff0000, v82
    v_lshlrev_b32_e64 v158, 16, v83
    v_and_b32 v159, 0xffff0000, v83
    v_lshlrev_b32_e64 v160, 16, v84
    v_and_b32 v161, 0xffff0000, v84
    v_lshlrev_b32_e64 v162, 16, v85
    v_and_b32 v163, 0xffff0000, v85
    v_lshlrev_b32_e64 v164, 16, v86
    v_and_b32 v165, 0xffff0000, v86
    v_lshlrev_b32_e64 v166, 16, v87
    v_and_b32 v167, 0xffff0000, v87
    v_lshlrev_b32_e64 v168, 16, v88
    v_and_b32 v169, 0xffff0000, v88
    v_lshlrev_b32_e64 v170, 16, v89
    v_and_b32 v171, 0xffff0000, v89
    v_lshlrev_b32_e64 v172, 16, v90
    v_and_b32 v173, 0xffff0000, v90
    v_lshlrev_b32_e64 v174, 16, v91
    v_and_b32 v175, 0xffff0000, v91
    v_pk_add_f32 v[12:13], v[120:121], v[122:123]
    v_pk_add_f32 v[12:13], v[12:13], v[124:125]
    v_pk_add_f32 v[12:13], v[12:13], v[126:127]
    v_pk_add_f32 v[12:13], v[12:13], v[128:129]
    v_pk_add_f32 v[12:13], v[12:13], v[130:131]
    v_pk_add_f32 v[12:13], v[12:13], v[132:133]
    v_pk_add_f32 v[12:13], v[12:13], v[134:135]
    v_pk_add_f32 v[12:13], v[12:13], v[136:137]
    v_pk_add_f32 v[12:13], v[12:13], v[138:139]
    v_pk_add_f32 v[12:13], v[12:13], v[140:141]
    v_pk_add_f32 v[12:13], v[12:13], v[142:143]
    v_pk_add_f32 v[12:13], v[12:13], v[144:145]
    v_pk_add_f32 v[12:13], v[12:13], v[146:147]
    v_pk_add_f32 v[12:13], v[12:13], v[148:149]
    v_pk_add_f32 v[12:13], v[12:13], v[150:151]
    v_pk_add_f32 v[12:13], v[12:13], v[152:153]
    v_pk_add_f32 v[12:13], v[12:13], v[154:155]
    v_pk_add_f32 v[12:13], v[12:13], v[156:157]
    v_pk_add_f32 v[12:13], v[12:13], v[158:159]
    v_pk_add_f32 v[12:13], v[12:13], v[160:161]
    v_pk_add_f32 v[12:13], v[12:13], v[162:163]
    v_pk_add_f32 v[12:13], v[12:13], v[164:165]
    v_pk_add_f32 v[12:13], v[12:13], v[166:167]
    v_pk_add_f32 v[12:13], v[12:13], v[168:169]
    v_pk_add_f32 v[12:13], v[12:13], v[170:171]
    v_pk_add_f32 v[12:13], v[12:13], v[172:173]
    v_pk_add_f32 v[12:13], v[12:13], v[174:175]
    v_add_f32 v12, v12, v13
    s_nop 1
    v_add_f32_dpp v12, v12, v12 row_ror:8 row_mask:0xf bank_mask:0xf
    v_mov_b32 v13, v12
    s_nop 1
    v_permlane16_swap_b32 v12, v13
    s_nop 0
    v_add_f32 v12, v12, v13
    v_mov_b32 v13, v12
    s_nop 1
    v_permlane32_swap_b32 v12, v13
    s_nop 0
    v_add_f32 v12, v12, v13
    v_mul_f32 v12, 0x3b124925, v12
    v_mov_b32 v14, 0
    v_mov_b32 v15, 0
    v_mov_b32_e64 v13, v12
    v_pk_add_f32 v[16:17], v[120:121], v[12:13] neg_lo:[0,1] neg_hi:[0,1]
    v_pk_fma_f32 v[14:15], v[16:17], v[16:17], v[14:15]
    v_pk_add_f32 v[18:19], v[122:123], v[12:13] neg_lo:[0,1] neg_hi:[0,1]
    v_pk_fma_f32 v[14:15], v[18:19], v[18:19], v[14:15]
    v_pk_add_f32 v[16:17], v[124:125], v[12:13] neg_lo:[0,1] neg_hi:[0,1]
    v_pk_fma_f32 v[14:15], v[16:17], v[16:17], v[14:15]
    v_pk_add_f32 v[18:19], v[126:127], v[12:13] neg_lo:[0,1] neg_hi:[0,1]
    v_pk_fma_f32 v[14:15], v[18:19], v[18:19], v[14:15]
    v_pk_add_f32 v[16:17], v[128:129], v[12:13] neg_lo:[0,1] neg_hi:[0,1]
    v_pk_fma_f32 v[14:15], v[16:17], v[16:17], v[14:15]
    v_pk_add_f32 v[18:19], v[130:131], v[12:13] neg_lo:[0,1] neg_hi:[0,1]
    v_pk_fma_f32 v[14:15], v[18:19], v[18:19], v[14:15]
    v_pk_add_f32 v[16:17], v[132:133], v[12:13] neg_lo:[0,1] neg_hi:[0,1]
    v_pk_fma_f32 v[14:15], v[16:17], v[16:17], v[14:15]
    v_pk_add_f32 v[18:19], v[134:135], v[12:13] neg_lo:[0,1] neg_hi:[0,1]
    v_pk_fma_f32 v[14:15], v[18:19], v[18:19], v[14:15]
    v_pk_add_f32 v[16:17], v[136:137], v[12:13] neg_lo:[0,1] neg_hi:[0,1]
    v_pk_fma_f32 v[14:15], v[16:17], v[16:17], v[14:15]
    v_pk_add_f32 v[18:19], v[138:139], v[12:13] neg_lo:[0,1] neg_hi:[0,1]
    v_pk_fma_f32 v[14:15], v[18:19], v[18:19], v[14:15]
    v_pk_add_f32 v[16:17], v[140:141], v[12:13] neg_lo:[0,1] neg_hi:[0,1]
    v_pk_fma_f32 v[14:15], v[16:17], v[16:17], v[14:15]
    v_pk_add_f32 v[18:19], v[142:143], v[12:13] neg_lo:[0,1] neg_hi:[0,1]
    v_pk_fma_f32 v[14:15], v[18:19], v[18:19], v[14:15]
    v_pk_add_f32 v[16:17], v[144:145], v[12:13] neg_lo:[0,1] neg_hi:[0,1]
    v_pk_fma_f32 v[14:15], v[16:17], v[16:17], v[14:15]
    v_pk_add_f32 v[18:19], v[146:147], v[12:13] neg_lo:[0,1] neg_hi:[0,1]
    v_pk_fma_f32 v[14:15], v[18:19], v[18:19], v[14:15]
    v_pk_add_f32 v[16:17], v[148:149], v[12:13] neg_lo:[0,1] neg_hi:[0,1]
    v_pk_fma_f32 v[14:15], v[16:17], v[16:17], v[14:15]
    v_pk_add_f32 v[18:19], v[150:151], v[12:13] neg_lo:[0,1] neg_hi:[0,1]
    v_pk_fma_f32 v[14:15], v[18:19], v[18:19], v[14:15]
    v_pk_add_f32 v[16:17], v[152:153], v[12:13] neg_lo:[0,1] neg_hi:[0,1]
    v_pk_fma_f32 v[14:15], v[16:17], v[16:17], v[14:15]
    v_pk_add_f32 v[18:19], v[154:155], v[12:13] neg_lo:[0,1] neg_hi:[0,1]
    v_pk_fma_f32 v[14:15], v[18:19], v[18:19], v[14:15]
    v_pk_add_f32 v[16:17], v[156:157], v[12:13] neg_lo:[0,1] neg_hi:[0,1]
    v_pk_fma_f32 v[14:15], v[16:17], v[16:17], v[14:15]
    v_pk_add_f32 v[18:19], v[158:159], v[12:13] neg_lo:[0,1] neg_hi:[0,1]
    v_pk_fma_f32 v[14:15], v[18:19], v[18:19], v[14:15]
    v_pk_add_f32 v[16:17], v[160:161], v[12:13] neg_lo:[0,1] neg_hi:[0,1]
    v_pk_fma_f32 v[14:15], v[16:17], v[16:17], v[14:15]
    v_pk_add_f32 v[18:19], v[162:163], v[12:13] neg_lo:[0,1] neg_hi:[0,1]
    v_pk_fma_f32 v[14:15], v[18:19], v[18:19], v[14:15]
    v_pk_add_f32 v[16:17], v[164:165], v[12:13] neg_lo:[0,1] neg_hi:[0,1]
    v_pk_fma_f32 v[14:15], v[16:17], v[16:17], v[14:15]
    v_pk_add_f32 v[18:19], v[166:167], v[12:13] neg_lo:[0,1] neg_hi:[0,1]
    v_pk_fma_f32 v[14:15], v[18:19], v[18:19], v[14:15]
    v_pk_add_f32 v[16:17], v[168:169], v[12:13] neg_lo:[0,1] neg_hi:[0,1]
    v_pk_fma_f32 v[14:15], v[16:17], v[16:17], v[14:15]
    v_pk_add_f32 v[18:19], v[170:171], v[12:13] neg_lo:[0,1] neg_hi:[0,1]
    v_pk_fma_f32 v[14:15], v[18:19], v[18:19], v[14:15]
    v_pk_add_f32 v[16:17], v[172:173], v[12:13] neg_lo:[0,1] neg_hi:[0,1]
    v_pk_fma_f32 v[14:15], v[16:17], v[16:17], v[14:15]
    v_pk_add_f32 v[18:19], v[174:175], v[12:13] neg_lo:[0,1] neg_hi:[0,1]
    v_pk_fma_f32 v[14:15], v[18:19], v[18:19], v[14:15]
    v_add_f32 v14, v14, v15
    s_nop 1
    v_add_f32_dpp v14, v14, v14 row_ror:8 row_mask:0xf bank_mask:0xf
    v_mov_b32 v15, v14
    s_nop 1
    v_permlane16_swap_b32 v14, v15
    s_nop 0
    v_add_f32 v14, v14, v15
    v_mov_b32 v15, v14
    s_nop 1
    v_permlane32_swap_b32 v14, v15
    s_nop 0
    v_add_f32 v14, v14, v15
    v_mul_f32 v14, 0x3b124925, v14
    v_cvt_pk_bf16_f32 v14, v14, v14
    v_lshlrev_b32_e64 v14, 16, v14
    v_cvt_pk_bf16_f32 v12, v12, v12
    v_lshlrev_b32_e64 v12, 16, v12
    v_add_f32 v14, 0x3727c5ac, v14
    v_cvt_pk_bf16_f32 v14, v14, v14
    v_lshlrev_b32_e64 v14, 16, v14
    v_sqrt_f32 v14, v14
    s_nop 0
    v_cvt_pk_bf16_f32 v14, v14, v14
    v_lshlrev_b32 v14, 16, v14
    v_rcp_f32 v20, v14
    v_mov_b32 v13, v12
    v_mov_b32 v15, v14
    v_mov_b32_e64 v21, v20
    v_pk_add_f32 v[120:121], v[120:121], v[12:13] neg_lo:[0,1] neg_hi:[0,1]
    v_cvt_pk_bf16_f32 v16, v120, v121
    v_lshlrev_b32_e64 v120, 16, v16
    v_and_b32 v121, 0xffff0000, v16
    v_pk_mul_f32 v[18:19], v[120:121], v[20:21]
    v_pk_fma_f32 v[120:121], v[18:19], v[14:15], v[120:121] neg_lo:[1,0,0] neg_hi:[1,0,0]
    v_pk_fma_f32 v[18:19], v[120:121], v[20:21], v[18:19]
    v_cvt_pk_bf16_f32 v64, v18, v19
    v_pk_add_f32 v[122:123], v[122:123], v[12:13] neg_lo:[0,1] neg_hi:[0,1]
    v_cvt_pk_bf16_f32 v16, v122, v123
    v_lshlrev_b32_e64 v122, 16, v16
    v_and_b32 v123, 0xffff0000, v16
    v_pk_mul_f32 v[18:19], v[122:123], v[20:21]
    v_pk_fma_f32 v[122:123], v[18:19], v[14:15], v[122:123] neg_lo:[1,0,0] neg_hi:[1,0,0]
    v_pk_fma_f32 v[18:19], v[122:123], v[20:21], v[18:19]
    v_cvt_pk_bf16_f32 v65, v18, v19
    v_pk_add_f32 v[124:125], v[124:125], v[12:13] neg_lo:[0,1] neg_hi:[0,1]
    v_cvt_pk_bf16_f32 v16, v124, v125
    v_lshlrev_b32_e64 v124, 16, v16
    v_and_b32 v125, 0xffff0000, v16
    v_pk_mul_f32 v[18:19], v[124:125], v[20:21]
    v_pk_fma_f32 v[124:125], v[18:19], v[14:15], v[124:125] neg_lo:[1,0,0] neg_hi:[1,0,0]
    v_pk_fma_f32 v[18:19], v[124:125], v[20:21], v[18:19]
    v_cvt_pk_bf16_f32 v66, v18, v19
    v_pk_add_f32 v[126:127], v[126:127], v[12:13] neg_lo:[0,1] neg_hi:[0,1]
    v_cvt_pk_bf16_f32 v16, v126, v127
    v_lshlrev_b32_e64 v126, 16, v16
    v_and_b32 v127, 0xffff0000, v16
    v_pk_mul_f32 v[18:19], v[126:127], v[20:21]
    v_pk_fma_f32 v[126:127], v[18:19], v[14:15], v[126:127] neg_lo:[1,0,0] neg_hi:[1,0,0]
    v_pk_fma_f32 v[18:19], v[126:127], v[20:21], v[18:19]
    v_cvt_pk_bf16_f32 v67, v18, v19
    v_pk_add_f32 v[128:129], v[128:129], v[12:13] neg_lo:[0,1] neg_hi:[0,1]
    v_cvt_pk_bf16_f32 v16, v128, v129
    v_lshlrev_b32_e64 v128, 16, v16
    v_and_b32 v129, 0xffff0000, v16
    v_pk_mul_f32 v[18:19], v[128:129], v[20:21]
    v_pk_fma_f32 v[128:129], v[18:19], v[14:15], v[128:129] neg_lo:[1,0,0] neg_hi:[1,0,0]
    v_pk_fma_f32 v[18:19], v[128:129], v[20:21], v[18:19]
    v_cvt_pk_bf16_f32 v68, v18, v19
    v_pk_add_f32 v[130:131], v[130:131], v[12:13] neg_lo:[0,1] neg_hi:[0,1]
    v_cvt_pk_bf16_f32 v16, v130, v131
    v_lshlrev_b32_e64 v130, 16, v16
    v_and_b32 v131, 0xffff0000, v16
    v_pk_mul_f32 v[18:19], v[130:131], v[20:21]
    v_pk_fma_f32 v[130:131], v[18:19], v[14:15], v[130:131] neg_lo:[1,0,0] neg_hi:[1,0,0]
    v_pk_fma_f32 v[18:19], v[130:131], v[20:21], v[18:19]
    v_cvt_pk_bf16_f32 v69, v18, v19
    v_pk_add_f32 v[132:133], v[132:133], v[12:13] neg_lo:[0,1] neg_hi:[0,1]
    v_cvt_pk_bf16_f32 v16, v132, v133
    v_lshlrev_b32_e64 v132, 16, v16
    v_and_b32 v133, 0xffff0000, v16
    v_pk_mul_f32 v[18:19], v[132:133], v[20:21]
    v_pk_fma_f32 v[132:133], v[18:19], v[14:15], v[132:133] neg_lo:[1,0,0] neg_hi:[1,0,0]
    v_pk_fma_f32 v[18:19], v[132:133], v[20:21], v[18:19]
    v_cvt_pk_bf16_f32 v70, v18, v19
    v_pk_add_f32 v[134:135], v[134:135], v[12:13] neg_lo:[0,1] neg_hi:[0,1]
    v_cvt_pk_bf16_f32 v16, v134, v135
    v_lshlrev_b32_e64 v134, 16, v16
    v_and_b32 v135, 0xffff0000, v16
    v_pk_mul_f32 v[18:19], v[134:135], v[20:21]
    v_pk_fma_f32 v[134:135], v[18:19], v[14:15], v[134:135] neg_lo:[1,0,0] neg_hi:[1,0,0]
    v_pk_fma_f32 v[18:19], v[134:135], v[20:21], v[18:19]
    v_cvt_pk_bf16_f32 v71, v18, v19
    v_pk_add_f32 v[136:137], v[136:137], v[12:13] neg_lo:[0,1] neg_hi:[0,1]
    v_cvt_pk_bf16_f32 v16, v136, v137
    v_lshlrev_b32_e64 v136, 16, v16
    v_and_b32 v137, 0xffff0000, v16
    v_pk_mul_f32 v[18:19], v[136:137], v[20:21]
    v_pk_fma_f32 v[136:137], v[18:19], v[14:15], v[136:137] neg_lo:[1,0,0] neg_hi:[1,0,0]
    v_pk_fma_f32 v[18:19], v[136:137], v[20:21], v[18:19]
    v_cvt_pk_bf16_f32 v72, v18, v19
    v_pk_add_f32 v[138:139], v[138:139], v[12:13] neg_lo:[0,1] neg_hi:[0,1]
    v_cvt_pk_bf16_f32 v16, v138, v139
    v_lshlrev_b32_e64 v138, 16, v16
    v_and_b32 v139, 0xffff0000, v16
    v_pk_mul_f32 v[18:19], v[138:139], v[20:21]
    v_pk_fma_f32 v[138:139], v[18:19], v[14:15], v[138:139] neg_lo:[1,0,0] neg_hi:[1,0,0]
    v_pk_fma_f32 v[18:19], v[138:139], v[20:21], v[18:19]
    v_cvt_pk_bf16_f32 v73, v18, v19
    v_pk_add_f32 v[140:141], v[140:141], v[12:13] neg_lo:[0,1] neg_hi:[0,1]
    v_cvt_pk_bf16_f32 v16, v140, v141
    v_lshlrev_b32_e64 v140, 16, v16
    v_and_b32 v141, 0xffff0000, v16
    v_pk_mul_f32 v[18:19], v[140:141], v[20:21]
    v_pk_fma_f32 v[140:141], v[18:19], v[14:15], v[140:141] neg_lo:[1,0,0] neg_hi:[1,0,0]
    v_pk_fma_f32 v[18:19], v[140:141], v[20:21], v[18:19]
    v_cvt_pk_bf16_f32 v74, v18, v19
    v_pk_add_f32 v[142:143], v[142:143], v[12:13] neg_lo:[0,1] neg_hi:[0,1]
    v_cvt_pk_bf16_f32 v16, v142, v143
    v_lshlrev_b32_e64 v142, 16, v16
    v_and_b32 v143, 0xffff0000, v16
    v_pk_mul_f32 v[18:19], v[142:143], v[20:21]
    v_pk_fma_f32 v[142:143], v[18:19], v[14:15], v[142:143] neg_lo:[1,0,0] neg_hi:[1,0,0]
    v_pk_fma_f32 v[18:19], v[142:143], v[20:21], v[18:19]
    v_cvt_pk_bf16_f32 v75, v18, v19
    v_pk_add_f32 v[144:145], v[144:145], v[12:13] neg_lo:[0,1] neg_hi:[0,1]
    v_cvt_pk_bf16_f32 v16, v144, v145
    v_lshlrev_b32_e64 v144, 16, v16
    v_and_b32 v145, 0xffff0000, v16
    v_pk_mul_f32 v[18:19], v[144:145], v[20:21]
    v_pk_fma_f32 v[144:145], v[18:19], v[14:15], v[144:145] neg_lo:[1,0,0] neg_hi:[1,0,0]
    v_pk_fma_f32 v[18:19], v[144:145], v[20:21], v[18:19]
    v_cvt_pk_bf16_f32 v76, v18, v19
    v_pk_add_f32 v[146:147], v[146:147], v[12:13] neg_lo:[0,1] neg_hi:[0,1]
    v_cvt_pk_bf16_f32 v16, v146, v147
    v_lshlrev_b32_e64 v146, 16, v16
    v_and_b32 v147, 0xffff0000, v16
    v_pk_mul_f32 v[18:19], v[146:147], v[20:21]
    v_pk_fma_f32 v[146:147], v[18:19], v[14:15], v[146:147] neg_lo:[1,0,0] neg_hi:[1,0,0]
    v_pk_fma_f32 v[18:19], v[146:147], v[20:21], v[18:19]
    v_cvt_pk_bf16_f32 v77, v18, v19
    v_pk_add_f32 v[148:149], v[148:149], v[12:13] neg_lo:[0,1] neg_hi:[0,1]
    v_cvt_pk_bf16_f32 v16, v148, v149
    v_lshlrev_b32_e64 v148, 16, v16
    v_and_b32 v149, 0xffff0000, v16
    v_pk_mul_f32 v[18:19], v[148:149], v[20:21]
    v_pk_fma_f32 v[148:149], v[18:19], v[14:15], v[148:149] neg_lo:[1,0,0] neg_hi:[1,0,0]
    v_pk_fma_f32 v[18:19], v[148:149], v[20:21], v[18:19]
    v_cvt_pk_bf16_f32 v78, v18, v19
    v_pk_add_f32 v[150:151], v[150:151], v[12:13] neg_lo:[0,1] neg_hi:[0,1]
    v_cvt_pk_bf16_f32 v16, v150, v151
    v_lshlrev_b32_e64 v150, 16, v16
    v_and_b32 v151, 0xffff0000, v16
    v_pk_mul_f32 v[18:19], v[150:151], v[20:21]
    v_pk_fma_f32 v[150:151], v[18:19], v[14:15], v[150:151] neg_lo:[1,0,0] neg_hi:[1,0,0]
    v_pk_fma_f32 v[18:19], v[150:151], v[20:21], v[18:19]
    v_cvt_pk_bf16_f32 v79, v18, v19
    v_pk_add_f32 v[152:153], v[152:153], v[12:13] neg_lo:[0,1] neg_hi:[0,1]
    v_cvt_pk_bf16_f32 v16, v152, v153
    v_lshlrev_b32_e64 v152, 16, v16
    v_and_b32 v153, 0xffff0000, v16
    v_pk_mul_f32 v[18:19], v[152:153], v[20:21]
    v_pk_fma_f32 v[152:153], v[18:19], v[14:15], v[152:153] neg_lo:[1,0,0] neg_hi:[1,0,0]
    v_pk_fma_f32 v[18:19], v[152:153], v[20:21], v[18:19]
    v_cvt_pk_bf16_f32 v80, v18, v19
    v_pk_add_f32 v[154:155], v[154:155], v[12:13] neg_lo:[0,1] neg_hi:[0,1]
    v_cvt_pk_bf16_f32 v16, v154, v155
    v_lshlrev_b32_e64 v154, 16, v16
    v_and_b32 v155, 0xffff0000, v16
    v_pk_mul_f32 v[18:19], v[154:155], v[20:21]
    v_pk_fma_f32 v[154:155], v[18:19], v[14:15], v[154:155] neg_lo:[1,0,0] neg_hi:[1,0,0]
    v_pk_fma_f32 v[18:19], v[154:155], v[20:21], v[18:19]
    v_cvt_pk_bf16_f32 v81, v18, v19
    v_pk_add_f32 v[156:157], v[156:157], v[12:13] neg_lo:[0,1] neg_hi:[0,1]
    v_cvt_pk_bf16_f32 v16, v156, v157
    v_lshlrev_b32_e64 v156, 16, v16
    v_and_b32 v157, 0xffff0000, v16
    v_pk_mul_f32 v[18:19], v[156:157], v[20:21]
    v_pk_fma_f32 v[156:157], v[18:19], v[14:15], v[156:157] neg_lo:[1,0,0] neg_hi:[1,0,0]
    v_pk_fma_f32 v[18:19], v[156:157], v[20:21], v[18:19]
    v_cvt_pk_bf16_f32 v82, v18, v19
    v_pk_add_f32 v[158:159], v[158:159], v[12:13] neg_lo:[0,1] neg_hi:[0,1]
    v_cvt_pk_bf16_f32 v16, v158, v159
    v_lshlrev_b32_e64 v158, 16, v16
    v_and_b32 v159, 0xffff0000, v16
    v_pk_mul_f32 v[18:19], v[158:159], v[20:21]
    v_pk_fma_f32 v[158:159], v[18:19], v[14:15], v[158:159] neg_lo:[1,0,0] neg_hi:[1,0,0]
    v_pk_fma_f32 v[18:19], v[158:159], v[20:21], v[18:19]
    v_cvt_pk_bf16_f32 v83, v18, v19
    v_pk_add_f32 v[160:161], v[160:161], v[12:13] neg_lo:[0,1] neg_hi:[0,1]
    v_cvt_pk_bf16_f32 v16, v160, v161
    v_lshlrev_b32_e64 v160, 16, v16
    v_and_b32 v161, 0xffff0000, v16
    v_pk_mul_f32 v[18:19], v[160:161], v[20:21]
    v_pk_fma_f32 v[160:161], v[18:19], v[14:15], v[160:161] neg_lo:[1,0,0] neg_hi:[1,0,0]
    v_pk_fma_f32 v[18:19], v[160:161], v[20:21], v[18:19]
    v_cvt_pk_bf16_f32 v84, v18, v19
    v_pk_add_f32 v[162:163], v[162:163], v[12:13] neg_lo:[0,1] neg_hi:[0,1]
    v_cvt_pk_bf16_f32 v16, v162, v163
    v_lshlrev_b32_e64 v162, 16, v16
    v_and_b32 v163, 0xffff0000, v16
    v_pk_mul_f32 v[18:19], v[162:163], v[20:21]
    v_pk_fma_f32 v[162:163], v[18:19], v[14:15], v[162:163] neg_lo:[1,0,0] neg_hi:[1,0,0]
    v_pk_fma_f32 v[18:19], v[162:163], v[20:21], v[18:19]
    v_cvt_pk_bf16_f32 v85, v18, v19
    v_pk_add_f32 v[164:165], v[164:165], v[12:13] neg_lo:[0,1] neg_hi:[0,1]
    v_cvt_pk_bf16_f32 v16, v164, v165
    v_lshlrev_b32_e64 v164, 16, v16
    v_and_b32 v165, 0xffff0000, v16
    v_pk_mul_f32 v[18:19], v[164:165], v[20:21]
    v_pk_fma_f32 v[164:165], v[18:19], v[14:15], v[164:165] neg_lo:[1,0,0] neg_hi:[1,0,0]
    v_pk_fma_f32 v[18:19], v[164:165], v[20:21], v[18:19]
    v_cvt_pk_bf16_f32 v86, v18, v19
    v_pk_add_f32 v[166:167], v[166:167], v[12:13] neg_lo:[0,1] neg_hi:[0,1]
    v_cvt_pk_bf16_f32 v16, v166, v167
    v_lshlrev_b32_e64 v166, 16, v16
    v_and_b32 v167, 0xffff0000, v16
    v_pk_mul_f32 v[18:19], v[166:167], v[20:21]
    v_pk_fma_f32 v[166:167], v[18:19], v[14:15], v[166:167] neg_lo:[1,0,0] neg_hi:[1,0,0]
    v_pk_fma_f32 v[18:19], v[166:167], v[20:21], v[18:19]
    v_cvt_pk_bf16_f32 v87, v18, v19
    v_pk_add_f32 v[168:169], v[168:169], v[12:13] neg_lo:[0,1] neg_hi:[0,1]
    v_cvt_pk_bf16_f32 v16, v168, v169
    v_lshlrev_b32_e64 v168, 16, v16
    v_and_b32 v169, 0xffff0000, v16
    v_pk_mul_f32 v[18:19], v[168:169], v[20:21]
    v_pk_fma_f32 v[168:169], v[18:19], v[14:15], v[168:169] neg_lo:[1,0,0] neg_hi:[1,0,0]
    v_pk_fma_f32 v[18:19], v[168:169], v[20:21], v[18:19]
    v_cvt_pk_bf16_f32 v88, v18, v19
    v_pk_add_f32 v[170:171], v[170:171], v[12:13] neg_lo:[0,1] neg_hi:[0,1]
    v_cvt_pk_bf16_f32 v16, v170, v171
    v_lshlrev_b32_e64 v170, 16, v16
    v_and_b32 v171, 0xffff0000, v16
    v_pk_mul_f32 v[18:19], v[170:171], v[20:21]
    v_pk_fma_f32 v[170:171], v[18:19], v[14:15], v[170:171] neg_lo:[1,0,0] neg_hi:[1,0,0]
    v_pk_fma_f32 v[18:19], v[170:171], v[20:21], v[18:19]
    v_cvt_pk_bf16_f32 v89, v18, v19
    v_pk_add_f32 v[172:173], v[172:173], v[12:13] neg_lo:[0,1] neg_hi:[0,1]
    v_cvt_pk_bf16_f32 v16, v172, v173
    v_lshlrev_b32_e64 v172, 16, v16
    v_and_b32 v173, 0xffff0000, v16
    v_pk_mul_f32 v[18:19], v[172:173], v[20:21]
    v_pk_fma_f32 v[172:173], v[18:19], v[14:15], v[172:173] neg_lo:[1,0,0] neg_hi:[1,0,0]
    v_pk_fma_f32 v[18:19], v[172:173], v[20:21], v[18:19]
    v_cvt_pk_bf16_f32 v90, v18, v19
    v_pk_add_f32 v[174:175], v[174:175], v[12:13] neg_lo:[0,1] neg_hi:[0,1]
    v_cvt_pk_bf16_f32 v16, v174, v175
    v_lshlrev_b32_e64 v174, 16, v16
    v_and_b32 v175, 0xffff0000, v16
    v_pk_mul_f32 v[18:19], v[174:175], v[20:21]
    v_pk_fma_f32 v[174:175], v[18:19], v[14:15], v[174:175] neg_lo:[1,0,0] neg_hi:[1,0,0]
    v_pk_fma_f32 v[18:19], v[174:175], v[20:21], v[18:19]
    v_cvt_pk_bf16_f32 v91, v18, v19
    s_add_u32 s5, s22, 0
    s_nop 0
    buffer_store_dwordx4 v[64:67], v9, s[8:11], s5 offen offset:0 sc1
    buffer_store_dwordx4 v[68:71], v9, s[8:11], s5 offen offset:2048 sc1
    s_add_u32 s5, s5, 4096
    buffer_store_dwordx4 v[72:75], v9, s[8:11], s5 offen offset:0 sc1
    buffer_store_dwordx4 v[76:79], v9, s[8:11], s5 offen offset:2048 sc1
    s_add_u32 s5, s5, 4096
    buffer_store_dwordx4 v[80:83], v9, s[8:11], s5 offen offset:0 sc1
    buffer_store_dwordx4 v[84:87], v9, s[8:11], s5 offen offset:2048 sc1
    s_add_u32 s5, s5, 4096
    buffer_store_dwordx4 v[88:91], v9, s[8:11], s5 offen offset:0 sc1
    v_mov_b32 v29, 196
    s_mov_b32 s27, 0
    s_nop 0
PP_WZ0:
    buffer_load_dword v28, v29, s[12:15], 0 offen sc1
    s_add_u32 s27, s27, 1
    s_nop 0
    s_cmp_gt_u32 s27, 65536
    s_cbranch_scc1 CH_FAIL
    s_waitcnt vmcnt(0)
    v_cmp_eq_u32 vcc, 0, v28
    s_cbranch_vccnz PP_WZ0
    s_waitcnt vmcnt(0)
    s_barrier
    s_cmp_lg_u32 s16, 0
    s_cbranch_scc1 SIG_3
    s_mov_b32 s68, 85133952
    s_mov_b64 exec, 1
    v_mov_b32 v254, 0
    v_mov_b32_e64 v255, 1
    buffer_atomic_add v255, v254, s[8:11], s68 offen
    s_mov_b64 exec, -1
    s_nop 0
SIG_3:
    s_waitcnt vmcnt(17)
    v_lshlrev_b32 v120, 16, v92
    v_and_b32 v121, 0xffff0000, v92
    v_lshlrev_b32_e64 v122, 16, v93
    v_and_b32 v123, 0xffff0000, v93
    v_lshlrev_b32_e64 v124, 16, v94
    v_and_b32 v125, 0xffff0000, v94
    v_lshlrev_b32_e64 v126, 16, v95
    v_and_b32 v127, 0xffff0000, v95
    v_lshlrev_b32_e64 v128, 16, v96
    v_and_b32 v129, 0xffff0000, v96
    v_lshlrev_b32_e64 v130, 16, v97
    v_and_b32 v131, 0xffff0000, v97
    v_lshlrev_b32_e64 v132, 16, v98
    v_and_b32 v133, 0xffff0000, v98
    v_lshlrev_b32_e64 v134, 16, v99
    v_and_b32 v135, 0xffff0000, v99
    v_lshlrev_b32_e64 v136, 16, v100
    v_and_b32 v137, 0xffff0000, v100
    v_lshlrev_b32_e64 v138, 16, v101
    v_and_b32 v139, 0xffff0000, v101
    v_lshlrev_b32_e64 v140, 16, v102
    v_and_b32 v141, 0xffff0000, v102
    v_lshlrev_b32_e64 v142, 16, v103
    v_and_b32 v143, 0xffff0000, v103
    v_lshlrev_b32_e64 v144, 16, v104
    v_and_b32 v145, 0xffff0000, v104
    v_lshlrev_b32_e64 v146, 16, v105
    v_and_b32 v147, 0xffff0000, v105
    v_lshlrev_b32_e64 v148, 16, v106
    v_and_b32 v149, 0xffff0000, v106
    v_lshlrev_b32_e64 v150, 16, v107
    v_and_b32 v151, 0xffff0000, v107
    v_lshlrev_b32_e64 v152, 16, v108
    v_and_b32 v153, 0xffff0000, v108
    v_lshlrev_b32_e64 v154, 16, v109
    v_and_b32 v155, 0xffff0000, v109
    v_lshlrev_b32_e64 v156, 16, v110
    v_and_b32 v157, 0xffff0000, v110
    v_lshlrev_b32_e64 v158, 16, v111
    v_and_b32 v159, 0xffff0000, v111
    v_lshlrev_b32_e64 v160, 16, v112
    v_and_b32 v161, 0xffff0000, v112
    v_lshlrev_b32_e64 v162, 16, v113
    v_and_b32 v163, 0xffff0000, v113
    v_lshlrev_b32_e64 v164, 16, v114
    v_and_b32 v165, 0xffff0000, v114
    v_lshlrev_b32_e64 v166, 16, v115
    v_and_b32 v167, 0xffff0000, v115
    v_lshlrev_b32_e64 v168, 16, v116
    v_and_b32 v169, 0xffff0000, v116
    v_lshlrev_b32_e64 v170, 16, v117
    v_and_b32 v171, 0xffff0000, v117
    v_lshlrev_b32_e64 v172, 16, v118
    v_and_b32 v173, 0xffff0000, v118
    v_lshlrev_b32_e64 v174, 16, v119
    v_and_b32 v175, 0xffff0000, v119
    v_pk_add_f32 v[12:13], v[120:121], v[122:123]
    v_pk_add_f32 v[12:13], v[12:13], v[124:125]
    v_pk_add_f32 v[12:13], v[12:13], v[126:127]
    v_pk_add_f32 v[12:13], v[12:13], v[128:129]
    v_pk_add_f32 v[12:13], v[12:13], v[130:131]
    v_pk_add_f32 v[12:13], v[12:13], v[132:133]
    v_pk_add_f32 v[12:13], v[12:13], v[134:135]
    v_pk_add_f32 v[12:13], v[12:13], v[136:137]
    v_pk_add_f32 v[12:13], v[12:13], v[138:139]
    v_pk_add_f32 v[12:13], v[12:13], v[140:141]
    v_pk_add_f32 v[12:13], v[12:13], v[142:143]
    v_pk_add_f32 v[12:13], v[12:13], v[144:145]
    v_pk_add_f32 v[12:13], v[12:13], v[146:147]
    v_pk_add_f32 v[12:13], v[12:13], v[148:149]
    v_pk_add_f32 v[12:13], v[12:13], v[150:151]
    v_pk_add_f32 v[12:13], v[12:13], v[152:153]
    v_pk_add_f32 v[12:13], v[12:13], v[154:155]
    v_pk_add_f32 v[12:13], v[12:13], v[156:157]
    v_pk_add_f32 v[12:13], v[12:13], v[158:159]
    v_pk_add_f32 v[12:13], v[12:13], v[160:161]
    v_pk_add_f32 v[12:13], v[12:13], v[162:163]
    v_pk_add_f32 v[12:13], v[12:13], v[164:165]
    v_pk_add_f32 v[12:13], v[12:13], v[166:167]
    v_pk_add_f32 v[12:13], v[12:13], v[168:169]
    v_pk_add_f32 v[12:13], v[12:13], v[170:171]
    v_pk_add_f32 v[12:13], v[12:13], v[172:173]
    v_pk_add_f32 v[12:13], v[12:13], v[174:175]
    v_add_f32 v12, v12, v13
    s_nop 1
    v_add_f32_dpp v12, v12, v12 row_ror:8 row_mask:0xf bank_mask:0xf
    v_mov_b32 v13, v12
    s_nop 1
    v_permlane16_swap_b32 v12, v13
    s_nop 0
    v_add_f32 v12, v12, v13
    v_mov_b32 v13, v12
    s_nop 1
    v_permlane32_swap_b32 v12, v13
    s_nop 0
    v_add_f32 v12, v12, v13
    v_mul_f32 v12, 0x3b124925, v12
    v_mov_b32 v14, 0
    v_mov_b32 v15, 0
    v_mov_b32_e64 v13, v12
    v_pk_add_f32 v[16:17], v[120:121], v[12:13] neg_lo:[0,1] neg_hi:[0,1]
    v_pk_fma_f32 v[14:15], v[16:17], v[16:17], v[14:15]
    v_pk_add_f32 v[18:19], v[122:123], v[12:13] neg_lo:[0,1] neg_hi:[0,1]
    v_pk_fma_f32 v[14:15], v[18:19], v[18:19], v[14:15]
    v_pk_add_f32 v[16:17], v[124:125], v[12:13] neg_lo:[0,1] neg_hi:[0,1]
    v_pk_fma_f32 v[14:15], v[16:17], v[16:17], v[14:15]
    v_pk_add_f32 v[18:19], v[126:127], v[12:13] neg_lo:[0,1] neg_hi:[0,1]
    v_pk_fma_f32 v[14:15], v[18:19], v[18:19], v[14:15]
    v_pk_add_f32 v[16:17], v[128:129], v[12:13] neg_lo:[0,1] neg_hi:[0,1]
    v_pk_fma_f32 v[14:15], v[16:17], v[16:17], v[14:15]
    v_pk_add_f32 v[18:19], v[130:131], v[12:13] neg_lo:[0,1] neg_hi:[0,1]
    v_pk_fma_f32 v[14:15], v[18:19], v[18:19], v[14:15]
    v_pk_add_f32 v[16:17], v[132:133], v[12:13] neg_lo:[0,1] neg_hi:[0,1]
    v_pk_fma_f32 v[14:15], v[16:17], v[16:17], v[14:15]
    v_pk_add_f32 v[18:19], v[134:135], v[12:13] neg_lo:[0,1] neg_hi:[0,1]
    v_pk_fma_f32 v[14:15], v[18:19], v[18:19], v[14:15]
    v_pk_add_f32 v[16:17], v[136:137], v[12:13] neg_lo:[0,1] neg_hi:[0,1]
    v_pk_fma_f32 v[14:15], v[16:17], v[16:17], v[14:15]
    v_pk_add_f32 v[18:19], v[138:139], v[12:13] neg_lo:[0,1] neg_hi:[0,1]
    v_pk_fma_f32 v[14:15], v[18:19], v[18:19], v[14:15]
    v_pk_add_f32 v[16:17], v[140:141], v[12:13] neg_lo:[0,1] neg_hi:[0,1]
    v_pk_fma_f32 v[14:15], v[16:17], v[16:17], v[14:15]
    v_pk_add_f32 v[18:19], v[142:143], v[12:13] neg_lo:[0,1] neg_hi:[0,1]
    v_pk_fma_f32 v[14:15], v[18:19], v[18:19], v[14:15]
    v_pk_add_f32 v[16:17], v[144:145], v[12:13] neg_lo:[0,1] neg_hi:[0,1]
    v_pk_fma_f32 v[14:15], v[16:17], v[16:17], v[14:15]
    v_pk_add_f32 v[18:19], v[146:147], v[12:13] neg_lo:[0,1] neg_hi:[0,1]
    v_pk_fma_f32 v[14:15], v[18:19], v[18:19], v[14:15]
    v_pk_add_f32 v[16:17], v[148:149], v[12:13] neg_lo:[0,1] neg_hi:[0,1]
    v_pk_fma_f32 v[14:15], v[16:17], v[16:17], v[14:15]
    v_pk_add_f32 v[18:19], v[150:151], v[12:13] neg_lo:[0,1] neg_hi:[0,1]
    v_pk_fma_f32 v[14:15], v[18:19], v[18:19], v[14:15]
    v_pk_add_f32 v[16:17], v[152:153], v[12:13] neg_lo:[0,1] neg_hi:[0,1]
    v_pk_fma_f32 v[14:15], v[16:17], v[16:17], v[14:15]
    v_pk_add_f32 v[18:19], v[154:155], v[12:13] neg_lo:[0,1] neg_hi:[0,1]
    v_pk_fma_f32 v[14:15], v[18:19], v[18:19], v[14:15]
    v_pk_add_f32 v[16:17], v[156:157], v[12:13] neg_lo:[0,1] neg_hi:[0,1]
    v_pk_fma_f32 v[14:15], v[16:17], v[16:17], v[14:15]
    v_pk_add_f32 v[18:19], v[158:159], v[12:13] neg_lo:[0,1] neg_hi:[0,1]
    v_pk_fma_f32 v[14:15], v[18:19], v[18:19], v[14:15]
    v_pk_add_f32 v[16:17], v[160:161], v[12:13] neg_lo:[0,1] neg_hi:[0,1]
    v_pk_fma_f32 v[14:15], v[16:17], v[16:17], v[14:15]
    v_pk_add_f32 v[18:19], v[162:163], v[12:13] neg_lo:[0,1] neg_hi:[0,1]
    v_pk_fma_f32 v[14:15], v[18:19], v[18:19], v[14:15]
    v_pk_add_f32 v[16:17], v[164:165], v[12:13] neg_lo:[0,1] neg_hi:[0,1]
    v_pk_fma_f32 v[14:15], v[16:17], v[16:17], v[14:15]
    v_pk_add_f32 v[18:19], v[166:167], v[12:13] neg_lo:[0,1] neg_hi:[0,1]
    v_pk_fma_f32 v[14:15], v[18:19], v[18:19], v[14:15]
    v_pk_add_f32 v[16:17], v[168:169], v[12:13] neg_lo:[0,1] neg_hi:[0,1]
    v_pk_fma_f32 v[14:15], v[16:17], v[16:17], v[14:15]
    v_pk_add_f32 v[18:19], v[170:171], v[12:13] neg_lo:[0,1] neg_hi:[0,1]
    v_pk_fma_f32 v[14:15], v[18:19], v[18:19], v[14:15]
    v_pk_add_f32 v[16:17], v[172:173], v[12:13] neg_lo:[0,1] neg_hi:[0,1]
    v_pk_fma_f32 v[14:15], v[16:17], v[16:17], v[14:15]
    v_pk_add_f32 v[18:19], v[174:175], v[12:13] neg_lo:[0,1] neg_hi:[0,1]
    v_pk_fma_f32 v[14:15], v[18:19], v[18:19], v[14:15]
    v_add_f32 v14, v14, v15
    s_nop 1
    v_add_f32_dpp v14, v14, v14 row_ror:8 row_mask:0xf bank_mask:0xf
    v_mov_b32 v15, v14
    s_nop 1
    v_permlane16_swap_b32 v14, v15
    s_nop 0
    v_add_f32 v14, v14, v15
    v_mov_b32 v15, v14
    s_nop 1
    v_permlane32_swap_b32 v14, v15
    s_nop 0
    v_add_f32 v14, v14, v15
    v_mul_f32 v14, 0x3b124925, v14
    v_cvt_pk_bf16_f32 v14, v14, v14
    v_lshlrev_b32_e64 v14, 16, v14
    v_cvt_pk_bf16_f32 v12, v12, v12
    v_lshlrev_b32_e64 v12, 16, v12
    v_add_f32 v14, 0x3727c5ac, v14
    v_cvt_pk_bf16_f32 v14, v14, v14
    v_lshlrev_b32_e64 v14, 16, v14
    v_sqrt_f32 v14, v14
    s_nop 0
    v_cvt_pk_bf16_f32 v14, v14, v14
    v_lshlrev_b32 v14, 16, v14
    v_rcp_f32 v20, v14
    v_mov_b32 v13, v12
    v_mov_b32 v15, v14
    v_mov_b32_e64 v21, v20
    v_pk_add_f32 v[120:121], v[120:121], v[12:13] neg_lo:[0,1] neg_hi:[0,1]
    v_cvt_pk_bf16_f32 v16, v120, v121
    v_lshlrev_b32_e64 v120, 16, v16
    v_and_b32 v121, 0xffff0000, v16
    v_pk_mul_f32 v[18:19], v[120:121], v[20:21]
    v_pk_fma_f32 v[120:121], v[18:19], v[14:15], v[120:121] neg_lo:[1,0,0] neg_hi:[1,0,0]
    v_pk_fma_f32 v[18:19], v[120:121], v[20:21], v[18:19]
    v_cvt_pk_bf16_f32 v92, v18, v19
    v_pk_add_f32 v[122:123], v[122:123], v[12:13] neg_lo:[0,1] neg_hi:[0,1]
    v_cvt_pk_bf16_f32 v16, v122, v123
    v_lshlrev_b32_e64 v122, 16, v16
    v_and_b32 v123, 0xffff0000, v16
    v_pk_mul_f32 v[18:19], v[122:123], v[20:21]
    v_pk_fma_f32 v[122:123], v[18:19], v[14:15], v[122:123] neg_lo:[1,0,0] neg_hi:[1,0,0]
    v_pk_fma_f32 v[18:19], v[122:123], v[20:21], v[18:19]
    v_cvt_pk_bf16_f32 v93, v18, v19
    v_pk_add_f32 v[124:125], v[124:125], v[12:13] neg_lo:[0,1] neg_hi:[0,1]
    v_cvt_pk_bf16_f32 v16, v124, v125
    v_lshlrev_b32_e64 v124, 16, v16
    v_and_b32 v125, 0xffff0000, v16
    v_pk_mul_f32 v[18:19], v[124:125], v[20:21]
    v_pk_fma_f32 v[124:125], v[18:19], v[14:15], v[124:125] neg_lo:[1,0,0] neg_hi:[1,0,0]
    v_pk_fma_f32 v[18:19], v[124:125], v[20:21], v[18:19]
    v_cvt_pk_bf16_f32 v94, v18, v19
    v_pk_add_f32 v[126:127], v[126:127], v[12:13] neg_lo:[0,1] neg_hi:[0,1]
    v_cvt_pk_bf16_f32 v16, v126, v127
    v_lshlrev_b32_e64 v126, 16, v16
    v_and_b32 v127, 0xffff0000, v16
    v_pk_mul_f32 v[18:19], v[126:127], v[20:21]
    v_pk_fma_f32 v[126:127], v[18:19], v[14:15], v[126:127] neg_lo:[1,0,0] neg_hi:[1,0,0]
    v_pk_fma_f32 v[18:19], v[126:127], v[20:21], v[18:19]
    v_cvt_pk_bf16_f32 v95, v18, v19
    v_pk_add_f32 v[128:129], v[128:129], v[12:13] neg_lo:[0,1] neg_hi:[0,1]
    v_cvt_pk_bf16_f32 v16, v128, v129
    v_lshlrev_b32_e64 v128, 16, v16
    v_and_b32 v129, 0xffff0000, v16
    v_pk_mul_f32 v[18:19], v[128:129], v[20:21]
    v_pk_fma_f32 v[128:129], v[18:19], v[14:15], v[128:129] neg_lo:[1,0,0] neg_hi:[1,0,0]
    v_pk_fma_f32 v[18:19], v[128:129], v[20:21], v[18:19]
    v_cvt_pk_bf16_f32 v96, v18, v19
    v_pk_add_f32 v[130:131], v[130:131], v[12:13] neg_lo:[0,1] neg_hi:[0,1]
    v_cvt_pk_bf16_f32 v16, v130, v131
    v_lshlrev_b32_e64 v130, 16, v16
    v_and_b32 v131, 0xffff0000, v16
    v_pk_mul_f32 v[18:19], v[130:131], v[20:21]
    v_pk_fma_f32 v[130:131], v[18:19], v[14:15], v[130:131] neg_lo:[1,0,0] neg_hi:[1,0,0]
    v_pk_fma_f32 v[18:19], v[130:131], v[20:21], v[18:19]
    v_cvt_pk_bf16_f32 v97, v18, v19
    v_pk_add_f32 v[132:133], v[132:133], v[12:13] neg_lo:[0,1] neg_hi:[0,1]
    v_cvt_pk_bf16_f32 v16, v132, v133
    v_lshlrev_b32_e64 v132, 16, v16
    v_and_b32 v133, 0xffff0000, v16
    v_pk_mul_f32 v[18:19], v[132:133], v[20:21]
    v_pk_fma_f32 v[132:133], v[18:19], v[14:15], v[132:133] neg_lo:[1,0,0] neg_hi:[1,0,0]
    v_pk_fma_f32 v[18:19], v[132:133], v[20:21], v[18:19]
    v_cvt_pk_bf16_f32 v98, v18, v19
    v_pk_add_f32 v[134:135], v[134:135], v[12:13] neg_lo:[0,1] neg_hi:[0,1]
    v_cvt_pk_bf16_f32 v16, v134, v135
    v_lshlrev_b32_e64 v134, 16, v16
    v_and_b32 v135, 0xffff0000, v16
    v_pk_mul_f32 v[18:19], v[134:135], v[20:21]
    v_pk_fma_f32 v[134:135], v[18:19], v[14:15], v[134:135] neg_lo:[1,0,0] neg_hi:[1,0,0]
    v_pk_fma_f32 v[18:19], v[134:135], v[20:21], v[18:19]
    v_cvt_pk_bf16_f32 v99, v18, v19
    v_pk_add_f32 v[136:137], v[136:137], v[12:13] neg_lo:[0,1] neg_hi:[0,1]
    v_cvt_pk_bf16_f32 v16, v136, v137
    v_lshlrev_b32_e64 v136, 16, v16
    v_and_b32 v137, 0xffff0000, v16
    v_pk_mul_f32 v[18:19], v[136:137], v[20:21]
    v_pk_fma_f32 v[136:137], v[18:19], v[14:15], v[136:137] neg_lo:[1,0,0] neg_hi:[1,0,0]
    v_pk_fma_f32 v[18:19], v[136:137], v[20:21], v[18:19]
    v_cvt_pk_bf16_f32 v100, v18, v19
    v_pk_add_f32 v[138:139], v[138:139], v[12:13] neg_lo:[0,1] neg_hi:[0,1]
    v_cvt_pk_bf16_f32 v16, v138, v139
    v_lshlrev_b32_e64 v138, 16, v16
    v_and_b32 v139, 0xffff0000, v16
    v_pk_mul_f32 v[18:19], v[138:139], v[20:21]
    v_pk_fma_f32 v[138:139], v[18:19], v[14:15], v[138:139] neg_lo:[1,0,0] neg_hi:[1,0,0]
    v_pk_fma_f32 v[18:19], v[138:139], v[20:21], v[18:19]
    v_cvt_pk_bf16_f32 v101, v18, v19
    v_pk_add_f32 v[140:141], v[140:141], v[12:13] neg_lo:[0,1] neg_hi:[0,1]
    v_cvt_pk_bf16_f32 v16, v140, v141
    v_lshlrev_b32_e64 v140, 16, v16
    v_and_b32 v141, 0xffff0000, v16
    v_pk_mul_f32 v[18:19], v[140:141], v[20:21]
    v_pk_fma_f32 v[140:141], v[18:19], v[14:15], v[140:141] neg_lo:[1,0,0] neg_hi:[1,0,0]
    v_pk_fma_f32 v[18:19], v[140:141], v[20:21], v[18:19]
    v_cvt_pk_bf16_f32 v102, v18, v19
    v_pk_add_f32 v[142:143], v[142:143], v[12:13] neg_lo:[0,1] neg_hi:[0,1]
    v_cvt_pk_bf16_f32 v16, v142, v143
    v_lshlrev_b32_e64 v142, 16, v16
    v_and_b32 v143, 0xffff0000, v16
    v_pk_mul_f32 v[18:19], v[142:143], v[20:21]
    v_pk_fma_f32 v[142:143], v[18:19], v[14:15], v[142:143] neg_lo:[1,0,0] neg_hi:[1,0,0]
    v_pk_fma_f32 v[18:19], v[142:143], v[20:21], v[18:19]
    v_cvt_pk_bf16_f32 v103, v18, v19
    v_pk_add_f32 v[144:145], v[144:145], v[12:13] neg_lo:[0,1] neg_hi:[0,1]
    v_cvt_pk_bf16_f32 v16, v144, v145
    v_lshlrev_b32_e64 v144, 16, v16
    v_and_b32 v145, 0xffff0000, v16
    v_pk_mul_f32 v[18:19], v[144:145], v[20:21]
    v_pk_fma_f32 v[144:145], v[18:19], v[14:15], v[144:145] neg_lo:[1,0,0] neg_hi:[1,0,0]
    v_pk_fma_f32 v[18:19], v[144:145], v[20:21], v[18:19]
    v_cvt_pk_bf16_f32 v104, v18, v19
    v_pk_add_f32 v[146:147], v[146:147], v[12:13] neg_lo:[0,1] neg_hi:[0,1]
    v_cvt_pk_bf16_f32 v16, v146, v147
    v_lshlrev_b32_e64 v146, 16, v16
    v_and_b32 v147, 0xffff0000, v16
    v_pk_mul_f32 v[18:19], v[146:147], v[20:21]
    v_pk_fma_f32 v[146:147], v[18:19], v[14:15], v[146:147] neg_lo:[1,0,0] neg_hi:[1,0,0]
    v_pk_fma_f32 v[18:19], v[146:147], v[20:21], v[18:19]
    v_cvt_pk_bf16_f32 v105, v18, v19
    v_pk_add_f32 v[148:149], v[148:149], v[12:13] neg_lo:[0,1] neg_hi:[0,1]
    v_cvt_pk_bf16_f32 v16, v148, v149
    v_lshlrev_b32_e64 v148, 16, v16
    v_and_b32 v149, 0xffff0000, v16
    v_pk_mul_f32 v[18:19], v[148:149], v[20:21]
    v_pk_fma_f32 v[148:149], v[18:19], v[14:15], v[148:149] neg_lo:[1,0,0] neg_hi:[1,0,0]
    v_pk_fma_f32 v[18:19], v[148:149], v[20:21], v[18:19]
    v_cvt_pk_bf16_f32 v106, v18, v19
    v_pk_add_f32 v[150:151], v[150:151], v[12:13] neg_lo:[0,1] neg_hi:[0,1]
    v_cvt_pk_bf16_f32 v16, v150, v151
    v_lshlrev_b32_e64 v150, 16, v16
    v_and_b32 v151, 0xffff0000, v16
    v_pk_mul_f32 v[18:19], v[150:151], v[20:21]
    v_pk_fma_f32 v[150:151], v[18:19], v[14:15], v[150:151] neg_lo:[1,0,0] neg_hi:[1,0,0]
    v_pk_fma_f32 v[18:19], v[150:151], v[20:21], v[18:19]
    v_cvt_pk_bf16_f32 v107, v18, v19
    v_pk_add_f32 v[152:153], v[152:153], v[12:13] neg_lo:[0,1] neg_hi:[0,1]
    v_cvt_pk_bf16_f32 v16, v152, v153
    v_lshlrev_b32_e64 v152, 16, v16
    v_and_b32 v153, 0xffff0000, v16
    v_pk_mul_f32 v[18:19], v[152:153], v[20:21]
    v_pk_fma_f32 v[152:153], v[18:19], v[14:15], v[152:153] neg_lo:[1,0,0] neg_hi:[1,0,0]
    v_pk_fma_f32 v[18:19], v[152:153], v[20:21], v[18:19]
    v_cvt_pk_bf16_f32 v108, v18, v19
    v_pk_add_f32 v[154:155], v[154:155], v[12:13] neg_lo:[0,1] neg_hi:[0,1]
    v_cvt_pk_bf16_f32 v16, v154, v155
    v_lshlrev_b32_e64 v154, 16, v16
    v_and_b32 v155, 0xffff0000, v16
    v_pk_mul_f32 v[18:19], v[154:155], v[20:21]
    v_pk_fma_f32 v[154:155], v[18:19], v[14:15], v[154:155] neg_lo:[1,0,0] neg_hi:[1,0,0]
    v_pk_fma_f32 v[18:19], v[154:155], v[20:21], v[18:19]
    v_cvt_pk_bf16_f32 v109, v18, v19
    v_pk_add_f32 v[156:157], v[156:157], v[12:13] neg_lo:[0,1] neg_hi:[0,1]
    v_cvt_pk_bf16_f32 v16, v156, v157
    v_lshlrev_b32_e64 v156, 16, v16
    v_and_b32 v157, 0xffff0000, v16
    v_pk_mul_f32 v[18:19], v[156:157], v[20:21]
    v_pk_fma_f32 v[156:157], v[18:19], v[14:15], v[156:157] neg_lo:[1,0,0] neg_hi:[1,0,0]
    v_pk_fma_f32 v[18:19], v[156:157], v[20:21], v[18:19]
    v_cvt_pk_bf16_f32 v110, v18, v19
    v_pk_add_f32 v[158:159], v[158:159], v[12:13] neg_lo:[0,1] neg_hi:[0,1]
    v_cvt_pk_bf16_f32 v16, v158, v159
    v_lshlrev_b32_e64 v158, 16, v16
    v_and_b32 v159, 0xffff0000, v16
    v_pk_mul_f32 v[18:19], v[158:159], v[20:21]
    v_pk_fma_f32 v[158:159], v[18:19], v[14:15], v[158:159] neg_lo:[1,0,0] neg_hi:[1,0,0]
    v_pk_fma_f32 v[18:19], v[158:159], v[20:21], v[18:19]
    v_cvt_pk_bf16_f32 v111, v18, v19
    v_pk_add_f32 v[160:161], v[160:161], v[12:13] neg_lo:[0,1] neg_hi:[0,1]
    v_cvt_pk_bf16_f32 v16, v160, v161
    v_lshlrev_b32_e64 v160, 16, v16
    v_and_b32 v161, 0xffff0000, v16
    v_pk_mul_f32 v[18:19], v[160:161], v[20:21]
    v_pk_fma_f32 v[160:161], v[18:19], v[14:15], v[160:161] neg_lo:[1,0,0] neg_hi:[1,0,0]
    v_pk_fma_f32 v[18:19], v[160:161], v[20:21], v[18:19]
    v_cvt_pk_bf16_f32 v112, v18, v19
    v_pk_add_f32 v[162:163], v[162:163], v[12:13] neg_lo:[0,1] neg_hi:[0,1]
    v_cvt_pk_bf16_f32 v16, v162, v163
    v_lshlrev_b32_e64 v162, 16, v16
    v_and_b32 v163, 0xffff0000, v16
    v_pk_mul_f32 v[18:19], v[162:163], v[20:21]
    v_pk_fma_f32 v[162:163], v[18:19], v[14:15], v[162:163] neg_lo:[1,0,0] neg_hi:[1,0,0]
    v_pk_fma_f32 v[18:19], v[162:163], v[20:21], v[18:19]
    v_cvt_pk_bf16_f32 v113, v18, v19
    v_pk_add_f32 v[164:165], v[164:165], v[12:13] neg_lo:[0,1] neg_hi:[0,1]
    v_cvt_pk_bf16_f32 v16, v164, v165
    v_lshlrev_b32_e64 v164, 16, v16
    v_and_b32 v165, 0xffff0000, v16
    v_pk_mul_f32 v[18:19], v[164:165], v[20:21]
    v_pk_fma_f32 v[164:165], v[18:19], v[14:15], v[164:165] neg_lo:[1,0,0] neg_hi:[1,0,0]
    v_pk_fma_f32 v[18:19], v[164:165], v[20:21], v[18:19]
    v_cvt_pk_bf16_f32 v114, v18, v19
    v_pk_add_f32 v[166:167], v[166:167], v[12:13] neg_lo:[0,1] neg_hi:[0,1]
    v_cvt_pk_bf16_f32 v16, v166, v167
    v_lshlrev_b32_e64 v166, 16, v16
    v_and_b32 v167, 0xffff0000, v16
    v_pk_mul_f32 v[18:19], v[166:167], v[20:21]
    v_pk_fma_f32 v[166:167], v[18:19], v[14:15], v[166:167] neg_lo:[1,0,0] neg_hi:[1,0,0]
    v_pk_fma_f32 v[18:19], v[166:167], v[20:21], v[18:19]
    v_cvt_pk_bf16_f32 v115, v18, v19
    v_pk_add_f32 v[168:169], v[168:169], v[12:13] neg_lo:[0,1] neg_hi:[0,1]
    v_cvt_pk_bf16_f32 v16, v168, v169
    v_lshlrev_b32_e64 v168, 16, v16
    v_and_b32 v169, 0xffff0000, v16
    v_pk_mul_f32 v[18:19], v[168:169], v[20:21]
    v_pk_fma_f32 v[168:169], v[18:19], v[14:15], v[168:169] neg_lo:[1,0,0] neg_hi:[1,0,0]
    v_pk_fma_f32 v[18:19], v[168:169], v[20:21], v[18:19]
    v_cvt_pk_bf16_f32 v116, v18, v19
    v_pk_add_f32 v[170:171], v[170:171], v[12:13] neg_lo:[0,1] neg_hi:[0,1]
    v_cvt_pk_bf16_f32 v16, v170, v171
    v_lshlrev_b32_e64 v170, 16, v16
    v_and_b32 v171, 0xffff0000, v16
    v_pk_mul_f32 v[18:19], v[170:171], v[20:21]
    v_pk_fma_f32 v[170:171], v[18:19], v[14:15], v[170:171] neg_lo:[1,0,0] neg_hi:[1,0,0]
    v_pk_fma_f32 v[18:19], v[170:171], v[20:21], v[18:19]
    v_cvt_pk_bf16_f32 v117, v18, v19
    v_pk_add_f32 v[172:173], v[172:173], v[12:13] neg_lo:[0,1] neg_hi:[0,1]
    v_cvt_pk_bf16_f32 v16, v172, v173
    v_lshlrev_b32_e64 v172, 16, v16
    v_and_b32 v173, 0xffff0000, v16
    v_pk_mul_f32 v[18:19], v[172:173], v[20:21]
    v_pk_fma_f32 v[172:173], v[18:19], v[14:15], v[172:173] neg_lo:[1,0,0] neg_hi:[1,0,0]
    v_pk_fma_f32 v[18:19], v[172:173], v[20:21], v[18:19]
    v_cvt_pk_bf16_f32 v118, v18, v19
    v_pk_add_f32 v[174:175], v[174:175], v[12:13] neg_lo:[0,1] neg_hi:[0,1]
    v_cvt_pk_bf16_f32 v16, v174, v175
    v_lshlrev_b32_e64 v174, 16, v16
    v_and_b32 v175, 0xffff0000, v16
    v_pk_mul_f32 v[18:19], v[174:175], v[20:21]
    v_pk_fma_f32 v[174:175], v[18:19], v[14:15], v[174:175] neg_lo:[1,0,0] neg_hi:[1,0,0]
    v_pk_fma_f32 v[18:19], v[174:175], v[20:21], v[18:19]
    v_cvt_pk_bf16_f32 v119, v18, v19
    s_add_u32 s5, s22, 917504
    buffer_store_dwordx4 v[92:95], v9, s[8:11], s5 offen offset:0 sc1
    buffer_store_dwordx4 v[96:99], v9, s[8:11], s5 offen offset:2048 sc1
    s_add_u32 s5, s5, 4096
    buffer_store_dwordx4 v[100:103], v9, s[8:11], s5 offen offset:0 sc1
    buffer_store_dwordx4 v[104:107], v9, s[8:11], s5 offen offset:2048 sc1
    s_add_u32 s5, s5, 4096
    buffer_store_dwordx4 v[108:111], v9, s[8:11], s5 offen offset:0 sc1
    buffer_store_dwordx4 v[112:115], v9, s[8:11], s5 offen offset:2048 sc1
    s_add_u32 s5, s5, 4096
    buffer_store_dwordx4 v[116:119], v9, s[8:11], s5 offen offset:0 sc1
    s_mov_b32 s31, 2560
    v_mov_b32 v29, 196
    buffer_load_dword v28, v29, s[12:15], 0 offen sc1
PP_DONE:
    s_mov_b32 s27, 0
    s_nop 0
PP_WZ:
    s_add_u32 s27, s27, 1
    s_nop 0
    s_cmp_gt_u32 s27, 65536
    s_cbranch_scc1 CH_FAIL
    s_waitcnt vmcnt(0)
    v_cmp_eq_u32_e64 vcc, 0, v28
    s_cbranch_vccz PP_WZ_OK
    s_sleep 4
    buffer_load_dword v28, v29, s[12:15], 0 offen sc1
    s_branch PP_WZ
    s_nop 0
PP_WZ_OK:
    s_waitcnt vmcnt(0)
    s_barrier
    s_cmp_lg_u32 s16, 0
    s_cbranch_scc1 SIG_4
    s_add_u32 s68, s31, 85131264
    s_mov_b64 exec, 1
    v_mov_b32 v254, 0
    v_mov_b32_e64 v255, 1
    buffer_atomic_add v255, v254, s[8:11], s68 offen
    s_mov_b64 exec, -1
    s_nop 0
SIG_4:
    v_mov_b32 v6, 163776
    s_cmp_lg_u32 s16, 0
    s_cbranch_scc1 EL_WAIT
    s_mov_b32 s18, 0
    v_lshlrev_b32 v5, 2, v0
    v_min_u32 v5, 124, v5
    s_cmp_lt_u32 s17, 32
    s_cbranch_scc1 EL_PUT
EL_POLL0:
    s_mov_b64 exec, -1
    s_mov_b32 s27, 0
EL_POLL:
    buffer_load_dword v2, v5, s[12:15], 0 offen sc1
    s_add_u32 s27, s27, 1
    s_waitcnt vmcnt(0)
    v_cmp_eq_u32_e64 vcc, 0, v2
    v_readlane_b32 s30, v2, 31
    s_nop 2
    s_nop 0
    s_cmp_eq_u32 s30, 0xffff
    s_cbranch_scc1 EL_FALL
    s_cmp_eq_u32 vcc_lo, 0
    s_cbranch_scc1 EL_FAST
    s_sleep 2
    s_cmp_lt_u32 s27, 400
    s_cbranch_scc1 EL_POLL
    s_mov_b64 exec, 1
    v_mov_b32 v2, 0xffff
    v_mov_b32_e64 v3, 0
    v_mov_b32 v4, 124
    buffer_atomic_cmpswap v[2:3], v4, s[12:15], 0 offen
    s_branch EL_POLL0
    s_nop 0
EL_FALL:
    s_mov_b32 s17, s2
    s_mov_b32 s18, 1
    s_branch EL_PUT
    s_nop 0
EL_FAST:
    v_cmp_ge_u32_e64 vcc, s2, v2
    s_nop 3
    s_bcnt1_i32_b32 s30, vcc_lo
    s_sub_u32 s17, s2, s30
    s_add_u32 s17, s17, 32
EL_PUT:
    v_mov_b32 v2, s17
    v_mov_b32 v3, s18
    ds_write_b64 v6, v[2:3]
    s_nop 0
    s_waitcnt lgkmcnt(0)
EL_WAIT:
    s_nop 0
    s_barrier
    ds_read_b64 v[2:3], v6
    s_waitcnt lgkmcnt(0)
    v_readfirstlane_b32 s17, v2
    v_readfirstlane_b32 s18, v3
    s_mov_b32 s93, s17
CH_DISPATCH:
    s_mov_b32 s45, 0
    s_mov_b32 s40, 0
    s_cmp_ge_u32 s17, 32
    s_cbranch_scc1 WORKER
    s_cmp_ge_u32 s17, 30
    s_cbranch_scc1 SPR
    s_sub_u32 s28, s17, 16
    s_cmp_ge_u32 s17, 16
    s_cbranch_scc1 VA
    s_mov_b32 s28, s17
    s_cmp_eq_u32 s16, 1
    s_cbranch_scc1 SC1
    s_cmp_eq_u32 s16, 2
    s_cbranch_scc1 SC2
    s_cmp_eq_u32 s16, 3
    s_cbranch_scc1 SC3
SC0:
    v_and_b32 v1, 63, v0
    v_lshlrev_b32 v2, 4, v1
    v_mov_b32 v3, 0x4444
    v_mov_b32 v4, 0xeeee
    v_and_b32 v5, 8, v1
    v_cmp_ne_u32 vcc, 0, v5
    s_nop 1
    v_cndmask_b32 v3, v3, v4, vcc
    s_mul_i32 s25, s28, 401408
    s_add_u32 s25, s25, 2097152
    v_add_u32 v12, 45056, v2
    s_lshl_b32 s26, s28, 7
    v_mov_b32 v5, 0
    s_add_u32 s30, s26, 85137408
    s_mov_b32 s27, 0
    s_nop 0
SC0_WW:
    buffer_load_dword v4, v5, s[8:11], s30 offen sc1
    s_add_u32 s27, s27, 1
    s_nop 0
    s_cmp_gt_u32 s27, 65536
    s_cbranch_scc1 CH_FAIL
    s_waitcnt vmcnt(0)
    v_cmp_le_u32 vcc, 7, v4
    s_cbranch_vccnz SC0_WW_OK
    s_sleep 2
    s_branch SC0_WW
SC0_WW_OK:
    s_mov_b32 m0, 45056
    s_add_u32 s29, s25, 16384
    buffer_load_dwordx4 v2, s[8:11], s29 offen sc1 lds
    buffer_load_dwordx4 v2, s[8:11], s29 offen offset:1024 sc1 lds
    s_mov_b32 m0, 47104
    s_add_u32 s29, s25, 73728
    buffer_load_dwordx4 v2, s[8:11], s29 offen sc1 lds
    buffer_load_dwordx4 v2, s[8:11], s29 offen offset:1024 sc1 lds
    s_mov_b32 m0, 49152
    s_add_u32 s29, s25, 6144
    buffer_load_dwordx4 v2, s[8:11], s29 offen sc1 lds
    buffer_load_dwordx4 v2, s[8:11], s29 offen offset:1024 sc1 lds
    s_mov_b32 m0, 51200
    s_add_u32 s29, s25, 12288
    buffer_load_dwordx4 v2, s[8:11], s29 offen sc1 lds
    buffer_load_dwordx4 v2, s[8:11], s29 offen offset:1024 sc1 lds
    s_mov_b32 m0, 53248
    s_add_u32 s29, s25, 63488
    buffer_load_dwordx4 v2, s[8:11], s29 offen sc1 lds
    buffer_load_dwordx4 v2, s[8:11], s29 offen offset:1024 sc1 lds
    s_mov_b32 m0, 55296
    s_add_u32 s29, s25, 94208
    buffer_load_dwordx4 v2, s[8:11], s29 offen sc1 lds
    buffer_load_dwordx4 v2, s[8:11], s29 offen offset:1024 sc1 lds
    s_add_u32 s29, s25, 0
    s_nop 0
    buffer_load_dwordx4 a[0:3], v2, s[8:11], s29 offen sc1
    buffer_load_dwordx4 a[4:7], v2, s[8:11], s29 offen offset:1024 sc1
    s_add_u32 s29, s25, 14336
    buffer_load_dwordx4 a[8:11], v2, s[8:11], s29 offen sc1
    buffer_load_dwordx4 a[12:15], v2, s[8:11], s29 offen offset:1024 sc1
    s_add_u32 s29, s25, 28672
    buffer_load_dwordx4 a[16:19], v2, s[8:11], s29 offen sc1
    buffer_load_dwordx4 a[20:23], v2, s[8:11], s29 offen offset:1024 sc1
    s_add_u32 s29, s25, 43008
    buffer_load_dwordx4 a[24:27], v2, s[8:11], s29 offen sc1
    buffer_load_dwordx4 a[28:31], v2, s[8:11], s29 offen offset:1024 sc1
    s_add_u32 s29, s25, 57344
    buffer_load_dwordx4 a[32:35], v2, s[8:11], s29 offen sc1
    buffer_load_dwordx4 a[36:39], v2, s[8:11], s29 offen offset:1024 sc1
    s_add_u32 s29, s25, 71680
    buffer_load_dwordx4 a[40:43], v2, s[8:11], s29 offen sc1
    buffer_load_dwordx4 a[44:47], v2, s[8:11], s29 offen offset:1024 sc1
    s_add_u32 s29, s25, 86016
    buffer_load_dwordx4 a[48:51], v2, s[8:11], s29 offen sc1
    buffer_load_dwordx4 a[52:55], v2, s[8:11], s29 offen offset:1024 sc1
    s_add_u32 s29, s25, 2048
    buffer_load_dwordx4 a[56:59], v2, s[8:11], s29 offen sc1
    buffer_load_dwordx4 a[60:63], v2, s[8:11], s29 offen offset:1024 sc1
    s_add_u32 s29, s25, 30720
    buffer_load_dwordx4 a[64:67], v2, s[8:11], s29 offen sc1
    buffer_load_dwordx4 a[68:71], v2, s[8:11], s29 offen offset:1024 sc1
    s_add_u32 s29, s25, 45056
    buffer_load_dwordx4 a[72:75], v2, s[8:11], s29 offen sc1
    buffer_load_dwordx4 a[76:79], v2, s[8:11], s29 offen offset:1024 sc1
    s_add_u32 s29, s25, 59392
    buffer_load_dwordx4 a[80:83], v2, s[8:11], s29 offen sc1
    buffer_load_dwordx4 a[84:87], v2, s[8:11], s29 offen offset:1024 sc1
    s_add_u32 s29, s25, 88064
    buffer_load_dwordx4 a[88:91], v2, s[8:11], s29 offen sc1
    buffer_load_dwordx4 a[92:95], v2, s[8:11], s29 offen offset:1024 sc1
    s_nop 0
    s_waitcnt vmcnt(24)
    s_add_u32 s29, s25, 4096
    buffer_load_dwordx4 a[96:99], v2, s[8:11], s29 offen sc1
    buffer_load_dwordx4 a[100:103], v2, s[8:11], s29 offen offset:1024 sc1
    s_add_u32 s29, s25, 18432
    buffer_load_dwordx4 a[104:107], v2, s[8:11], s29 offen sc1
    buffer_load_dwordx4 a[108:111], v2, s[8:11], s29 offen offset:1024 sc1
    s_add_u32 s29, s25, 20480
    buffer_load_dwordx4 a[112:115], v2, s[8:11], s29 offen sc1
    buffer_load_dwordx4 a[116:119], v2, s[8:11], s29 offen offset:1024 sc1
    s_add_u32 s29, s25, 8192
    buffer_load_dwordx4 a[120:123], v2, s[8:11], s29 offen sc1
    buffer_load_dwordx4 a[124:127], v2, s[8:11], s29 offen offset:1024 sc1
    s_add_u32 s29, s25, 22528
    buffer_load_dwordx4 a[128:131], v2, s[8:11], s29 offen sc1
    buffer_load_dwordx4 a[132:135], v2, s[8:11], s29 offen offset:1024 sc1
    s_add_u32 s29, s25, 10240
    buffer_load_dwordx4 a[136:139], v2, s[8:11], s29 offen sc1
    buffer_load_dwordx4 a[140:143], v2, s[8:11], s29 offen offset:1024 sc1
    s_add_u32 s29, s25, 24576
    buffer_load_dwordx4 a[144:147], v2, s[8:11], s29 offen sc1
    buffer_load_dwordx4 a[148:151], v2, s[8:11], s29 offen offset:1024 sc1
    s_add_u32 s29, s25, 26624
    buffer_load_dwordx4 a[152:155], v2, s[8:11], s29 offen sc1
    buffer_load_dwordx4 a[156:159], v2, s[8:11], s29 offen offset:1024 sc1
    s_add_u32 s29, s25, 32768
    buffer_load_dwordx4 a[160:163], v2, s[8:11], s29 offen sc1
    buffer_load_dwordx4 a[164:167], v2, s[8:11], s29 offen offset:1024 sc1
    s_add_u32 s29, s25, 47104
    buffer_load_dwordx4 a[168:171], v2, s[8:11], s29 offen sc1
    buffer_load_dwordx4 a[172:175], v2, s[8:11], s29 offen offset:1024 sc1
    s_add_u32 s29, s25, 34816
    buffer_load_dwordx4 a[176:179], v2, s[8:11], s29 offen sc1
    buffer_load_dwordx4 a[180:183], v2, s[8:11], s29 offen offset:1024 sc1
    s_add_u32 s29, s25, 49152
    buffer_load_dwordx4 a[184:187], v2, s[8:11], s29 offen sc1
    buffer_load_dwordx4 a[188:191], v2, s[8:11], s29 offen offset:1024 sc1
    s_nop 0
    s_waitcnt vmcnt(24)
    s_add_u32 s29, s25, 36864
    buffer_load_dwordx4 a[192:195], v2, s[8:11], s29 offen sc1
    buffer_load_dwordx4 a[196:199], v2, s[8:11], s29 offen offset:1024 sc1
    s_add_u32 s29, s25, 51200
    buffer_load_dwordx4 a[200:203], v2, s[8:11], s29 offen sc1
    buffer_load_dwordx4 a[204:207], v2, s[8:11], s29 offen offset:1024 sc1
    s_add_u32 s29, s25, 38912
    buffer_load_dwordx4 a[208:211], v2, s[8:11], s29 offen sc1
    buffer_load_dwordx4 a[212:215], v2, s[8:11], s29 offen offset:1024 sc1
    s_add_u32 s29, s25, 53248
    buffer_load_dwordx4 a[216:219], v2, s[8:11], s29 offen sc1
    buffer_load_dwordx4 a[220:223], v2, s[8:11], s29 offen offset:1024 sc1
    s_add_u32 s29, s25, 40960
    buffer_load_dwordx4 a[224:227], v2, s[8:11], s29 offen sc1
    buffer_load_dwordx4 a[228:231], v2, s[8:11], s29 offen offset:1024 sc1
    s_add_u32 s29, s25, 55296
    buffer_load_dwordx4 a[232:235], v2, s[8:11], s29 offen sc1
    buffer_load_dwordx4 a[236:239], v2, s[8:11], s29 offen offset:1024 sc1
    s_add_u32 s29, s25, 61440
    buffer_load_dwordx4 a[240:243], v2, s[8:11], s29 offen sc1
    buffer_load_dwordx4 a[244:247], v2, s[8:11], s29 offen offset:1024 sc1
    s_add_u32 s29, s25, 75776
    buffer_load_dwordx4 a[248:251], v2, s[8:11], s29 offen sc1
    buffer_load_dwordx4 a[252:255], v2, s[8:11], s29 offen offset:1024 sc1
    s_add_u32 s29, s25, 77824
    buffer_load_dwordx4 v[168:171], v2, s[8:11], s29 offen sc1
    buffer_load_dwordx4 v[172:175], v2, s[8:11], s29 offen offset:1024 sc1
    s_add_u32 s29, s25, 65536
    buffer_load_dwordx4 v[176:179], v2, s[8:11], s29 offen sc1
    buffer_load_dwordx4 v[180:183], v2, s[8:11], s29 offen offset:1024 sc1
    s_add_u32 s29, s25, 79872
    buffer_load_dwordx4 v[184:187], v2, s[8:11], s29 offen sc1
    buffer_load_dwordx4 v[188:191], v2, s[8:11], s29 offen offset:1024 sc1
    s_add_u32 s29, s25, 67584
    buffer_load_dwordx4 v[192:195], v2, s[8:11], s29 offen sc1
    buffer_load_dwordx4 v[196:199], v2, s[8:11], s29 offen offset:1024 sc1
    s_nop 0
    s_waitcnt vmcnt(24)
    s_add_u32 s29, s25, 81920
    buffer_load_dwordx4 v[200:203], v2, s[8:11], s29 offen sc1
    buffer_load_dwordx4 v[204:207], v2, s[8:11], s29 offen offset:1024 sc1
    s_add_u32 s29, s25, 69632
    buffer_load_dwordx4 v[208:211], v2, s[8:11], s29 offen sc1
    buffer_load_dwordx4 v[212:215], v2, s[8:11], s29 offen offset:1024 sc1
    s_add_u32 s29, s25, 83968
    buffer_load_dwordx4 v[216:219], v2, s[8:11], s29 offen sc1
    buffer_load_dwordx4 v[220:223], v2, s[8:11], s29 offen offset:1024 sc1
    s_add_u32 s29, s25, 90112
    buffer_load_dwordx4 v[224:227], v2, s[8:11], s29 offen sc1
    buffer_load_dwordx4 v[228:231], v2, s[8:11], s29 offen offset:1024 sc1
    s_add_u32 s29, s25, 92160
    buffer_load_dwordx4 v[232:235], v2, s[8:11], s29 offen sc1
    buffer_load_dwordx4 v[236:239], v2, s[8:11], s29 offen offset:1024 sc1
    s_add_u32 s29, s25, 96256
    buffer_load_dwordx4 v[240:243], v2, s[8:11], s29 offen sc1
    buffer_load_dwordx4 v[244:247], v2, s[8:11], s29 offen offset:1024 sc1
    s_add_u32 s29, s25, 98304
    buffer_load_dwordx4 v[248:251], v2, s[8:11], s29 offen sc1
    buffer_load_dwordx4 v[252:255], v2, s[8:11], s29 offen offset:1024 sc1
    v_and_b32 v4, 3, v1
    v_lshrrev_b32 v5, 2, v1
    v_mul_u32_u24 v7, 192, v4
    v_lshl_add_u32 v7, v5, 3, v7
    v_add_u32 v7, 0, v7
    v_and_b32 v4, 15, v1
    v_lshrrev_b32_e64 v5, 4, v1
    v_mul_u32_u24 v6, 192, v5
    v_lshl_add_u32 v6, v4, 3, v6
    v_add_u32 v6, 0, v6
    v_and_b32 v164, 7, v4
    v_mul_u32_u24 v8, 208, v164
    v_add_u32 v8, 21504, v8
    v_lshrrev_b32_e64 v164, 3, v4
    v_lshl_add_u32 v9, v5, 3, v8
    v_lshl_add_u32 v9, v164, 2, v9
    v_lshl_add_u32 v8, v5, 4, v8
    v_lshl_add_u32 v8, v164, 6, v8
    v_mov_b32 v164, 0xf149f2ca
    ds_write_b32 v9, v164 offset:160
    v_and_b32 v4, 31, v1
    v_lshrrev_b32 v5, 5, v1
    v_bfe_u32 v128, v4, 3, 1
    v_lshlrev_b32_e64 v128, 3, v128
    v_bfe_u32 v129, v4, 2, 1
    v_lshl_add_u32 v128, v129, 1, v128
    v_bfe_u32 v129, v4, 1, 1
    v_lshl_add_u32 v128, v129, 2, v128
    v_and_b32_e64 v129, 1, v4
    v_lshl_add_u32 v128, v129, 4, v128
    v_min_u32 v129, 23, v4
    v_lshlrev_b32 v129, 1, v129
    v_cmp_gt_u32 vcc, 16, v4
    s_nop 1
    v_cndmask_b32 v10, v129, v128, vcc
    v_lshlrev_b32 v10, 2, v10
    v_mul_u32_u24 v164, 208, v5
    v_add3_u32 v10, v10, v164, 0
    v_add_u32 v10, 21504, v10
    v_add_u32 v5, 0, v5
    v_lshrrev_b32 v130, 2, v4
    v_lshlrev_b32_e64 v130, 7, v130
    v_lshl_add_u32 v130, v5, 4, v130
    v_and_b32_e64 v129, 3, v4
    v_lshl_add_u32 v130, v129, 2, v130
    s_and_b32 s29, s28, 3
    s_lshl_b32 s29, s29, 9
    v_add_u32 v130, s29, v130
    v_subrev_u32 v129, 16, v4
    v_lshlrev_b32 v129, 4, v129
    v_add_u32 v129, v129, v5
    s_and_b32 s29, s28, 1
    s_lshl_b32 s29, s29, 3
    v_add_u32 v129, s29, v129
    v_lshlrev_b32 v129, 3, v129
    s_bfe_u32 s29, s28, 0x10001
    s_lshl_b32 s29, s29, 2
    s_nop 0
    s_add_u32 s29, s29, 2048
    v_add_u32_e64 v129, s29, v129
    v_cmp_gt_u32 vcc, 16, v4
    s_nop 1
    v_cndmask_b32 v11, v129, v130, vcc
    s_lshr_b32 s29, s28, 2
    s_mul_i32 s29, s29, 2560
    v_add_u32 v11, s29, v11
    v_mov_b32 v129, 0x40000000
    v_cmp_gt_u32 vcc, 20, v4
    s_nop 1
    v_cndmask_b32 v11, v129, v11, vcc
    v_mov_b32 v104, 0
    v_mov_b32 v105, 0
    v_mov_b32 v106, 0
    v_mov_b32 v107, 0
    v_mov_b32 v108, 0
    v_mov_b32 v109, 0
    v_mov_b32 v110, 0
    v_mov_b32 v111, 0
    v_mov_b32 v112, 0
    v_mov_b32 v113, 0
    v_mov_b32 v114, 0
    v_mov_b32 v115, 0
    v_mov_b32 v116, 0
    v_mov_b32 v117, 0
    v_mov_b32 v118, 0
    v_mov_b32 v119, 0
    v_mov_b32 v120, 0
    v_mov_b32 v121, 0
    v_mov_b32 v122, 0
    v_mov_b32 v123, 0
    v_mov_b32 v124, 0
    v_mov_b32 v125, 0
    v_mov_b32 v126, 0
    v_mov_b32 v127, 0
    s_mov_b32 s19, 0
    s_mov_b32 s20, 83886080
    s_mov_b32 s21, 83890176
    s_mov_b32 s22, 84443136
    s_mov_b32 s23, 0
    s_add_u32 s29, s28, 0
    s_and_b32 s29, s29, 7
    s_lshl_b32 s70, s29, 10
    s_lshr_b32 s30, s29, 2
    s_nop 0
    s_mul_i32 s30, s30, 10240
    s_add_u32 s78, s70, s30
    s_nop 0
    s_add_u32 s70, s70, 110592
    s_add_u32 s29, s28, 1
    s_and_b32 s29, s29, 7
    s_lshl_b32 s71, s29, 10
    s_lshr_b32 s30, s29, 2
    s_mul_i32 s30, s30, 10240
    s_add_u32 s79, s71, s30
    s_nop 0
    s_add_u32 s71, s71, 110592
    s_add_u32 s29, s28, 2
    s_and_b32 s29, s29, 7
    s_lshl_b32 s72, s29, 10
    s_lshr_b32 s30, s29, 2
    s_mul_i32 s30, s30, 10240
    s_add_u32 s80, s72, s30
    s_nop 0
    s_add_u32 s72, s72, 110592
    s_add_u32 s29, s28, 3
    s_and_b32 s29, s29, 7
    s_lshl_b32 s73, s29, 10
    s_lshr_b32 s30, s29, 2
    s_mul_i32 s30, s30, 10240
    s_add_u32 s81, s73, s30
    s_nop 0
    s_add_u32 s73, s73, 110592
    s_add_u32 s29, s28, 4
    s_and_b32 s29, s29, 7
    s_lshl_b32 s74, s29, 10
    s_lshr_b32 s30, s29, 2
    s_mul_i32 s30, s30, 10240
    s_add_u32 s82, s74, s30
    s_nop 0
    s_add_u32 s74, s74, 110592
    s_add_u32 s29, s28, 5
    s_and_b32 s29, s29, 7
    s_lshl_b32 s75, s29, 10
    s_lshr_b32 s30, s29, 2
    s_mul_i32 s30, s30, 10240
    s_add_u32 s83, s75, s30
    s_nop 0
    s_add_u32 s75, s75, 110592
    s_add_u32 s29, s28, 6
    s_and_b32 s29, s29, 7
    s_lshl_b32 s76, s29, 10
    s_lshr_b32 s30, s29, 2
    s_mul_i32 s30, s30, 10240
    s_add_u32 s84, s76, s30
    s_nop 0
    s_add_u32 s76, s76, 110592
    s_add_u32 s29, s28, 7
    s_and_b32 s29, s29, 7
    s_lshl_b32 s77, s29, 10
    s_lshr_b32 s30, s29, 2
    s_mul_i32 s30, s30, 10240
    s_add_u32 s85, s77, s30
    s_nop 0
    s_add_u32 s77, s77, 110592
    v_add_u32 v13, 110592, v2
    v_mov_b32_e64 v14, 0x40000000
    v_cmp_eq_u32 vcc, 0, v1
    s_nop 1
    v_cndmask_b32 v14, v14, v1, vcc
    s_lshr_b32 s24, s28, 2
    s_lshl_b32 s24, s24, 7
    s_and_b32 s29, s28, 3
    s_lshl_b32 s29, s29, 2
    s_add_u32 s24, s24, s29
    s_add_u32 s24, s24, 85098496
    v_mov_b32_e64 v5, 0
    s_mov_b32 s30, 85133824
    s_mov_b32 s27, 0
    s_nop 0
SC0_WX:
    buffer_load_dword v4, v5, s[8:11], s30 offen sc1
    s_add_u32 s27, s27, 1
    s_nop 0
    s_cmp_gt_u32 s27, 65536
    s_cbranch_scc1 CH_FAIL
    s_waitcnt vmcnt(0)
    v_cmp_le_u32 vcc, 32, v4
    s_cbranch_vccnz SC0_WX_OK
    s_sleep 4
    s_branch SC0_WX
SC0_WX_OK:
    s_mov_b32 m0, s70
    s_add_u32 s26, s23, s78
    buffer_load_dwordx4 v2, s[8:11], s26 offen sc1 lds
    s_mov_b32 m0, s71
    s_add_u32 s26, s23, s79
    buffer_load_dwordx4 v2, s[8:11], s26 offen sc1 lds
    s_mov_b32 m0, s72
    s_add_u32 s26, s23, s80
    buffer_load_dwordx4 v2, s[8:11], s26 offen sc1 lds
    s_mov_b32 m0, s73
    s_add_u32 s26, s23, s81
    buffer_load_dwordx4 v2, s[8:11], s26 offen sc1 lds
    s_mov_b32 m0, s74
    s_add_u32 s26, s23, s82
    buffer_load_dwordx4 v2, s[8:11], s26 offen sc1 lds
    s_mov_b32 m0, s75
    s_add_u32 s26, s23, s83
    buffer_load_dwordx4 v2, s[8:11], s26 offen sc1 lds
    s_mov_b32 m0, s76
    s_add_u32 s26, s23, s84
    buffer_load_dwordx4 v2, s[8:11], s26 offen sc1 lds
    s_mov_b32 m0, s77
    s_add_u32 s26, s23, s85
    buffer_load_dwordx4 v2, s[8:11], s26 offen sc1 lds
    s_add_u32 s23, s23, 28672
    s_nop 0
    s_waitcnt vmcnt(0) lgkmcnt(0)
    s_cmp_lg_u32 s18, 0
    s_cbranch_scc1 SC0_CF_OK
    v_mov_b32 v5, 124
    s_mov_b32 s27, 0
    s_nop 0
SC0_CF:
    buffer_load_dword v4, v5, s[12:15], 0 offen sc1
    s_add_u32 s27, s27, 1
    s_waitcnt vmcnt(0)
    v_readfirstlane_b32 s30, v4
    s_nop 3
    s_cmp_eq_u32 s30, 0xffff
    s_cbranch_scc1 CH_REDO
    s_cmp_lg_u32 s30, 0
    s_cbranch_scc1 SC0_CF_OK
    s_sleep 2
    s_cmp_lt_u32 s27, 400
    s_cbranch_scc1 SC0_CF
    s_mov_b64 exec, 1
    v_mov_b32 v44, 0xffff
    v_mov_b32_e64 v45, 0
    buffer_atomic_cmpswap v[44:45], v5, s[12:15], 0 offen
    s_mov_b64 exec, -1
    s_mov_b32 s27, 0
    s_branch SC0_CF
    s_nop 0
SC0_CF_OK:
    s_barrier
    s_cmp_eq_u32 s18, 0
    s_cbranch_scc0 SC0_LOOP1
.p2align 7
SC0_LOOP0:
    ds_read_b128 v[140:143], v12 offset:0
    ds_read_b128 v[144:147], v12 offset:1024
    ds_read_b128 v[148:151], v12 offset:2048
    ds_read_b128 v[152:155], v12 offset:3072
    ds_read_b128 v[156:159], v12 offset:4096
    ds_read_b128 v[160:163], v12 offset:5120
    v_mov_b32 v44, 0
    v_mov_b32 v45, 0
    v_mov_b32 v46, 0
    v_mov_b32 v47, 0
    v_mov_b32 v48, 0
    v_mov_b32 v49, 0
    v_mov_b32 v50, 0
    v_mov_b32 v51, 0
    v_mov_b32 v52, 0
    v_mov_b32 v53, 0
    v_mov_b32 v54, 0
    v_mov_b32 v55, 0
    v_mov_b32 v56, 0
    v_mov_b32 v57, 0
    v_mov_b32 v58, 0
    v_mov_b32 v59, 0
    v_mov_b32 v60, 0
    v_mov_b32 v61, 0
    v_mov_b32 v62, 0
    v_mov_b32 v63, 0
    v_mov_b32 v64, 0
    v_mov_b32 v65, 0
    v_mov_b32 v66, 0
    v_mov_b32 v67, 0
    v_mov_b32 v68, 0
    v_mov_b32 v69, 0
    v_mov_b32 v70, 0
    v_mov_b32 v71, 0
    v_mov_b32 v136, 0
    v_mov_b32 v137, 0
    v_mov_b32_e64 v138, 0
    v_mov_b32 v139, 0
    s_waitcnt vmcnt(0)
    ds_read_b128 v[72:75], v13 offset:0
    ds_read_b128 v[76:79], v13 offset:1024
    ds_read_b128 v[80:83], v13 offset:2048
    ds_read_b128 v[84:87], v13 offset:3072
    ds_read_b128 v[88:91], v13 offset:4096
    ds_read_b128 v[92:95], v13 offset:5120
    ds_read_b128 v[96:99], v13 offset:6144
    ds_read_b128 v[100:103], v13 offset:7168
    s_mov_b32 s27, 0
    s_nop 0
    buffer_load_dwordx4 v[16:19], v2, s[8:11], s20 offen offset:0 sc1
    buffer_load_dwordx4 v[20:23], v2, s[8:11], s20 offen offset:1024 sc1
    s_nop 15
    s_nop 15
SC0_LOOP0_POLL:
    buffer_load_dwordx4 v[16:19], v2, s[8:11], s20 offen offset:0 sc1
    buffer_load_dwordx4 v[20:23], v2, s[8:11], s20 offen offset:1024 sc1
    s_add_u32 s27, s27, 1
    s_nop 0
    s_cmp_gt_u32 s27, 65536
    s_cbranch_scc1 CH_FAIL
    s_waitcnt vmcnt(2)
    v_max3_u32 v4, v16, v17, v18
    v_max3_u32 v4, v4, v19, v20
    v_max3_u32 v4, v4, v21, v22
    v_max_u32_e64 v4, v4, v23
    v_cmp_eq_u32 vcc, -1, v4
    s_cbranch_vccnz SC0_LOOP0_POLL
    ds_write_b128 v2, v[16:19] offset:36864
    ds_write_b128 v2, v[20:23] offset:37888
    v_smfmac_f32_16x16x64_bf16 v[44:47], v[16:19], a[0:7], v3
    v_smfmac_f32_16x16x64_bf16 v[48:51], v[16:19], a[8:15], v3
    v_smfmac_f32_16x16x64_bf16 v[52:55], v[16:19], a[16:23], v3
    v_smfmac_f32_16x16x64_bf16 v[56:59], v[16:19], a[24:31], v3
    v_smfmac_f32_16x16x64_bf16 v[60:63], v[16:19], a[32:39], v3
    v_smfmac_f32_16x16x64_bf16 v[64:67], v[16:19], a[40:47], v3
    s_waitcnt lgkmcnt(0)
    s_barrier
    ds_read_b128 v[24:27], v2 offset:38912
    ds_read_b128 v[28:31], v2 offset:39936
    ds_read_b128 v[32:35], v2 offset:40960
    ds_read_b128 v[36:39], v2 offset:41984
    ds_read_b128 v[40:43], v2 offset:43008
    v_smfmac_f32_16x16x64_bf16 v[68:71], v[16:19], a[48:55], v3
    v_smfmac_f32_16x16x64_bf16 v[44:47], v[20:23], a[56:63], v3
    v_smfmac_f32_16x16x64_bf16 v[48:51], v[20:23], v[140:147], v3
    ds_read_b128 v[140:143], v12 offset:6144
    v_smfmac_f32_16x16x64_bf16 v[52:55], v[20:23], a[64:71], v3
    ds_read_b128 v[144:147], v12 offset:7168
    v_smfmac_f32_16x16x64_bf16 v[56:59], v[20:23], a[72:79], v3
    v_smfmac_f32_16x16x64_bf16 v[60:63], v[20:23], a[80:87], v3
    v_smfmac_f32_16x16x64_bf16 v[64:67], v[20:23], v[148:155], v3
    ds_read_b128 v[148:151], v12 offset:8192
    v_smfmac_f32_16x16x64_bf16 v[68:71], v[20:23], a[88:95], v3
    ds_read_b128 v[152:155], v12 offset:9216
    s_nop 0
    s_waitcnt lgkmcnt(8)
    v_smfmac_f32_16x16x64_bf16 v[44:47], v[24:27], a[96:103], v3
    v_smfmac_f32_16x16x64_bf16 v[48:51], v[24:27], a[104:111], v3
    s_nop 0
    s_waitcnt lgkmcnt(7)
    v_smfmac_f32_16x16x64_bf16 v[44:47], v[28:31], v[156:163], v3
    ds_read_b128 v[156:159], v12 offset:10240
    v_smfmac_f32_16x16x64_bf16 v[48:51], v[28:31], a[112:119], v3
    ds_read_b128 v[160:163], v12 offset:11264
    s_nop 0
    s_waitcnt lgkmcnt(8)
    v_smfmac_f32_16x16x64_bf16 v[44:47], v[32:35], a[120:127], v3
    v_smfmac_f32_16x16x64_bf16 v[48:51], v[32:35], a[128:135], v3
    s_nop 0
    s_waitcnt lgkmcnt(7)
    v_smfmac_f32_16x16x64_bf16 v[44:47], v[36:39], a[136:143], v3
    v_smfmac_f32_16x16x64_bf16 v[48:51], v[36:39], a[144:151], v3
    s_waitcnt lgkmcnt(6)
    s_waitcnt lgkmcnt(4)
    v_smfmac_f32_16x16x64_bf16 v[44:47], v[40:43], v[140:147], v3
    v_smfmac_f32_16x16x64_bf16 v[48:51], v[40:43], a[152:159], v3
    v_smfmac_f32_16x16x64_bf16 v[52:55], v[24:27], a[160:167], v3
    v_smfmac_f32_16x16x64_bf16 v[56:59], v[24:27], a[168:175], v3
    v_smfmac_f32_16x16x64_bf16 v[52:55], v[28:31], a[176:183], v3
    v_smfmac_f32_16x16x64_bf16 v[56:59], v[28:31], a[184:191], v3
    v_smfmac_f32_16x16x64_bf16 v[52:55], v[32:35], a[192:199], v3
    v_smfmac_f32_16x16x64_bf16 v[56:59], v[32:35], a[200:207], v3
    v_smfmac_f32_16x16x64_bf16 v[52:55], v[36:39], a[208:215], v3
    v_cvt_pk_bf16_f32 v164, v44, v45
    v_smfmac_f32_16x16x64_bf16 v[56:59], v[36:39], a[216:223], v3
    v_cvt_pk_bf16_f32 v165, v46, v47
    v_smfmac_f32_16x16x64_bf16 v[52:55], v[40:43], a[224:231], v3
    ds_write_b64 v6, v[164:165] offset:0
    v_smfmac_f32_16x16x64_bf16 v[56:59], v[40:43], a[232:239], v3
    ds_read_b64_tr_b16 v[108:109], v7 offset:0
    v_smfmac_f32_16x16x64_bf16 v[60:63], v[24:27], a[240:247], v3
    v_cvt_pk_bf16_f32 v166, v48, v49
    v_smfmac_f32_16x16x64_bf16 v[64:67], v[24:27], a[248:255], v3
    v_cvt_pk_bf16_f32 v167, v50, v51
    s_nop 0
    s_waitcnt lgkmcnt(4)
    v_smfmac_f32_16x16x64_bf16 v[60:63], v[28:31], v[148:155], v3
    ds_write_b64 v6, v[166:167] offset:768
    v_smfmac_f32_16x16x64_bf16 v[64:67], v[28:31], v[168:175], v3
    ds_read_b64_tr_b16 v[110:111], v7 offset:768
    v_smfmac_f32_16x16x64_bf16 v[60:63], v[32:35], v[176:183], v3
    v_cvt_pk_bf16_f32 v164, v52, v53
    v_smfmac_f32_16x16x64_bf16 v[64:67], v[32:35], v[184:191], v3
    v_cvt_pk_bf16_f32 v165, v54, v55
    v_smfmac_f32_16x16x64_bf16 v[60:63], v[36:39], v[192:199], v3
    ds_write_b64 v6, v[164:165] offset:1536
    v_smfmac_f32_16x16x64_bf16 v[64:67], v[36:39], v[200:207], v3
    ds_read_b64_tr_b16 v[112:113], v7 offset:1536
    v_smfmac_f32_16x16x64_bf16 v[60:63], v[40:43], v[208:215], v3
    v_cvt_pk_bf16_f32 v166, v56, v57
    v_smfmac_f32_16x16x64_bf16 v[64:67], v[40:43], v[216:223], v3
    v_cvt_pk_bf16_f32 v167, v58, v59
    v_smfmac_f32_16x16x64_bf16 v[68:71], v[24:27], v[224:231], v3
    ds_write_b64 v6, v[166:167] offset:2304
    v_smfmac_f32_16x16x64_bf16 v[68:71], v[28:31], v[232:239], v3
    ds_read_b64_tr_b16 v[114:115], v7 offset:2304
    s_nop 0
    s_waitcnt lgkmcnt(8)
    v_smfmac_f32_16x16x64_bf16 v[68:71], v[32:35], v[156:163], v3
    v_cvt_pk_bf16_f32 v164, v60, v61
    v_smfmac_f32_16x16x64_bf16 v[68:71], v[36:39], v[240:247], v3
    v_cvt_pk_bf16_f32 v165, v62, v63
    v_smfmac_f32_16x16x64_bf16 v[68:71], v[40:43], v[248:255], v3
    ds_write_b64 v6, v[164:165] offset:3072
    s_nop 0
    s_waitcnt lgkmcnt(5)
    v_mfma_f32_16x16x32_bf16 v[128:131], v[72:75], v[108:111], 0
    ds_read_b64_tr_b16 v[116:117], v7 offset:3072
    v_cvt_pk_bf16_f32 v166, v64, v65
    v_mfma_f32_16x16x32_bf16 v[132:135], v[88:91], v[108:111], 0
    v_cvt_pk_bf16_f32 v167, v66, v67
    ds_write_b64 v6, v[166:167] offset:3840
    s_nop 0
    s_waitcnt lgkmcnt(3)
    v_smfmac_f32_16x16x64_bf16 v[136:139], v[16:19], v[108:115], v3
    ds_read_b64_tr_b16 v[118:119], v7 offset:3840
    v_mfma_f32_16x16x32_bf16 v[128:131], v[76:79], v[112:115], v[128:131]
    v_cvt_pk_bf16_f32 v164, v68, v69
    v_cvt_pk_bf16_f32 v165, v70, v71
    v_mfma_f32_16x16x32_bf16 v[132:135], v[92:95], v[112:115], v[132:135]
    ds_write_b64 v6, v[164:165] offset:4608
    ds_read_b64_tr_b16 v[120:121], v7 offset:4608
    s_nop 0
    s_waitcnt lgkmcnt(2)
    v_mfma_f32_16x16x32_bf16 v[128:131], v[80:83], v[116:119], v[128:131]
    v_mfma_f32_16x16x32_bf16 v[132:135], v[96:99], v[116:119], v[132:135]
    s_nop 0
    s_waitcnt lgkmcnt(0)
    v_smfmac_f32_16x16x64_bf16 v[136:139], v[20:23], v[116:123], v3
    v_mfma_f32_16x16x32_bf16 v[128:131], v[84:87], v[120:123], v[128:131]
    v_mfma_f32_16x16x32_bf16 v[132:135], v[100:103], v[120:123], v[132:135]
    s_nop 4
    s_nop 0
    v_permlane32_swap_b32 v136, v138
    v_permlane32_swap_b32 v137, v139
    v_add_f32_dpp v44, v128, v128 row_ror:8 row_mask:0xf bank_mask:0x3
    v_add_f32_dpp v45, v129, v129 row_ror:8 row_mask:0xf bank_mask:0x3
    v_add_f32_dpp v46, v130, v130 row_ror:8 row_mask:0xf bank_mask:0x3
    v_add_f32_dpp v47, v131, v131 row_ror:8 row_mask:0xf bank_mask:0x3
    v_add_f32 v136, v136, v138
    v_add_f32 v137, v137, v139
    v_add_f32_dpp v44, v132, v132 row_ror:8 row_mask:0xf bank_mask:0xc
    v_add_f32_dpp v45, v133, v133 row_ror:8 row_mask:0xf bank_mask:0xc
    v_add_f32_dpp v46, v134, v134 row_ror:8 row_mask:0xf bank_mask:0xc
    v_add_f32_dpp v47, v135, v135 row_ror:8 row_mask:0xf bank_mask:0xc
    ds_write_b128 v8, v[44:47]
    v_add_f32_dpp v164, v136, v136 row_ror:8 row_mask:0xf bank_mask:0x3
    v_add_f32_dpp v164, v137, v137 row_ror:8 row_mask:0xf bank_mask:0xc
    ds_write_b32 v9, v164 offset:128
    s_waitcnt lgkmcnt(0)
    s_barrier
    ds_read_b64 v[44:45], v10 offset:0
    ds_read_b64 v[46:47], v10 offset:1664
    ds_read_b64 v[48:49], v10 offset:3328
    ds_read_b64 v[50:51], v10 offset:4992
    s_nop 0
    s_waitcnt lgkmcnt(2)
    v_pk_add_f32 v[44:45], v[44:45], v[46:47]
    s_nop 0
    s_waitcnt lgkmcnt(0)
    v_pk_add_f32 v[48:49], v[48:49], v[50:51]
    v_pk_add_f32 v[44:45], v[44:45], v[48:49]
    v_max_f32 v46, v44, v45
    s_nop 1
    v_max_f32_dpp v46, v46, v46 quad_perm:[1,0,3,2] row_mask:0xf bank_mask:0xf
    s_nop 0
    s_nop 0
    v_max_f32_dpp v46, v46, v46 quad_perm:[2,3,0,1] row_mask:0xf bank_mask:0xf
    s_nop 0
    s_nop 0
    v_max_f32_dpp v46, v46, v46 row_half_mirror row_mask:0xf bank_mask:0xf
    s_nop 0
    s_nop 0
    v_max_f32_dpp v46, v46, v46 row_mirror row_mask:0xf bank_mask:0xf
    v_mov_b32 v47, v46
    s_nop 1
    v_permlane16_swap_b32 v46, v47
    s_nop 0
    v_max_f32 v46, v46, v47
    v_sub_f32 v44, v44, v46
    v_sub_f32 v45, v45, v46
    v_exp_f32 v44, v44
    v_exp_f32 v45, v45
    s_nop 0
    v_add_f32 v46, v44, v45
    s_nop 1
    v_add_f32_dpp v46, v46, v46 quad_perm:[1,0,3,2] row_mask:0xf bank_mask:0xf
    s_nop 0
    s_nop 0
    v_add_f32_dpp v46, v46, v46 quad_perm:[2,3,0,1] row_mask:0xf bank_mask:0xf
    s_nop 0
    s_nop 0
    v_add_f32_dpp v46, v46, v46 row_half_mirror row_mask:0xf bank_mask:0xf
    s_nop 0
    s_nop 0
    v_add_f32_dpp v46, v46, v46 row_mirror row_mask:0xf bank_mask:0xf
    v_mov_b32 v47, v46
    s_nop 1
    v_permlane16_swap_b32 v46, v47
    s_nop 0
    v_add_f32 v46, v46, v47
    v_rcp_f32 v46, v46
    s_nop 0
    v_mul_f32 v44, v44, v46
    v_mul_f32_e64 v45, v45, v46
    v_cvt_pk_bf16_f32 v164, v44, v45
    v_min_u32_e64 v164, 0xfffffffe, v164
    buffer_store_dword v164, v11, s[8:11], s22 offen
    s_nop 0
    s_sleep 5
    s_mov_b32 m0, s70
    s_add_u32 s26, s23, s78
    buffer_load_dwordx4 v2, s[8:11], s26 offen sc1 lds
    s_mov_b32 m0, s71
    s_add_u32 s26, s23, s79
    buffer_load_dwordx4 v2, s[8:11], s26 offen sc1 lds
    s_mov_b32 m0, s72
    s_add_u32 s26, s23, s80
    buffer_load_dwordx4 v2, s[8:11], s26 offen sc1 lds
    s_mov_b32 m0, s73
    s_add_u32 s26, s23, s81
    buffer_load_dwordx4 v2, s[8:11], s26 offen sc1 lds
    s_mov_b32 m0, s74
    s_add_u32 s26, s23, s82
    buffer_load_dwordx4 v2, s[8:11], s26 offen sc1 lds
    s_mov_b32 m0, s75
    s_add_u32 s26, s23, s83
    buffer_load_dwordx4 v2, s[8:11], s26 offen sc1 lds
    s_mov_b32 m0, s76
    s_add_u32 s26, s23, s84
    buffer_load_dwordx4 v2, s[8:11], s26 offen sc1 lds
    s_mov_b32 m0, s77
    s_add_u32 s26, s23, s85
    buffer_load_dwordx4 v2, s[8:11], s26 offen sc1 lds
    s_add_u32 s23, s23, 28672
    s_add_u32 s20, s20, 8192
    s_add_u32 s21, s21, 8192
    s_add_u32 s22, s22, 10240
    s_add_u32 s19, s19, 1
    s_cmp_lt_u32 s19, 63
    s_cbranch_scc1 SC0_LOOP0
    s_branch CH_DONE
.p2align 7
SC0_LOOP1:
    ds_read_b128 v[140:143], v12 offset:0
    ds_read_b128 v[144:147], v12 offset:1024
    ds_read_b128 v[148:151], v12 offset:2048
    ds_read_b128 v[152:155], v12 offset:3072
    ds_read_b128 v[156:159], v12 offset:4096
    ds_read_b128 v[160:163], v12 offset:5120
    v_mov_b32 v44, 0
    v_mov_b32 v45, 0
    v_mov_b32 v46, 0
    v_mov_b32 v47, 0
    v_mov_b32 v48, 0
    v_mov_b32 v49, 0
    v_mov_b32 v50, 0
    v_mov_b32 v51, 0
    v_mov_b32 v52, 0
    v_mov_b32 v53, 0
    v_mov_b32 v54, 0
    v_mov_b32 v55, 0
    v_mov_b32 v56, 0
    v_mov_b32 v57, 0
    v_mov_b32 v58, 0
    v_mov_b32 v59, 0
    v_mov_b32 v60, 0
    v_mov_b32 v61, 0
    v_mov_b32 v62, 0
    v_mov_b32 v63, 0
    v_mov_b32 v64, 0
    v_mov_b32 v65, 0
    v_mov_b32 v66, 0
    v_mov_b32 v67, 0
    v_mov_b32 v68, 0
    v_mov_b32 v69, 0
    v_mov_b32 v70, 0
    v_mov_b32 v71, 0
    v_mov_b32 v136, 0
    v_mov_b32 v137, 0
    v_mov_b32_e64 v138, 0
    v_mov_b32 v139, 0
    s_waitcnt vmcnt(0)
    ds_read_b128 v[72:75], v13 offset:0
    ds_read_b128 v[76:79], v13 offset:1024
    ds_read_b128 v[80:83], v13 offset:2048
    ds_read_b128 v[84:87], v13 offset:3072
    ds_read_b128 v[88:91], v13 offset:4096
    ds_read_b128 v[92:95], v13 offset:5120
    ds_read_b128 v[96:99], v13 offset:6144
    ds_read_b128 v[100:103], v13 offset:7168
    s_mov_b32 s27, 0
    s_nop 0
    buffer_load_dwordx4 v[16:19], v2, s[8:11], s20 offen offset:0 sc1
    buffer_load_dwordx4 v[20:23], v2, s[8:11], s20 offen offset:1024 sc1
    s_nop 15
    s_nop 15
SC0_LOOP1_POLL:
    buffer_load_dwordx4 v[16:19], v2, s[8:11], s20 offen offset:0 sc1
    buffer_load_dwordx4 v[20:23], v2, s[8:11], s20 offen offset:1024 sc1
    s_add_u32 s27, s27, 1
    s_nop 0
    s_cmp_gt_u32 s27, 65536
    s_cbranch_scc1 CH_FAIL
    s_waitcnt vmcnt(2)
    v_max3_u32 v4, v16, v17, v18
    v_max3_u32 v4, v4, v19, v20
    v_max3_u32 v4, v4, v21, v22
    v_max_u32_e64 v4, v4, v23
    v_cmp_eq_u32 vcc, -1, v4
    s_cbranch_vccnz SC0_LOOP1_POLL
    ds_write_b128 v2, v[16:19] offset:36864
    ds_write_b128 v2, v[20:23] offset:37888
    v_smfmac_f32_16x16x64_bf16 v[44:47], v[16:19], a[0:7], v3
    v_smfmac_f32_16x16x64_bf16 v[48:51], v[16:19], a[8:15], v3
    v_smfmac_f32_16x16x64_bf16 v[52:55], v[16:19], a[16:23], v3
    v_smfmac_f32_16x16x64_bf16 v[56:59], v[16:19], a[24:31], v3
    v_smfmac_f32_16x16x64_bf16 v[60:63], v[16:19], a[32:39], v3
    v_smfmac_f32_16x16x64_bf16 v[64:67], v[16:19], a[40:47], v3
    s_waitcnt lgkmcnt(0)
    s_barrier
    ds_read_b128 v[24:27], v2 offset:38912
    ds_read_b128 v[28:31], v2 offset:39936
    ds_read_b128 v[32:35], v2 offset:40960
    ds_read_b128 v[36:39], v2 offset:41984
    ds_read_b128 v[40:43], v2 offset:43008
    v_smfmac_f32_16x16x64_bf16 v[68:71], v[16:19], a[48:55], v3
    v_smfmac_f32_16x16x64_bf16 v[44:47], v[20:23], a[56:63], v3
    v_smfmac_f32_16x16x64_bf16 v[48:51], v[20:23], v[140:147], v3
    ds_read_b128 v[140:143], v12 offset:6144
    v_smfmac_f32_16x16x64_bf16 v[52:55], v[20:23], a[64:71], v3
    ds_read_b128 v[144:147], v12 offset:7168
    v_smfmac_f32_16x16x64_bf16 v[56:59], v[20:23], a[72:79], v3
    v_smfmac_f32_16x16x64_bf16 v[60:63], v[20:23], a[80:87], v3
    v_smfmac_f32_16x16x64_bf16 v[64:67], v[20:23], v[148:155], v3
    ds_read_b128 v[148:151], v12 offset:8192
    v_smfmac_f32_16x16x64_bf16 v[68:71], v[20:23], a[88:95], v3
    ds_read_b128 v[152:155], v12 offset:9216
    s_nop 0
    s_waitcnt lgkmcnt(8)
    v_smfmac_f32_16x16x64_bf16 v[44:47], v[24:27], a[96:103], v3
    v_smfmac_f32_16x16x64_bf16 v[48:51], v[24:27], a[104:111], v3
    s_nop 0
    s_waitcnt lgkmcnt(7)
    v_smfmac_f32_16x16x64_bf16 v[44:47], v[28:31], v[156:163], v3
    ds_read_b128 v[156:159], v12 offset:10240
    v_smfmac_f32_16x16x64_bf16 v[48:51], v[28:31], a[112:119], v3
    ds_read_b128 v[160:163], v12 offset:11264
    s_nop 0
    s_waitcnt lgkmcnt(8)
    v_smfmac_f32_16x16x64_bf16 v[44:47], v[32:35], a[120:127], v3
    v_smfmac_f32_16x16x64_bf16 v[48:51], v[32:35], a[128:135], v3
    s_nop 0
    s_waitcnt lgkmcnt(7)
    v_smfmac_f32_16x16x64_bf16 v[44:47], v[36:39], a[136:143], v3
    v_smfmac_f32_16x16x64_bf16 v[48:51], v[36:39], a[144:151], v3
    s_waitcnt lgkmcnt(6)
    s_waitcnt lgkmcnt(4)
    v_smfmac_f32_16x16x64_bf16 v[44:47], v[40:43], v[140:147], v3
    v_smfmac_f32_16x16x64_bf16 v[48:51], v[40:43], a[152:159], v3
    v_smfmac_f32_16x16x64_bf16 v[52:55], v[24:27], a[160:167], v3
    v_smfmac_f32_16x16x64_bf16 v[56:59], v[24:27], a[168:175], v3
    v_smfmac_f32_16x16x64_bf16 v[52:55], v[28:31], a[176:183], v3
    v_smfmac_f32_16x16x64_bf16 v[56:59], v[28:31], a[184:191], v3
    v_smfmac_f32_16x16x64_bf16 v[52:55], v[32:35], a[192:199], v3
    v_smfmac_f32_16x16x64_bf16 v[56:59], v[32:35], a[200:207], v3
    v_smfmac_f32_16x16x64_bf16 v[52:55], v[36:39], a[208:215], v3
    v_cvt_pk_bf16_f32 v164, v44, v45
    v_smfmac_f32_16x16x64_bf16 v[56:59], v[36:39], a[216:223], v3
    v_cvt_pk_bf16_f32 v165, v46, v47
    v_smfmac_f32_16x16x64_bf16 v[52:55], v[40:43], a[224:231], v3
    ds_write_b64 v6, v[164:165] offset:0
    v_smfmac_f32_16x16x64_bf16 v[56:59], v[40:43], a[232:239], v3
    ds_read_b64_tr_b16 v[108:109], v7 offset:0
    v_smfmac_f32_16x16x64_bf16 v[60:63], v[24:27], a[240:247], v3
    v_cvt_pk_bf16_f32 v166, v48, v49
    v_smfmac_f32_16x16x64_bf16 v[64:67], v[24:27], a[248:255], v3
    v_cvt_pk_bf16_f32 v167, v50, v51
    s_nop 0
    s_waitcnt lgkmcnt(4)
    v_smfmac_f32_16x16x64_bf16 v[60:63], v[28:31], v[148:155], v3
    ds_write_b64 v6, v[166:167] offset:768
    v_smfmac_f32_16x16x64_bf16 v[64:67], v[28:31], v[168:175], v3
    ds_read_b64_tr_b16 v[110:111], v7 offset:768
    v_smfmac_f32_16x16x64_bf16 v[60:63], v[32:35], v[176:183], v3
    v_cvt_pk_bf16_f32 v164, v52, v53
    v_smfmac_f32_16x16x64_bf16 v[64:67], v[32:35], v[184:191], v3
    v_cvt_pk_bf16_f32 v165, v54, v55
    v_smfmac_f32_16x16x64_bf16 v[60:63], v[36:39], v[192:199], v3
    ds_write_b64 v6, v[164:165] offset:1536
    v_smfmac_f32_16x16x64_bf16 v[64:67], v[36:39], v[200:207], v3
    ds_read_b64_tr_b16 v[112:113], v7 offset:1536
    v_smfmac_f32_16x16x64_bf16 v[60:63], v[40:43], v[208:215], v3
    v_cvt_pk_bf16_f32 v166, v56, v57
    v_smfmac_f32_16x16x64_bf16 v[64:67], v[40:43], v[216:223], v3
    v_cvt_pk_bf16_f32 v167, v58, v59
    v_smfmac_f32_16x16x64_bf16 v[68:71], v[24:27], v[224:231], v3
    ds_write_b64 v6, v[166:167] offset:2304
    v_smfmac_f32_16x16x64_bf16 v[68:71], v[28:31], v[232:239], v3
    ds_read_b64_tr_b16 v[114:115], v7 offset:2304
    s_nop 0
    s_waitcnt lgkmcnt(8)
    v_smfmac_f32_16x16x64_bf16 v[68:71], v[32:35], v[156:163], v3
    v_cvt_pk_bf16_f32 v164, v60, v61
    v_smfmac_f32_16x16x64_bf16 v[68:71], v[36:39], v[240:247], v3
    v_cvt_pk_bf16_f32 v165, v62, v63
    v_smfmac_f32_16x16x64_bf16 v[68:71], v[40:43], v[248:255], v3
    ds_write_b64 v6, v[164:165] offset:3072
    s_nop 0
    s_waitcnt lgkmcnt(5)
    v_mfma_f32_16x16x32_bf16 v[128:131], v[72:75], v[108:111], 0
    ds_read_b64_tr_b16 v[116:117], v7 offset:3072
    v_cvt_pk_bf16_f32 v166, v64, v65
    v_mfma_f32_16x16x32_bf16 v[132:135], v[88:91], v[108:111], 0
    v_cvt_pk_bf16_f32 v167, v66, v67
    ds_write_b64 v6, v[166:167] offset:3840
    s_nop 0
    s_waitcnt lgkmcnt(3)
    v_smfmac_f32_16x16x64_bf16 v[136:139], v[16:19], v[108:115], v3
    ds_read_b64_tr_b16 v[118:119], v7 offset:3840
    v_mfma_f32_16x16x32_bf16 v[128:131], v[76:79], v[112:115], v[128:131]
    v_cvt_pk_bf16_f32 v164, v68, v69
    v_cvt_pk_bf16_f32 v165, v70, v71
    v_mfma_f32_16x16x32_bf16 v[132:135], v[92:95], v[112:115], v[132:135]
    ds_write_b64 v6, v[164:165] offset:4608
    ds_read_b64_tr_b16 v[120:121], v7 offset:4608
    s_nop 0
    s_waitcnt lgkmcnt(2)
    v_mfma_f32_16x16x32_bf16 v[128:131], v[80:83], v[116:119], v[128:131]
    v_mfma_f32_16x16x32_bf16 v[132:135], v[96:99], v[116:119], v[132:135]
    s_nop 0
    s_waitcnt lgkmcnt(0)
    v_smfmac_f32_16x16x64_bf16 v[136:139], v[20:23], v[116:123], v3
    v_mfma_f32_16x16x32_bf16 v[128:131], v[84:87], v[120:123], v[128:131]
    v_mfma_f32_16x16x32_bf16 v[132:135], v[100:103], v[120:123], v[132:135]
    s_nop 4
    s_nop 0
    v_permlane32_swap_b32 v136, v138
    v_permlane32_swap_b32 v137, v139
    v_add_f32_dpp v44, v128, v128 row_ror:8 row_mask:0xf bank_mask:0x3
    v_add_f32_dpp v45, v129, v129 row_ror:8 row_mask:0xf bank_mask:0x3
    v_add_f32_dpp v46, v130, v130 row_ror:8 row_mask:0xf bank_mask:0x3
    v_add_f32_dpp v47, v131, v131 row_ror:8 row_mask:0xf bank_mask:0x3
    v_add_f32 v136, v136, v138
    v_add_f32 v137, v137, v139
    v_add_f32_dpp v44, v132, v132 row_ror:8 row_mask:0xf bank_mask:0xc
    v_add_f32_dpp v45, v133, v133 row_ror:8 row_mask:0xf bank_mask:0xc
    v_add_f32_dpp v46, v134, v134 row_ror:8 row_mask:0xf bank_mask:0xc
    v_add_f32_dpp v47, v135, v135 row_ror:8 row_mask:0xf bank_mask:0xc
    ds_write_b128 v8, v[44:47]
    v_add_f32_dpp v164, v136, v136 row_ror:8 row_mask:0xf bank_mask:0x3
    v_add_f32_dpp v164, v137, v137 row_ror:8 row_mask:0xf bank_mask:0xc
    ds_write_b32 v9, v164 offset:128
    s_waitcnt lgkmcnt(0)
    s_barrier
    ds_read_b64 v[44:45], v10 offset:0
    ds_read_b64 v[46:47], v10 offset:1664
    ds_read_b64 v[48:49], v10 offset:3328
    ds_read_b64 v[50:51], v10 offset:4992
    s_nop 0
    s_waitcnt lgkmcnt(2)
    v_pk_add_f32 v[44:45], v[44:45], v[46:47]
    s_nop 0
    s_waitcnt lgkmcnt(0)
    v_pk_add_f32 v[48:49], v[48:49], v[50:51]
    v_pk_add_f32 v[44:45], v[44:45], v[48:49]
    v_max_f32 v46, v44, v45
    s_nop 1
    v_max_f32_dpp v46, v46, v46 quad_perm:[1,0,3,2] row_mask:0xf bank_mask:0xf
    s_nop 0
    s_nop 0
    v_max_f32_dpp v46, v46, v46 quad_perm:[2,3,0,1] row_mask:0xf bank_mask:0xf
    s_nop 0
    s_nop 0
    v_max_f32_dpp v46, v46, v46 row_half_mirror row_mask:0xf bank_mask:0xf
    s_nop 0
    s_nop 0
    v_max_f32_dpp v46, v46, v46 row_mirror row_mask:0xf bank_mask:0xf
    v_mov_b32 v47, v46
    s_nop 1
    v_permlane16_swap_b32 v46, v47
    s_nop 0
    v_max_f32 v46, v46, v47
    v_sub_f32 v44, v44, v46
    v_sub_f32 v45, v45, v46
    v_exp_f32 v44, v44
    v_exp_f32 v45, v45
    s_nop 0
    v_add_f32 v46, v44, v45
    s_nop 1
    v_add_f32_dpp v46, v46, v46 quad_perm:[1,0,3,2] row_mask:0xf bank_mask:0xf
    s_nop 0
    s_nop 0
    v_add_f32_dpp v46, v46, v46 quad_perm:[2,3,0,1] row_mask:0xf bank_mask:0xf
    s_nop 0
    s_nop 0
    v_add_f32_dpp v46, v46, v46 row_half_mirror row_mask:0xf bank_mask:0xf
    s_nop 0
    s_nop 0
    v_add_f32_dpp v46, v46, v46 row_mirror row_mask:0xf bank_mask:0xf
    v_mov_b32 v47, v46
    s_nop 1
    v_permlane16_swap_b32 v46, v47
    s_nop 0
    v_add_f32 v46, v46, v47
    v_rcp_f32 v46, v46
    s_nop 0
    v_mul_f32 v44, v44, v46
    v_mul_f32_e64 v45, v45, v46
    v_cvt_pk_bf16_f32 v164, v44, v45
    v_min_u32_e64 v164, 0xfffffffe, v164
    buffer_store_dword v164, v11, s[8:11], s22 offen sc1
    s_nop 0
    s_sleep 5
    s_mov_b32 m0, s70
    s_add_u32 s26, s23, s78
    buffer_load_dwordx4 v2, s[8:11], s26 offen sc1 lds
    s_mov_b32 m0, s71
    s_add_u32 s26, s23, s79
    buffer_load_dwordx4 v2, s[8:11], s26 offen sc1 lds
    s_mov_b32 m0, s72
    s_add_u32 s26, s23, s80
    buffer_load_dwordx4 v2, s[8:11], s26 offen sc1 lds
    s_mov_b32 m0, s73
    s_add_u32 s26, s23, s81
    buffer_load_dwordx4 v2, s[8:11], s26 offen sc1 lds
    s_mov_b32 m0, s74
    s_add_u32 s26, s23, s82
    buffer_load_dwordx4 v2, s[8:11], s26 offen sc1 lds
    s_mov_b32 m0, s75
    s_add_u32 s26, s23, s83
    buffer_load_dwordx4 v2, s[8:11], s26 offen sc1 lds
    s_mov_b32 m0, s76
    s_add_u32 s26, s23, s84
    buffer_load_dwordx4 v2, s[8:11], s26 offen sc1 lds
    s_mov_b32 m0, s77
    s_add_u32 s26, s23, s85
    buffer_load_dwordx4 v2, s[8:11], s26 offen sc1 lds
    s_add_u32 s23, s23, 28672
    s_add_u32 s20, s20, 8192
    s_add_u32 s21, s21, 8192
    s_add_u32 s22, s22, 10240
    s_add_u32 s19, s19, 1
    s_cmp_lt_u32 s19, 63
    s_cbranch_scc1 SC0_LOOP1
    s_branch CH_DONE
SC1:
    v_and_b32 v1, 63, v0
    v_lshlrev_b32 v2, 4, v1
    v_mov_b32 v3, 0x4444
    v_mov_b32 v4, 0xeeee
    v_and_b32 v5, 8, v1
    v_cmp_ne_u32 vcc, 0, v5
    s_nop 1
    v_cndmask_b32 v3, v3, v4, vcc
    s_mul_i32 s25, s28, 401408
    s_add_u32 s25, s25, 2197504
    v_add_u32 v12, 57344, v2
    s_lshl_b32 s26, s28, 7
    v_mov_b32 v5, 0
    s_add_u32 s30, s26, 85137408
    s_mov_b32 s27, 0
    s_nop 0
SC1_WW:
    buffer_load_dword v4, v5, s[8:11], s30 offen sc1
    s_add_u32 s27, s27, 1
    s_nop 0
    s_cmp_gt_u32 s27, 65536
    s_cbranch_scc1 CH_FAIL
    s_waitcnt vmcnt(0)
    v_cmp_le_u32 vcc, 7, v4
    s_cbranch_vccnz SC1_WW_OK
    s_sleep 2
    s_branch SC1_WW
SC1_WW_OK:
    s_mov_b32 m0, 57344
    s_add_u32 s29, s25, 20480
    buffer_load_dwordx4 v2, s[8:11], s29 offen sc1 lds
    buffer_load_dwordx4 v2, s[8:11], s29 offen offset:1024 sc1 lds
    s_mov_b32 m0, 59392
    s_add_u32 s29, s25, 77824
    buffer_load_dwordx4 v2, s[8:11], s29 offen sc1 lds
    buffer_load_dwordx4 v2, s[8:11], s29 offen offset:1024 sc1 lds
    s_mov_b32 m0, 61440
    s_add_u32 s29, s25, 16384
    buffer_load_dwordx4 v2, s[8:11], s29 offen sc1 lds
    buffer_load_dwordx4 v2, s[8:11], s29 offen offset:1024 sc1 lds
    s_mov_b32 m0, 63488
    s_add_u32 s29, s25, 26624
    buffer_load_dwordx4 v2, s[8:11], s29 offen sc1 lds
    buffer_load_dwordx4 v2, s[8:11], s29 offen offset:1024 sc1 lds
    s_mov_b32 m0, 65536
    s_add_u32 s29, s25, 73728
    buffer_load_dwordx4 v2, s[8:11], s29 offen sc1 lds
    buffer_load_dwordx4 v2, s[8:11], s29 offen offset:1024 sc1 lds
    s_mov_b32 m0, 67584
    s_add_u32 s29, s25, 8192
    buffer_load_dwordx4 v2, s[8:11], s29 offen sc1 lds
    buffer_load_dwordx4 v2, s[8:11], s29 offen offset:1024 sc1 lds
    s_add_u32 s29, s25, 4096
    buffer_load_dwordx4 a[0:3], v2, s[8:11], s29 offen sc1
    buffer_load_dwordx4 a[4:7], v2, s[8:11], s29 offen offset:1024 sc1
    s_add_u32 s29, s25, 18432
    buffer_load_dwordx4 a[8:11], v2, s[8:11], s29 offen sc1
    buffer_load_dwordx4 a[12:15], v2, s[8:11], s29 offen offset:1024 sc1
    s_add_u32 s29, s25, 32768
    buffer_load_dwordx4 a[16:19], v2, s[8:11], s29 offen sc1
    buffer_load_dwordx4 a[20:23], v2, s[8:11], s29 offen offset:1024 sc1
    s_add_u32 s29, s25, 47104
    buffer_load_dwordx4 a[24:27], v2, s[8:11], s29 offen sc1
    buffer_load_dwordx4 a[28:31], v2, s[8:11], s29 offen offset:1024 sc1
    s_add_u32 s29, s25, 61440
    buffer_load_dwordx4 a[32:35], v2, s[8:11], s29 offen sc1
    buffer_load_dwordx4 a[36:39], v2, s[8:11], s29 offen offset:1024 sc1
    s_add_u32 s29, s25, 75776
    buffer_load_dwordx4 a[40:43], v2, s[8:11], s29 offen sc1
    buffer_load_dwordx4 a[44:47], v2, s[8:11], s29 offen offset:1024 sc1
    s_add_u32 s29, s25, 90112
    buffer_load_dwordx4 a[48:51], v2, s[8:11], s29 offen sc1
    buffer_load_dwordx4 a[52:55], v2, s[8:11], s29 offen offset:1024 sc1
    s_add_u32 s29, s25, 6144
    buffer_load_dwordx4 a[56:59], v2, s[8:11], s29 offen sc1
    buffer_load_dwordx4 a[60:63], v2, s[8:11], s29 offen offset:1024 sc1
    s_add_u32 s29, s25, 34816
    buffer_load_dwordx4 a[64:67], v2, s[8:11], s29 offen sc1
    buffer_load_dwordx4 a[68:71], v2, s[8:11], s29 offen offset:1024 sc1
    s_add_u32 s29, s25, 49152
    buffer_load_dwordx4 a[72:75], v2, s[8:11], s29 offen sc1
    buffer_load_dwordx4 a[76:79], v2, s[8:11], s29 offen offset:1024 sc1
    s_add_u32 s29, s25, 63488
    buffer_load_dwordx4 a[80:83], v2, s[8:11], s29 offen sc1
    buffer_load_dwordx4 a[84:87], v2, s[8:11], s29 offen offset:1024 sc1
    s_add_u32 s29, s25, 92160
    buffer_load_dwordx4 a[88:91], v2, s[8:11], s29 offen sc1
    buffer_load_dwordx4 a[92:95], v2, s[8:11], s29 offen offset:1024 sc1
    s_nop 0
    s_waitcnt vmcnt(24)
    s_add_u32 s29, s25, 14336
    buffer_load_dwordx4 a[96:99], v2, s[8:11], s29 offen sc1
    buffer_load_dwordx4 a[100:103], v2, s[8:11], s29 offen offset:1024 sc1
    s_add_u32 s29, s25, 28672
    buffer_load_dwordx4 a[104:107], v2, s[8:11], s29 offen sc1
    buffer_load_dwordx4 a[108:111], v2, s[8:11], s29 offen offset:1024 sc1
    s_add_u32 s29, s25, 30720
    buffer_load_dwordx4 a[112:115], v2, s[8:11], s29 offen sc1
    buffer_load_dwordx4 a[116:119], v2, s[8:11], s29 offen offset:1024 sc1
    s_add_u32 s29, s25, 22528
    buffer_load_dwordx4 a[120:123], v2, s[8:11], s29 offen sc1
    buffer_load_dwordx4 a[124:127], v2, s[8:11], s29 offen offset:1024 sc1
    s_add_u32 s29, s25, 36864
    buffer_load_dwordx4 a[128:131], v2, s[8:11], s29 offen sc1
    buffer_load_dwordx4 a[132:135], v2, s[8:11], s29 offen offset:1024 sc1
    s_add_u32 s29, s25, 24576
    buffer_load_dwordx4 a[136:139], v2, s[8:11], s29 offen sc1
    buffer_load_dwordx4 a[140:143], v2, s[8:11], s29 offen offset:1024 sc1
    s_add_u32 s29, s25, 38912
    buffer_load_dwordx4 a[144:147], v2, s[8:11], s29 offen sc1
    buffer_load_dwordx4 a[148:151], v2, s[8:11], s29 offen offset:1024 sc1
    s_add_u32 s29, s25, 40960
    buffer_load_dwordx4 a[152:155], v2, s[8:11], s29 offen sc1
    buffer_load_dwordx4 a[156:159], v2, s[8:11], s29 offen offset:1024 sc1
    s_add_u32 s29, s25, 43008
    buffer_load_dwordx4 a[160:163], v2, s[8:11], s29 offen sc1
    buffer_load_dwordx4 a[164:167], v2, s[8:11], s29 offen offset:1024 sc1
    s_add_u32 s29, s25, 57344
    buffer_load_dwordx4 a[168:171], v2, s[8:11], s29 offen sc1
    buffer_load_dwordx4 a[172:175], v2, s[8:11], s29 offen offset:1024 sc1
    s_add_u32 s29, s25, 45056
    buffer_load_dwordx4 a[176:179], v2, s[8:11], s29 offen sc1
    buffer_load_dwordx4 a[180:183], v2, s[8:11], s29 offen offset:1024 sc1
    s_add_u32 s29, s25, 59392
    buffer_load_dwordx4 a[184:187], v2, s[8:11], s29 offen sc1
    buffer_load_dwordx4 a[188:191], v2, s[8:11], s29 offen offset:1024 sc1
    s_nop 0
    s_waitcnt vmcnt(24)
    s_add_u32 s29, s25, 51200
    buffer_load_dwordx4 a[192:195], v2, s[8:11], s29 offen sc1
    buffer_load_dwordx4 a[196:199], v2, s[8:11], s29 offen offset:1024 sc1
    s_add_u32 s29, s25, 65536
    buffer_load_dwordx4 a[200:203], v2, s[8:11], s29 offen sc1
    buffer_load_dwordx4 a[204:207], v2, s[8:11], s29 offen offset:1024 sc1
    s_add_u32 s29, s25, 53248
    buffer_load_dwordx4 a[208:211], v2, s[8:11], s29 offen sc1
    buffer_load_dwordx4 a[212:215], v2, s[8:11], s29 offen offset:1024 sc1
    s_add_u32 s29, s25, 67584
    buffer_load_dwordx4 a[216:219], v2, s[8:11], s29 offen sc1
    buffer_load_dwordx4 a[220:223], v2, s[8:11], s29 offen offset:1024 sc1
    s_add_u32 s29, s25, 55296
    buffer_load_dwordx4 a[224:227], v2, s[8:11], s29 offen sc1
    buffer_load_dwordx4 a[228:231], v2, s[8:11], s29 offen offset:1024 sc1
    s_add_u32 s29, s25, 69632
    buffer_load_dwordx4 a[232:235], v2, s[8:11], s29 offen sc1
    buffer_load_dwordx4 a[236:239], v2, s[8:11], s29 offen offset:1024 sc1
    s_add_u32 s29, s25, 71680
    buffer_load_dwordx4 a[240:243], v2, s[8:11], s29 offen sc1
    buffer_load_dwordx4 a[244:247], v2, s[8:11], s29 offen offset:1024 sc1
    s_add_u32 s29, s25, 86016
    buffer_load_dwordx4 a[248:251], v2, s[8:11], s29 offen sc1
    buffer_load_dwordx4 a[252:255], v2, s[8:11], s29 offen offset:1024 sc1
    s_add_u32 s29, s25, 88064
    buffer_load_dwordx4 v[168:171], v2, s[8:11], s29 offen sc1
    buffer_load_dwordx4 v[172:175], v2, s[8:11], s29 offen offset:1024 sc1
    s_add_u32 s29, s25, 79872
    buffer_load_dwordx4 v[176:179], v2, s[8:11], s29 offen sc1
    buffer_load_dwordx4 v[180:183], v2, s[8:11], s29 offen offset:1024 sc1
    s_add_u32 s29, s25, 94208
    buffer_load_dwordx4 v[184:187], v2, s[8:11], s29 offen sc1
    buffer_load_dwordx4 v[188:191], v2, s[8:11], s29 offen offset:1024 sc1
    s_add_u32 s29, s25, 81920
    buffer_load_dwordx4 v[192:195], v2, s[8:11], s29 offen sc1
    buffer_load_dwordx4 v[196:199], v2, s[8:11], s29 offen offset:1024 sc1
    s_nop 0
    s_waitcnt vmcnt(24)
    s_add_u32 s29, s25, 96256
    buffer_load_dwordx4 v[200:203], v2, s[8:11], s29 offen sc1
    buffer_load_dwordx4 v[204:207], v2, s[8:11], s29 offen offset:1024 sc1
    s_add_u32 s29, s25, 83968
    buffer_load_dwordx4 v[208:211], v2, s[8:11], s29 offen sc1
    buffer_load_dwordx4 v[212:215], v2, s[8:11], s29 offen offset:1024 sc1
    s_add_u32 s29, s25, 98304
    buffer_load_dwordx4 v[216:219], v2, s[8:11], s29 offen sc1
    buffer_load_dwordx4 v[220:223], v2, s[8:11], s29 offen offset:1024 sc1
    s_add_u32 s29, s25, 0
    s_nop 0
    buffer_load_dwordx4 v[224:227], v2, s[8:11], s29 offen sc1
    buffer_load_dwordx4 v[228:231], v2, s[8:11], s29 offen offset:1024 sc1
    s_add_u32 s29, s25, 2048
    buffer_load_dwordx4 v[232:235], v2, s[8:11], s29 offen sc1
    buffer_load_dwordx4 v[236:239], v2, s[8:11], s29 offen offset:1024 sc1
    s_add_u32 s29, s25, 10240
    buffer_load_dwordx4 v[240:243], v2, s[8:11], s29 offen sc1
    buffer_load_dwordx4 v[244:247], v2, s[8:11], s29 offen offset:1024 sc1
    s_add_u32 s29, s25, 12288
    buffer_load_dwordx4 v[248:251], v2, s[8:11], s29 offen sc1
    buffer_load_dwordx4 v[252:255], v2, s[8:11], s29 offen offset:1024 sc1
    v_and_b32 v4, 3, v1
    v_lshrrev_b32 v5, 2, v1
    v_mul_u32_u24 v7, 192, v4
    v_lshl_add_u32 v7, v5, 3, v7
    v_add_u32 v7, 5376, v7
    v_and_b32 v4, 15, v1
    v_lshrrev_b32 v5, 4, v1
    v_mul_u32_u24 v6, 192, v5
    v_lshl_add_u32 v6, v4, 3, v6
    v_add_u32 v6, 5376, v6
    v_and_b32_e64 v164, 7, v4
    v_mul_u32_u24 v8, 208, v164
    v_add_u32 v8, 23168, v8
    v_lshrrev_b32_e64 v164, 3, v4
    v_lshl_add_u32 v9, v5, 3, v8
    v_lshl_add_u32 v9, v164, 2, v9
    v_lshl_add_u32 v8, v5, 4, v8
    v_lshl_add_u32 v8, v164, 6, v8
    v_mov_b32 v164, 0xf149f2ca
    ds_write_b32 v9, v164 offset:160
    v_and_b32 v4, 31, v1
    v_lshrrev_b32 v5, 5, v1
    v_bfe_u32 v128, v4, 3, 1
    v_lshlrev_b32_e64 v128, 3, v128
    v_bfe_u32 v129, v4, 2, 1
    v_lshl_add_u32 v128, v129, 1, v128
    v_bfe_u32 v129, v4, 1, 1
    v_lshl_add_u32 v128, v129, 2, v128
    v_and_b32_e64 v129, 1, v4
    v_lshl_add_u32 v128, v129, 4, v128
    v_min_u32 v129, 23, v4
    v_lshlrev_b32 v129, 1, v129
    v_cmp_gt_u32 vcc, 16, v4
    s_nop 1
    v_cndmask_b32 v10, v129, v128, vcc
    v_lshlrev_b32 v10, 2, v10
    v_mul_u32_u24 v164, 208, v5
    v_add3_u32 v10, v10, v164, 0
    v_add_u32 v10, 21920, v10
    v_add_u32 v5, 2, v5
    v_lshrrev_b32 v130, 2, v4
    v_lshlrev_b32_e64 v130, 7, v130
    v_lshl_add_u32 v130, v5, 4, v130
    v_and_b32_e64 v129, 3, v4
    v_lshl_add_u32 v130, v129, 2, v130
    s_and_b32 s29, s28, 3
    s_lshl_b32 s29, s29, 9
    v_add_u32 v130, s29, v130
    v_subrev_u32 v129, 16, v4
    v_lshlrev_b32 v129, 4, v129
    v_add_u32 v129, v129, v5
    s_and_b32 s29, s28, 1
    s_lshl_b32 s29, s29, 3
    v_add_u32 v129, s29, v129
    v_lshlrev_b32 v129, 3, v129
    s_bfe_u32 s29, s28, 0x10001
    s_lshl_b32 s29, s29, 2
    s_nop 0
    s_add_u32 s29, s29, 2048
    v_add_u32_e64 v129, s29, v129
    v_cmp_gt_u32 vcc, 16, v4
    s_nop 1
    v_cndmask_b32 v11, v129, v130, vcc
    s_lshr_b32 s29, s28, 2
    s_mul_i32 s29, s29, 2560
    v_add_u32 v11, s29, v11
    v_mov_b32 v129, 0x40000000
    v_cmp_gt_u32 vcc, 20, v4
    s_nop 1
    v_cndmask_b32 v11, v129, v11, vcc
    v_mov_b32 v104, 0
    v_mov_b32 v105, 0
    v_mov_b32 v106, 0
    v_mov_b32 v107, 0
    v_mov_b32 v108, 0
    v_mov_b32 v109, 0
    v_mov_b32 v110, 0
    v_mov_b32 v111, 0
    v_mov_b32 v112, 0
    v_mov_b32 v113, 0
    v_mov_b32 v114, 0
    v_mov_b32 v115, 0
    v_mov_b32 v116, 0
    v_mov_b32 v117, 0
    v_mov_b32 v118, 0
    v_mov_b32 v119, 0
    v_mov_b32 v120, 0
    v_mov_b32 v121, 0
    v_mov_b32 v122, 0
    v_mov_b32 v123, 0
    v_mov_b32 v124, 0
    v_mov_b32 v125, 0
    v_mov_b32 v126, 0
    v_mov_b32 v127, 0
    s_mov_b32 s19, 0
    s_mov_b32 s20, 83886080
    s_mov_b32 s21, 83890176
    s_mov_b32 s22, 84443136
    s_mov_b32 s23, 3072
    s_add_u32 s29, s28, 0
    s_and_b32 s29, s29, 7
    s_lshl_b32 s70, s29, 10
    s_lshr_b32 s30, s29, 2
    s_mul_i32 s30, s30, 10240
    s_add_u32 s78, s70, s30
    s_nop 0
    s_add_u32 s70, s70, 118784
    s_add_u32 s29, s28, 1
    s_and_b32 s29, s29, 7
    s_lshl_b32 s71, s29, 10
    s_lshr_b32 s30, s29, 2
    s_mul_i32 s30, s30, 10240
    s_add_u32 s79, s71, s30
    s_nop 0
    s_add_u32 s71, s71, 118784
    s_add_u32 s29, s28, 2
    s_and_b32 s29, s29, 7
    s_lshl_b32 s72, s29, 10
    s_lshr_b32 s30, s29, 2
    s_mul_i32 s30, s30, 10240
    s_add_u32 s80, s72, s30
    s_nop 0
    s_add_u32 s72, s72, 118784
    s_add_u32 s29, s28, 3
    s_and_b32 s29, s29, 7
    s_lshl_b32 s73, s29, 10
    s_lshr_b32 s30, s29, 2
    s_mul_i32 s30, s30, 10240
    s_add_u32 s81, s73, s30
    s_nop 0
    s_add_u32 s73, s73, 118784
    s_add_u32 s29, s28, 4
    s_and_b32 s29, s29, 7
    s_lshl_b32 s74, s29, 10
    s_lshr_b32 s30, s29, 2
    s_mul_i32 s30, s30, 10240
    s_add_u32 s82, s74, s30
    s_nop 0
    s_add_u32 s74, s74, 118784
    s_add_u32 s29, s28, 5
    s_and_b32 s29, s29, 7
    s_lshl_b32 s75, s29, 10
    s_lshr_b32 s30, s29, 2
    s_mul_i32 s30, s30, 10240
    s_add_u32 s83, s75, s30
    s_nop 0
    s_add_u32 s75, s75, 118784
    s_add_u32 s29, s28, 6
    s_and_b32 s29, s29, 7
    s_lshl_b32 s76, s29, 10
    s_lshr_b32 s30, s29, 2
    s_mul_i32 s30, s30, 10240
    s_add_u32 s84, s76, s30
    s_nop 0
    s_add_u32 s76, s76, 118784
    s_add_u32 s29, s28, 7
    s_and_b32 s29, s29, 7
    s_lshl_b32 s77, s29, 10
    s_lshr_b32 s30, s29, 2
    s_mul_i32 s30, s30, 10240
    s_add_u32 s85, s77, s30
    s_nop 0
    s_add_u32 s77, s77, 118784
    v_add_u32 v13, 118784, v2
    v_mov_b32_e64 v14, 0x40000000
    v_cmp_eq_u32 vcc, 0, v1
    s_nop 1
    v_cndmask_b32 v14, v14, v1, vcc
    s_lshr_b32 s24, s28, 2
    s_lshl_b32 s24, s24, 7
    s_and_b32 s29, s28, 3
    s_lshl_b32 s29, s29, 2
    s_add_u32 s24, s24, s29
    s_add_u32 s24, s24, 85098496
    v_mov_b32_e64 v5, 0
    s_mov_b32 s30, 85133824
    s_mov_b32 s27, 0
    s_nop 0
SC1_WX:
    buffer_load_dword v4, v5, s[8:11], s30 offen sc1
    s_add_u32 s27, s27, 1
    s_nop 0
    s_cmp_gt_u32 s27, 65536
    s_cbranch_scc1 CH_FAIL
    s_waitcnt vmcnt(0)
    v_cmp_le_u32 vcc, 32, v4
    s_cbranch_vccnz SC1_WX_OK
    s_sleep 4
    s_branch SC1_WX
SC1_WX_OK:
    s_mov_b32 m0, s70
    s_add_u32 s26, s23, s78
    buffer_load_dwordx4 v2, s[8:11], s26 offen sc1 lds
    s_mov_b32 m0, s71
    s_add_u32 s26, s23, s79
    buffer_load_dwordx4 v2, s[8:11], s26 offen sc1 lds
    s_mov_b32 m0, s72
    s_add_u32 s26, s23, s80
    buffer_load_dwordx4 v2, s[8:11], s26 offen sc1 lds
    s_mov_b32 m0, s73
    s_add_u32 s26, s23, s81
    buffer_load_dwordx4 v2, s[8:11], s26 offen sc1 lds
    s_mov_b32 m0, s74
    s_add_u32 s26, s23, s82
    buffer_load_dwordx4 v2, s[8:11], s26 offen sc1 lds
    s_mov_b32 m0, s75
    s_add_u32 s26, s23, s83
    buffer_load_dwordx4 v2, s[8:11], s26 offen sc1 lds
    s_mov_b32 m0, s76
    s_add_u32 s26, s23, s84
    buffer_load_dwordx4 v2, s[8:11], s26 offen sc1 lds
    s_mov_b32 m0, s77
    s_add_u32 s26, s23, s85
    buffer_load_dwordx4 v2, s[8:11], s26 offen sc1 lds
    s_add_u32 s23, s23, 28672
    s_nop 0
    s_waitcnt vmcnt(0) lgkmcnt(0)
    s_cmp_lg_u32 s18, 0
    s_cbranch_scc1 SC1_CF_OK
    v_mov_b32 v5, 124
    s_mov_b32 s27, 0
    s_nop 0
SC1_CF:
    buffer_load_dword v4, v5, s[12:15], 0 offen sc1
    s_add_u32 s27, s27, 1
    s_waitcnt vmcnt(0)
    v_readfirstlane_b32 s30, v4
    s_nop 3
    s_cmp_eq_u32 s30, 0xffff
    s_cbranch_scc1 CH_REDO
    s_cmp_lg_u32 s30, 0
    s_cbranch_scc1 SC1_CF_OK
    s_sleep 2
    s_cmp_lt_u32 s27, 400
    s_cbranch_scc1 SC1_CF
    s_mov_b64 exec, 1
    v_mov_b32 v44, 0xffff
    v_mov_b32_e64 v45, 0
    buffer_atomic_cmpswap v[44:45], v5, s[12:15], 0 offen
    s_mov_b64 exec, -1
    s_mov_b32 s27, 0
    s_branch SC1_CF
    s_nop 0
SC1_CF_OK:
    s_barrier
    s_cmp_eq_u32 s18, 0
    s_cbranch_scc0 SC1_LOOP1
.p2align 7
SC1_LOOP0:
    ds_read_b128 v[140:143], v12 offset:0
    ds_read_b128 v[144:147], v12 offset:1024
    ds_read_b128 v[148:151], v12 offset:2048
    ds_read_b128 v[152:155], v12 offset:3072
    ds_read_b128 v[156:159], v12 offset:4096
    ds_read_b128 v[160:163], v12 offset:5120
    v_mov_b32 v44, 0
    v_mov_b32 v45, 0
    v_mov_b32 v46, 0
    v_mov_b32 v47, 0
    v_mov_b32 v48, 0
    v_mov_b32 v49, 0
    v_mov_b32 v50, 0
    v_mov_b32 v51, 0
    v_mov_b32 v52, 0
    v_mov_b32 v53, 0
    v_mov_b32 v54, 0
    v_mov_b32 v55, 0
    v_mov_b32 v56, 0
    v_mov_b32 v57, 0
    v_mov_b32 v58, 0
    v_mov_b32 v59, 0
    v_mov_b32 v60, 0
    v_mov_b32 v61, 0
    v_mov_b32 v62, 0
    v_mov_b32 v63, 0
    v_mov_b32 v64, 0
    v_mov_b32 v65, 0
    v_mov_b32 v66, 0
    v_mov_b32 v67, 0
    v_mov_b32 v68, 0
    v_mov_b32 v69, 0
    v_mov_b32 v70, 0
    v_mov_b32 v71, 0
    v_mov_b32 v136, 0
    v_mov_b32 v137, 0
    v_mov_b32_e64 v138, 0
    v_mov_b32 v139, 0
    s_waitcnt vmcnt(0)
    ds_read_b128 v[72:75], v13 offset:0
    ds_read_b128 v[76:79], v13 offset:1024
    ds_read_b128 v[80:83], v13 offset:2048
    ds_read_b128 v[84:87], v13 offset:3072
    ds_read_b128 v[88:91], v13 offset:4096
    ds_read_b128 v[92:95], v13 offset:5120
    ds_read_b128 v[96:99], v13 offset:6144
    ds_read_b128 v[100:103], v13 offset:7168
    s_mov_b32 s27, 0
    s_nop 0
    buffer_load_dwordx4 v[24:27], v2, s[8:11], s20 offen offset:2048 sc1
    buffer_load_dwordx4 v[28:31], v2, s[8:11], s20 offen offset:3072 sc1
    s_nop 15
    s_nop 15
SC1_LOOP0_POLL:
    buffer_load_dwordx4 v[24:27], v2, s[8:11], s20 offen offset:2048 sc1
    buffer_load_dwordx4 v[28:31], v2, s[8:11], s20 offen offset:3072 sc1
    s_add_u32 s27, s27, 1
    s_nop 0
    s_cmp_gt_u32 s27, 65536
    s_cbranch_scc1 CH_FAIL
    s_waitcnt vmcnt(2)
    v_max3_u32 v4, v24, v25, v26
    v_max3_u32 v4, v4, v27, v28
    v_max3_u32 v4, v4, v29, v30
    v_max_u32_e64 v4, v4, v31
    v_cmp_eq_u32 vcc, -1, v4
    s_cbranch_vccnz SC1_LOOP0_POLL
    ds_write_b128 v2, v[24:27] offset:38912
    ds_write_b128 v2, v[28:31] offset:39936
    v_smfmac_f32_16x16x64_bf16 v[44:47], v[24:27], a[0:7], v3
    v_smfmac_f32_16x16x64_bf16 v[48:51], v[24:27], a[8:15], v3
    v_smfmac_f32_16x16x64_bf16 v[52:55], v[24:27], a[16:23], v3
    v_smfmac_f32_16x16x64_bf16 v[56:59], v[24:27], a[24:31], v3
    v_smfmac_f32_16x16x64_bf16 v[60:63], v[24:27], a[32:39], v3
    v_smfmac_f32_16x16x64_bf16 v[64:67], v[24:27], a[40:47], v3
    s_waitcnt lgkmcnt(0)
    s_barrier
    ds_read_b128 v[16:19], v2 offset:36864
    ds_read_b128 v[20:23], v2 offset:37888
    ds_read_b128 v[32:35], v2 offset:40960
    ds_read_b128 v[36:39], v2 offset:41984
    ds_read_b128 v[40:43], v2 offset:43008
    v_smfmac_f32_16x16x64_bf16 v[68:71], v[24:27], a[48:55], v3
    v_smfmac_f32_16x16x64_bf16 v[44:47], v[28:31], a[56:63], v3
    v_smfmac_f32_16x16x64_bf16 v[48:51], v[28:31], v[140:147], v3
    ds_read_b128 v[140:143], v12 offset:6144
    v_smfmac_f32_16x16x64_bf16 v[52:55], v[28:31], a[64:71], v3
    ds_read_b128 v[144:147], v12 offset:7168
    v_smfmac_f32_16x16x64_bf16 v[56:59], v[28:31], a[72:79], v3
    v_smfmac_f32_16x16x64_bf16 v[60:63], v[28:31], a[80:87], v3
    v_smfmac_f32_16x16x64_bf16 v[64:67], v[28:31], v[148:155], v3
    ds_read_b128 v[148:151], v12 offset:8192
    v_smfmac_f32_16x16x64_bf16 v[68:71], v[28:31], a[88:95], v3
    ds_read_b128 v[152:155], v12 offset:9216
    s_nop 0
    s_waitcnt lgkmcnt(8)
    v_smfmac_f32_16x16x64_bf16 v[48:51], v[16:19], a[96:103], v3
    v_smfmac_f32_16x16x64_bf16 v[52:55], v[16:19], a[104:111], v3
    s_nop 0
    s_waitcnt lgkmcnt(7)
    v_smfmac_f32_16x16x64_bf16 v[48:51], v[20:23], v[156:163], v3
    ds_read_b128 v[156:159], v12 offset:10240
    v_smfmac_f32_16x16x64_bf16 v[52:55], v[20:23], a[112:119], v3
    ds_read_b128 v[160:163], v12 offset:11264
    s_nop 0
    s_waitcnt lgkmcnt(8)
    v_smfmac_f32_16x16x64_bf16 v[48:51], v[32:35], a[120:127], v3
    v_smfmac_f32_16x16x64_bf16 v[52:55], v[32:35], a[128:135], v3
    s_nop 0
    s_waitcnt lgkmcnt(7)
    v_smfmac_f32_16x16x64_bf16 v[48:51], v[36:39], a[136:143], v3
    v_smfmac_f32_16x16x64_bf16 v[52:55], v[36:39], a[144:151], v3
    s_waitcnt lgkmcnt(6)
    s_waitcnt lgkmcnt(4)
    v_smfmac_f32_16x16x64_bf16 v[48:51], v[40:43], v[140:147], v3
    v_smfmac_f32_16x16x64_bf16 v[52:55], v[40:43], a[152:159], v3
    v_smfmac_f32_16x16x64_bf16 v[56:59], v[16:19], a[160:167], v3
    v_smfmac_f32_16x16x64_bf16 v[60:63], v[16:19], a[168:175], v3
    v_smfmac_f32_16x16x64_bf16 v[56:59], v[20:23], a[176:183], v3
    v_smfmac_f32_16x16x64_bf16 v[60:63], v[20:23], a[184:191], v3
    v_smfmac_f32_16x16x64_bf16 v[56:59], v[32:35], a[192:199], v3
    v_smfmac_f32_16x16x64_bf16 v[60:63], v[32:35], a[200:207], v3
    v_smfmac_f32_16x16x64_bf16 v[56:59], v[36:39], a[208:215], v3
    v_cvt_pk_bf16_f32 v164, v48, v49
    v_smfmac_f32_16x16x64_bf16 v[60:63], v[36:39], a[216:223], v3
    v_cvt_pk_bf16_f32 v165, v50, v51
    v_smfmac_f32_16x16x64_bf16 v[56:59], v[40:43], a[224:231], v3
    ds_write_b64 v6, v[164:165] offset:768
    v_smfmac_f32_16x16x64_bf16 v[60:63], v[40:43], a[232:239], v3
    ds_read_b64_tr_b16 v[112:113], v7 offset:768
    v_smfmac_f32_16x16x64_bf16 v[64:67], v[16:19], a[240:247], v3
    v_cvt_pk_bf16_f32 v166, v52, v53
    v_smfmac_f32_16x16x64_bf16 v[68:71], v[16:19], a[248:255], v3
    v_cvt_pk_bf16_f32 v167, v54, v55
    s_nop 0
    s_waitcnt lgkmcnt(4)
    v_smfmac_f32_16x16x64_bf16 v[64:67], v[20:23], v[148:155], v3
    ds_write_b64 v6, v[166:167] offset:1536
    v_smfmac_f32_16x16x64_bf16 v[68:71], v[20:23], v[168:175], v3
    ds_read_b64_tr_b16 v[114:115], v7 offset:1536
    v_smfmac_f32_16x16x64_bf16 v[64:67], v[32:35], v[176:183], v3
    v_cvt_pk_bf16_f32 v164, v56, v57
    v_smfmac_f32_16x16x64_bf16 v[68:71], v[32:35], v[184:191], v3
    v_cvt_pk_bf16_f32 v165, v58, v59
    v_smfmac_f32_16x16x64_bf16 v[64:67], v[36:39], v[192:199], v3
    ds_write_b64 v6, v[164:165] offset:2304
    v_smfmac_f32_16x16x64_bf16 v[68:71], v[36:39], v[200:207], v3
    ds_read_b64_tr_b16 v[116:117], v7 offset:2304
    v_smfmac_f32_16x16x64_bf16 v[64:67], v[40:43], v[208:215], v3
    v_cvt_pk_bf16_f32 v166, v60, v61
    v_smfmac_f32_16x16x64_bf16 v[68:71], v[40:43], v[216:223], v3
    v_cvt_pk_bf16_f32 v167, v62, v63
    v_smfmac_f32_16x16x64_bf16 v[44:47], v[16:19], v[224:231], v3
    ds_write_b64 v6, v[166:167] offset:3072
    v_smfmac_f32_16x16x64_bf16 v[44:47], v[20:23], v[232:239], v3
    ds_read_b64_tr_b16 v[118:119], v7 offset:3072
    s_nop 0
    s_waitcnt lgkmcnt(8)
    v_smfmac_f32_16x16x64_bf16 v[44:47], v[32:35], v[156:163], v3
    v_cvt_pk_bf16_f32 v164, v64, v65
    v_smfmac_f32_16x16x64_bf16 v[44:47], v[36:39], v[240:247], v3
    v_cvt_pk_bf16_f32 v165, v66, v67
    v_smfmac_f32_16x16x64_bf16 v[44:47], v[40:43], v[248:255], v3
    ds_write_b64 v6, v[164:165] offset:3840
    s_nop 0
    s_waitcnt lgkmcnt(5)
    v_mfma_f32_16x16x32_bf16 v[128:131], v[76:79], v[112:115], 0
    ds_read_b64_tr_b16 v[120:121], v7 offset:3840
    v_cvt_pk_bf16_f32 v166, v68, v69
    v_mfma_f32_16x16x32_bf16 v[132:135], v[92:95], v[112:115], 0
    v_cvt_pk_bf16_f32 v167, v70, v71
    ds_write_b64 v6, v[166:167] offset:4608
    s_nop 0
    s_waitcnt lgkmcnt(3)
    v_smfmac_f32_16x16x64_bf16 v[136:139], v[24:27], v[112:119], v3
    ds_read_b64_tr_b16 v[122:123], v7 offset:4608
    v_mfma_f32_16x16x32_bf16 v[128:131], v[80:83], v[116:119], v[128:131]
    v_cvt_pk_bf16_f32 v166, v44, v45
    v_cvt_pk_bf16_f32 v167, v46, v47
    v_mfma_f32_16x16x32_bf16 v[132:135], v[96:99], v[116:119], v[132:135]
    ds_write_b64 v6, v[166:167] offset:0
    ds_read_b64_tr_b16 v[110:111], v7 offset:0
    s_nop 0
    s_waitcnt lgkmcnt(2)
    v_smfmac_f32_16x16x64_bf16 v[136:139], v[28:31], v[120:127], v3
    v_mfma_f32_16x16x32_bf16 v[128:131], v[84:87], v[120:123], v[128:131]
    v_mfma_f32_16x16x32_bf16 v[132:135], v[100:103], v[120:123], v[132:135]
    s_nop 0
    s_waitcnt lgkmcnt(0)
    v_smfmac_f32_16x16x64_bf16 v[136:139], v[20:23], v[104:111], v3
    v_mfma_f32_16x16x32_bf16 v[128:131], v[72:75], v[108:111], v[128:131]
    v_mfma_f32_16x16x32_bf16 v[132:135], v[88:91], v[108:111], v[132:135]
    s_nop 4
    s_nop 0
    v_permlane32_swap_b32 v136, v138
    v_permlane32_swap_b32 v137, v139
    v_add_f32_dpp v44, v128, v128 row_ror:8 row_mask:0xf bank_mask:0x3
    v_add_f32_dpp v45, v129, v129 row_ror:8 row_mask:0xf bank_mask:0x3
    v_add_f32_dpp v46, v130, v130 row_ror:8 row_mask:0xf bank_mask:0x3
    v_add_f32_dpp v47, v131, v131 row_ror:8 row_mask:0xf bank_mask:0x3
    v_add_f32 v136, v136, v138
    v_add_f32 v137, v137, v139
    v_add_f32_dpp v44, v132, v132 row_ror:8 row_mask:0xf bank_mask:0xc
    v_add_f32_dpp v45, v133, v133 row_ror:8 row_mask:0xf bank_mask:0xc
    v_add_f32_dpp v46, v134, v134 row_ror:8 row_mask:0xf bank_mask:0xc
    v_add_f32_dpp v47, v135, v135 row_ror:8 row_mask:0xf bank_mask:0xc
    ds_write_b128 v8, v[44:47]
    v_add_f32_dpp v164, v136, v136 row_ror:8 row_mask:0xf bank_mask:0x3
    v_add_f32_dpp v164, v137, v137 row_ror:8 row_mask:0xf bank_mask:0xc
    ds_write_b32 v9, v164 offset:128
    s_waitcnt lgkmcnt(0)
    s_barrier
    ds_read_b64 v[44:45], v10 offset:0
    ds_read_b64 v[46:47], v10 offset:1664
    ds_read_b64 v[48:49], v10 offset:3328
    ds_read_b64 v[50:51], v10 offset:4992
    s_nop 0
    s_waitcnt lgkmcnt(2)
    v_pk_add_f32 v[44:45], v[44:45], v[46:47]
    s_nop 0
    s_waitcnt lgkmcnt(0)
    v_pk_add_f32 v[48:49], v[48:49], v[50:51]
    v_pk_add_f32 v[44:45], v[44:45], v[48:49]
    v_max_f32 v46, v44, v45
    s_nop 1
    v_max_f32_dpp v46, v46, v46 quad_perm:[1,0,3,2] row_mask:0xf bank_mask:0xf
    s_nop 0
    s_nop 0
    v_max_f32_dpp v46, v46, v46 quad_perm:[2,3,0,1] row_mask:0xf bank_mask:0xf
    s_nop 0
    s_nop 0
    v_max_f32_dpp v46, v46, v46 row_half_mirror row_mask:0xf bank_mask:0xf
    s_nop 0
    s_nop 0
    v_max_f32_dpp v46, v46, v46 row_mirror row_mask:0xf bank_mask:0xf
    v_mov_b32 v47, v46
    s_nop 1
    v_permlane16_swap_b32 v46, v47
    s_nop 0
    v_max_f32 v46, v46, v47
    v_sub_f32 v44, v44, v46
    v_sub_f32 v45, v45, v46
    v_exp_f32 v44, v44
    v_exp_f32 v45, v45
    s_nop 0
    v_add_f32 v46, v44, v45
    s_nop 1
    v_add_f32_dpp v46, v46, v46 quad_perm:[1,0,3,2] row_mask:0xf bank_mask:0xf
    s_nop 0
    s_nop 0
    v_add_f32_dpp v46, v46, v46 quad_perm:[2,3,0,1] row_mask:0xf bank_mask:0xf
    s_nop 0
    s_nop 0
    v_add_f32_dpp v46, v46, v46 row_half_mirror row_mask:0xf bank_mask:0xf
    s_nop 0
    s_nop 0
    v_add_f32_dpp v46, v46, v46 row_mirror row_mask:0xf bank_mask:0xf
    v_mov_b32 v47, v46
    s_nop 1
    v_permlane16_swap_b32 v46, v47
    s_nop 0
    v_add_f32 v46, v46, v47
    v_rcp_f32 v46, v46
    s_nop 0
    v_mul_f32 v44, v44, v46
    v_mul_f32_e64 v45, v45, v46
    v_cvt_pk_bf16_f32 v164, v44, v45
    v_min_u32_e64 v164, 0xfffffffe, v164
    buffer_store_dword v164, v11, s[8:11], s22 offen
    s_nop 0
    s_sleep 5
    s_mov_b32 m0, s70
    s_add_u32 s26, s23, s78
    buffer_load_dwordx4 v2, s[8:11], s26 offen sc1 lds
    s_mov_b32 m0, s71
    s_add_u32 s26, s23, s79
    buffer_load_dwordx4 v2, s[8:11], s26 offen sc1 lds
    s_mov_b32 m0, s72
    s_add_u32 s26, s23, s80
    buffer_load_dwordx4 v2, s[8:11], s26 offen sc1 lds
    s_mov_b32 m0, s73
    s_add_u32 s26, s23, s81
    buffer_load_dwordx4 v2, s[8:11], s26 offen sc1 lds
    s_mov_b32 m0, s74
    s_add_u32 s26, s23, s82
    buffer_load_dwordx4 v2, s[8:11], s26 offen sc1 lds
    s_mov_b32 m0, s75
    s_add_u32 s26, s23, s83
    buffer_load_dwordx4 v2, s[8:11], s26 offen sc1 lds
    s_mov_b32 m0, s76
    s_add_u32 s26, s23, s84
    buffer_load_dwordx4 v2, s[8:11], s26 offen sc1 lds
    s_mov_b32 m0, s77
    s_add_u32 s26, s23, s85
    buffer_load_dwordx4 v2, s[8:11], s26 offen sc1 lds
    s_add_u32 s23, s23, 28672
    s_add_u32 s20, s20, 8192
    s_add_u32 s21, s21, 8192
    s_add_u32 s22, s22, 10240
    s_add_u32 s19, s19, 1
    s_cmp_lt_u32 s19, 63
    s_cbranch_scc1 SC1_LOOP0
    s_branch CH_DONE
.p2align 7
SC1_LOOP1:
    ds_read_b128 v[140:143], v12 offset:0
    ds_read_b128 v[144:147], v12 offset:1024
    ds_read_b128 v[148:151], v12 offset:2048
    ds_read_b128 v[152:155], v12 offset:3072
    ds_read_b128 v[156:159], v12 offset:4096
    ds_read_b128 v[160:163], v12 offset:5120
    v_mov_b32 v44, 0
    v_mov_b32 v45, 0
    v_mov_b32 v46, 0
    v_mov_b32 v47, 0
    v_mov_b32 v48, 0
    v_mov_b32 v49, 0
    v_mov_b32 v50, 0
    v_mov_b32 v51, 0
    v_mov_b32 v52, 0
    v_mov_b32 v53, 0
    v_mov_b32 v54, 0
    v_mov_b32 v55, 0
    v_mov_b32 v56, 0
    v_mov_b32 v57, 0
    v_mov_b32 v58, 0
    v_mov_b32 v59, 0
    v_mov_b32 v60, 0
    v_mov_b32 v61, 0
    v_mov_b32 v62, 0
    v_mov_b32 v63, 0
    v_mov_b32 v64, 0
    v_mov_b32 v65, 0
    v_mov_b32 v66, 0
    v_mov_b32 v67, 0
    v_mov_b32 v68, 0
    v_mov_b32 v69, 0
    v_mov_b32 v70, 0
    v_mov_b32 v71, 0
    v_mov_b32 v136, 0
    v_mov_b32 v137, 0
    v_mov_b32_e64 v138, 0
    v_mov_b32 v139, 0
    s_waitcnt vmcnt(0)
    ds_read_b128 v[72:75], v13 offset:0
    ds_read_b128 v[76:79], v13 offset:1024
    ds_read_b128 v[80:83], v13 offset:2048
    ds_read_b128 v[84:87], v13 offset:3072
    ds_read_b128 v[88:91], v13 offset:4096
    ds_read_b128 v[92:95], v13 offset:5120
    ds_read_b128 v[96:99], v13 offset:6144
    ds_read_b128 v[100:103], v13 offset:7168
    s_mov_b32 s27, 0
    s_nop 0
    buffer_load_dwordx4 v[24:27], v2, s[8:11], s20 offen offset:2048 sc1
    buffer_load_dwordx4 v[28:31], v2, s[8:11], s20 offen offset:3072 sc1
    s_nop 15
    s_nop 15
SC1_LOOP1_POLL:
    buffer_load_dwordx4 v[24:27], v2, s[8:11], s20 offen offset:2048 sc1
    buffer_load_dwordx4 v[28:31], v2, s[8:11], s20 offen offset:3072 sc1
    s_add_u32 s27, s27, 1
    s_nop 0
    s_cmp_gt_u32 s27, 65536
    s_cbranch_scc1 CH_FAIL
    s_waitcnt vmcnt(2)
    v_max3_u32 v4, v24, v25, v26
    v_max3_u32 v4, v4, v27, v28
    v_max3_u32 v4, v4, v29, v30
    v_max_u32_e64 v4, v4, v31
    v_cmp_eq_u32 vcc, -1, v4
    s_cbranch_vccnz SC1_LOOP1_POLL
    ds_write_b128 v2, v[24:27] offset:38912
    ds_write_b128 v2, v[28:31] offset:39936
    v_smfmac_f32_16x16x64_bf16 v[44:47], v[24:27], a[0:7], v3
    v_smfmac_f32_16x16x64_bf16 v[48:51], v[24:27], a[8:15], v3
    v_smfmac_f32_16x16x64_bf16 v[52:55], v[24:27], a[16:23], v3
    v_smfmac_f32_16x16x64_bf16 v[56:59], v[24:27], a[24:31], v3
    v_smfmac_f32_16x16x64_bf16 v[60:63], v[24:27], a[32:39], v3
    v_smfmac_f32_16x16x64_bf16 v[64:67], v[24:27], a[40:47], v3
    s_waitcnt lgkmcnt(0)
    s_barrier
    ds_read_b128 v[16:19], v2 offset:36864
    ds_read_b128 v[20:23], v2 offset:37888
    ds_read_b128 v[32:35], v2 offset:40960
    ds_read_b128 v[36:39], v2 offset:41984
    ds_read_b128 v[40:43], v2 offset:43008
    v_smfmac_f32_16x16x64_bf16 v[68:71], v[24:27], a[48:55], v3
    v_smfmac_f32_16x16x64_bf16 v[44:47], v[28:31], a[56:63], v3
    v_smfmac_f32_16x16x64_bf16 v[48:51], v[28:31], v[140:147], v3
    ds_read_b128 v[140:143], v12 offset:6144
    v_smfmac_f32_16x16x64_bf16 v[52:55], v[28:31], a[64:71], v3
    ds_read_b128 v[144:147], v12 offset:7168
    v_smfmac_f32_16x16x64_bf16 v[56:59], v[28:31], a[72:79], v3
    v_smfmac_f32_16x16x64_bf16 v[60:63], v[28:31], a[80:87], v3
    v_smfmac_f32_16x16x64_bf16 v[64:67], v[28:31], v[148:155], v3
    ds_read_b128 v[148:151], v12 offset:8192
    v_smfmac_f32_16x16x64_bf16 v[68:71], v[28:31], a[88:95], v3
    ds_read_b128 v[152:155], v12 offset:9216
    s_nop 0
    s_waitcnt lgkmcnt(8)
    v_smfmac_f32_16x16x64_bf16 v[48:51], v[16:19], a[96:103], v3
    v_smfmac_f32_16x16x64_bf16 v[52:55], v[16:19], a[104:111], v3
    s_nop 0
    s_waitcnt lgkmcnt(7)
    v_smfmac_f32_16x16x64_bf16 v[48:51], v[20:23], v[156:163], v3
    ds_read_b128 v[156:159], v12 offset:10240
    v_smfmac_f32_16x16x64_bf16 v[52:55], v[20:23], a[112:119], v3
    ds_read_b128 v[160:163], v12 offset:11264
    s_nop 0
    s_waitcnt lgkmcnt(8)
    v_smfmac_f32_16x16x64_bf16 v[48:51], v[32:35], a[120:127], v3
    v_smfmac_f32_16x16x64_bf16 v[52:55], v[32:35], a[128:135], v3
    s_nop 0
    s_waitcnt lgkmcnt(7)
    v_smfmac_f32_16x16x64_bf16 v[48:51], v[36:39], a[136:143], v3
    v_smfmac_f32_16x16x64_bf16 v[52:55], v[36:39], a[144:151], v3
    s_waitcnt lgkmcnt(6)
    s_waitcnt lgkmcnt(4)
    v_smfmac_f32_16x16x64_bf16 v[48:51], v[40:43], v[140:147], v3
    v_smfmac_f32_16x16x64_bf16 v[52:55], v[40:43], a[152:159], v3
    v_smfmac_f32_16x16x64_bf16 v[56:59], v[16:19], a[160:167], v3
    v_smfmac_f32_16x16x64_bf16 v[60:63], v[16:19], a[168:175], v3
    v_smfmac_f32_16x16x64_bf16 v[56:59], v[20:23], a[176:183], v3
    v_smfmac_f32_16x16x64_bf16 v[60:63], v[20:23], a[184:191], v3
    v_smfmac_f32_16x16x64_bf16 v[56:59], v[32:35], a[192:199], v3
    v_smfmac_f32_16x16x64_bf16 v[60:63], v[32:35], a[200:207], v3
    v_smfmac_f32_16x16x64_bf16 v[56:59], v[36:39], a[208:215], v3
    v_cvt_pk_bf16_f32 v164, v48, v49
    v_smfmac_f32_16x16x64_bf16 v[60:63], v[36:39], a[216:223], v3
    v_cvt_pk_bf16_f32 v165, v50, v51
    v_smfmac_f32_16x16x64_bf16 v[56:59], v[40:43], a[224:231], v3
    ds_write_b64 v6, v[164:165] offset:768
    v_smfmac_f32_16x16x64_bf16 v[60:63], v[40:43], a[232:239], v3
    ds_read_b64_tr_b16 v[112:113], v7 offset:768
    v_smfmac_f32_16x16x64_bf16 v[64:67], v[16:19], a[240:247], v3
    v_cvt_pk_bf16_f32 v166, v52, v53
    v_smfmac_f32_16x16x64_bf16 v[68:71], v[16:19], a[248:255], v3
    v_cvt_pk_bf16_f32 v167, v54, v55
    s_nop 0
    s_waitcnt lgkmcnt(4)
    v_smfmac_f32_16x16x64_bf16 v[64:67], v[20:23], v[148:155], v3
    ds_write_b64 v6, v[166:167] offset:1536
    v_smfmac_f32_16x16x64_bf16 v[68:71], v[20:23], v[168:175], v3
    ds_read_b64_tr_b16 v[114:115], v7 offset:1536
    v_smfmac_f32_16x16x64_bf16 v[64:67], v[32:35], v[176:183], v3
    v_cvt_pk_bf16_f32 v164, v56, v57
    v_smfmac_f32_16x16x64_bf16 v[68:71], v[32:35], v[184:191], v3
    v_cvt_pk_bf16_f32 v165, v58, v59
    v_smfmac_f32_16x16x64_bf16 v[64:67], v[36:39], v[192:199], v3
    ds_write_b64 v6, v[164:165] offset:2304
    v_smfmac_f32_16x16x64_bf16 v[68:71], v[36:39], v[200:207], v3
    ds_read_b64_tr_b16 v[116:117], v7 offset:2304
    v_smfmac_f32_16x16x64_bf16 v[64:67], v[40:43], v[208:215], v3
    v_cvt_pk_bf16_f32 v166, v60, v61
    v_smfmac_f32_16x16x64_bf16 v[68:71], v[40:43], v[216:223], v3
    v_cvt_pk_bf16_f32 v167, v62, v63
    v_smfmac_f32_16x16x64_bf16 v[44:47], v[16:19], v[224:231], v3
    ds_write_b64 v6, v[166:167] offset:3072
    v_smfmac_f32_16x16x64_bf16 v[44:47], v[20:23], v[232:239], v3
    ds_read_b64_tr_b16 v[118:119], v7 offset:3072
    s_nop 0
    s_waitcnt lgkmcnt(8)
    v_smfmac_f32_16x16x64_bf16 v[44:47], v[32:35], v[156:163], v3
    v_cvt_pk_bf16_f32 v164, v64, v65
    v_smfmac_f32_16x16x64_bf16 v[44:47], v[36:39], v[240:247], v3
    v_cvt_pk_bf16_f32 v165, v66, v67
    v_smfmac_f32_16x16x64_bf16 v[44:47], v[40:43], v[248:255], v3
    ds_write_b64 v6, v[164:165] offset:3840
    s_nop 0
    s_waitcnt lgkmcnt(5)
    v_mfma_f32_16x16x32_bf16 v[128:131], v[76:79], v[112:115], 0
    ds_read_b64_tr_b16 v[120:121], v7 offset:3840
    v_cvt_pk_bf16_f32 v166, v68, v69
    v_mfma_f32_16x16x32_bf16 v[132:135], v[92:95], v[112:115], 0
    v_cvt_pk_bf16_f32 v167, v70, v71
    ds_write_b64 v6, v[166:167] offset:4608
    s_nop 0
    s_waitcnt lgkmcnt(3)
    v_smfmac_f32_16x16x64_bf16 v[136:139], v[24:27], v[112:119], v3
    ds_read_b64_tr_b16 v[122:123], v7 offset:4608
    v_mfma_f32_16x16x32_bf16 v[128:131], v[80:83], v[116:119], v[128:131]
    v_cvt_pk_bf16_f32 v166, v44, v45
    v_cvt_pk_bf16_f32 v167, v46, v47
    v_mfma_f32_16x16x32_bf16 v[132:135], v[96:99], v[116:119], v[132:135]
    ds_write_b64 v6, v[166:167] offset:0
    ds_read_b64_tr_b16 v[110:111], v7 offset:0
    s_nop 0
    s_waitcnt lgkmcnt(2)
    v_smfmac_f32_16x16x64_bf16 v[136:139], v[28:31], v[120:127], v3
    v_mfma_f32_16x16x32_bf16 v[128:131], v[84:87], v[120:123], v[128:131]
    v_mfma_f32_16x16x32_bf16 v[132:135], v[100:103], v[120:123], v[132:135]
    s_nop 0
    s_waitcnt lgkmcnt(0)
    v_smfmac_f32_16x16x64_bf16 v[136:139], v[20:23], v[104:111], v3
    v_mfma_f32_16x16x32_bf16 v[128:131], v[72:75], v[108:111], v[128:131]
    v_mfma_f32_16x16x32_bf16 v[132:135], v[88:91], v[108:111], v[132:135]
    s_nop 4
    s_nop 0
    v_permlane32_swap_b32 v136, v138
    v_permlane32_swap_b32 v137, v139
    v_add_f32_dpp v44, v128, v128 row_ror:8 row_mask:0xf bank_mask:0x3
    v_add_f32_dpp v45, v129, v129 row_ror:8 row_mask:0xf bank_mask:0x3
    v_add_f32_dpp v46, v130, v130 row_ror:8 row_mask:0xf bank_mask:0x3
    v_add_f32_dpp v47, v131, v131 row_ror:8 row_mask:0xf bank_mask:0x3
    v_add_f32 v136, v136, v138
    v_add_f32 v137, v137, v139
    v_add_f32_dpp v44, v132, v132 row_ror:8 row_mask:0xf bank_mask:0xc
    v_add_f32_dpp v45, v133, v133 row_ror:8 row_mask:0xf bank_mask:0xc
    v_add_f32_dpp v46, v134, v134 row_ror:8 row_mask:0xf bank_mask:0xc
    v_add_f32_dpp v47, v135, v135 row_ror:8 row_mask:0xf bank_mask:0xc
    ds_write_b128 v8, v[44:47]
    v_add_f32_dpp v164, v136, v136 row_ror:8 row_mask:0xf bank_mask:0x3
    v_add_f32_dpp v164, v137, v137 row_ror:8 row_mask:0xf bank_mask:0xc
    ds_write_b32 v9, v164 offset:128
    s_waitcnt lgkmcnt(0)
    s_barrier
    ds_read_b64 v[44:45], v10 offset:0
    ds_read_b64 v[46:47], v10 offset:1664
    ds_read_b64 v[48:49], v10 offset:3328
    ds_read_b64 v[50:51], v10 offset:4992
    s_nop 0
    s_waitcnt lgkmcnt(2)
    v_pk_add_f32 v[44:45], v[44:45], v[46:47]
    s_nop 0
    s_waitcnt lgkmcnt(0)
    v_pk_add_f32 v[48:49], v[48:49], v[50:51]
    v_pk_add_f32 v[44:45], v[44:45], v[48:49]
    v_max_f32 v46, v44, v45
    s_nop 1
    v_max_f32_dpp v46, v46, v46 quad_perm:[1,0,3,2] row_mask:0xf bank_mask:0xf
    s_nop 0
    s_nop 0
    v_max_f32_dpp v46, v46, v46 quad_perm:[2,3,0,1] row_mask:0xf bank_mask:0xf
    s_nop 0
    s_nop 0
    v_max_f32_dpp v46, v46, v46 row_half_mirror row_mask:0xf bank_mask:0xf
    s_nop 0
    s_nop 0
    v_max_f32_dpp v46, v46, v46 row_mirror row_mask:0xf bank_mask:0xf
    v_mov_b32 v47, v46
    s_nop 1
    v_permlane16_swap_b32 v46, v47
    s_nop 0
    v_max_f32 v46, v46, v47
    v_sub_f32 v44, v44, v46
    v_sub_f32 v45, v45, v46
    v_exp_f32 v44, v44
    v_exp_f32 v45, v45
    s_nop 0
    v_add_f32 v46, v44, v45
    s_nop 1
    v_add_f32_dpp v46, v46, v46 quad_perm:[1,0,3,2] row_mask:0xf bank_mask:0xf
    s_nop 0
    s_nop 0
    v_add_f32_dpp v46, v46, v46 quad_perm:[2,3,0,1] row_mask:0xf bank_mask:0xf
    s_nop 0
    s_nop 0
    v_add_f32_dpp v46, v46, v46 row_half_mirror row_mask:0xf bank_mask:0xf
    s_nop 0
    s_nop 0
    v_add_f32_dpp v46, v46, v46 row_mirror row_mask:0xf bank_mask:0xf
    v_mov_b32 v47, v46
    s_nop 1
    v_permlane16_swap_b32 v46, v47
    s_nop 0
    v_add_f32 v46, v46, v47
    v_rcp_f32 v46, v46
    s_nop 0
    v_mul_f32 v44, v44, v46
    v_mul_f32_e64 v45, v45, v46
    v_cvt_pk_bf16_f32 v164, v44, v45
    v_min_u32_e64 v164, 0xfffffffe, v164
    buffer_store_dword v164, v11, s[8:11], s22 offen sc1
    s_nop 0
    s_sleep 5
    s_mov_b32 m0, s70
    s_add_u32 s26, s23, s78
    buffer_load_dwordx4 v2, s[8:11], s26 offen sc1 lds
    s_mov_b32 m0, s71
    s_add_u32 s26, s23, s79
    buffer_load_dwordx4 v2, s[8:11], s26 offen sc1 lds
    s_mov_b32 m0, s72
    s_add_u32 s26, s23, s80
    buffer_load_dwordx4 v2, s[8:11], s26 offen sc1 lds
    s_mov_b32 m0, s73
    s_add_u32 s26, s23, s81
    buffer_load_dwordx4 v2, s[8:11], s26 offen sc1 lds
    s_mov_b32 m0, s74
    s_add_u32 s26, s23, s82
    buffer_load_dwordx4 v2, s[8:11], s26 offen sc1 lds
    s_mov_b32 m0, s75
    s_add_u32 s26, s23, s83
    buffer_load_dwordx4 v2, s[8:11], s26 offen sc1 lds
    s_mov_b32 m0, s76
    s_add_u32 s26, s23, s84
    buffer_load_dwordx4 v2, s[8:11], s26 offen sc1 lds
    s_mov_b32 m0, s77
    s_add_u32 s26, s23, s85
    buffer_load_dwordx4 v2, s[8:11], s26 offen sc1 lds
    s_add_u32 s23, s23, 28672
    s_add_u32 s20, s20, 8192
    s_add_u32 s21, s21, 8192
    s_add_u32 s22, s22, 10240
    s_add_u32 s19, s19, 1
    s_cmp_lt_u32 s19, 63
    s_cbranch_scc1 SC1_LOOP1
    s_branch CH_DONE
SC2:
    v_and_b32 v1, 63, v0
    v_lshlrev_b32 v2, 4, v1
    v_mov_b32 v3, 0x4444
    v_mov_b32 v4, 0xeeee
    v_and_b32 v5, 8, v1
    v_cmp_ne_u32 vcc, 0, v5
    s_nop 1
    v_cndmask_b32 v3, v3, v4, vcc
    s_mul_i32 s25, s28, 401408
    s_add_u32 s25, s25, 2297856
    v_add_u32 v12, 69632, v2
    s_lshl_b32 s26, s28, 7
    v_mov_b32 v5, 0
    s_add_u32 s30, s26, 85137408
    s_mov_b32 s27, 0
    s_nop 0
SC2_WW:
    buffer_load_dword v4, v5, s[8:11], s30 offen sc1
    s_add_u32 s27, s27, 1
    s_nop 0
    s_cmp_gt_u32 s27, 65536
    s_cbranch_scc1 CH_FAIL
    s_waitcnt vmcnt(0)
    v_cmp_le_u32 vcc, 7, v4
    s_cbranch_vccnz SC2_WW_OK
    s_sleep 2
    s_branch SC2_WW
SC2_WW_OK:
    s_mov_b32 m0, 69632
    s_add_u32 s29, s25, 24576
    buffer_load_dwordx4 v2, s[8:11], s29 offen sc1 lds
    buffer_load_dwordx4 v2, s[8:11], s29 offen offset:1024 sc1 lds
    s_mov_b32 m0, 71680
    s_add_u32 s29, s25, 81920
    buffer_load_dwordx4 v2, s[8:11], s29 offen sc1 lds
    buffer_load_dwordx4 v2, s[8:11], s29 offen offset:1024 sc1 lds
    s_mov_b32 m0, 73728
    s_add_u32 s29, s25, 2048
    buffer_load_dwordx4 v2, s[8:11], s29 offen sc1 lds
    buffer_load_dwordx4 v2, s[8:11], s29 offen offset:1024 sc1 lds
    s_mov_b32 m0, 75776
    s_add_u32 s29, s25, 12288
    buffer_load_dwordx4 v2, s[8:11], s29 offen sc1 lds
    buffer_load_dwordx4 v2, s[8:11], s29 offen offset:1024 sc1 lds
    s_mov_b32 m0, 77824
    s_add_u32 s29, s25, 59392
    buffer_load_dwordx4 v2, s[8:11], s29 offen sc1 lds
    buffer_load_dwordx4 v2, s[8:11], s29 offen offset:1024 sc1 lds
    s_mov_b32 m0, 79872
    s_add_u32 s29, s25, 90112
    buffer_load_dwordx4 v2, s[8:11], s29 offen sc1 lds
    buffer_load_dwordx4 v2, s[8:11], s29 offen offset:1024 sc1 lds
    s_add_u32 s29, s25, 8192
    buffer_load_dwordx4 a[0:3], v2, s[8:11], s29 offen sc1
    buffer_load_dwordx4 a[4:7], v2, s[8:11], s29 offen offset:1024 sc1
    s_add_u32 s29, s25, 22528
    buffer_load_dwordx4 a[8:11], v2, s[8:11], s29 offen sc1
    buffer_load_dwordx4 a[12:15], v2, s[8:11], s29 offen offset:1024 sc1
    s_add_u32 s29, s25, 36864
    buffer_load_dwordx4 a[16:19], v2, s[8:11], s29 offen sc1
    buffer_load_dwordx4 a[20:23], v2, s[8:11], s29 offen offset:1024 sc1
    s_add_u32 s29, s25, 51200
    buffer_load_dwordx4 a[24:27], v2, s[8:11], s29 offen sc1
    buffer_load_dwordx4 a[28:31], v2, s[8:11], s29 offen offset:1024 sc1
    s_add_u32 s29, s25, 65536
    buffer_load_dwordx4 a[32:35], v2, s[8:11], s29 offen sc1
    buffer_load_dwordx4 a[36:39], v2, s[8:11], s29 offen offset:1024 sc1
    s_add_u32 s29, s25, 79872
    buffer_load_dwordx4 a[40:43], v2, s[8:11], s29 offen sc1
    buffer_load_dwordx4 a[44:47], v2, s[8:11], s29 offen offset:1024 sc1
    s_add_u32 s29, s25, 94208
    buffer_load_dwordx4 a[48:51], v2, s[8:11], s29 offen sc1
    buffer_load_dwordx4 a[52:55], v2, s[8:11], s29 offen offset:1024 sc1
    s_add_u32 s29, s25, 10240
    buffer_load_dwordx4 a[56:59], v2, s[8:11], s29 offen sc1
    buffer_load_dwordx4 a[60:63], v2, s[8:11], s29 offen offset:1024 sc1
    s_add_u32 s29, s25, 38912
    buffer_load_dwordx4 a[64:67], v2, s[8:11], s29 offen sc1
    buffer_load_dwordx4 a[68:71], v2, s[8:11], s29 offen offset:1024 sc1
    s_add_u32 s29, s25, 53248
    buffer_load_dwordx4 a[72:75], v2, s[8:11], s29 offen sc1
    buffer_load_dwordx4 a[76:79], v2, s[8:11], s29 offen offset:1024 sc1
    s_add_u32 s29, s25, 67584
    buffer_load_dwordx4 a[80:83], v2, s[8:11], s29 offen sc1
    buffer_load_dwordx4 a[84:87], v2, s[8:11], s29 offen offset:1024 sc1
    s_add_u32 s29, s25, 96256
    buffer_load_dwordx4 a[88:91], v2, s[8:11], s29 offen sc1
    buffer_load_dwordx4 a[92:95], v2, s[8:11], s29 offen offset:1024 sc1
    s_waitcnt vmcnt(24)
    s_add_u32 s29, s25, 0
    buffer_load_dwordx4 a[96:99], v2, s[8:11], s29 offen sc1
    buffer_load_dwordx4 a[100:103], v2, s[8:11], s29 offen offset:1024 sc1
    s_add_u32 s29, s25, 14336
    buffer_load_dwordx4 a[104:107], v2, s[8:11], s29 offen sc1
    buffer_load_dwordx4 a[108:111], v2, s[8:11], s29 offen offset:1024 sc1
    s_add_u32 s29, s25, 16384
    buffer_load_dwordx4 a[112:115], v2, s[8:11], s29 offen sc1
    buffer_load_dwordx4 a[116:119], v2, s[8:11], s29 offen offset:1024 sc1
    s_add_u32 s29, s25, 4096
    buffer_load_dwordx4 a[120:123], v2, s[8:11], s29 offen sc1
    buffer_load_dwordx4 a[124:127], v2, s[8:11], s29 offen offset:1024 sc1
    s_add_u32 s29, s25, 18432
    buffer_load_dwordx4 a[128:131], v2, s[8:11], s29 offen sc1
    buffer_load_dwordx4 a[132:135], v2, s[8:11], s29 offen offset:1024 sc1
    s_add_u32 s29, s25, 6144
    buffer_load_dwordx4 a[136:139], v2, s[8:11], s29 offen sc1
    buffer_load_dwordx4 a[140:143], v2, s[8:11], s29 offen offset:1024 sc1
    s_add_u32 s29, s25, 20480
    buffer_load_dwordx4 a[144:147], v2, s[8:11], s29 offen sc1
    buffer_load_dwordx4 a[148:151], v2, s[8:11], s29 offen offset:1024 sc1
    s_add_u32 s29, s25, 26624
    buffer_load_dwordx4 a[152:155], v2, s[8:11], s29 offen sc1
    buffer_load_dwordx4 a[156:159], v2, s[8:11], s29 offen offset:1024 sc1
    s_add_u32 s29, s25, 28672
    buffer_load_dwordx4 a[160:163], v2, s[8:11], s29 offen sc1
    buffer_load_dwordx4 a[164:167], v2, s[8:11], s29 offen offset:1024 sc1
    s_add_u32 s29, s25, 43008
    buffer_load_dwordx4 a[168:171], v2, s[8:11], s29 offen sc1
    buffer_load_dwordx4 a[172:175], v2, s[8:11], s29 offen offset:1024 sc1
    s_add_u32 s29, s25, 30720
    buffer_load_dwordx4 a[176:179], v2, s[8:11], s29 offen sc1
    buffer_load_dwordx4 a[180:183], v2, s[8:11], s29 offen offset:1024 sc1
    s_add_u32 s29, s25, 45056
    buffer_load_dwordx4 a[184:187], v2, s[8:11], s29 offen sc1
    buffer_load_dwordx4 a[188:191], v2, s[8:11], s29 offen offset:1024 sc1
    s_nop 0
    s_waitcnt vmcnt(24)
    s_add_u32 s29, s25, 32768
    buffer_load_dwordx4 a[192:195], v2, s[8:11], s29 offen sc1
    buffer_load_dwordx4 a[196:199], v2, s[8:11], s29 offen offset:1024 sc1
    s_add_u32 s29, s25, 47104
    buffer_load_dwordx4 a[200:203], v2, s[8:11], s29 offen sc1
    buffer_load_dwordx4 a[204:207], v2, s[8:11], s29 offen offset:1024 sc1
    s_add_u32 s29, s25, 34816
    buffer_load_dwordx4 a[208:211], v2, s[8:11], s29 offen sc1
    buffer_load_dwordx4 a[212:215], v2, s[8:11], s29 offen offset:1024 sc1
    s_add_u32 s29, s25, 49152
    buffer_load_dwordx4 a[216:219], v2, s[8:11], s29 offen sc1
    buffer_load_dwordx4 a[220:223], v2, s[8:11], s29 offen offset:1024 sc1
    s_add_u32 s29, s25, 40960
    buffer_load_dwordx4 a[224:227], v2, s[8:11], s29 offen sc1
    buffer_load_dwordx4 a[228:231], v2, s[8:11], s29 offen offset:1024 sc1
    s_add_u32 s29, s25, 55296
    buffer_load_dwordx4 a[232:235], v2, s[8:11], s29 offen sc1
    buffer_load_dwordx4 a[236:239], v2, s[8:11], s29 offen offset:1024 sc1
    s_add_u32 s29, s25, 57344
    buffer_load_dwordx4 a[240:243], v2, s[8:11], s29 offen sc1
    buffer_load_dwordx4 a[244:247], v2, s[8:11], s29 offen offset:1024 sc1
    s_add_u32 s29, s25, 71680
    buffer_load_dwordx4 a[248:251], v2, s[8:11], s29 offen sc1
    buffer_load_dwordx4 a[252:255], v2, s[8:11], s29 offen offset:1024 sc1
    s_add_u32 s29, s25, 73728
    buffer_load_dwordx4 v[168:171], v2, s[8:11], s29 offen sc1
    buffer_load_dwordx4 v[172:175], v2, s[8:11], s29 offen offset:1024 sc1
    s_add_u32 s29, s25, 61440
    buffer_load_dwordx4 v[176:179], v2, s[8:11], s29 offen sc1
    buffer_load_dwordx4 v[180:183], v2, s[8:11], s29 offen offset:1024 sc1
    s_add_u32 s29, s25, 75776
    buffer_load_dwordx4 v[184:187], v2, s[8:11], s29 offen sc1
    buffer_load_dwordx4 v[188:191], v2, s[8:11], s29 offen offset:1024 sc1
    s_add_u32 s29, s25, 63488
    buffer_load_dwordx4 v[192:195], v2, s[8:11], s29 offen sc1
    buffer_load_dwordx4 v[196:199], v2, s[8:11], s29 offen offset:1024 sc1
    s_nop 0
    s_waitcnt vmcnt(24)
    s_add_u32 s29, s25, 77824
    buffer_load_dwordx4 v[200:203], v2, s[8:11], s29 offen sc1
    buffer_load_dwordx4 v[204:207], v2, s[8:11], s29 offen offset:1024 sc1
    s_add_u32 s29, s25, 69632
    buffer_load_dwordx4 v[208:211], v2, s[8:11], s29 offen sc1
    buffer_load_dwordx4 v[212:215], v2, s[8:11], s29 offen offset:1024 sc1
    s_add_u32 s29, s25, 83968
    buffer_load_dwordx4 v[216:219], v2, s[8:11], s29 offen sc1
    buffer_load_dwordx4 v[220:223], v2, s[8:11], s29 offen offset:1024 sc1
    s_add_u32 s29, s25, 86016
    buffer_load_dwordx4 v[224:227], v2, s[8:11], s29 offen sc1
    buffer_load_dwordx4 v[228:231], v2, s[8:11], s29 offen offset:1024 sc1
    s_add_u32 s29, s25, 88064
    buffer_load_dwordx4 v[232:235], v2, s[8:11], s29 offen sc1
    buffer_load_dwordx4 v[236:239], v2, s[8:11], s29 offen offset:1024 sc1
    s_add_u32 s29, s25, 92160
    buffer_load_dwordx4 v[240:243], v2, s[8:11], s29 offen sc1
    buffer_load_dwordx4 v[244:247], v2, s[8:11], s29 offen offset:1024 sc1
    s_add_u32 s29, s25, 98304
    buffer_load_dwordx4 v[248:251], v2, s[8:11], s29 offen sc1
    buffer_load_dwordx4 v[252:255], v2, s[8:11], s29 offen offset:1024 sc1
    v_and_b32 v4, 3, v1
    v_lshrrev_b32 v5, 2, v1
    v_mul_u32_u24 v7, 192, v4
    v_lshl_add_u32 v7, v5, 3, v7
    v_add_u32 v7, 10752, v7
    v_and_b32 v4, 15, v1
    v_lshrrev_b32 v5, 4, v1
    v_mul_u32_u24 v6, 192, v5
    v_lshl_add_u32 v6, v4, 3, v6
    v_add_u32 v6, 10752, v6
    v_and_b32_e64 v164, 7, v4
    v_mul_u32_u24 v8, 208, v164
    v_add_u32 v8, 24832, v8
    v_lshrrev_b32_e64 v164, 3, v4
    v_lshl_add_u32 v9, v5, 3, v8
    v_lshl_add_u32 v9, v164, 2, v9
    v_lshl_add_u32 v8, v5, 4, v8
    v_lshl_add_u32 v8, v164, 6, v8
    v_mov_b32 v164, 0xf149f2ca
    ds_write_b32 v9, v164 offset:160
    v_and_b32 v4, 31, v1
    v_lshrrev_b32 v5, 5, v1
    v_bfe_u32 v128, v4, 3, 1
    v_lshlrev_b32_e64 v128, 3, v128
    v_bfe_u32 v129, v4, 2, 1
    v_lshl_add_u32 v128, v129, 1, v128
    v_bfe_u32 v129, v4, 1, 1
    v_lshl_add_u32 v128, v129, 2, v128
    v_and_b32_e64 v129, 1, v4
    v_lshl_add_u32 v128, v129, 4, v128
    v_min_u32 v129, 23, v4
    v_lshlrev_b32 v129, 1, v129
    v_cmp_gt_u32 vcc, 16, v4
    s_nop 1
    v_cndmask_b32 v10, v129, v128, vcc
    v_lshlrev_b32 v10, 2, v10
    v_mul_u32_u24 v164, 208, v5
    v_add3_u32 v10, v10, v164, 0
    v_add_u32 v10, 22336, v10
    v_add_u32 v5, 4, v5
    v_lshrrev_b32 v130, 2, v4
    v_lshlrev_b32_e64 v130, 7, v130
    v_lshl_add_u32 v130, v5, 4, v130
    v_and_b32_e64 v129, 3, v4
    v_lshl_add_u32 v130, v129, 2, v130
    s_and_b32 s29, s28, 3
    s_lshl_b32 s29, s29, 9
    v_add_u32 v130, s29, v130
    v_subrev_u32 v129, 16, v4
    v_lshlrev_b32 v129, 4, v129
    v_add_u32 v129, v129, v5
    s_and_b32 s29, s28, 1
    s_lshl_b32 s29, s29, 3
    v_add_u32 v129, s29, v129
    v_lshlrev_b32 v129, 3, v129
    s_bfe_u32 s29, s28, 0x10001
    s_lshl_b32 s29, s29, 2
    s_nop 0
    s_add_u32 s29, s29, 2048
    v_add_u32_e64 v129, s29, v129
    v_cmp_gt_u32 vcc, 16, v4
    s_nop 1
    v_cndmask_b32 v11, v129, v130, vcc
    s_lshr_b32 s29, s28, 2
    s_mul_i32 s29, s29, 2560
    v_add_u32 v11, s29, v11
    v_mov_b32 v129, 0x40000000
    v_cmp_gt_u32 vcc, 20, v4
    s_nop 1
    v_cndmask_b32 v11, v129, v11, vcc
    v_mov_b32 v104, 0
    v_mov_b32 v105, 0
    v_mov_b32 v106, 0
    v_mov_b32 v107, 0
    v_mov_b32 v108, 0
    v_mov_b32 v109, 0
    v_mov_b32 v110, 0
    v_mov_b32 v111, 0
    v_mov_b32 v112, 0
    v_mov_b32 v113, 0
    v_mov_b32 v114, 0
    v_mov_b32 v115, 0
    v_mov_b32 v116, 0
    v_mov_b32 v117, 0
    v_mov_b32 v118, 0
    v_mov_b32 v119, 0
    v_mov_b32 v120, 0
    v_mov_b32 v121, 0
    v_mov_b32 v122, 0
    v_mov_b32 v123, 0
    v_mov_b32 v124, 0
    v_mov_b32 v125, 0
    v_mov_b32 v126, 0
    v_mov_b32 v127, 0
    s_mov_b32 s19, 0
    s_mov_b32 s20, 83886080
    s_mov_b32 s21, 83890176
    s_mov_b32 s22, 84443136
    s_mov_b32 s23, 7168
    s_add_u32 s29, s28, 0
    s_and_b32 s29, s29, 7
    s_lshl_b32 s70, s29, 10
    s_lshr_b32 s30, s29, 2
    s_mul_i32 s30, s30, 10240
    s_add_u32 s78, s70, s30
    s_nop 0
    s_add_u32 s70, s70, 126976
    s_add_u32 s29, s28, 1
    s_and_b32 s29, s29, 7
    s_lshl_b32 s71, s29, 10
    s_lshr_b32 s30, s29, 2
    s_mul_i32 s30, s30, 10240
    s_add_u32 s79, s71, s30
    s_nop 0
    s_add_u32 s71, s71, 126976
    s_add_u32 s29, s28, 2
    s_and_b32 s29, s29, 7
    s_lshl_b32 s72, s29, 10
    s_lshr_b32 s30, s29, 2
    s_mul_i32 s30, s30, 10240
    s_add_u32 s80, s72, s30
    s_nop 0
    s_add_u32 s72, s72, 126976
    s_add_u32 s29, s28, 3
    s_and_b32 s29, s29, 7
    s_lshl_b32 s73, s29, 10
    s_lshr_b32 s30, s29, 2
    s_mul_i32 s30, s30, 10240
    s_add_u32 s81, s73, s30
    s_nop 0
    s_add_u32 s73, s73, 126976
    s_add_u32 s29, s28, 4
    s_and_b32 s29, s29, 7
    s_lshl_b32 s74, s29, 10
    s_lshr_b32 s30, s29, 2
    s_mul_i32 s30, s30, 10240
    s_add_u32 s82, s74, s30
    s_nop 0
    s_add_u32 s74, s74, 126976
    s_add_u32 s29, s28, 5
    s_and_b32 s29, s29, 7
    s_lshl_b32 s75, s29, 10
    s_lshr_b32 s30, s29, 2
    s_mul_i32 s30, s30, 10240
    s_add_u32 s83, s75, s30
    s_nop 0
    s_add_u32 s75, s75, 126976
    s_add_u32 s29, s28, 6
    s_and_b32 s29, s29, 7
    s_lshl_b32 s76, s29, 10
    s_lshr_b32 s30, s29, 2
    s_mul_i32 s30, s30, 10240
    s_add_u32 s84, s76, s30
    s_nop 0
    s_add_u32 s76, s76, 126976
    s_add_u32 s29, s28, 7
    s_and_b32 s29, s29, 7
    s_lshl_b32 s77, s29, 10
    s_lshr_b32 s30, s29, 2
    s_mul_i32 s30, s30, 10240
    s_add_u32 s85, s77, s30
    s_nop 0
    s_add_u32 s77, s77, 126976
    v_add_u32 v13, 126976, v2
    v_mov_b32_e64 v14, 0x40000000
    v_cmp_eq_u32 vcc, 0, v1
    s_nop 1
    v_cndmask_b32 v14, v14, v1, vcc
    s_lshr_b32 s24, s28, 2
    s_lshl_b32 s24, s24, 7
    s_and_b32 s29, s28, 3
    s_lshl_b32 s29, s29, 2
    s_add_u32 s24, s24, s29
    s_add_u32 s24, s24, 85098496
    v_mov_b32_e64 v5, 0
    s_mov_b32 s30, 85133824
    s_mov_b32 s27, 0
    s_nop 0
SC2_WX:
    buffer_load_dword v4, v5, s[8:11], s30 offen sc1
    s_add_u32 s27, s27, 1
    s_nop 0
    s_cmp_gt_u32 s27, 65536
    s_cbranch_scc1 CH_FAIL
    s_waitcnt vmcnt(0)
    v_cmp_le_u32 vcc, 32, v4
    s_cbranch_vccnz SC2_WX_OK
    s_sleep 4
    s_branch SC2_WX
SC2_WX_OK:
    s_mov_b32 m0, s70
    s_add_u32 s26, s23, s78
    buffer_load_dwordx4 v2, s[8:11], s26 offen sc1 lds
    s_mov_b32 m0, s71
    s_add_u32 s26, s23, s79
    buffer_load_dwordx4 v2, s[8:11], s26 offen sc1 lds
    s_mov_b32 m0, s72
    s_add_u32 s26, s23, s80
    buffer_load_dwordx4 v2, s[8:11], s26 offen sc1 lds
    s_mov_b32 m0, s73
    s_add_u32 s26, s23, s81
    buffer_load_dwordx4 v2, s[8:11], s26 offen sc1 lds
    s_mov_b32 m0, s74
    s_add_u32 s26, s23, s82
    buffer_load_dwordx4 v2, s[8:11], s26 offen sc1 lds
    s_mov_b32 m0, s75
    s_add_u32 s26, s23, s83
    buffer_load_dwordx4 v2, s[8:11], s26 offen sc1 lds
    s_mov_b32 m0, s76
    s_add_u32 s26, s23, s84
    buffer_load_dwordx4 v2, s[8:11], s26 offen sc1 lds
    s_mov_b32 m0, s77
    s_add_u32 s26, s23, s85
    buffer_load_dwordx4 v2, s[8:11], s26 offen sc1 lds
    s_add_u32 s23, s23, 28672
    s_nop 0
    s_waitcnt vmcnt(0) lgkmcnt(0)
    s_cmp_lg_u32 s18, 0
    s_cbranch_scc1 SC2_CF_OK
    v_mov_b32 v5, 124
    s_mov_b32 s27, 0
    s_nop 0
SC2_CF:
    buffer_load_dword v4, v5, s[12:15], 0 offen sc1
    s_add_u32 s27, s27, 1
    s_waitcnt vmcnt(0)
    v_readfirstlane_b32 s30, v4
    s_nop 3
    s_cmp_eq_u32 s30, 0xffff
    s_cbranch_scc1 CH_REDO
    s_cmp_lg_u32 s30, 0
    s_cbranch_scc1 SC2_CF_OK
    s_sleep 2
    s_cmp_lt_u32 s27, 400
    s_cbranch_scc1 SC2_CF
    s_mov_b64 exec, 1
    v_mov_b32 v44, 0xffff
    v_mov_b32_e64 v45, 0
    buffer_atomic_cmpswap v[44:45], v5, s[12:15], 0 offen
    s_mov_b64 exec, -1
    s_mov_b32 s27, 0
    s_branch SC2_CF
    s_nop 0
SC2_CF_OK:
    s_barrier
    s_cmp_eq_u32 s18, 0
    s_cbranch_scc0 SC2_LOOP1
.p2align 7
SC2_LOOP0:
    ds_read_b128 v[140:143], v12 offset:0
    ds_read_b128 v[144:147], v12 offset:1024
    ds_read_b128 v[148:151], v12 offset:2048
    ds_read_b128 v[152:155], v12 offset:3072
    ds_read_b128 v[156:159], v12 offset:4096
    ds_read_b128 v[160:163], v12 offset:5120
    v_mov_b32 v44, 0
    v_mov_b32 v45, 0
    v_mov_b32 v46, 0
    v_mov_b32 v47, 0
    v_mov_b32 v48, 0
    v_mov_b32 v49, 0
    v_mov_b32 v50, 0
    v_mov_b32 v51, 0
    v_mov_b32 v52, 0
    v_mov_b32 v53, 0
    v_mov_b32 v54, 0
    v_mov_b32 v55, 0
    v_mov_b32 v56, 0
    v_mov_b32 v57, 0
    v_mov_b32 v58, 0
    v_mov_b32 v59, 0
    v_mov_b32 v60, 0
    v_mov_b32 v61, 0
    v_mov_b32 v62, 0
    v_mov_b32 v63, 0
    v_mov_b32 v64, 0
    v_mov_b32 v65, 0
    v_mov_b32 v66, 0
    v_mov_b32 v67, 0
    v_mov_b32 v68, 0
    v_mov_b32 v69, 0
    v_mov_b32 v70, 0
    v_mov_b32 v71, 0
    v_mov_b32 v136, 0
    v_mov_b32 v137, 0
    v_mov_b32_e64 v138, 0
    v_mov_b32 v139, 0
    s_waitcnt vmcnt(0)
    ds_read_b128 v[72:75], v13 offset:0
    ds_read_b128 v[76:79], v13 offset:1024
    ds_read_b128 v[80:83], v13 offset:2048
    ds_read_b128 v[84:87], v13 offset:3072
    ds_read_b128 v[88:91], v13 offset:4096
    ds_read_b128 v[92:95], v13 offset:5120
    ds_read_b128 v[96:99], v13 offset:6144
    ds_read_b128 v[100:103], v13 offset:7168
    s_mov_b32 s27, 0
    s_nop 0
    buffer_load_dwordx4 v[32:35], v2, s[8:11], s21 offen offset:0 sc1
    buffer_load_dwordx4 v[36:39], v2, s[8:11], s21 offen offset:1024 sc1
    s_nop 15
    s_nop 15
SC2_LOOP0_POLL:
    buffer_load_dwordx4 v[32:35], v2, s[8:11], s21 offen offset:0 sc1
    buffer_load_dwordx4 v[36:39], v2, s[8:11], s21 offen offset:1024 sc1
    s_add_u32 s27, s27, 1
    s_nop 0
    s_cmp_gt_u32 s27, 65536
    s_cbranch_scc1 CH_FAIL
    s_waitcnt vmcnt(2)
    v_max3_u32 v4, v32, v33, v34
    v_max3_u32 v4, v4, v35, v36
    v_max3_u32 v4, v4, v37, v38
    v_max_u32_e64 v4, v4, v39
    v_cmp_eq_u32 vcc, -1, v4
    s_cbranch_vccnz SC2_LOOP0_POLL
    ds_write_b128 v2, v[32:35] offset:40960
    ds_write_b128 v2, v[36:39] offset:41984
    v_smfmac_f32_16x16x64_bf16 v[44:47], v[32:35], a[0:7], v3
    v_smfmac_f32_16x16x64_bf16 v[48:51], v[32:35], a[8:15], v3
    v_smfmac_f32_16x16x64_bf16 v[52:55], v[32:35], a[16:23], v3
    v_smfmac_f32_16x16x64_bf16 v[56:59], v[32:35], a[24:31], v3
    v_smfmac_f32_16x16x64_bf16 v[60:63], v[32:35], a[32:39], v3
    v_smfmac_f32_16x16x64_bf16 v[64:67], v[32:35], a[40:47], v3
    s_waitcnt lgkmcnt(0)
    s_barrier
    ds_read_b128 v[16:19], v2 offset:36864
    ds_read_b128 v[20:23], v2 offset:37888
    ds_read_b128 v[24:27], v2 offset:38912
    ds_read_b128 v[28:31], v2 offset:39936
    ds_read_b128 v[40:43], v2 offset:43008
    v_smfmac_f32_16x16x64_bf16 v[68:71], v[32:35], a[48:55], v3
    v_smfmac_f32_16x16x64_bf16 v[44:47], v[36:39], a[56:63], v3
    v_smfmac_f32_16x16x64_bf16 v[48:51], v[36:39], v[140:147], v3
    ds_read_b128 v[140:143], v12 offset:6144
    v_smfmac_f32_16x16x64_bf16 v[52:55], v[36:39], a[64:71], v3
    ds_read_b128 v[144:147], v12 offset:7168
    v_smfmac_f32_16x16x64_bf16 v[56:59], v[36:39], a[72:79], v3
    v_smfmac_f32_16x16x64_bf16 v[60:63], v[36:39], a[80:87], v3
    v_smfmac_f32_16x16x64_bf16 v[64:67], v[36:39], v[148:155], v3
    ds_read_b128 v[148:151], v12 offset:8192
    v_smfmac_f32_16x16x64_bf16 v[68:71], v[36:39], a[88:95], v3
    ds_read_b128 v[152:155], v12 offset:9216
    s_nop 0
    s_waitcnt lgkmcnt(8)
    v_smfmac_f32_16x16x64_bf16 v[44:47], v[16:19], a[96:103], v3
    v_smfmac_f32_16x16x64_bf16 v[48:51], v[16:19], a[104:111], v3
    s_nop 0
    s_waitcnt lgkmcnt(7)
    v_smfmac_f32_16x16x64_bf16 v[44:47], v[20:23], v[156:163], v3
    ds_read_b128 v[156:159], v12 offset:10240
    v_smfmac_f32_16x16x64_bf16 v[48:51], v[20:23], a[112:119], v3
    ds_read_b128 v[160:163], v12 offset:11264
    s_nop 0
    s_waitcnt lgkmcnt(8)
    v_smfmac_f32_16x16x64_bf16 v[44:47], v[24:27], a[120:127], v3
    v_smfmac_f32_16x16x64_bf16 v[48:51], v[24:27], a[128:135], v3
    s_nop 0
    s_waitcnt lgkmcnt(7)
    v_smfmac_f32_16x16x64_bf16 v[44:47], v[28:31], a[136:143], v3
    v_smfmac_f32_16x16x64_bf16 v[48:51], v[28:31], a[144:151], v3
    s_waitcnt lgkmcnt(6)
    s_waitcnt lgkmcnt(4)
    v_smfmac_f32_16x16x64_bf16 v[44:47], v[40:43], v[140:147], v3
    v_smfmac_f32_16x16x64_bf16 v[48:51], v[40:43], a[152:159], v3
    v_smfmac_f32_16x16x64_bf16 v[52:55], v[16:19], a[160:167], v3
    v_smfmac_f32_16x16x64_bf16 v[56:59], v[16:19], a[168:175], v3
    v_smfmac_f32_16x16x64_bf16 v[52:55], v[20:23], a[176:183], v3
    v_smfmac_f32_16x16x64_bf16 v[56:59], v[20:23], a[184:191], v3
    v_smfmac_f32_16x16x64_bf16 v[52:55], v[24:27], a[192:199], v3
    v_smfmac_f32_16x16x64_bf16 v[56:59], v[24:27], a[200:207], v3
    v_smfmac_f32_16x16x64_bf16 v[52:55], v[28:31], a[208:215], v3
    v_cvt_pk_bf16_f32 v164, v44, v45
    v_smfmac_f32_16x16x64_bf16 v[56:59], v[28:31], a[216:223], v3
    v_cvt_pk_bf16_f32 v165, v46, v47
    v_smfmac_f32_16x16x64_bf16 v[52:55], v[40:43], a[224:231], v3
    ds_write_b64 v6, v[164:165] offset:0
    v_smfmac_f32_16x16x64_bf16 v[56:59], v[40:43], a[232:239], v3
    ds_read_b64_tr_b16 v[108:109], v7 offset:0
    v_smfmac_f32_16x16x64_bf16 v[60:63], v[16:19], a[240:247], v3
    v_cvt_pk_bf16_f32 v166, v48, v49
    v_smfmac_f32_16x16x64_bf16 v[64:67], v[16:19], a[248:255], v3
    v_cvt_pk_bf16_f32 v167, v50, v51
    s_nop 0
    s_waitcnt lgkmcnt(4)
    v_smfmac_f32_16x16x64_bf16 v[60:63], v[20:23], v[148:155], v3
    ds_write_b64 v6, v[166:167] offset:768
    v_smfmac_f32_16x16x64_bf16 v[64:67], v[20:23], v[168:175], v3
    ds_read_b64_tr_b16 v[110:111], v7 offset:768
    v_smfmac_f32_16x16x64_bf16 v[60:63], v[24:27], v[176:183], v3
    v_cvt_pk_bf16_f32 v164, v52, v53
    v_smfmac_f32_16x16x64_bf16 v[64:67], v[24:27], v[184:191], v3
    v_cvt_pk_bf16_f32 v165, v54, v55
    v_smfmac_f32_16x16x64_bf16 v[60:63], v[28:31], v[192:199], v3
    ds_write_b64 v6, v[164:165] offset:1536
    v_smfmac_f32_16x16x64_bf16 v[64:67], v[28:31], v[200:207], v3
    ds_read_b64_tr_b16 v[112:113], v7 offset:1536
    v_smfmac_f32_16x16x64_bf16 v[60:63], v[40:43], v[208:215], v3
    v_cvt_pk_bf16_f32 v166, v56, v57
    v_smfmac_f32_16x16x64_bf16 v[64:67], v[40:43], v[216:223], v3
    v_cvt_pk_bf16_f32 v167, v58, v59
    v_smfmac_f32_16x16x64_bf16 v[68:71], v[16:19], v[224:231], v3
    ds_write_b64 v6, v[166:167] offset:2304
    v_smfmac_f32_16x16x64_bf16 v[68:71], v[20:23], v[232:239], v3
    ds_read_b64_tr_b16 v[114:115], v7 offset:2304
    s_nop 0
    s_waitcnt lgkmcnt(8)
    v_smfmac_f32_16x16x64_bf16 v[68:71], v[24:27], v[156:163], v3
    v_cvt_pk_bf16_f32 v164, v60, v61
    v_smfmac_f32_16x16x64_bf16 v[68:71], v[28:31], v[240:247], v3
    v_cvt_pk_bf16_f32 v165, v62, v63
    v_smfmac_f32_16x16x64_bf16 v[68:71], v[40:43], v[248:255], v3
    ds_write_b64 v6, v[164:165] offset:3072
    s_nop 0
    s_waitcnt lgkmcnt(5)
    v_smfmac_f32_16x16x64_bf16 v[136:139], v[28:31], v[104:111], v3
    ds_read_b64_tr_b16 v[116:117], v7 offset:3072
    v_cvt_pk_bf16_f32 v166, v64, v65
    v_mfma_f32_16x16x32_bf16 v[128:131], v[72:75], v[108:111], 0
    v_cvt_pk_bf16_f32 v167, v66, v67
    ds_write_b64 v6, v[166:167] offset:3840
    v_mfma_f32_16x16x32_bf16 v[132:135], v[88:91], v[108:111], 0
    ds_read_b64_tr_b16 v[118:119], v7 offset:3840
    s_nop 0
    s_waitcnt lgkmcnt(4)
    v_mfma_f32_16x16x32_bf16 v[128:131], v[76:79], v[112:115], v[128:131]
    v_mfma_f32_16x16x32_bf16 v[132:135], v[92:95], v[112:115], v[132:135]
    v_cvt_pk_bf16_f32 v164, v68, v69
    v_cvt_pk_bf16_f32 v165, v70, v71
    ds_write_b64 v6, v[164:165] offset:4608
    ds_read_b64_tr_b16 v[120:121], v7 offset:4608
    s_nop 0
    s_waitcnt lgkmcnt(2)
    v_smfmac_f32_16x16x64_bf16 v[136:139], v[32:35], v[112:119], v3
    v_mfma_f32_16x16x32_bf16 v[128:131], v[80:83], v[116:119], v[128:131]
    v_mfma_f32_16x16x32_bf16 v[132:135], v[96:99], v[116:119], v[132:135]
    s_nop 0
    s_waitcnt lgkmcnt(0)
    v_smfmac_f32_16x16x64_bf16 v[136:139], v[36:39], v[120:127], v3
    v_mfma_f32_16x16x32_bf16 v[128:131], v[84:87], v[120:123], v[128:131]
    v_mfma_f32_16x16x32_bf16 v[132:135], v[100:103], v[120:123], v[132:135]
    s_nop 4
    s_nop 0
    v_permlane32_swap_b32 v136, v138
    v_permlane32_swap_b32 v137, v139
    v_add_f32_dpp v44, v128, v128 row_ror:8 row_mask:0xf bank_mask:0x3
    v_add_f32_dpp v45, v129, v129 row_ror:8 row_mask:0xf bank_mask:0x3
    v_add_f32_dpp v46, v130, v130 row_ror:8 row_mask:0xf bank_mask:0x3
    v_add_f32_dpp v47, v131, v131 row_ror:8 row_mask:0xf bank_mask:0x3
    v_add_f32 v136, v136, v138
    v_add_f32 v137, v137, v139
    v_add_f32_dpp v44, v132, v132 row_ror:8 row_mask:0xf bank_mask:0xc
    v_add_f32_dpp v45, v133, v133 row_ror:8 row_mask:0xf bank_mask:0xc
    v_add_f32_dpp v46, v134, v134 row_ror:8 row_mask:0xf bank_mask:0xc
    v_add_f32_dpp v47, v135, v135 row_ror:8 row_mask:0xf bank_mask:0xc
    ds_write_b128 v8, v[44:47]
    v_add_f32_dpp v164, v136, v136 row_ror:8 row_mask:0xf bank_mask:0x3
    v_add_f32_dpp v164, v137, v137 row_ror:8 row_mask:0xf bank_mask:0xc
    ds_write_b32 v9, v164 offset:128
    s_waitcnt lgkmcnt(0)
    s_barrier
    ds_read_b64 v[44:45], v10 offset:0
    ds_read_b64 v[46:47], v10 offset:1664
    ds_read_b64 v[48:49], v10 offset:3328
    ds_read_b64 v[50:51], v10 offset:4992
    s_nop 0
    s_waitcnt lgkmcnt(2)
    v_pk_add_f32 v[44:45], v[44:45], v[46:47]
    s_nop 0
    s_waitcnt lgkmcnt(0)
    v_pk_add_f32 v[48:49], v[48:49], v[50:51]
    v_pk_add_f32 v[44:45], v[44:45], v[48:49]
    v_max_f32 v46, v44, v45
    s_nop 1
    v_max_f32_dpp v46, v46, v46 quad_perm:[1,0,3,2] row_mask:0xf bank_mask:0xf
    s_nop 0
    s_nop 0
    v_max_f32_dpp v46, v46, v46 quad_perm:[2,3,0,1] row_mask:0xf bank_mask:0xf
    s_nop 0
    s_nop 0
    v_max_f32_dpp v46, v46, v46 row_half_mirror row_mask:0xf bank_mask:0xf
    s_nop 0
    s_nop 0
    v_max_f32_dpp v46, v46, v46 row_mirror row_mask:0xf bank_mask:0xf
    v_mov_b32 v47, v46
    s_nop 1
    v_permlane16_swap_b32 v46, v47
    s_nop 0
    v_max_f32 v46, v46, v47
    v_sub_f32 v44, v44, v46
    v_sub_f32 v45, v45, v46
    v_exp_f32 v44, v44
    v_exp_f32 v45, v45
    s_nop 0
    v_add_f32 v46, v44, v45
    s_nop 1
    v_add_f32_dpp v46, v46, v46 quad_perm:[1,0,3,2] row_mask:0xf bank_mask:0xf
    s_nop 0
    s_nop 0
    v_add_f32_dpp v46, v46, v46 quad_perm:[2,3,0,1] row_mask:0xf bank_mask:0xf
    s_nop 0
    s_nop 0
    v_add_f32_dpp v46, v46, v46 row_half_mirror row_mask:0xf bank_mask:0xf
    s_nop 0
    s_nop 0
    v_add_f32_dpp v46, v46, v46 row_mirror row_mask:0xf bank_mask:0xf
    v_mov_b32 v47, v46
    s_nop 1
    v_permlane16_swap_b32 v46, v47
    s_nop 0
    v_add_f32 v46, v46, v47
    v_rcp_f32 v46, v46
    s_nop 0
    v_mul_f32 v44, v44, v46
    v_mul_f32_e64 v45, v45, v46
    v_cvt_pk_bf16_f32 v164, v44, v45
    v_min_u32_e64 v164, 0xfffffffe, v164
    buffer_store_dword v164, v11, s[8:11], s22 offen
    s_nop 0
    s_sleep 5
    s_mov_b32 m0, s70
    s_add_u32 s26, s23, s78
    buffer_load_dwordx4 v2, s[8:11], s26 offen sc1 lds
    s_mov_b32 m0, s71
    s_add_u32 s26, s23, s79
    buffer_load_dwordx4 v2, s[8:11], s26 offen sc1 lds
    s_mov_b32 m0, s72
    s_add_u32 s26, s23, s80
    buffer_load_dwordx4 v2, s[8:11], s26 offen sc1 lds
    s_mov_b32 m0, s73
    s_add_u32 s26, s23, s81
    buffer_load_dwordx4 v2, s[8:11], s26 offen sc1 lds
    s_mov_b32 m0, s74
    s_add_u32 s26, s23, s82
    buffer_load_dwordx4 v2, s[8:11], s26 offen sc1 lds
    s_mov_b32 m0, s75
    s_add_u32 s26, s23, s83
    buffer_load_dwordx4 v2, s[8:11], s26 offen sc1 lds
    s_mov_b32 m0, s76
    s_add_u32 s26, s23, s84
    buffer_load_dwordx4 v2, s[8:11], s26 offen sc1 lds
    s_mov_b32 m0, s77
    s_add_u32 s26, s23, s85
    buffer_load_dwordx4 v2, s[8:11], s26 offen sc1 lds
    s_add_u32 s23, s23, 28672
    s_add_u32 s20, s20, 8192
    s_add_u32 s21, s21, 8192
    s_add_u32 s22, s22, 10240
    s_add_u32 s19, s19, 1
    s_cmp_lt_u32 s19, 63
    s_cbranch_scc1 SC2_LOOP0
    s_branch CH_DONE
.p2align 7
SC2_LOOP1:
    ds_read_b128 v[140:143], v12 offset:0
    ds_read_b128 v[144:147], v12 offset:1024
    ds_read_b128 v[148:151], v12 offset:2048
    ds_read_b128 v[152:155], v12 offset:3072
    ds_read_b128 v[156:159], v12 offset:4096
    ds_read_b128 v[160:163], v12 offset:5120
    v_mov_b32 v44, 0
    v_mov_b32 v45, 0
    v_mov_b32 v46, 0
    v_mov_b32 v47, 0
    v_mov_b32 v48, 0
    v_mov_b32 v49, 0
    v_mov_b32 v50, 0
    v_mov_b32 v51, 0
    v_mov_b32 v52, 0
    v_mov_b32 v53, 0
    v_mov_b32 v54, 0
    v_mov_b32 v55, 0
    v_mov_b32 v56, 0
    v_mov_b32 v57, 0
    v_mov_b32 v58, 0
    v_mov_b32 v59, 0
    v_mov_b32 v60, 0
    v_mov_b32 v61, 0
    v_mov_b32 v62, 0
    v_mov_b32 v63, 0
    v_mov_b32 v64, 0
    v_mov_b32 v65, 0
    v_mov_b32 v66, 0
    v_mov_b32 v67, 0
    v_mov_b32 v68, 0
    v_mov_b32 v69, 0
    v_mov_b32 v70, 0
    v_mov_b32 v71, 0
    v_mov_b32 v136, 0
    v_mov_b32 v137, 0
    v_mov_b32_e64 v138, 0
    v_mov_b32 v139, 0
    s_waitcnt vmcnt(0)
    ds_read_b128 v[72:75], v13 offset:0
    ds_read_b128 v[76:79], v13 offset:1024
    ds_read_b128 v[80:83], v13 offset:2048
    ds_read_b128 v[84:87], v13 offset:3072
    ds_read_b128 v[88:91], v13 offset:4096
    ds_read_b128 v[92:95], v13 offset:5120
    ds_read_b128 v[96:99], v13 offset:6144
    ds_read_b128 v[100:103], v13 offset:7168
    s_mov_b32 s27, 0
    s_nop 0
    buffer_load_dwordx4 v[32:35], v2, s[8:11], s21 offen offset:0 sc1
    buffer_load_dwordx4 v[36:39], v2, s[8:11], s21 offen offset:1024 sc1
    s_nop 15
    s_nop 15
SC2_LOOP1_POLL:
    buffer_load_dwordx4 v[32:35], v2, s[8:11], s21 offen offset:0 sc1
    buffer_load_dwordx4 v[36:39], v2, s[8:11], s21 offen offset:1024 sc1
    s_add_u32 s27, s27, 1
    s_nop 0
    s_cmp_gt_u32 s27, 65536
    s_cbranch_scc1 CH_FAIL
    s_waitcnt vmcnt(2)
    v_max3_u32 v4, v32, v33, v34
    v_max3_u32 v4, v4, v35, v36
    v_max3_u32 v4, v4, v37, v38
    v_max_u32_e64 v4, v4, v39
    v_cmp_eq_u32 vcc, -1, v4
    s_cbranch_vccnz SC2_LOOP1_POLL
    ds_write_b128 v2, v[32:35] offset:40960
    ds_write_b128 v2, v[36:39] offset:41984
    v_smfmac_f32_16x16x64_bf16 v[44:47], v[32:35], a[0:7], v3
    v_smfmac_f32_16x16x64_bf16 v[48:51], v[32:35], a[8:15], v3
    v_smfmac_f32_16x16x64_bf16 v[52:55], v[32:35], a[16:23], v3
    v_smfmac_f32_16x16x64_bf16 v[56:59], v[32:35], a[24:31], v3
    v_smfmac_f32_16x16x64_bf16 v[60:63], v[32:35], a[32:39], v3
    v_smfmac_f32_16x16x64_bf16 v[64:67], v[32:35], a[40:47], v3
    s_waitcnt lgkmcnt(0)
    s_barrier
    ds_read_b128 v[16:19], v2 offset:36864
    ds_read_b128 v[20:23], v2 offset:37888
    ds_read_b128 v[24:27], v2 offset:38912
    ds_read_b128 v[28:31], v2 offset:39936
    ds_read_b128 v[40:43], v2 offset:43008
    v_smfmac_f32_16x16x64_bf16 v[68:71], v[32:35], a[48:55], v3
    v_smfmac_f32_16x16x64_bf16 v[44:47], v[36:39], a[56:63], v3
    v_smfmac_f32_16x16x64_bf16 v[48:51], v[36:39], v[140:147], v3
    ds_read_b128 v[140:143], v12 offset:6144
    v_smfmac_f32_16x16x64_bf16 v[52:55], v[36:39], a[64:71], v3
    ds_read_b128 v[144:147], v12 offset:7168
    v_smfmac_f32_16x16x64_bf16 v[56:59], v[36:39], a[72:79], v3
    v_smfmac_f32_16x16x64_bf16 v[60:63], v[36:39], a[80:87], v3
    v_smfmac_f32_16x16x64_bf16 v[64:67], v[36:39], v[148:155], v3
    ds_read_b128 v[148:151], v12 offset:8192
    v_smfmac_f32_16x16x64_bf16 v[68:71], v[36:39], a[88:95], v3
    ds_read_b128 v[152:155], v12 offset:9216
    s_nop 0
    s_waitcnt lgkmcnt(8)
    v_smfmac_f32_16x16x64_bf16 v[44:47], v[16:19], a[96:103], v3
    v_smfmac_f32_16x16x64_bf16 v[48:51], v[16:19], a[104:111], v3
    s_nop 0
    s_waitcnt lgkmcnt(7)
    v_smfmac_f32_16x16x64_bf16 v[44:47], v[20:23], v[156:163], v3
    ds_read_b128 v[156:159], v12 offset:10240
    v_smfmac_f32_16x16x64_bf16 v[48:51], v[20:23], a[112:119], v3
    ds_read_b128 v[160:163], v12 offset:11264
    s_nop 0
    s_waitcnt lgkmcnt(8)
    v_smfmac_f32_16x16x64_bf16 v[44:47], v[24:27], a[120:127], v3
    v_smfmac_f32_16x16x64_bf16 v[48:51], v[24:27], a[128:135], v3
    s_nop 0
    s_waitcnt lgkmcnt(7)
    v_smfmac_f32_16x16x64_bf16 v[44:47], v[28:31], a[136:143], v3
    v_smfmac_f32_16x16x64_bf16 v[48:51], v[28:31], a[144:151], v3
    s_waitcnt lgkmcnt(6)
    s_waitcnt lgkmcnt(4)
    v_smfmac_f32_16x16x64_bf16 v[44:47], v[40:43], v[140:147], v3
    v_smfmac_f32_16x16x64_bf16 v[48:51], v[40:43], a[152:159], v3
    v_smfmac_f32_16x16x64_bf16 v[52:55], v[16:19], a[160:167], v3
    v_smfmac_f32_16x16x64_bf16 v[56:59], v[16:19], a[168:175], v3
    v_smfmac_f32_16x16x64_bf16 v[52:55], v[20:23], a[176:183], v3
    v_smfmac_f32_16x16x64_bf16 v[56:59], v[20:23], a[184:191], v3
    v_smfmac_f32_16x16x64_bf16 v[52:55], v[24:27], a[192:199], v3
    v_smfmac_f32_16x16x64_bf16 v[56:59], v[24:27], a[200:207], v3
    v_smfmac_f32_16x16x64_bf16 v[52:55], v[28:31], a[208:215], v3
    v_cvt_pk_bf16_f32 v164, v44, v45
    v_smfmac_f32_16x16x64_bf16 v[56:59], v[28:31], a[216:223], v3
    v_cvt_pk_bf16_f32 v165, v46, v47
    v_smfmac_f32_16x16x64_bf16 v[52:55], v[40:43], a[224:231], v3
    ds_write_b64 v6, v[164:165] offset:0
    v_smfmac_f32_16x16x64_bf16 v[56:59], v[40:43], a[232:239], v3
    ds_read_b64_tr_b16 v[108:109], v7 offset:0
    v_smfmac_f32_16x16x64_bf16 v[60:63], v[16:19], a[240:247], v3
    v_cvt_pk_bf16_f32 v166, v48, v49
    v_smfmac_f32_16x16x64_bf16 v[64:67], v[16:19], a[248:255], v3
    v_cvt_pk_bf16_f32 v167, v50, v51
    s_nop 0
    s_waitcnt lgkmcnt(4)
    v_smfmac_f32_16x16x64_bf16 v[60:63], v[20:23], v[148:155], v3
    ds_write_b64 v6, v[166:167] offset:768
    v_smfmac_f32_16x16x64_bf16 v[64:67], v[20:23], v[168:175], v3
    ds_read_b64_tr_b16 v[110:111], v7 offset:768
    v_smfmac_f32_16x16x64_bf16 v[60:63], v[24:27], v[176:183], v3
    v_cvt_pk_bf16_f32 v164, v52, v53
    v_smfmac_f32_16x16x64_bf16 v[64:67], v[24:27], v[184:191], v3
    v_cvt_pk_bf16_f32 v165, v54, v55
    v_smfmac_f32_16x16x64_bf16 v[60:63], v[28:31], v[192:199], v3
    ds_write_b64 v6, v[164:165] offset:1536
    v_smfmac_f32_16x16x64_bf16 v[64:67], v[28:31], v[200:207], v3
    ds_read_b64_tr_b16 v[112:113], v7 offset:1536
    v_smfmac_f32_16x16x64_bf16 v[60:63], v[40:43], v[208:215], v3
    v_cvt_pk_bf16_f32 v166, v56, v57
    v_smfmac_f32_16x16x64_bf16 v[64:67], v[40:43], v[216:223], v3
    v_cvt_pk_bf16_f32 v167, v58, v59
    v_smfmac_f32_16x16x64_bf16 v[68:71], v[16:19], v[224:231], v3
    ds_write_b64 v6, v[166:167] offset:2304
    v_smfmac_f32_16x16x64_bf16 v[68:71], v[20:23], v[232:239], v3
    ds_read_b64_tr_b16 v[114:115], v7 offset:2304
    s_nop 0
    s_waitcnt lgkmcnt(8)
    v_smfmac_f32_16x16x64_bf16 v[68:71], v[24:27], v[156:163], v3
    v_cvt_pk_bf16_f32 v164, v60, v61
    v_smfmac_f32_16x16x64_bf16 v[68:71], v[28:31], v[240:247], v3
    v_cvt_pk_bf16_f32 v165, v62, v63
    v_smfmac_f32_16x16x64_bf16 v[68:71], v[40:43], v[248:255], v3
    ds_write_b64 v6, v[164:165] offset:3072
    s_nop 0
    s_waitcnt lgkmcnt(5)
    v_smfmac_f32_16x16x64_bf16 v[136:139], v[28:31], v[104:111], v3
    ds_read_b64_tr_b16 v[116:117], v7 offset:3072
    v_cvt_pk_bf16_f32 v166, v64, v65
    v_mfma_f32_16x16x32_bf16 v[128:131], v[72:75], v[108:111], 0
    v_cvt_pk_bf16_f32 v167, v66, v67
    ds_write_b64 v6, v[166:167] offset:3840
    v_mfma_f32_16x16x32_bf16 v[132:135], v[88:91], v[108:111], 0
    ds_read_b64_tr_b16 v[118:119], v7 offset:3840
    s_nop 0
    s_waitcnt lgkmcnt(4)
    v_mfma_f32_16x16x32_bf16 v[128:131], v[76:79], v[112:115], v[128:131]
    v_mfma_f32_16x16x32_bf16 v[132:135], v[92:95], v[112:115], v[132:135]
    v_cvt_pk_bf16_f32 v164, v68, v69
    v_cvt_pk_bf16_f32 v165, v70, v71
    ds_write_b64 v6, v[164:165] offset:4608
    ds_read_b64_tr_b16 v[120:121], v7 offset:4608
    s_nop 0
    s_waitcnt lgkmcnt(2)
    v_smfmac_f32_16x16x64_bf16 v[136:139], v[32:35], v[112:119], v3
    v_mfma_f32_16x16x32_bf16 v[128:131], v[80:83], v[116:119], v[128:131]
    v_mfma_f32_16x16x32_bf16 v[132:135], v[96:99], v[116:119], v[132:135]
    s_nop 0
    s_waitcnt lgkmcnt(0)
    v_smfmac_f32_16x16x64_bf16 v[136:139], v[36:39], v[120:127], v3
    v_mfma_f32_16x16x32_bf16 v[128:131], v[84:87], v[120:123], v[128:131]
    v_mfma_f32_16x16x32_bf16 v[132:135], v[100:103], v[120:123], v[132:135]
    s_nop 4
    s_nop 0
    v_permlane32_swap_b32 v136, v138
    v_permlane32_swap_b32 v137, v139
    v_add_f32_dpp v44, v128, v128 row_ror:8 row_mask:0xf bank_mask:0x3
    v_add_f32_dpp v45, v129, v129 row_ror:8 row_mask:0xf bank_mask:0x3
    v_add_f32_dpp v46, v130, v130 row_ror:8 row_mask:0xf bank_mask:0x3
    v_add_f32_dpp v47, v131, v131 row_ror:8 row_mask:0xf bank_mask:0x3
    v_add_f32 v136, v136, v138
    v_add_f32 v137, v137, v139
    v_add_f32_dpp v44, v132, v132 row_ror:8 row_mask:0xf bank_mask:0xc
    v_add_f32_dpp v45, v133, v133 row_ror:8 row_mask:0xf bank_mask:0xc
    v_add_f32_dpp v46, v134, v134 row_ror:8 row_mask:0xf bank_mask:0xc
    v_add_f32_dpp v47, v135, v135 row_ror:8 row_mask:0xf bank_mask:0xc
    ds_write_b128 v8, v[44:47]
    v_add_f32_dpp v164, v136, v136 row_ror:8 row_mask:0xf bank_mask:0x3
    v_add_f32_dpp v164, v137, v137 row_ror:8 row_mask:0xf bank_mask:0xc
    ds_write_b32 v9, v164 offset:128
    s_waitcnt lgkmcnt(0)
    s_barrier
    ds_read_b64 v[44:45], v10 offset:0
    ds_read_b64 v[46:47], v10 offset:1664
    ds_read_b64 v[48:49], v10 offset:3328
    ds_read_b64 v[50:51], v10 offset:4992
    s_nop 0
    s_waitcnt lgkmcnt(2)
    v_pk_add_f32 v[44:45], v[44:45], v[46:47]
    s_nop 0
    s_waitcnt lgkmcnt(0)
    v_pk_add_f32 v[48:49], v[48:49], v[50:51]
    v_pk_add_f32 v[44:45], v[44:45], v[48:49]
    v_max_f32 v46, v44, v45
    s_nop 1
    v_max_f32_dpp v46, v46, v46 quad_perm:[1,0,3,2] row_mask:0xf bank_mask:0xf
    s_nop 0
    s_nop 0
    v_max_f32_dpp v46, v46, v46 quad_perm:[2,3,0,1] row_mask:0xf bank_mask:0xf
    s_nop 0
    s_nop 0
    v_max_f32_dpp v46, v46, v46 row_half_mirror row_mask:0xf bank_mask:0xf
    s_nop 0
    s_nop 0
    v_max_f32_dpp v46, v46, v46 row_mirror row_mask:0xf bank_mask:0xf
    v_mov_b32 v47, v46
    s_nop 1
    v_permlane16_swap_b32 v46, v47
    s_nop 0
    v_max_f32 v46, v46, v47
    v_sub_f32 v44, v44, v46
    v_sub_f32 v45, v45, v46
    v_exp_f32 v44, v44
    v_exp_f32 v45, v45
    s_nop 0
    v_add_f32 v46, v44, v45
    s_nop 1
    v_add_f32_dpp v46, v46, v46 quad_perm:[1,0,3,2] row_mask:0xf bank_mask:0xf
    s_nop 0
    s_nop 0
    v_add_f32_dpp v46, v46, v46 quad_perm:[2,3,0,1] row_mask:0xf bank_mask:0xf
    s_nop 0
    s_nop 0
    v_add_f32_dpp v46, v46, v46 row_half_mirror row_mask:0xf bank_mask:0xf
    s_nop 0
    s_nop 0
    v_add_f32_dpp v46, v46, v46 row_mirror row_mask:0xf bank_mask:0xf
    v_mov_b32 v47, v46
    s_nop 1
    v_permlane16_swap_b32 v46, v47
    s_nop 0
    v_add_f32 v46, v46, v47
    v_rcp_f32 v46, v46
    s_nop 0
    v_mul_f32 v44, v44, v46
    v_mul_f32_e64 v45, v45, v46
    v_cvt_pk_bf16_f32 v164, v44, v45
    v_min_u32_e64 v164, 0xfffffffe, v164
    buffer_store_dword v164, v11, s[8:11], s22 offen sc1
    s_nop 0
    s_sleep 5
    s_mov_b32 m0, s70
    s_add_u32 s26, s23, s78
    buffer_load_dwordx4 v2, s[8:11], s26 offen sc1 lds
    s_mov_b32 m0, s71
    s_add_u32 s26, s23, s79
    buffer_load_dwordx4 v2, s[8:11], s26 offen sc1 lds
    s_mov_b32 m0, s72
    s_add_u32 s26, s23, s80
    buffer_load_dwordx4 v2, s[8:11], s26 offen sc1 lds
    s_mov_b32 m0, s73
    s_add_u32 s26, s23, s81
    buffer_load_dwordx4 v2, s[8:11], s26 offen sc1 lds
    s_mov_b32 m0, s74
    s_add_u32 s26, s23, s82
    buffer_load_dwordx4 v2, s[8:11], s26 offen sc1 lds
    s_mov_b32 m0, s75
    s_add_u32 s26, s23, s83
    buffer_load_dwordx4 v2, s[8:11], s26 offen sc1 lds
    s_mov_b32 m0, s76
    s_add_u32 s26, s23, s84
    buffer_load_dwordx4 v2, s[8:11], s26 offen sc1 lds
    s_mov_b32 m0, s77
    s_add_u32 s26, s23, s85
    buffer_load_dwordx4 v2, s[8:11], s26 offen sc1 lds
    s_add_u32 s23, s23, 28672
    s_add_u32 s20, s20, 8192
    s_add_u32 s21, s21, 8192
    s_add_u32 s22, s22, 10240
    s_add_u32 s19, s19, 1
    s_cmp_lt_u32 s19, 63
    s_cbranch_scc1 SC2_LOOP1
    s_branch CH_DONE
SC3:
    v_and_b32 v1, 63, v0
    v_lshlrev_b32 v2, 4, v1
    v_mov_b32 v3, 0x4444
    v_mov_b32 v4, 0xeeee
    v_and_b32 v5, 8, v1
    v_cmp_ne_u32 vcc, 0, v5
    s_nop 1
    v_cndmask_b32 v3, v3, v4, vcc
    s_mul_i32 s25, s28, 401408
    s_add_u32 s25, s25, 2398208
    v_add_u32 v12, 81920, v2
    s_lshl_b32 s26, s28, 7
    v_mov_b32 v5, 0
    s_add_u32 s30, s26, 85137408
    s_mov_b32 s27, 0
    s_nop 0
SC3_WW:
    buffer_load_dword v4, v5, s[8:11], s30 offen sc1
    s_add_u32 s27, s27, 1
    s_nop 0
    s_cmp_gt_u32 s27, 65536
    s_cbranch_scc1 CH_FAIL
    s_waitcnt vmcnt(0)
    v_cmp_le_u32 vcc, 7, v4
    s_cbranch_vccnz SC3_WW_OK
    s_sleep 2
    s_branch SC3_WW
SC3_WW_OK:
    s_mov_b32 m0, 81920
    s_add_u32 s29, s25, 14336
    buffer_load_dwordx4 v2, s[8:11], s29 offen sc1 lds
    buffer_load_dwordx4 v2, s[8:11], s29 offen offset:1024 sc1 lds
    s_mov_b32 m0, 83968
    s_add_u32 s29, s25, 71680
    buffer_load_dwordx4 v2, s[8:11], s29 offen sc1 lds
    buffer_load_dwordx4 v2, s[8:11], s29 offen offset:1024 sc1 lds
    s_mov_b32 m0, 86016
    s_add_u32 s29, s25, 18432
    buffer_load_dwordx4 v2, s[8:11], s29 offen sc1 lds
    buffer_load_dwordx4 v2, s[8:11], s29 offen offset:1024 sc1 lds
    s_mov_b32 m0, 88064
    s_add_u32 s29, s25, 24576
    buffer_load_dwordx4 v2, s[8:11], s29 offen sc1 lds
    buffer_load_dwordx4 v2, s[8:11], s29 offen offset:1024 sc1 lds
    s_mov_b32 m0, 90112
    s_add_u32 s29, s25, 75776
    buffer_load_dwordx4 v2, s[8:11], s29 offen sc1 lds
    buffer_load_dwordx4 v2, s[8:11], s29 offen offset:1024 sc1 lds
    s_mov_b32 m0, 92160
    s_add_u32 s29, s25, 6144
    buffer_load_dwordx4 v2, s[8:11], s29 offen sc1 lds
    buffer_load_dwordx4 v2, s[8:11], s29 offen offset:1024 sc1 lds
    s_add_u32 s29, s25, 12288
    buffer_load_dwordx4 a[0:3], v2, s[8:11], s29 offen sc1
    buffer_load_dwordx4 a[4:7], v2, s[8:11], s29 offen offset:1024 sc1
    s_add_u32 s29, s25, 26624
    buffer_load_dwordx4 a[8:11], v2, s[8:11], s29 offen sc1
    buffer_load_dwordx4 a[12:15], v2, s[8:11], s29 offen offset:1024 sc1
    s_add_u32 s29, s25, 40960
    buffer_load_dwordx4 a[16:19], v2, s[8:11], s29 offen sc1
    buffer_load_dwordx4 a[20:23], v2, s[8:11], s29 offen offset:1024 sc1
    s_add_u32 s29, s25, 55296
    buffer_load_dwordx4 a[24:27], v2, s[8:11], s29 offen sc1
    buffer_load_dwordx4 a[28:31], v2, s[8:11], s29 offen offset:1024 sc1
    s_add_u32 s29, s25, 69632
    buffer_load_dwordx4 a[32:35], v2, s[8:11], s29 offen sc1
    buffer_load_dwordx4 a[36:39], v2, s[8:11], s29 offen offset:1024 sc1
    s_add_u32 s29, s25, 83968
    buffer_load_dwordx4 a[40:43], v2, s[8:11], s29 offen sc1
    buffer_load_dwordx4 a[44:47], v2, s[8:11], s29 offen offset:1024 sc1
    s_add_u32 s29, s25, 98304
    buffer_load_dwordx4 a[48:51], v2, s[8:11], s29 offen sc1
    buffer_load_dwordx4 a[52:55], v2, s[8:11], s29 offen offset:1024 sc1
    s_add_u32 s29, s25, 0
    s_nop 0
    buffer_load_dwordx4 a[56:59], v2, s[8:11], s29 offen sc1
    buffer_load_dwordx4 a[60:63], v2, s[8:11], s29 offen offset:1024 sc1
    s_add_u32 s29, s25, 28672
    buffer_load_dwordx4 a[64:67], v2, s[8:11], s29 offen sc1
    buffer_load_dwordx4 a[68:71], v2, s[8:11], s29 offen offset:1024 sc1
    s_add_u32 s29, s25, 43008
    buffer_load_dwordx4 a[72:75], v2, s[8:11], s29 offen sc1
    buffer_load_dwordx4 a[76:79], v2, s[8:11], s29 offen offset:1024 sc1
    s_add_u32 s29, s25, 57344
    buffer_load_dwordx4 a[80:83], v2, s[8:11], s29 offen sc1
    buffer_load_dwordx4 a[84:87], v2, s[8:11], s29 offen offset:1024 sc1
    s_add_u32 s29, s25, 86016
    buffer_load_dwordx4 a[88:91], v2, s[8:11], s29 offen sc1
    buffer_load_dwordx4 a[92:95], v2, s[8:11], s29 offen offset:1024 sc1
    s_nop 0
    s_waitcnt vmcnt(24)
    s_add_u32 s29, s25, 16384
    buffer_load_dwordx4 a[96:99], v2, s[8:11], s29 offen sc1
    buffer_load_dwordx4 a[100:103], v2, s[8:11], s29 offen offset:1024 sc1
    s_add_u32 s29, s25, 30720
    buffer_load_dwordx4 a[104:107], v2, s[8:11], s29 offen sc1
    buffer_load_dwordx4 a[108:111], v2, s[8:11], s29 offen offset:1024 sc1
    s_add_u32 s29, s25, 32768
    buffer_load_dwordx4 a[112:115], v2, s[8:11], s29 offen sc1
    buffer_load_dwordx4 a[116:119], v2, s[8:11], s29 offen offset:1024 sc1
    s_add_u32 s29, s25, 20480
    buffer_load_dwordx4 a[120:123], v2, s[8:11], s29 offen sc1
    buffer_load_dwordx4 a[124:127], v2, s[8:11], s29 offen offset:1024 sc1
    s_add_u32 s29, s25, 34816
    buffer_load_dwordx4 a[128:131], v2, s[8:11], s29 offen sc1
    buffer_load_dwordx4 a[132:135], v2, s[8:11], s29 offen offset:1024 sc1
    s_add_u32 s29, s25, 22528
    buffer_load_dwordx4 a[136:139], v2, s[8:11], s29 offen sc1
    buffer_load_dwordx4 a[140:143], v2, s[8:11], s29 offen offset:1024 sc1
    s_add_u32 s29, s25, 36864
    buffer_load_dwordx4 a[144:147], v2, s[8:11], s29 offen sc1
    buffer_load_dwordx4 a[148:151], v2, s[8:11], s29 offen offset:1024 sc1
    s_add_u32 s29, s25, 38912
    buffer_load_dwordx4 a[152:155], v2, s[8:11], s29 offen sc1
    buffer_load_dwordx4 a[156:159], v2, s[8:11], s29 offen offset:1024 sc1
    s_add_u32 s29, s25, 45056
    buffer_load_dwordx4 a[160:163], v2, s[8:11], s29 offen sc1
    buffer_load_dwordx4 a[164:167], v2, s[8:11], s29 offen offset:1024 sc1
    s_add_u32 s29, s25, 59392
    buffer_load_dwordx4 a[168:171], v2, s[8:11], s29 offen sc1
    buffer_load_dwordx4 a[172:175], v2, s[8:11], s29 offen offset:1024 sc1
    s_add_u32 s29, s25, 47104
    buffer_load_dwordx4 a[176:179], v2, s[8:11], s29 offen sc1
    buffer_load_dwordx4 a[180:183], v2, s[8:11], s29 offen offset:1024 sc1
    s_add_u32 s29, s25, 61440
    buffer_load_dwordx4 a[184:187], v2, s[8:11], s29 offen sc1
    buffer_load_dwordx4 a[188:191], v2, s[8:11], s29 offen offset:1024 sc1
    s_nop 0
    s_waitcnt vmcnt(24)
    s_add_u32 s29, s25, 49152
    buffer_load_dwordx4 a[192:195], v2, s[8:11], s29 offen sc1
    buffer_load_dwordx4 a[196:199], v2, s[8:11], s29 offen offset:1024 sc1
    s_add_u32 s29, s25, 63488
    buffer_load_dwordx4 a[200:203], v2, s[8:11], s29 offen sc1
    buffer_load_dwordx4 a[204:207], v2, s[8:11], s29 offen offset:1024 sc1
    s_add_u32 s29, s25, 51200
    buffer_load_dwordx4 a[208:211], v2, s[8:11], s29 offen sc1
    buffer_load_dwordx4 a[212:215], v2, s[8:11], s29 offen offset:1024 sc1
    s_add_u32 s29, s25, 65536
    buffer_load_dwordx4 a[216:219], v2, s[8:11], s29 offen sc1
    buffer_load_dwordx4 a[220:223], v2, s[8:11], s29 offen offset:1024 sc1
    s_add_u32 s29, s25, 53248
    buffer_load_dwordx4 a[224:227], v2, s[8:11], s29 offen sc1
    buffer_load_dwordx4 a[228:231], v2, s[8:11], s29 offen offset:1024 sc1
    s_add_u32 s29, s25, 67584
    buffer_load_dwordx4 a[232:235], v2, s[8:11], s29 offen sc1
    buffer_load_dwordx4 a[236:239], v2, s[8:11], s29 offen offset:1024 sc1
    s_add_u32 s29, s25, 73728
    buffer_load_dwordx4 a[240:243], v2, s[8:11], s29 offen sc1
    buffer_load_dwordx4 a[244:247], v2, s[8:11], s29 offen offset:1024 sc1
    s_add_u32 s29, s25, 88064
    buffer_load_dwordx4 a[248:251], v2, s[8:11], s29 offen sc1
    buffer_load_dwordx4 a[252:255], v2, s[8:11], s29 offen offset:1024 sc1
    s_add_u32 s29, s25, 90112
    buffer_load_dwordx4 v[168:171], v2, s[8:11], s29 offen sc1
    buffer_load_dwordx4 v[172:175], v2, s[8:11], s29 offen offset:1024 sc1
    s_add_u32 s29, s25, 77824
    buffer_load_dwordx4 v[176:179], v2, s[8:11], s29 offen sc1
    buffer_load_dwordx4 v[180:183], v2, s[8:11], s29 offen offset:1024 sc1
    s_add_u32 s29, s25, 92160
    buffer_load_dwordx4 v[184:187], v2, s[8:11], s29 offen sc1
    buffer_load_dwordx4 v[188:191], v2, s[8:11], s29 offen offset:1024 sc1
    s_add_u32 s29, s25, 79872
    buffer_load_dwordx4 v[192:195], v2, s[8:11], s29 offen sc1
    buffer_load_dwordx4 v[196:199], v2, s[8:11], s29 offen offset:1024 sc1
    s_nop 0
    s_waitcnt vmcnt(24)
    s_add_u32 s29, s25, 94208
    buffer_load_dwordx4 v[200:203], v2, s[8:11], s29 offen sc1
    buffer_load_dwordx4 v[204:207], v2, s[8:11], s29 offen offset:1024 sc1
    s_add_u32 s29, s25, 81920
    buffer_load_dwordx4 v[208:211], v2, s[8:11], s29 offen sc1
    buffer_load_dwordx4 v[212:215], v2, s[8:11], s29 offen offset:1024 sc1
    s_add_u32 s29, s25, 96256
    buffer_load_dwordx4 v[216:219], v2, s[8:11], s29 offen sc1
    buffer_load_dwordx4 v[220:223], v2, s[8:11], s29 offen offset:1024 sc1
    s_add_u32 s29, s25, 2048
    buffer_load_dwordx4 v[224:227], v2, s[8:11], s29 offen sc1
    buffer_load_dwordx4 v[228:231], v2, s[8:11], s29 offen offset:1024 sc1
    s_add_u32 s29, s25, 4096
    buffer_load_dwordx4 v[232:235], v2, s[8:11], s29 offen sc1
    buffer_load_dwordx4 v[236:239], v2, s[8:11], s29 offen offset:1024 sc1
    s_add_u32 s29, s25, 8192
    buffer_load_dwordx4 v[240:243], v2, s[8:11], s29 offen sc1
    buffer_load_dwordx4 v[244:247], v2, s[8:11], s29 offen offset:1024 sc1
    s_add_u32 s29, s25, 10240
    buffer_load_dwordx4 v[248:251], v2, s[8:11], s29 offen sc1
    buffer_load_dwordx4 v[252:255], v2, s[8:11], s29 offen offset:1024 sc1
    v_and_b32 v4, 3, v1
    v_lshrrev_b32 v5, 2, v1
    v_mul_u32_u24 v7, 192, v4
    v_lshl_add_u32 v7, v5, 3, v7
    v_add_u32 v7, 16128, v7
    v_and_b32 v4, 15, v1
    v_lshrrev_b32 v5, 4, v1
    v_mul_u32_u24 v6, 192, v5
    v_lshl_add_u32 v6, v4, 3, v6
    v_add_u32 v6, 16128, v6
    v_and_b32_e64 v164, 7, v4
    v_mul_u32_u24 v8, 208, v164
    v_add_u32 v8, 26496, v8
    v_lshrrev_b32_e64 v164, 3, v4
    v_lshl_add_u32 v9, v5, 3, v8
    v_lshl_add_u32 v9, v164, 2, v9
    v_lshl_add_u32 v8, v5, 4, v8
    v_lshl_add_u32 v8, v164, 6, v8
    v_mov_b32 v164, 0xf149f2ca
    ds_write_b32 v9, v164 offset:160
    v_and_b32 v4, 31, v1
    v_lshrrev_b32 v5, 5, v1
    v_bfe_u32 v128, v4, 3, 1
    v_lshlrev_b32_e64 v128, 3, v128
    v_bfe_u32 v129, v4, 2, 1
    v_lshl_add_u32 v128, v129, 1, v128
    v_bfe_u32 v129, v4, 1, 1
    v_lshl_add_u32 v128, v129, 2, v128
    v_and_b32_e64 v129, 1, v4
    v_lshl_add_u32 v128, v129, 4, v128
    v_min_u32 v129, 23, v4
    v_lshlrev_b32 v129, 1, v129
    v_cmp_gt_u32 vcc, 16, v4
    s_nop 1
    v_cndmask_b32 v10, v129, v128, vcc
    v_lshlrev_b32 v10, 2, v10
    v_mul_u32_u24 v164, 208, v5
    v_add3_u32 v10, v10, v164, 0
    v_add_u32 v10, 22752, v10
    v_add_u32 v5, 6, v5
    v_lshrrev_b32 v130, 2, v4
    v_lshlrev_b32_e64 v130, 7, v130
    v_lshl_add_u32 v130, v5, 4, v130
    v_and_b32_e64 v129, 3, v4
    v_lshl_add_u32 v130, v129, 2, v130
    s_and_b32 s29, s28, 3
    s_lshl_b32 s29, s29, 9
    v_add_u32 v130, s29, v130
    v_subrev_u32 v129, 16, v4
    v_lshlrev_b32 v129, 4, v129
    v_add_u32 v129, v129, v5
    s_and_b32 s29, s28, 1
    s_lshl_b32 s29, s29, 3
    v_add_u32 v129, s29, v129
    v_lshlrev_b32 v129, 3, v129
    s_bfe_u32 s29, s28, 0x10001
    s_lshl_b32 s29, s29, 2
    s_nop 0
    s_add_u32 s29, s29, 2048
    v_add_u32_e64 v129, s29, v129
    v_cmp_gt_u32 vcc, 16, v4
    s_nop 1
    v_cndmask_b32 v11, v129, v130, vcc
    s_lshr_b32 s29, s28, 2
    s_mul_i32 s29, s29, 2560
    v_add_u32 v11, s29, v11
    v_mov_b32 v129, 0x40000000
    v_cmp_gt_u32 vcc, 20, v4
    s_nop 1
    v_cndmask_b32 v11, v129, v11, vcc
    v_mov_b32 v104, 0
    v_mov_b32 v105, 0
    v_mov_b32 v106, 0
    v_mov_b32 v107, 0
    v_mov_b32 v108, 0
    v_mov_b32 v109, 0
    v_mov_b32 v110, 0
    v_mov_b32 v111, 0
    v_mov_b32 v112, 0
    v_mov_b32 v113, 0
    v_mov_b32 v114, 0
    v_mov_b32 v115, 0
    v_mov_b32 v116, 0
    v_mov_b32 v117, 0
    v_mov_b32 v118, 0
    v_mov_b32 v119, 0
    v_mov_b32 v120, 0
    v_mov_b32 v121, 0
    v_mov_b32 v122, 0
    v_mov_b32 v123, 0
    v_mov_b32 v124, 0
    v_mov_b32 v125, 0
    v_mov_b32 v126, 0
    v_mov_b32 v127, 0
    s_mov_b32 s19, 0
    s_mov_b32 s20, 83886080
    s_mov_b32 s21, 83890176
    s_mov_b32 s22, 84443136
    s_mov_b32 s23, 10240
    s_add_u32 s29, s28, 0
    s_and_b32 s29, s29, 7
    s_lshl_b32 s70, s29, 10
    s_lshr_b32 s30, s29, 2
    s_mul_i32 s30, s30, 10240
    s_add_u32 s78, s70, s30
    s_nop 0
    s_add_u32 s70, s70, 135168
    s_add_u32 s29, s28, 1
    s_and_b32 s29, s29, 7
    s_lshl_b32 s71, s29, 10
    s_lshr_b32 s30, s29, 2
    s_mul_i32 s30, s30, 10240
    s_add_u32 s79, s71, s30
    s_nop 0
    s_add_u32 s71, s71, 135168
    s_add_u32 s29, s28, 2
    s_and_b32 s29, s29, 7
    s_lshl_b32 s72, s29, 10
    s_lshr_b32 s30, s29, 2
    s_mul_i32 s30, s30, 10240
    s_add_u32 s80, s72, s30
    s_nop 0
    s_add_u32 s72, s72, 135168
    s_add_u32 s29, s28, 3
    s_and_b32 s29, s29, 7
    s_lshl_b32 s73, s29, 10
    s_lshr_b32 s30, s29, 2
    s_mul_i32 s30, s30, 10240
    s_add_u32 s81, s73, s30
    s_nop 0
    s_add_u32 s73, s73, 135168
    s_add_u32 s29, s28, 4
    s_and_b32 s29, s29, 7
    s_lshl_b32 s74, s29, 10
    s_lshr_b32 s30, s29, 2
    s_mul_i32 s30, s30, 10240
    s_add_u32 s82, s74, s30
    s_nop 0
    s_add_u32 s74, s74, 135168
    s_add_u32 s29, s28, 5
    s_and_b32 s29, s29, 7
    s_lshl_b32 s75, s29, 10
    s_lshr_b32 s30, s29, 2
    s_mul_i32 s30, s30, 10240
    s_add_u32 s83, s75, s30
    s_nop 0
    s_add_u32 s75, s75, 135168
    s_add_u32 s29, s28, 6
    s_and_b32 s29, s29, 7
    s_lshl_b32 s76, s29, 10
    s_lshr_b32 s30, s29, 2
    s_mul_i32 s30, s30, 10240
    s_add_u32 s84, s76, s30
    s_nop 0
    s_add_u32 s76, s76, 135168
    s_add_u32 s29, s28, 7
    s_and_b32 s29, s29, 7
    s_lshl_b32 s77, s29, 10
    s_lshr_b32 s30, s29, 2
    s_mul_i32 s30, s30, 10240
    s_add_u32 s85, s77, s30
    s_nop 0
    s_add_u32 s77, s77, 135168
    v_add_u32 v13, 135168, v2
    v_mov_b32_e64 v14, 0x40000000
    v_cmp_eq_u32 vcc, 0, v1
    s_nop 1
    v_cndmask_b32 v14, v14, v1, vcc
    s_lshr_b32 s24, s28, 2
    s_lshl_b32 s24, s24, 7
    s_and_b32 s29, s28, 3
    s_lshl_b32 s29, s29, 2
    s_add_u32 s24, s24, s29
    s_add_u32 s24, s24, 85098496
    v_mov_b32_e64 v5, 0
    s_mov_b32 s30, 85133824
    s_mov_b32 s27, 0
    s_nop 0
SC3_WX:
    buffer_load_dword v4, v5, s[8:11], s30 offen sc1
    s_add_u32 s27, s27, 1
    s_nop 0
    s_cmp_gt_u32 s27, 65536
    s_cbranch_scc1 CH_FAIL
    s_waitcnt vmcnt(0)
    v_cmp_le_u32 vcc, 32, v4
    s_cbranch_vccnz SC3_WX_OK
    s_sleep 4
    s_branch SC3_WX
SC3_WX_OK:
    s_mov_b32 m0, s70
    s_add_u32 s26, s23, s78
    buffer_load_dwordx4 v2, s[8:11], s26 offen sc1 lds
    s_mov_b32 m0, s71
    s_add_u32 s26, s23, s79
    buffer_load_dwordx4 v2, s[8:11], s26 offen sc1 lds
    s_mov_b32 m0, s72
    s_add_u32 s26, s23, s80
    buffer_load_dwordx4 v2, s[8:11], s26 offen sc1 lds
    s_mov_b32 m0, s73
    s_add_u32 s26, s23, s81
    buffer_load_dwordx4 v2, s[8:11], s26 offen sc1 lds
    s_mov_b32 m0, s74
    s_add_u32 s26, s23, s82
    buffer_load_dwordx4 v2, s[8:11], s26 offen sc1 lds
    s_mov_b32 m0, s75
    s_add_u32 s26, s23, s83
    buffer_load_dwordx4 v2, s[8:11], s26 offen sc1 lds
    s_mov_b32 m0, s76
    s_add_u32 s26, s23, s84
    buffer_load_dwordx4 v2, s[8:11], s26 offen sc1 lds
    s_mov_b32 m0, s77
    s_add_u32 s26, s23, s85
    buffer_load_dwordx4 v2, s[8:11], s26 offen sc1 lds
    s_add_u32 s23, s23, 28672
    s_nop 0
    s_waitcnt vmcnt(0) lgkmcnt(0)
    s_cmp_lg_u32 s18, 0
    s_cbranch_scc1 SC3_CF_OK
    v_mov_b32 v5, 124
    s_mov_b32 s27, 0
    s_nop 0
SC3_CF:
    buffer_load_dword v4, v5, s[12:15], 0 offen sc1
    s_add_u32 s27, s27, 1
    s_waitcnt vmcnt(0)
    v_readfirstlane_b32 s30, v4
    s_nop 3
    s_cmp_eq_u32 s30, 0xffff
    s_cbranch_scc1 CH_REDO
    s_cmp_lg_u32 s30, 0
    s_cbranch_scc1 SC3_CF_OK
    s_sleep 2
    s_cmp_lt_u32 s27, 400
    s_cbranch_scc1 SC3_CF
    s_mov_b64 exec, 1
    v_mov_b32 v44, 0xffff
    v_mov_b32_e64 v45, 0
    buffer_atomic_cmpswap v[44:45], v5, s[12:15], 0 offen
    s_mov_b64 exec, -1
    s_mov_b32 s27, 0
    s_branch SC3_CF
    s_nop 0
SC3_CF_OK:
    s_barrier
    s_cmp_eq_u32 s18, 0
    s_cbranch_scc0 SC3_LOOP1
.p2align 7
SC3_LOOP0:
    ds_read_b128 v[140:143], v12 offset:0
    ds_read_b128 v[144:147], v12 offset:1024
    ds_read_b128 v[148:151], v12 offset:2048
    ds_read_b128 v[152:155], v12 offset:3072
    ds_read_b128 v[156:159], v12 offset:4096
    ds_read_b128 v[160:163], v12 offset:5120
    v_mov_b32 v44, 0
    v_mov_b32 v45, 0
    v_mov_b32 v46, 0
    v_mov_b32 v47, 0
    v_mov_b32 v48, 0
    v_mov_b32 v49, 0
    v_mov_b32 v50, 0
    v_mov_b32 v51, 0
    v_mov_b32 v52, 0
    v_mov_b32 v53, 0
    v_mov_b32 v54, 0
    v_mov_b32 v55, 0
    v_mov_b32 v56, 0
    v_mov_b32 v57, 0
    v_mov_b32 v58, 0
    v_mov_b32 v59, 0
    v_mov_b32 v60, 0
    v_mov_b32 v61, 0
    v_mov_b32 v62, 0
    v_mov_b32 v63, 0
    v_mov_b32 v64, 0
    v_mov_b32 v65, 0
    v_mov_b32 v66, 0
    v_mov_b32 v67, 0
    v_mov_b32 v68, 0
    v_mov_b32 v69, 0
    v_mov_b32 v70, 0
    v_mov_b32 v71, 0
    v_mov_b32 v136, 0
    v_mov_b32 v137, 0
    v_mov_b32_e64 v138, 0
    v_mov_b32 v139, 0
    s_waitcnt vmcnt(0)
    ds_read_b128 v[72:75], v13 offset:0
    ds_read_b128 v[76:79], v13 offset:1024
    ds_read_b128 v[80:83], v13 offset:2048
    ds_read_b128 v[84:87], v13 offset:3072
    ds_read_b128 v[88:91], v13 offset:4096
    ds_read_b128 v[92:95], v13 offset:5120
    ds_read_b128 v[96:99], v13 offset:6144
    ds_read_b128 v[100:103], v13 offset:7168
    s_mov_b32 s27, 0
    s_nop 0
    buffer_load_dwordx4 v[40:43], v2, s[8:11], s21 offen offset:2048 sc1
    buffer_load_dwordx4 v[16:19], v2, s[8:11], s20 offen offset:0 sc1
    s_nop 15
    s_nop 15
SC3_LOOP0_POLL:
    buffer_load_dwordx4 v[40:43], v2, s[8:11], s21 offen offset:2048 sc1
    buffer_load_dwordx4 v[16:19], v2, s[8:11], s20 offen offset:0 sc1
    s_add_u32 s27, s27, 1
    s_nop 0
    s_cmp_gt_u32 s27, 65536
    s_cbranch_scc1 CH_FAIL
    s_waitcnt vmcnt(2)
    v_max3_u32 v4, v40, v41, v42
    v_max3_u32 v4, v4, v43, v16
    v_max3_u32 v4, v4, v17, v18
    v_max_u32_e64 v4, v4, v19
    v_cmp_eq_u32 vcc, -1, v4
    s_cbranch_vccnz SC3_LOOP0_POLL
    ds_write_b128 v2, v[40:43] offset:43008
    v_smfmac_f32_16x16x64_bf16 v[44:47], v[40:43], a[0:7], v3
    v_smfmac_f32_16x16x64_bf16 v[48:51], v[40:43], a[8:15], v3
    v_smfmac_f32_16x16x64_bf16 v[52:55], v[40:43], a[16:23], v3
    v_smfmac_f32_16x16x64_bf16 v[56:59], v[40:43], a[24:31], v3
    v_smfmac_f32_16x16x64_bf16 v[60:63], v[40:43], a[32:39], v3
    v_smfmac_f32_16x16x64_bf16 v[64:67], v[40:43], a[40:47], v3
    s_waitcnt lgkmcnt(0)
    s_barrier
    ds_read_b128 v[20:23], v2 offset:37888
    ds_read_b128 v[24:27], v2 offset:38912
    ds_read_b128 v[28:31], v2 offset:39936
    ds_read_b128 v[32:35], v2 offset:40960
    ds_read_b128 v[36:39], v2 offset:41984
    v_smfmac_f32_16x16x64_bf16 v[68:71], v[40:43], a[48:55], v3
    v_smfmac_f32_16x16x64_bf16 v[44:47], v[16:19], a[56:63], v3
    v_smfmac_f32_16x16x64_bf16 v[48:51], v[16:19], v[140:147], v3
    ds_read_b128 v[140:143], v12 offset:6144
    v_smfmac_f32_16x16x64_bf16 v[52:55], v[16:19], a[64:71], v3
    ds_read_b128 v[144:147], v12 offset:7168
    v_smfmac_f32_16x16x64_bf16 v[56:59], v[16:19], a[72:79], v3
    v_smfmac_f32_16x16x64_bf16 v[60:63], v[16:19], a[80:87], v3
    v_smfmac_f32_16x16x64_bf16 v[64:67], v[16:19], v[148:155], v3
    ds_read_b128 v[148:151], v12 offset:8192
    v_smfmac_f32_16x16x64_bf16 v[68:71], v[16:19], a[88:95], v3
    ds_read_b128 v[152:155], v12 offset:9216
    s_nop 0
    s_waitcnt lgkmcnt(8)
    v_smfmac_f32_16x16x64_bf16 v[48:51], v[20:23], a[96:103], v3
    v_smfmac_f32_16x16x64_bf16 v[52:55], v[20:23], a[104:111], v3
    s_nop 0
    s_waitcnt lgkmcnt(7)
    v_smfmac_f32_16x16x64_bf16 v[48:51], v[24:27], v[156:163], v3
    ds_read_b128 v[156:159], v12 offset:10240
    v_smfmac_f32_16x16x64_bf16 v[52:55], v[24:27], a[112:119], v3
    ds_read_b128 v[160:163], v12 offset:11264
    s_nop 0
    s_waitcnt lgkmcnt(8)
    v_smfmac_f32_16x16x64_bf16 v[48:51], v[28:31], a[120:127], v3
    v_smfmac_f32_16x16x64_bf16 v[52:55], v[28:31], a[128:135], v3
    s_nop 0
    s_waitcnt lgkmcnt(7)
    v_smfmac_f32_16x16x64_bf16 v[48:51], v[32:35], a[136:143], v3
    v_smfmac_f32_16x16x64_bf16 v[52:55], v[32:35], a[144:151], v3
    s_waitcnt lgkmcnt(6)
    s_waitcnt lgkmcnt(4)
    v_smfmac_f32_16x16x64_bf16 v[48:51], v[36:39], v[140:147], v3
    v_smfmac_f32_16x16x64_bf16 v[52:55], v[36:39], a[152:159], v3
    v_smfmac_f32_16x16x64_bf16 v[56:59], v[20:23], a[160:167], v3
    v_smfmac_f32_16x16x64_bf16 v[60:63], v[20:23], a[168:175], v3
    v_smfmac_f32_16x16x64_bf16 v[56:59], v[24:27], a[176:183], v3
    v_smfmac_f32_16x16x64_bf16 v[60:63], v[24:27], a[184:191], v3
    v_smfmac_f32_16x16x64_bf16 v[56:59], v[28:31], a[192:199], v3
    v_smfmac_f32_16x16x64_bf16 v[60:63], v[28:31], a[200:207], v3
    v_smfmac_f32_16x16x64_bf16 v[56:59], v[32:35], a[208:215], v3
    v_cvt_pk_bf16_f32 v164, v48, v49
    v_smfmac_f32_16x16x64_bf16 v[60:63], v[32:35], a[216:223], v3
    v_cvt_pk_bf16_f32 v165, v50, v51
    v_smfmac_f32_16x16x64_bf16 v[56:59], v[36:39], a[224:231], v3
    ds_write_b64 v6, v[164:165] offset:768
    v_smfmac_f32_16x16x64_bf16 v[60:63], v[36:39], a[232:239], v3
    ds_read_b64_tr_b16 v[112:113], v7 offset:768
    v_smfmac_f32_16x16x64_bf16 v[64:67], v[20:23], a[240:247], v3
    v_cvt_pk_bf16_f32 v166, v52, v53
    v_smfmac_f32_16x16x64_bf16 v[68:71], v[20:23], a[248:255], v3
    v_cvt_pk_bf16_f32 v167, v54, v55
    s_nop 0
    s_waitcnt lgkmcnt(4)
    v_smfmac_f32_16x16x64_bf16 v[64:67], v[24:27], v[148:155], v3
    ds_write_b64 v6, v[166:167] offset:1536
    v_smfmac_f32_16x16x64_bf16 v[68:71], v[24:27], v[168:175], v3
    ds_read_b64_tr_b16 v[114:115], v7 offset:1536
    v_smfmac_f32_16x16x64_bf16 v[64:67], v[28:31], v[176:183], v3
    v_cvt_pk_bf16_f32 v164, v56, v57
    v_smfmac_f32_16x16x64_bf16 v[68:71], v[28:31], v[184:191], v3
    v_cvt_pk_bf16_f32 v165, v58, v59
    v_smfmac_f32_16x16x64_bf16 v[64:67], v[32:35], v[192:199], v3
    ds_write_b64 v6, v[164:165] offset:2304
    v_smfmac_f32_16x16x64_bf16 v[68:71], v[32:35], v[200:207], v3
    ds_read_b64_tr_b16 v[116:117], v7 offset:2304
    v_smfmac_f32_16x16x64_bf16 v[64:67], v[36:39], v[208:215], v3
    v_cvt_pk_bf16_f32 v166, v60, v61
    v_smfmac_f32_16x16x64_bf16 v[68:71], v[36:39], v[216:223], v3
    v_cvt_pk_bf16_f32 v167, v62, v63
    v_smfmac_f32_16x16x64_bf16 v[44:47], v[20:23], v[224:231], v3
    ds_write_b64 v6, v[166:167] offset:3072
    v_smfmac_f32_16x16x64_bf16 v[44:47], v[24:27], v[232:239], v3
    ds_read_b64_tr_b16 v[118:119], v7 offset:3072
    s_nop 0
    s_waitcnt lgkmcnt(8)
    v_smfmac_f32_16x16x64_bf16 v[44:47], v[28:31], v[156:163], v3
    v_cvt_pk_bf16_f32 v164, v64, v65
    v_smfmac_f32_16x16x64_bf16 v[44:47], v[32:35], v[240:247], v3
    v_cvt_pk_bf16_f32 v165, v66, v67
    v_smfmac_f32_16x16x64_bf16 v[44:47], v[36:39], v[248:255], v3
    ds_write_b64 v6, v[164:165] offset:3840
    s_nop 0
    s_waitcnt lgkmcnt(5)
    v_mfma_f32_16x16x32_bf16 v[128:131], v[76:79], v[112:115], 0
    ds_read_b64_tr_b16 v[120:121], v7 offset:3840
    v_cvt_pk_bf16_f32 v166, v68, v69
    v_mfma_f32_16x16x32_bf16 v[132:135], v[92:95], v[112:115], 0
    v_cvt_pk_bf16_f32 v167, v70, v71
    ds_write_b64 v6, v[166:167] offset:4608
    s_nop 0
    s_waitcnt lgkmcnt(3)
    v_mfma_f32_16x16x32_bf16 v[128:131], v[80:83], v[116:119], v[128:131]
    ds_read_b64_tr_b16 v[122:123], v7 offset:4608
    v_mfma_f32_16x16x32_bf16 v[132:135], v[96:99], v[116:119], v[132:135]
    v_cvt_pk_bf16_f32 v166, v44, v45
    v_cvt_pk_bf16_f32 v167, v46, v47
    ds_write_b64 v6, v[166:167] offset:0
    ds_read_b64_tr_b16 v[110:111], v7 offset:0
    s_nop 0
    s_waitcnt lgkmcnt(2)
    v_smfmac_f32_16x16x64_bf16 v[136:139], v[40:43], v[116:123], v3
    v_mfma_f32_16x16x32_bf16 v[128:131], v[84:87], v[120:123], v[128:131]
    v_mfma_f32_16x16x32_bf16 v[132:135], v[100:103], v[120:123], v[132:135]
    s_nop 0
    s_waitcnt lgkmcnt(0)
    v_smfmac_f32_16x16x64_bf16 v[136:139], v[36:39], v[108:115], v3
    v_mfma_f32_16x16x32_bf16 v[128:131], v[72:75], v[108:111], v[128:131]
    v_mfma_f32_16x16x32_bf16 v[132:135], v[88:91], v[108:111], v[132:135]
    s_nop 4
    s_nop 0
    v_permlane32_swap_b32 v136, v138
    v_permlane32_swap_b32 v137, v139
    v_add_f32_dpp v44, v128, v128 row_ror:8 row_mask:0xf bank_mask:0x3
    v_add_f32_dpp v45, v129, v129 row_ror:8 row_mask:0xf bank_mask:0x3
    v_add_f32_dpp v46, v130, v130 row_ror:8 row_mask:0xf bank_mask:0x3
    v_add_f32_dpp v47, v131, v131 row_ror:8 row_mask:0xf bank_mask:0x3
    v_add_f32 v136, v136, v138
    v_add_f32 v137, v137, v139
    v_add_f32_dpp v44, v132, v132 row_ror:8 row_mask:0xf bank_mask:0xc
    v_add_f32_dpp v45, v133, v133 row_ror:8 row_mask:0xf bank_mask:0xc
    v_add_f32_dpp v46, v134, v134 row_ror:8 row_mask:0xf bank_mask:0xc
    v_add_f32_dpp v47, v135, v135 row_ror:8 row_mask:0xf bank_mask:0xc
    ds_write_b128 v8, v[44:47]
    v_add_f32_dpp v164, v136, v136 row_ror:8 row_mask:0xf bank_mask:0x3
    v_add_f32_dpp v164, v137, v137 row_ror:8 row_mask:0xf bank_mask:0xc
    ds_write_b32 v9, v164 offset:128
    s_waitcnt lgkmcnt(0)
    s_barrier
    ds_read_b64 v[44:45], v10 offset:0
    ds_read_b64 v[46:47], v10 offset:1664
    ds_read_b64 v[48:49], v10 offset:3328
    ds_read_b64 v[50:51], v10 offset:4992
    s_nop 0
    s_waitcnt lgkmcnt(2)
    v_pk_add_f32 v[44:45], v[44:45], v[46:47]
    s_nop 0
    s_waitcnt lgkmcnt(0)
    v_pk_add_f32 v[48:49], v[48:49], v[50:51]
    v_pk_add_f32 v[44:45], v[44:45], v[48:49]
    v_max_f32 v46, v44, v45
    s_nop 1
    v_max_f32_dpp v46, v46, v46 quad_perm:[1,0,3,2] row_mask:0xf bank_mask:0xf
    s_nop 0
    s_nop 0
    v_max_f32_dpp v46, v46, v46 quad_perm:[2,3,0,1] row_mask:0xf bank_mask:0xf
    s_nop 0
    s_nop 0
    v_max_f32_dpp v46, v46, v46 row_half_mirror row_mask:0xf bank_mask:0xf
    s_nop 0
    s_nop 0
    v_max_f32_dpp v46, v46, v46 row_mirror row_mask:0xf bank_mask:0xf
    v_mov_b32 v47, v46
    s_nop 1
    v_permlane16_swap_b32 v46, v47
    s_nop 0
    v_max_f32 v46, v46, v47
    v_sub_f32 v44, v44, v46
    v_sub_f32 v45, v45, v46
    v_exp_f32 v44, v44
    v_exp_f32 v45, v45
    s_nop 0
    v_add_f32 v46, v44, v45
    s_nop 1
    v_add_f32_dpp v46, v46, v46 quad_perm:[1,0,3,2] row_mask:0xf bank_mask:0xf
    s_nop 0
    s_nop 0
    v_add_f32_dpp v46, v46, v46 quad_perm:[2,3,0,1] row_mask:0xf bank_mask:0xf
    s_nop 0
    s_nop 0
    v_add_f32_dpp v46, v46, v46 row_half_mirror row_mask:0xf bank_mask:0xf
    s_nop 0
    s_nop 0
    v_add_f32_dpp v46, v46, v46 row_mirror row_mask:0xf bank_mask:0xf
    v_mov_b32 v47, v46
    s_nop 1
    v_permlane16_swap_b32 v46, v47
    s_nop 0
    v_add_f32 v46, v46, v47
    v_rcp_f32 v46, v46
    s_nop 0
    v_mul_f32 v44, v44, v46
    v_mul_f32_e64 v45, v45, v46
    v_cvt_pk_bf16_f32 v164, v44, v45
    v_min_u32_e64 v164, 0xfffffffe, v164
    buffer_store_dword v164, v11, s[8:11], s22 offen
    s_nop 0
    s_sleep 5
    s_mov_b32 m0, s70
    s_add_u32 s26, s23, s78
    buffer_load_dwordx4 v2, s[8:11], s26 offen sc1 lds
    s_mov_b32 m0, s71
    s_add_u32 s26, s23, s79
    buffer_load_dwordx4 v2, s[8:11], s26 offen sc1 lds
    s_mov_b32 m0, s72
    s_add_u32 s26, s23, s80
    buffer_load_dwordx4 v2, s[8:11], s26 offen sc1 lds
    s_mov_b32 m0, s73
    s_add_u32 s26, s23, s81
    buffer_load_dwordx4 v2, s[8:11], s26 offen sc1 lds
    s_mov_b32 m0, s74
    s_add_u32 s26, s23, s82
    buffer_load_dwordx4 v2, s[8:11], s26 offen sc1 lds
    s_mov_b32 m0, s75
    s_add_u32 s26, s23, s83
    buffer_load_dwordx4 v2, s[8:11], s26 offen sc1 lds
    s_mov_b32 m0, s76
    s_add_u32 s26, s23, s84
    buffer_load_dwordx4 v2, s[8:11], s26 offen sc1 lds
    s_mov_b32 m0, s77
    s_add_u32 s26, s23, s85
    buffer_load_dwordx4 v2, s[8:11], s26 offen sc1 lds
    s_add_u32 s23, s23, 28672
    s_add_u32 s20, s20, 8192
    s_add_u32 s21, s21, 8192
    s_add_u32 s22, s22, 10240
    s_add_u32 s19, s19, 1
    s_cmp_lt_u32 s19, 63
    s_cbranch_scc1 SC3_LOOP0
    s_branch CH_DONE
.p2align 7
SC3_LOOP1:
    ds_read_b128 v[140:143], v12 offset:0
    ds_read_b128 v[144:147], v12 offset:1024
    ds_read_b128 v[148:151], v12 offset:2048
    ds_read_b128 v[152:155], v12 offset:3072
    ds_read_b128 v[156:159], v12 offset:4096
    ds_read_b128 v[160:163], v12 offset:5120
    v_mov_b32 v44, 0
    v_mov_b32 v45, 0
    v_mov_b32 v46, 0
    v_mov_b32 v47, 0
    v_mov_b32 v48, 0
    v_mov_b32 v49, 0
    v_mov_b32 v50, 0
    v_mov_b32 v51, 0
    v_mov_b32 v52, 0
    v_mov_b32 v53, 0
    v_mov_b32 v54, 0
    v_mov_b32 v55, 0
    v_mov_b32 v56, 0
    v_mov_b32 v57, 0
    v_mov_b32 v58, 0
    v_mov_b32 v59, 0
    v_mov_b32 v60, 0
    v_mov_b32 v61, 0
    v_mov_b32 v62, 0
    v_mov_b32 v63, 0
    v_mov_b32 v64, 0
    v_mov_b32 v65, 0
    v_mov_b32 v66, 0
    v_mov_b32 v67, 0
    v_mov_b32 v68, 0
    v_mov_b32 v69, 0
    v_mov_b32 v70, 0
    v_mov_b32 v71, 0
    v_mov_b32 v136, 0
    v_mov_b32 v137, 0
    v_mov_b32_e64 v138, 0
    v_mov_b32 v139, 0
    s_waitcnt vmcnt(0)
    ds_read_b128 v[72:75], v13 offset:0
    ds_read_b128 v[76:79], v13 offset:1024
    ds_read_b128 v[80:83], v13 offset:2048
    ds_read_b128 v[84:87], v13 offset:3072
    ds_read_b128 v[88:91], v13 offset:4096
    ds_read_b128 v[92:95], v13 offset:5120
    ds_read_b128 v[96:99], v13 offset:6144
    ds_read_b128 v[100:103], v13 offset:7168
    s_mov_b32 s27, 0
    s_nop 0
    buffer_load_dwordx4 v[40:43], v2, s[8:11], s21 offen offset:2048 sc1
    buffer_load_dwordx4 v[16:19], v2, s[8:11], s20 offen offset:0 sc1
    s_nop 15
    s_nop 15
SC3_LOOP1_POLL:
    buffer_load_dwordx4 v[40:43], v2, s[8:11], s21 offen offset:2048 sc1
    buffer_load_dwordx4 v[16:19], v2, s[8:11], s20 offen offset:0 sc1
    s_add_u32 s27, s27, 1
    s_nop 0
    s_cmp_gt_u32 s27, 65536
    s_cbranch_scc1 CH_FAIL
    s_waitcnt vmcnt(2)
    v_max3_u32 v4, v40, v41, v42
    v_max3_u32 v4, v4, v43, v16
    v_max3_u32 v4, v4, v17, v18
    v_max_u32_e64 v4, v4, v19
    v_cmp_eq_u32 vcc, -1, v4
    s_cbranch_vccnz SC3_LOOP1_POLL
    ds_write_b128 v2, v[40:43] offset:43008
    v_smfmac_f32_16x16x64_bf16 v[44:47], v[40:43], a[0:7], v3
    v_smfmac_f32_16x16x64_bf16 v[48:51], v[40:43], a[8:15], v3
    v_smfmac_f32_16x16x64_bf16 v[52:55], v[40:43], a[16:23], v3
    v_smfmac_f32_16x16x64_bf16 v[56:59], v[40:43], a[24:31], v3
    v_smfmac_f32_16x16x64_bf16 v[60:63], v[40:43], a[32:39], v3
    v_smfmac_f32_16x16x64_bf16 v[64:67], v[40:43], a[40:47], v3
    s_waitcnt lgkmcnt(0)
    s_barrier
    ds_read_b128 v[20:23], v2 offset:37888
    ds_read_b128 v[24:27], v2 offset:38912
    ds_read_b128 v[28:31], v2 offset:39936
    ds_read_b128 v[32:35], v2 offset:40960
    ds_read_b128 v[36:39], v2 offset:41984
    v_smfmac_f32_16x16x64_bf16 v[68:71], v[40:43], a[48:55], v3
    v_smfmac_f32_16x16x64_bf16 v[44:47], v[16:19], a[56:63], v3
    v_smfmac_f32_16x16x64_bf16 v[48:51], v[16:19], v[140:147], v3
    ds_read_b128 v[140:143], v12 offset:6144
    v_smfmac_f32_16x16x64_bf16 v[52:55], v[16:19], a[64:71], v3
    ds_read_b128 v[144:147], v12 offset:7168
    v_smfmac_f32_16x16x64_bf16 v[56:59], v[16:19], a[72:79], v3
    v_smfmac_f32_16x16x64_bf16 v[60:63], v[16:19], a[80:87], v3
    v_smfmac_f32_16x16x64_bf16 v[64:67], v[16:19], v[148:155], v3
    ds_read_b128 v[148:151], v12 offset:8192
    v_smfmac_f32_16x16x64_bf16 v[68:71], v[16:19], a[88:95], v3
    ds_read_b128 v[152:155], v12 offset:9216
    s_nop 0
    s_waitcnt lgkmcnt(8)
    v_smfmac_f32_16x16x64_bf16 v[48:51], v[20:23], a[96:103], v3
    v_smfmac_f32_16x16x64_bf16 v[52:55], v[20:23], a[104:111], v3
    s_nop 0
    s_waitcnt lgkmcnt(7)
    v_smfmac_f32_16x16x64_bf16 v[48:51], v[24:27], v[156:163], v3
    ds_read_b128 v[156:159], v12 offset:10240
    v_smfmac_f32_16x16x64_bf16 v[52:55], v[24:27], a[112:119], v3
    ds_read_b128 v[160:163], v12 offset:11264
    s_nop 0
    s_waitcnt lgkmcnt(8)
    v_smfmac_f32_16x16x64_bf16 v[48:51], v[28:31], a[120:127], v3
    v_smfmac_f32_16x16x64_bf16 v[52:55], v[28:31], a[128:135], v3
    s_nop 0
    s_waitcnt lgkmcnt(7)
    v_smfmac_f32_16x16x64_bf16 v[48:51], v[32:35], a[136:143], v3
    v_smfmac_f32_16x16x64_bf16 v[52:55], v[32:35], a[144:151], v3
    s_waitcnt lgkmcnt(6)
    s_waitcnt lgkmcnt(4)
    v_smfmac_f32_16x16x64_bf16 v[48:51], v[36:39], v[140:147], v3
    v_smfmac_f32_16x16x64_bf16 v[52:55], v[36:39], a[152:159], v3
    v_smfmac_f32_16x16x64_bf16 v[56:59], v[20:23], a[160:167], v3
    v_smfmac_f32_16x16x64_bf16 v[60:63], v[20:23], a[168:175], v3
    v_smfmac_f32_16x16x64_bf16 v[56:59], v[24:27], a[176:183], v3
    v_smfmac_f32_16x16x64_bf16 v[60:63], v[24:27], a[184:191], v3
    v_smfmac_f32_16x16x64_bf16 v[56:59], v[28:31], a[192:199], v3
    v_smfmac_f32_16x16x64_bf16 v[60:63], v[28:31], a[200:207], v3
    v_smfmac_f32_16x16x64_bf16 v[56:59], v[32:35], a[208:215], v3
    v_cvt_pk_bf16_f32 v164, v48, v49
    v_smfmac_f32_16x16x64_bf16 v[60:63], v[32:35], a[216:223], v3
    v_cvt_pk_bf16_f32 v165, v50, v51
    v_smfmac_f32_16x16x64_bf16 v[56:59], v[36:39], a[224:231], v3
    ds_write_b64 v6, v[164:165] offset:768
    v_smfmac_f32_16x16x64_bf16 v[60:63], v[36:39], a[232:239], v3
    ds_read_b64_tr_b16 v[112:113], v7 offset:768
    v_smfmac_f32_16x16x64_bf16 v[64:67], v[20:23], a[240:247], v3
    v_cvt_pk_bf16_f32 v166, v52, v53
    v_smfmac_f32_16x16x64_bf16 v[68:71], v[20:23], a[248:255], v3
    v_cvt_pk_bf16_f32 v167, v54, v55
    s_nop 0
    s_waitcnt lgkmcnt(4)
    v_smfmac_f32_16x16x64_bf16 v[64:67], v[24:27], v[148:155], v3
    ds_write_b64 v6, v[166:167] offset:1536
    v_smfmac_f32_16x16x64_bf16 v[68:71], v[24:27], v[168:175], v3
    ds_read_b64_tr_b16 v[114:115], v7 offset:1536
    v_smfmac_f32_16x16x64_bf16 v[64:67], v[28:31], v[176:183], v3
    v_cvt_pk_bf16_f32 v164, v56, v57
    v_smfmac_f32_16x16x64_bf16 v[68:71], v[28:31], v[184:191], v3
    v_cvt_pk_bf16_f32 v165, v58, v59
    v_smfmac_f32_16x16x64_bf16 v[64:67], v[32:35], v[192:199], v3
    ds_write_b64 v6, v[164:165] offset:2304
    v_smfmac_f32_16x16x64_bf16 v[68:71], v[32:35], v[200:207], v3
    ds_read_b64_tr_b16 v[116:117], v7 offset:2304
    v_smfmac_f32_16x16x64_bf16 v[64:67], v[36:39], v[208:215], v3
    v_cvt_pk_bf16_f32 v166, v60, v61
    v_smfmac_f32_16x16x64_bf16 v[68:71], v[36:39], v[216:223], v3
    v_cvt_pk_bf16_f32 v167, v62, v63
    v_smfmac_f32_16x16x64_bf16 v[44:47], v[20:23], v[224:231], v3
    ds_write_b64 v6, v[166:167] offset:3072
    v_smfmac_f32_16x16x64_bf16 v[44:47], v[24:27], v[232:239], v3
    ds_read_b64_tr_b16 v[118:119], v7 offset:3072
    s_nop 0
    s_waitcnt lgkmcnt(8)
    v_smfmac_f32_16x16x64_bf16 v[44:47], v[28:31], v[156:163], v3
    v_cvt_pk_bf16_f32 v164, v64, v65
    v_smfmac_f32_16x16x64_bf16 v[44:47], v[32:35], v[240:247], v3
    v_cvt_pk_bf16_f32 v165, v66, v67
    v_smfmac_f32_16x16x64_bf16 v[44:47], v[36:39], v[248:255], v3
    ds_write_b64 v6, v[164:165] offset:3840
    s_nop 0
    s_waitcnt lgkmcnt(5)
    v_mfma_f32_16x16x32_bf16 v[128:131], v[76:79], v[112:115], 0
    ds_read_b64_tr_b16 v[120:121], v7 offset:3840
    v_cvt_pk_bf16_f32 v166, v68, v69
    v_mfma_f32_16x16x32_bf16 v[132:135], v[92:95], v[112:115], 0
    v_cvt_pk_bf16_f32 v167, v70, v71
    ds_write_b64 v6, v[166:167] offset:4608
    s_nop 0
    s_waitcnt lgkmcnt(3)
    v_mfma_f32_16x16x32_bf16 v[128:131], v[80:83], v[116:119], v[128:131]
    ds_read_b64_tr_b16 v[122:123], v7 offset:4608
    v_mfma_f32_16x16x32_bf16 v[132:135], v[96:99], v[116:119], v[132:135]
    v_cvt_pk_bf16_f32 v166, v44, v45
    v_cvt_pk_bf16_f32 v167, v46, v47
    ds_write_b64 v6, v[166:167] offset:0
    ds_read_b64_tr_b16 v[110:111], v7 offset:0
    s_nop 0
    s_waitcnt lgkmcnt(2)
    v_smfmac_f32_16x16x64_bf16 v[136:139], v[40:43], v[116:123], v3
    v_mfma_f32_16x16x32_bf16 v[128:131], v[84:87], v[120:123], v[128:131]
    v_mfma_f32_16x16x32_bf16 v[132:135], v[100:103], v[120:123], v[132:135]
    s_nop 0
    s_waitcnt lgkmcnt(0)
    v_smfmac_f32_16x16x64_bf16 v[136:139], v[36:39], v[108:115], v3
    v_mfma_f32_16x16x32_bf16 v[128:131], v[72:75], v[108:111], v[128:131]
    v_mfma_f32_16x16x32_bf16 v[132:135], v[88:91], v[108:111], v[132:135]
    s_nop 4
    s_nop 0
    v_permlane32_swap_b32 v136, v138
    v_permlane32_swap_b32 v137, v139
    v_add_f32_dpp v44, v128, v128 row_ror:8 row_mask:0xf bank_mask:0x3
    v_add_f32_dpp v45, v129, v129 row_ror:8 row_mask:0xf bank_mask:0x3
    v_add_f32_dpp v46, v130, v130 row_ror:8 row_mask:0xf bank_mask:0x3
    v_add_f32_dpp v47, v131, v131 row_ror:8 row_mask:0xf bank_mask:0x3
    v_add_f32 v136, v136, v138
    v_add_f32 v137, v137, v139
    v_add_f32_dpp v44, v132, v132 row_ror:8 row_mask:0xf bank_mask:0xc
    v_add_f32_dpp v45, v133, v133 row_ror:8 row_mask:0xf bank_mask:0xc
    v_add_f32_dpp v46, v134, v134 row_ror:8 row_mask:0xf bank_mask:0xc
    v_add_f32_dpp v47, v135, v135 row_ror:8 row_mask:0xf bank_mask:0xc
    ds_write_b128 v8, v[44:47]
    v_add_f32_dpp v164, v136, v136 row_ror:8 row_mask:0xf bank_mask:0x3
    v_add_f32_dpp v164, v137, v137 row_ror:8 row_mask:0xf bank_mask:0xc
    ds_write_b32 v9, v164 offset:128
    s_waitcnt lgkmcnt(0)
    s_barrier
    ds_read_b64 v[44:45], v10 offset:0
    ds_read_b64 v[46:47], v10 offset:1664
    ds_read_b64 v[48:49], v10 offset:3328
    ds_read_b64 v[50:51], v10 offset:4992
    s_nop 0
    s_waitcnt lgkmcnt(2)
    v_pk_add_f32 v[44:45], v[44:45], v[46:47]
    s_nop 0
    s_waitcnt lgkmcnt(0)
    v_pk_add_f32 v[48:49], v[48:49], v[50:51]
    v_pk_add_f32 v[44:45], v[44:45], v[48:49]
    v_max_f32 v46, v44, v45
    s_nop 1
    v_max_f32_dpp v46, v46, v46 quad_perm:[1,0,3,2] row_mask:0xf bank_mask:0xf
    s_nop 0
    s_nop 0
    v_max_f32_dpp v46, v46, v46 quad_perm:[2,3,0,1] row_mask:0xf bank_mask:0xf
    s_nop 0
    s_nop 0
    v_max_f32_dpp v46, v46, v46 row_half_mirror row_mask:0xf bank_mask:0xf
    s_nop 0
    s_nop 0
    v_max_f32_dpp v46, v46, v46 row_mirror row_mask:0xf bank_mask:0xf
    v_mov_b32 v47, v46
    s_nop 1
    v_permlane16_swap_b32 v46, v47
    s_nop 0
    v_max_f32 v46, v46, v47
    v_sub_f32 v44, v44, v46
    v_sub_f32 v45, v45, v46
    v_exp_f32 v44, v44
    v_exp_f32 v45, v45
    s_nop 0
    v_add_f32 v46, v44, v45
    s_nop 1
    v_add_f32_dpp v46, v46, v46 quad_perm:[1,0,3,2] row_mask:0xf bank_mask:0xf
    s_nop 0
    s_nop 0
    v_add_f32_dpp v46, v46, v46 quad_perm:[2,3,0,1] row_mask:0xf bank_mask:0xf
    s_nop 0
    s_nop 0
    v_add_f32_dpp v46, v46, v46 row_half_mirror row_mask:0xf bank_mask:0xf
    s_nop 0
    s_nop 0
    v_add_f32_dpp v46, v46, v46 row_mirror row_mask:0xf bank_mask:0xf
    v_mov_b32 v47, v46
    s_nop 1
    v_permlane16_swap_b32 v46, v47
    s_nop 0
    v_add_f32 v46, v46, v47
    v_rcp_f32 v46, v46
    s_nop 0
    v_mul_f32 v44, v44, v46
    v_mul_f32_e64 v45, v45, v46
    v_cvt_pk_bf16_f32 v164, v44, v45
    v_min_u32_e64 v164, 0xfffffffe, v164
    buffer_store_dword v164, v11, s[8:11], s22 offen sc1
    s_nop 0
    s_sleep 5
    s_mov_b32 m0, s70
    s_add_u32 s26, s23, s78
    buffer_load_dwordx4 v2, s[8:11], s26 offen sc1 lds
    s_mov_b32 m0, s71
    s_add_u32 s26, s23, s79
    buffer_load_dwordx4 v2, s[8:11], s26 offen sc1 lds
    s_mov_b32 m0, s72
    s_add_u32 s26, s23, s80
    buffer_load_dwordx4 v2, s[8:11], s26 offen sc1 lds
    s_mov_b32 m0, s73
    s_add_u32 s26, s23, s81
    buffer_load_dwordx4 v2, s[8:11], s26 offen sc1 lds
    s_mov_b32 m0, s74
    s_add_u32 s26, s23, s82
    buffer_load_dwordx4 v2, s[8:11], s26 offen sc1 lds
    s_mov_b32 m0, s75
    s_add_u32 s26, s23, s83
    buffer_load_dwordx4 v2, s[8:11], s26 offen sc1 lds
    s_mov_b32 m0, s76
    s_add_u32 s26, s23, s84
    buffer_load_dwordx4 v2, s[8:11], s26 offen sc1 lds
    s_mov_b32 m0, s77
    s_add_u32 s26, s23, s85
    buffer_load_dwordx4 v2, s[8:11], s26 offen sc1 lds
    s_add_u32 s23, s23, 28672
    s_add_u32 s20, s20, 8192
    s_add_u32 s21, s21, 8192
    s_add_u32 s22, s22, 10240
    s_add_u32 s19, s19, 1
    s_cmp_lt_u32 s19, 63
    s_cbranch_scc1 SC3_LOOP1
    s_branch CH_DONE
VA:
    v_and_b32 v1, 63, v0
    v_lshlrev_b32 v2, 4, v1
    v_lshlrev_b32 v3, 3, v1
    v_lshlrev_b32 v10, 2, v1
    v_mov_b32 v4, 0x4444
    v_mov_b32 v5, 0xeeee
    v_and_b32 v6, 8, v1
    v_cmp_ne_u32 vcc, 0, v6
    s_nop 1
    v_cndmask_b32 v4, v4, v5, vcc
    s_mul_i32 s25, s16, 1605632
    s_mul_i32 s29, s28, 28672
    s_add_u32 s25, s25, s29
    s_nop 0
    s_add_u32 s25, s25, 9437184
    s_mul_i32 s29, s16, 28672
    s_add_u32 s29, s29, 18432
    v_add_u32 v7, s29, v2
    s_lshl_b32 s29, s16, 1
    s_add_u32 s29, s29, 0
    s_sub_u32 s30, s29, 7
    s_cmp_ge_u32 s29, 7
    s_cselect_b32 s29, s30, s29
    s_lshl_b32 s29, s29, 11
    s_add_u32 s70, s29, s25
    s_lshl_b32 s29, s16, 1
    s_add_u32 s29, s29, 1
    s_sub_u32 s30, s29, 7
    s_cmp_ge_u32 s29, 7
    s_cselect_b32 s29, s30, s29
    s_lshl_b32 s29, s29, 11
    s_add_u32 s71, s29, s25
    s_lshl_b32 s29, s16, 1
    s_add_u32 s29, s29, 2
    s_sub_u32 s30, s29, 7
    s_cmp_ge_u32 s29, 7
    s_cselect_b32 s29, s30, s29
    s_lshl_b32 s30, s29, 10
    v_add_u32 v15, s30, v2
    s_lshl_b32 s29, s29, 11
    s_add_u32 s72, s29, s25
    s_lshl_b32 s29, s16, 1
    s_add_u32 s29, s29, 3
    s_sub_u32 s30, s29, 7
    s_cmp_ge_u32 s29, 7
    s_cselect_b32 s29, s30, s29
    s_lshl_b32 s30, s29, 10
    v_add_u32 v16, s30, v2
    s_lshl_b32 s29, s29, 11
    s_add_u32 s73, s29, s25
    s_lshl_b32 s29, s16, 1
    s_add_u32 s29, s29, 4
    s_sub_u32 s30, s29, 7
    s_cmp_ge_u32 s29, 7
    s_cselect_b32 s29, s30, s29
    s_lshl_b32 s30, s29, 10
    v_add_u32 v252, s30, v2
    s_lshl_b32 s29, s29, 11
    s_add_u32 s74, s29, s25
    s_lshl_b32 s29, s16, 1
    s_add_u32 s29, s29, 5
    s_sub_u32 s30, s29, 7
    s_cmp_ge_u32 s29, 7
    s_cselect_b32 s29, s30, s29
    s_lshl_b32 s30, s29, 10
    v_add_u32 v253, s30, v2
    s_lshl_b32 s29, s29, 11
    s_add_u32 s75, s29, s25
    s_lshl_b32 s29, s16, 1
    s_add_u32 s29, s29, 6
    s_sub_u32 s30, s29, 7
    s_cmp_ge_u32 s29, 7
    s_cselect_b32 s29, s30, s29
    s_lshl_b32 s30, s29, 10
    v_add_u32 v254, s30, v2
    s_lshl_b32 s29, s29, 11
    s_add_u32 s76, s29, s25
    s_lshl_b32 s26, s16, 9
    v_min_u32 v6, 3, v1
    v_lshlrev_b32_e64 v6, 7, v6
    s_add_u32 s30, s26, 85135360
    s_mov_b32 s27, 0
    s_nop 0
VA_WW:
    buffer_load_dword v5, v6, s[8:11], s30 offen sc1
    s_add_u32 s27, s27, 1
    s_nop 0
    s_cmp_gt_u32 s27, 65536
    s_cbranch_scc1 CH_FAIL
    s_waitcnt vmcnt(0)
    v_cmp_gt_u32 vcc, 7, v5
    s_cbranch_vccz VA_WW_OK
    s_sleep 2
    s_branch VA_WW
VA_WW_OK:
    s_mul_i32 s26, s16, 28672
    s_add_u32 m0, s26, 18432
    s_add_u32 s29, s70, 415744
    buffer_load_dwordx4 v2, s[8:11], s29 offen sc1 lds
    buffer_load_dwordx4 v2, s[8:11], s29 offen offset:1024 sc1 lds
    s_add_u32 m0, s26, 20480
    s_add_u32 s29, s70, 1204224
    buffer_load_dwordx4 v2, s[8:11], s29 offen sc1 lds
    buffer_load_dwordx4 v2, s[8:11], s29 offen offset:1024 sc1 lds
    s_add_u32 m0, s26, 22528
    s_add_u32 s29, s71, 14336
    buffer_load_dwordx4 v2, s[8:11], s29 offen sc1 lds
    buffer_load_dwordx4 v2, s[8:11], s29 offen offset:1024 sc1 lds
    s_add_u32 m0, s26, 24576
    s_add_u32 s29, s71, 802816
    buffer_load_dwordx4 v2, s[8:11], s29 offen sc1 lds
    buffer_load_dwordx4 v2, s[8:11], s29 offen offset:1024 sc1 lds
    s_add_u32 m0, s26, 26624
    s_add_u32 s29, s71, 1218560
    buffer_load_dwordx4 v2, s[8:11], s29 offen sc1 lds
    buffer_load_dwordx4 v2, s[8:11], s29 offen offset:1024 sc1 lds
    s_add_u32 m0, s26, 28672
    s_add_u32 s29, s73, 0
    s_nop 0
    buffer_load_dwordx4 v2, s[8:11], s29 offen sc1 lds
    buffer_load_dwordx4 v2, s[8:11], s29 offen offset:1024 sc1 lds
    s_add_u32 m0, s26, 30720
    s_add_u32 s29, s74, 14336
    buffer_load_dwordx4 v2, s[8:11], s29 offen sc1 lds
    buffer_load_dwordx4 v2, s[8:11], s29 offen offset:1024 sc1 lds
    s_add_u32 m0, s26, 32768
    s_add_u32 s29, s76, 0
    s_nop 0
    buffer_load_dwordx4 v2, s[8:11], s29 offen sc1 lds
    buffer_load_dwordx4 v2, s[8:11], s29 offen offset:1024 sc1 lds
    s_add_u32 m0, s26, 34816
    s_add_u32 s29, s72, 415744
    buffer_load_dwordx4 v2, s[8:11], s29 offen sc1 lds
    buffer_load_dwordx4 v2, s[8:11], s29 offen offset:1024 sc1 lds
    s_add_u32 m0, s26, 36864
    s_add_u32 s29, s74, 401408
    buffer_load_dwordx4 v2, s[8:11], s29 offen sc1 lds
    buffer_load_dwordx4 v2, s[8:11], s29 offen offset:1024 sc1 lds
    s_add_u32 m0, s26, 38912
    s_add_u32 s29, s76, 401408
    buffer_load_dwordx4 v2, s[8:11], s29 offen sc1 lds
    buffer_load_dwordx4 v2, s[8:11], s29 offen offset:1024 sc1 lds
    s_add_u32 m0, s26, 40960
    s_add_u32 s29, s74, 802816
    buffer_load_dwordx4 v2, s[8:11], s29 offen sc1 lds
    buffer_load_dwordx4 v2, s[8:11], s29 offen offset:1024 sc1 lds
    s_add_u32 m0, s26, 43008
    s_add_u32 s29, s72, 1204224
    buffer_load_dwordx4 v2, s[8:11], s29 offen sc1 lds
    buffer_load_dwordx4 v2, s[8:11], s29 offen offset:1024 sc1 lds
    s_add_u32 m0, s26, 45056
    s_add_u32 s29, s75, 1204224
    buffer_load_dwordx4 v2, s[8:11], s29 offen sc1 lds
    buffer_load_dwordx4 v2, s[8:11], s29 offen offset:1024 sc1 lds
    s_add_u32 s29, s70, 0
    s_nop 0
    buffer_load_dwordx4 a[0:3], v2, s[8:11], s29 offen sc1
    buffer_load_dwordx4 a[4:7], v2, s[8:11], s29 offen offset:1024 sc1
    s_add_u32 s29, s70, 14336
    buffer_load_dwordx4 a[8:11], v2, s[8:11], s29 offen sc1
    buffer_load_dwordx4 a[12:15], v2, s[8:11], s29 offen offset:1024 sc1
    s_add_u32 s29, s70, 401408
    buffer_load_dwordx4 a[16:19], v2, s[8:11], s29 offen sc1
    buffer_load_dwordx4 a[20:23], v2, s[8:11], s29 offen offset:1024 sc1
    s_add_u32 s29, s70, 802816
    buffer_load_dwordx4 a[24:27], v2, s[8:11], s29 offen sc1
    buffer_load_dwordx4 a[28:31], v2, s[8:11], s29 offen offset:1024 sc1
    s_add_u32 s29, s70, 817152
    buffer_load_dwordx4 a[32:35], v2, s[8:11], s29 offen sc1
    buffer_load_dwordx4 a[36:39], v2, s[8:11], s29 offen offset:1024 sc1
    s_add_u32 s29, s70, 1218560
    buffer_load_dwordx4 a[40:43], v2, s[8:11], s29 offen sc1
    buffer_load_dwordx4 a[44:47], v2, s[8:11], s29 offen offset:1024 sc1
    s_add_u32 s29, s71, 0
    s_nop 0
    buffer_load_dwordx4 a[48:51], v2, s[8:11], s29 offen sc1
    buffer_load_dwordx4 a[52:55], v2, s[8:11], s29 offen offset:1024 sc1
    s_add_u32 s29, s71, 401408
    buffer_load_dwordx4 a[56:59], v2, s[8:11], s29 offen sc1
    buffer_load_dwordx4 a[60:63], v2, s[8:11], s29 offen offset:1024 sc1
    s_add_u32 s29, s71, 415744
    buffer_load_dwordx4 a[64:67], v2, s[8:11], s29 offen sc1
    buffer_load_dwordx4 a[68:71], v2, s[8:11], s29 offen offset:1024 sc1
    s_add_u32 s29, s71, 817152
    buffer_load_dwordx4 a[72:75], v2, s[8:11], s29 offen sc1
    buffer_load_dwordx4 a[76:79], v2, s[8:11], s29 offen offset:1024 sc1
    s_add_u32 s29, s71, 1204224
    buffer_load_dwordx4 a[80:83], v2, s[8:11], s29 offen sc1
    buffer_load_dwordx4 a[84:87], v2, s[8:11], s29 offen offset:1024 sc1
    s_add_u32 s29, s72, 0
    s_nop 0
    buffer_load_dwordx4 a[88:91], v2, s[8:11], s29 offen sc1
    buffer_load_dwordx4 a[92:95], v2, s[8:11], s29 offen offset:1024 sc1
    s_nop 0
    s_waitcnt vmcnt(24)
    s_add_u32 s29, s72, 14336
    buffer_load_dwordx4 a[96:99], v2, s[8:11], s29 offen sc1
    buffer_load_dwordx4 a[100:103], v2, s[8:11], s29 offen offset:1024 sc1
    s_add_u32 s29, s73, 14336
    buffer_load_dwordx4 a[104:107], v2, s[8:11], s29 offen sc1
    buffer_load_dwordx4 a[108:111], v2, s[8:11], s29 offen offset:1024 sc1
    s_add_u32 s29, s74, 0
    s_nop 0
    buffer_load_dwordx4 a[112:115], v2, s[8:11], s29 offen sc1
    buffer_load_dwordx4 a[116:119], v2, s[8:11], s29 offen offset:1024 sc1
    s_add_u32 s29, s75, 0
    s_nop 0
    buffer_load_dwordx4 a[120:123], v2, s[8:11], s29 offen sc1
    buffer_load_dwordx4 a[124:127], v2, s[8:11], s29 offen offset:1024 sc1
    s_add_u32 s29, s75, 14336
    buffer_load_dwordx4 a[128:131], v2, s[8:11], s29 offen sc1
    buffer_load_dwordx4 a[132:135], v2, s[8:11], s29 offen offset:1024 sc1
    s_add_u32 s29, s76, 14336
    buffer_load_dwordx4 a[136:139], v2, s[8:11], s29 offen sc1
    buffer_load_dwordx4 a[140:143], v2, s[8:11], s29 offen offset:1024 sc1
    s_add_u32 s29, s72, 401408
    buffer_load_dwordx4 a[144:147], v2, s[8:11], s29 offen sc1
    buffer_load_dwordx4 a[148:151], v2, s[8:11], s29 offen offset:1024 sc1
    s_add_u32 s29, s73, 401408
    buffer_load_dwordx4 a[152:155], v2, s[8:11], s29 offen sc1
    buffer_load_dwordx4 a[156:159], v2, s[8:11], s29 offen offset:1024 sc1
    s_add_u32 s29, s73, 415744
    buffer_load_dwordx4 a[160:163], v2, s[8:11], s29 offen sc1
    buffer_load_dwordx4 a[164:167], v2, s[8:11], s29 offen offset:1024 sc1
    s_add_u32 s29, s74, 415744
    buffer_load_dwordx4 a[168:171], v2, s[8:11], s29 offen sc1
    buffer_load_dwordx4 a[172:175], v2, s[8:11], s29 offen offset:1024 sc1
    s_add_u32 s29, s75, 401408
    buffer_load_dwordx4 a[176:179], v2, s[8:11], s29 offen sc1
    buffer_load_dwordx4 a[180:183], v2, s[8:11], s29 offen offset:1024 sc1
    s_add_u32 s29, s75, 415744
    buffer_load_dwordx4 a[184:187], v2, s[8:11], s29 offen sc1
    buffer_load_dwordx4 a[188:191], v2, s[8:11], s29 offen offset:1024 sc1
    s_nop 0
    s_waitcnt vmcnt(24)
    s_add_u32 s29, s76, 415744
    buffer_load_dwordx4 a[192:195], v2, s[8:11], s29 offen sc1
    buffer_load_dwordx4 a[196:199], v2, s[8:11], s29 offen offset:1024 sc1
    s_add_u32 s29, s72, 802816
    buffer_load_dwordx4 a[200:203], v2, s[8:11], s29 offen sc1
    buffer_load_dwordx4 a[204:207], v2, s[8:11], s29 offen offset:1024 sc1
    s_add_u32 s29, s72, 817152
    buffer_load_dwordx4 a[208:211], v2, s[8:11], s29 offen sc1
    buffer_load_dwordx4 a[212:215], v2, s[8:11], s29 offen offset:1024 sc1
    s_add_u32 s29, s73, 802816
    buffer_load_dwordx4 a[216:219], v2, s[8:11], s29 offen sc1
    buffer_load_dwordx4 a[220:223], v2, s[8:11], s29 offen offset:1024 sc1
    s_add_u32 s29, s73, 817152
    buffer_load_dwordx4 a[224:227], v2, s[8:11], s29 offen sc1
    buffer_load_dwordx4 a[228:231], v2, s[8:11], s29 offen offset:1024 sc1
    s_add_u32 s29, s74, 817152
    buffer_load_dwordx4 a[232:235], v2, s[8:11], s29 offen sc1
    buffer_load_dwordx4 a[236:239], v2, s[8:11], s29 offen offset:1024 sc1
    s_add_u32 s29, s75, 802816
    buffer_load_dwordx4 a[240:243], v2, s[8:11], s29 offen sc1
    buffer_load_dwordx4 a[244:247], v2, s[8:11], s29 offen offset:1024 sc1
    s_add_u32 s29, s75, 817152
    buffer_load_dwordx4 a[248:251], v2, s[8:11], s29 offen sc1
    buffer_load_dwordx4 a[252:255], v2, s[8:11], s29 offen offset:1024 sc1
    s_add_u32 s29, s76, 802816
    buffer_load_dwordx4 v[172:175], v2, s[8:11], s29 offen sc1
    buffer_load_dwordx4 v[176:179], v2, s[8:11], s29 offen offset:1024 sc1
    s_add_u32 s29, s76, 817152
    buffer_load_dwordx4 v[180:183], v2, s[8:11], s29 offen sc1
    buffer_load_dwordx4 v[184:187], v2, s[8:11], s29 offen offset:1024 sc1
    s_add_u32 s29, s72, 1218560
    buffer_load_dwordx4 v[188:191], v2, s[8:11], s29 offen sc1
    buffer_load_dwordx4 v[192:195], v2, s[8:11], s29 offen offset:1024 sc1
    s_add_u32 s29, s73, 1204224
    buffer_load_dwordx4 v[196:199], v2, s[8:11], s29 offen sc1
    buffer_load_dwordx4 v[200:203], v2, s[8:11], s29 offen offset:1024 sc1
    s_nop 0
    s_waitcnt vmcnt(24)
    s_add_u32 s29, s73, 1218560
    buffer_load_dwordx4 v[204:207], v2, s[8:11], s29 offen sc1
    buffer_load_dwordx4 v[208:211], v2, s[8:11], s29 offen offset:1024 sc1
    s_add_u32 s29, s74, 1204224
    buffer_load_dwordx4 v[212:215], v2, s[8:11], s29 offen sc1
    buffer_load_dwordx4 v[216:219], v2, s[8:11], s29 offen offset:1024 sc1
    s_add_u32 s29, s74, 1218560
    buffer_load_dwordx4 v[220:223], v2, s[8:11], s29 offen sc1
    buffer_load_dwordx4 v[224:227], v2, s[8:11], s29 offen offset:1024 sc1
    s_add_u32 s29, s75, 1218560
    buffer_load_dwordx4 v[228:231], v2, s[8:11], s29 offen sc1
    buffer_load_dwordx4 v[232:235], v2, s[8:11], s29 offen offset:1024 sc1
    s_add_u32 s29, s76, 1204224
    buffer_load_dwordx4 v[236:239], v2, s[8:11], s29 offen sc1
    buffer_load_dwordx4 v[240:243], v2, s[8:11], s29 offen offset:1024 sc1
    s_add_u32 s29, s76, 1218560
    buffer_load_dwordx4 v[244:247], v2, s[8:11], s29 offen sc1
    buffer_load_dwordx4 v[248:251], v2, s[8:11], s29 offen offset:1024 sc1
    v_bfe_u32 v132, v1, 1, 1
    v_lshlrev_b32_e64 v132, 3, v132
    v_bfe_u32 v133, v1, 4, 1
    v_lshl_add_u32 v132, v133, 2, v132
    v_bfe_u32 v133, v1, 5, 1
    v_lshl_add_u32 v132, v133, 1, v132
    v_lshlrev_b32_e64 v132, 2, v132
    v_bfe_u32 v133, v1, 2, 2
    v_add_u32 v132, v132, v133
    v_lshlrev_b32 v132, 5, v132
    v_and_b32_e64 v133, 1, v1
    v_lshl_add_u32 v132, v133, 2, v132
    s_lshl_b32 s29, s16, 3
    s_add_u32 s29, s29, 0
    v_add_u32_e64 v8, s29, v132
    v_add_u32 v12, 2048, v8
    v_and_b32 v13, 3, v1
    v_lshlrev_b32 v13, 2, v13
    s_lshl_b32 s29, s16, 11
    v_add_u32 v17, s29, v2
    s_add_u32 s29, s29, 1024
    s_cmp_eq_u32 s16, 3
    s_cselect_b32 s29, 0, s29
    v_add_u32 v18, s29, v2
    s_and_b32 s29, s16, 1
    s_lshl_b32 s29, s29, 11
    s_add_u32 s29, s29, 0
    v_lshlrev_b32_e64 v9, 5, v1
    v_add_u32 v9, s29, v9
    s_mov_b32 s19, 0
    s_mov_b32 s20, 83886080
    s_mov_b32 s21, 83890176
    s_mul_i32 s22, s16, 2560
    s_add_u32 s22, s22, 84443136
    s_and_b32 s29, s16, 1
    s_lshl_b32 s31, s28, 1
    s_add_u32 s31, s31, s29
    s_lshl_b32 s31, s31, 8
    s_add_u32 s31, s31, 83894272
    s_lshl_b32 s29, s28, 2
    s_add_u32 s29, s29, s16
    s_lshl_b32 s29, s29, 2
    v_mov_b32 v11, 0x40000000
    v_mov_b32_e64 v5, s29
    v_cmp_eq_u32 vcc, 0, v1
    s_nop 1
    v_cndmask_b32 v11, v11, v5, vcc
    s_lshl_b32 s26, s16, 7
    s_add_u32 s26, s26, 85098496
    v_mov_b32 v14, 0
    v_mov_b32 v48, 0
    v_mov_b32 v49, 0
    v_mov_b32 v50, 0
    v_mov_b32 v51, 0
    v_mov_b32 v52, 0
    v_mov_b32 v53, 0
    v_mov_b32 v54, 0
    v_mov_b32 v55, 0
    v_mov_b32 v56, 0
    v_mov_b32 v57, 0
    v_mov_b32 v58, 0
    v_mov_b32 v59, 0
    v_mov_b32 v60, 0
    v_mov_b32 v61, 0
    v_mov_b32 v62, 0
    v_mov_b32 v63, 0
    v_mov_b32 v64, 0
    v_mov_b32 v65, 0
    v_mov_b32 v66, 0
    v_mov_b32 v67, 0
    v_mov_b32 v68, 0
    v_mov_b32 v69, 0
    v_mov_b32 v70, 0
    v_mov_b32 v71, 0
    v_mov_b32 v72, 0
    v_mov_b32 v73, 0
    v_mov_b32 v74, 0
    v_mov_b32 v75, 0
    v_mov_b32 v76, 0
    v_mov_b32 v77, 0
    v_mov_b32 v78, 0
    v_mov_b32 v79, 0
    v_mov_b32 v112, 0
    v_mov_b32 v113, 0
    v_mov_b32 v114, 0
    v_mov_b32 v115, 0
    v_mov_b32 v116, 0
    v_mov_b32 v117, 0
    v_mov_b32 v118, 0
    v_mov_b32_e64 v119, 0
    s_mul_i32 s23, s16, 28672
    s_lshl_b32 s29, s28, 11
    s_add_u32 s23, s23, s29
    s_add_u32 s23, s23, 117456896
    s_mul_i32 s24, s16, 114688
    s_lshl_b32 s29, s28, 11
    s_add_u32 s24, s24, s29
    s_add_u32 s24, s24, 50331648
    s_nop 0
    s_waitcnt vmcnt(0) lgkmcnt(0)
    s_cmp_lg_u32 s18, 0
    s_cbranch_scc1 VA_CF_OK
    v_mov_b32 v6, 124
    s_mov_b32 s27, 0
    s_nop 0
VA_CF:
    buffer_load_dword v5, v6, s[12:15], 0 offen sc1
    s_add_u32 s27, s27, 1
    s_waitcnt vmcnt(0)
    v_readfirstlane_b32 s30, v5
    s_nop 3
    s_cmp_eq_u32 s30, 0xffff
    s_cbranch_scc1 CH_REDO
    s_cmp_lg_u32 s30, 0
    s_cbranch_scc1 VA_CF_OK
    s_sleep 2
    s_cmp_lt_u32 s27, 400
    s_cbranch_scc1 VA_CF
    s_mov_b64 exec, 1
    v_mov_b32 v44, 0xffff
    v_mov_b32_e64 v45, 0
    buffer_atomic_cmpswap v[44:45], v6, s[12:15], 0 offen
    s_mov_b64 exec, -1
    s_mov_b32 s27, 0
    s_branch VA_CF
    s_nop 0
VA_CF_OK:
    v_mov_b32_e64 v6, 0
    s_mov_b32 s30, 85131264
    s_mov_b32 s27, 0
    s_nop 0
VA_WU:
    buffer_load_dword v5, v6, s[8:11], s30 offen sc1
    s_add_u32 s27, s27, 1
    s_nop 0
    s_cmp_gt_u32 s27, 65536
    s_cbranch_scc1 CH_FAIL
    s_waitcnt vmcnt(0)
    v_cmp_le_u32 vcc, 224, v5
    s_cbranch_vccnz VA_WU_OK
    s_nop 0
    s_sleep 4
    s_branch VA_WU
VA_WU_OK:
    s_barrier
    s_cmp_eq_u32 s18, 0
    s_cbranch_scc0 VA_LOOP1
.p2align 7
VA_LOOP0:
    ds_read_b128 v[140:143], v7 offset:0
    ds_read_b128 v[144:147], v7 offset:1024
    ds_read_b128 v[148:151], v7 offset:2048
    ds_read_b128 v[152:155], v7 offset:3072
    ds_read_b128 v[156:159], v7 offset:4096
    ds_read_b128 v[160:163], v7 offset:5120
    ds_read_b128 v[164:167], v7 offset:6144
    ds_read_b128 v[168:171], v7 offset:7168
    s_cmp_lg_u32 s19, 16
    s_cbranch_scc1 VA_LOOP0_NW
    v_mov_b32_e64 v6, 0
    s_mov_b32 s30, 85133440
    s_mov_b32 s27, 0
    s_nop 0
VA_LOOP0_WU2:
    buffer_load_dword v5, v6, s[8:11], s30 offen sc1
    s_add_u32 s27, s27, 1
    s_nop 0
    s_cmp_gt_u32 s27, 65536
    s_cbranch_scc1 CH_FAIL
    s_waitcnt vmcnt(0)
    v_cmp_le_u32 vcc, 168, v5
    s_cbranch_vccnz VA_LOOP0_WU2_OK
    s_nop 0
    s_sleep 4
    s_branch VA_LOOP0_WU2
VA_LOOP0_WU2_OK:
VA_LOOP0_NW:
    s_mov_b32 s27, 0
    s_nop 0
    buffer_load_dwordx4 v[20:23], v17, s[8:11], s20 offen sc1
    buffer_load_dwordx4 v[24:27], v18, s[8:11], s20 offen sc1
    s_nop 15
    s_nop 7
VA_LOOP0_POLL:
    buffer_load_dwordx4 v[20:23], v17, s[8:11], s20 offen sc1
    buffer_load_dwordx4 v[24:27], v18, s[8:11], s20 offen sc1
    s_add_u32 s27, s27, 1
    s_nop 0
    s_cmp_gt_u32 s27, 65536
    s_cbranch_scc1 CH_FAIL
    s_waitcnt vmcnt(2)
VA_LOOP0_CHK:
    v_max3_u32 v5, v20, v21, v22
    v_max3_u32 v5, v5, v23, v24
    v_max3_u32 v5, v5, v25, v26
    v_max_u32_e64 v5, v5, v27
    v_cmp_eq_u32 vcc, -1, v5
    s_cbranch_vccnz VA_LOOP0_POLL
    ds_write_b128 v17, v[20:23] offset:4096
    ds_write_b128 v18, v[24:27] offset:4096
    v_smfmac_f32_16x16x64_bf16 v[48:51], v[20:23], a[0:7], v4
    s_add_u32 s29, s24, 0
    s_nop 0
    buffer_load_dwordx4 v[80:83], v2, s[8:11], s29 offen offset:0 sc1
    v_smfmac_f32_16x16x64_bf16 v[52:55], v[20:23], a[8:15], v4
    buffer_load_dwordx4 v[88:91], v2, s[8:11], s29 offen offset:1024 sc1
    v_smfmac_f32_16x16x64_bf16 v[56:59], v[20:23], a[16:23], v4
    s_add_u32 s29, s24, 28672
    buffer_load_dwordx4 v[84:87], v2, s[8:11], s29 offen offset:0 sc1
    s_nop 0
    s_waitcnt lgkmcnt(8)
    v_smfmac_f32_16x16x64_bf16 v[60:63], v[20:23], v[140:147], v4
    ds_read_b128 v[140:143], v7 offset:8192
    buffer_load_dwordx4 v[92:95], v2, s[8:11], s29 offen offset:1024 sc1
    v_smfmac_f32_16x16x64_bf16 v[64:67], v[20:23], a[24:31], v4
    ds_read_b128 v[144:147], v7 offset:9216
    s_add_u32 s29, s24, 57344
    buffer_load_dwordx4 v[96:99], v2, s[8:11], s29 offen offset:0 sc1
    v_smfmac_f32_16x16x64_bf16 v[68:71], v[20:23], a[32:39], v4
    buffer_load_dwordx4 v[104:107], v2, s[8:11], s29 offen offset:1024 sc1
    s_nop 0
    s_waitcnt lgkmcnt(8)
    v_smfmac_f32_16x16x64_bf16 v[72:75], v[20:23], v[148:155], v4
    ds_read_b128 v[148:151], v7 offset:10240
    s_add_u32 s29, s24, 86016
    buffer_load_dwordx4 v[100:103], v2, s[8:11], s29 offen offset:0 sc1
    s_waitcnt lgkmcnt(0)
    s_barrier
    ds_read_b128 v[28:31], v15 offset:4096
    ds_read_b128 v[32:35], v16 offset:4096
    ds_read_b128 v[36:39], v252 offset:4096
    ds_read_b128 v[40:43], v253 offset:4096
    ds_read_b128 v[44:47], v254 offset:4096
    v_smfmac_f32_16x16x64_bf16 v[76:79], v[20:23], a[40:47], v4
    ds_read_b128 v[152:155], v7 offset:11264
    buffer_load_dwordx4 v[108:111], v2, s[8:11], s29 offen offset:1024 sc1
    v_smfmac_f32_16x16x64_bf16 v[48:51], v[24:27], a[48:55], v4
    v_smfmac_f32_16x16x64_bf16 v[52:55], v[24:27], v[156:163], v4
    ds_read_b128 v[156:159], v7 offset:12288
    v_smfmac_f32_16x16x64_bf16 v[56:59], v[24:27], a[56:63], v4
    ds_read_b128 v[160:163], v7 offset:13312
    buffer_store_dwordx4 v[112:115], v2, s[8:11], s23 offen offset:0 sc1
    v_smfmac_f32_16x16x64_bf16 v[60:63], v[24:27], a[64:71], v4
    v_smfmac_f32_16x16x64_bf16 v[64:67], v[24:27], v[164:171], v4
    ds_read_b128 v[164:167], v7 offset:14336
    v_smfmac_f32_16x16x64_bf16 v[68:71], v[24:27], a[72:79], v4
    ds_read_b128 v[168:171], v7 offset:15360
    buffer_store_dwordx4 v[116:119], v2, s[8:11], s23 offen offset:1024 sc1
    s_add_u32 s23, s23, 114688
    v_smfmac_f32_16x16x64_bf16 v[72:75], v[24:27], a[80:87], v4
    v_smfmac_f32_16x16x64_bf16 v[76:79], v[24:27], v[140:147], v4
    ds_read_b128 v[140:143], v7 offset:16384
    s_nop 0
    s_waitcnt lgkmcnt(10)
    v_smfmac_f32_16x16x64_bf16 v[48:51], v[28:31], a[88:95], v4
    ds_read_b128 v[144:147], v7 offset:17408
    v_smfmac_f32_16x16x64_bf16 v[52:55], v[28:31], a[96:103], v4
    s_waitcnt lgkmcnt(10)
    s_waitcnt lgkmcnt(6)
    v_smfmac_f32_16x16x64_bf16 v[48:51], v[32:35], v[148:155], v4
    ds_read_b128 v[148:151], v7 offset:18432
    v_smfmac_f32_16x16x64_bf16 v[52:55], v[32:35], a[104:111], v4
    ds_read_b128 v[152:155], v7 offset:19456
    v_smfmac_f32_16x16x64_bf16 v[48:51], v[36:39], a[112:119], v4
    s_nop 0
    s_waitcnt lgkmcnt(6)
    v_smfmac_f32_16x16x64_bf16 v[52:55], v[36:39], v[156:163], v4
    ds_read_b128 v[156:159], v7 offset:20480
    v_smfmac_f32_16x16x64_bf16 v[48:51], v[40:43], a[120:127], v4
    ds_read_b128 v[160:163], v7 offset:21504
    v_smfmac_f32_16x16x64_bf16 v[52:55], v[40:43], a[128:135], v4
    s_nop 0
    s_waitcnt lgkmcnt(6)
    v_smfmac_f32_16x16x64_bf16 v[48:51], v[44:47], v[164:171], v4
    ds_read_b128 v[164:167], v7 offset:22528
    v_smfmac_f32_16x16x64_bf16 v[52:55], v[44:47], a[136:143], v4
    ds_read_b128 v[168:171], v7 offset:23552
    v_smfmac_f32_16x16x64_bf16 v[56:59], v[28:31], a[144:151], v4
    s_nop 0
    s_waitcnt lgkmcnt(6)
    v_smfmac_f32_16x16x64_bf16 v[60:63], v[28:31], v[140:147], v4
    ds_read_b128 v[140:143], v7 offset:24576
    v_smfmac_f32_16x16x64_bf16 v[56:59], v[32:35], a[152:159], v4
    ds_read_b128 v[144:147], v7 offset:25600
    v_smfmac_f32_16x16x64_bf16 v[60:63], v[32:35], a[160:167], v4
    s_nop 0
    s_waitcnt lgkmcnt(6)
    v_smfmac_f32_16x16x64_bf16 v[56:59], v[36:39], v[148:155], v4
    ds_read_b128 v[148:151], v7 offset:26624
    v_smfmac_f32_16x16x64_bf16 v[60:63], v[36:39], a[168:175], v4
    ds_read_b128 v[152:155], v7 offset:27648
    v_smfmac_f32_16x16x64_bf16 v[56:59], v[40:43], a[176:183], v4
    v_permlane32_swap_b32 v48, v50
    s_nop 0
    v_smfmac_f32_16x16x64_bf16 v[60:63], v[40:43], a[184:191], v4
    v_permlane32_swap_b32 v49, v51
    s_waitcnt lgkmcnt(6)
    v_smfmac_f32_16x16x64_bf16 v[56:59], v[44:47], v[156:163], v4
    v_permlane32_swap_b32 v52, v54
    s_nop 0
    v_smfmac_f32_16x16x64_bf16 v[60:63], v[44:47], a[192:199], v4
    v_permlane32_swap_b32 v53, v55
    s_nop 0
    v_smfmac_f32_16x16x64_bf16 v[64:67], v[28:31], a[200:207], v4
    v_add_f32 v48, v48, v50
    v_add_f32 v49, v49, v51
    v_smfmac_f32_16x16x64_bf16 v[68:71], v[28:31], a[208:215], v4
    v_add_f32 v52, v52, v54
    v_add_f32 v53, v53, v55
    v_smfmac_f32_16x16x64_bf16 v[64:67], v[32:35], a[216:223], v4
    v_cvt_pk_bf16_f32 v112, v48, v49
    v_smfmac_f32_16x16x64_bf16 v[68:71], v[32:35], a[224:231], v4
    v_cvt_pk_bf16_f32 v116, v52, v53
    s_nop 0
    s_waitcnt lgkmcnt(4)
    v_smfmac_f32_16x16x64_bf16 v[64:67], v[36:39], v[164:171], v4
    v_smfmac_f32_16x16x64_bf16 v[68:71], v[36:39], a[232:239], v4
    v_smfmac_f32_16x16x64_bf16 v[64:67], v[40:43], a[240:247], v4
    v_permlane32_swap_b32 v56, v58
    s_nop 0
    v_smfmac_f32_16x16x64_bf16 v[68:71], v[40:43], a[248:255], v4
    v_permlane32_swap_b32 v57, v59
    s_nop 0
    v_smfmac_f32_16x16x64_bf16 v[64:67], v[44:47], v[172:179], v4
    v_permlane32_swap_b32 v60, v62
    s_nop 0
    v_smfmac_f32_16x16x64_bf16 v[68:71], v[44:47], v[180:187], v4
    v_permlane32_swap_b32 v61, v63
    s_waitcnt lgkmcnt(2)
    v_smfmac_f32_16x16x64_bf16 v[72:75], v[28:31], v[140:147], v4
    v_add_f32 v56, v56, v58
    v_add_f32 v57, v57, v59
    v_smfmac_f32_16x16x64_bf16 v[76:79], v[28:31], v[188:195], v4
    v_add_f32 v60, v60, v62
    v_add_f32 v61, v61, v63
    v_smfmac_f32_16x16x64_bf16 v[72:75], v[32:35], v[196:203], v4
    v_cvt_pk_bf16_f32 v113, v56, v57
    v_smfmac_f32_16x16x64_bf16 v[76:79], v[32:35], v[204:211], v4
    v_cvt_pk_bf16_f32 v117, v60, v61
    v_smfmac_f32_16x16x64_bf16 v[72:75], v[36:39], v[212:219], v4
    v_smfmac_f32_16x16x64_bf16 v[76:79], v[36:39], v[220:227], v4
    s_nop 0
    s_waitcnt lgkmcnt(0)
    v_smfmac_f32_16x16x64_bf16 v[72:75], v[40:43], v[148:155], v4
    v_permlane32_swap_b32 v64, v66
    s_nop 0
    v_smfmac_f32_16x16x64_bf16 v[76:79], v[40:43], v[228:235], v4
    v_permlane32_swap_b32 v65, v67
    s_nop 0
    v_smfmac_f32_16x16x64_bf16 v[72:75], v[44:47], v[236:243], v4
    v_permlane32_swap_b32 v68, v70
    s_nop 0
    v_smfmac_f32_16x16x64_bf16 v[76:79], v[44:47], v[244:251], v4
    v_permlane32_swap_b32 v69, v71
    s_nop 0
    s_add_u32 s24, s24, 458752
    v_add_f32 v64, v64, v66
    v_add_f32 v65, v65, v67
    v_add_f32 v68, v68, v70
    v_add_f32 v69, v69, v71
    v_cvt_pk_bf16_f32 v114, v64, v65
    v_cvt_pk_bf16_f32 v118, v68, v69
    v_mov_b32 v132, 0
    v_mov_b32 v133, 0
    v_mov_b32 v134, 0
    v_mov_b32 v135, 0
    v_mov_b32 v136, 0
    v_mov_b32 v137, 0
    v_mov_b32 v138, 0
    v_mov_b32 v139, 0
    v_permlane32_swap_b32 v72, v74
    v_permlane32_swap_b32 v73, v75
    v_permlane32_swap_b32 v76, v78
    v_permlane32_swap_b32 v77, v79
    v_add_f32 v72, v72, v74
    v_add_f32 v73, v73, v75
    v_add_f32 v76, v76, v78
    v_add_f32 v77, v77, v79
    v_cvt_pk_bf16_f32 v115, v72, v73
    v_cvt_pk_bf16_f32 v119, v76, v77
    s_cmp_eq_u32 s19, 63
    s_cbranch_scc1 VA_DONE
    s_mov_b32 s27, 0
    s_sleep 4
    buffer_load_dwordx4 v[120:123], v2, s[8:11], s22 offen sc1
    buffer_load_dwordx4 v[124:127], v2, s[8:11], s22 offen offset:1024 sc1
    buffer_load_dwordx2 v[128:129], v3, s[8:11], s22 offen offset:2048 sc1
    s_nop 15
    s_nop 15
VA_LOOP0_POLLB:
    buffer_load_dwordx4 v[120:123], v2, s[8:11], s22 offen sc1
    buffer_load_dwordx4 v[124:127], v2, s[8:11], s22 offen offset:1024 sc1
    buffer_load_dwordx2 v[128:129], v3, s[8:11], s22 offen offset:2048 sc1
    s_add_u32 s27, s27, 1
    s_nop 0
    s_cmp_gt_u32 s27, 65536
    s_cbranch_scc1 CH_FAIL
    s_waitcnt vmcnt(3)
    v_max3_u32 v5, v120, v121, v122
    v_max3_u32 v5, v5, v123, v124
    v_max3_u32 v5, v5, v125, v126
    v_max3_u32 v5, v5, v127, v128
    v_max_u32_e64 v5, v5, v129
    v_cmp_eq_u32 vcc, -1, v5
    s_cbranch_vccnz VA_LOOP0_POLLB
    v_smfmac_f32_16x16x64_bf16 v[132:135], v[120:123], v[80:87], v4
    v_smfmac_f32_16x16x64_bf16 v[136:139], v[120:123], v[88:95], v4
    v_smfmac_f32_16x16x64_bf16 v[132:135], v[124:127], v[96:103], v4
    v_smfmac_f32_16x16x64_bf16 v[136:139], v[124:127], v[104:111], v4
    s_nop 3
    s_nop 0
    v_smfmac_f32_16x16x32_bf16 v[132:135], v[128:129], v[112:115], v4
    v_smfmac_f32_16x16x32_bf16 v[136:139], v[128:129], v[116:119], v4
    s_nop 6
    v_permlane32_swap_b32 v132, v134
    v_permlane32_swap_b32 v133, v135
    v_permlane32_swap_b32 v136, v138
    v_add_f32_e64 v132, v132, v134
    v_add_f32 v133, v133, v135
    v_permlane32_swap_b32 v137, v139
    ds_write2_b32 v8, v132, v133 offset0:0 offset1:32
    v_add_f32 v136, v136, v138
    v_add_f32 v137, v137, v139
    ds_write2_b32 v12, v136, v137 offset0:0 offset1:32
    s_waitcnt lgkmcnt(0)
    s_barrier
    s_cmp_gt_u32 s16, 1
    s_cbranch_scc1 VA_LOOP0_NOPUB
    ds_read_b128 v[132:135], v9
    ds_read_b128 v[136:139], v9 offset:16
    s_nop 0
    s_waitcnt lgkmcnt(0)
    v_pk_add_f32 v[132:133], v[132:133], v[134:135]
    v_pk_add_f32 v[136:137], v[136:137], v[138:139]
    v_pk_add_f32 v[132:133], v[132:133], v[136:137]
    v_cvt_pk_bf16_f32 v14, v132, v133
    v_min_u32_e64 v14, 0xfffffffe, v14
    buffer_store_dword v14, v10, s[8:11], s31 offen
    s_cmp_lg_u32 s19, 62
    s_cbranch_scc1 VA_LOOP0_NOPUB
    s_add_u32 s29, s31, 8192
    buffer_store_dword v14, v10, s[8:11], s29 offen sc1
VA_LOOP0_NOPUB:
    v_mov_b32 v48, 0
    v_mov_b32 v49, 0
    v_mov_b32 v50, 0
    v_mov_b32 v51, 0
    v_mov_b32 v52, 0
    v_mov_b32 v53, 0
    v_mov_b32 v54, 0
    v_mov_b32 v55, 0
    v_mov_b32 v56, 0
    v_mov_b32 v57, 0
    v_mov_b32 v58, 0
    v_mov_b32 v59, 0
    v_mov_b32 v60, 0
    v_mov_b32 v61, 0
    v_mov_b32 v62, 0
    v_mov_b32 v63, 0
    v_mov_b32 v64, 0
    v_mov_b32 v65, 0
    v_mov_b32 v66, 0
    v_mov_b32 v67, 0
    v_mov_b32 v68, 0
    v_mov_b32 v69, 0
    v_mov_b32 v70, 0
    v_mov_b32 v71, 0
    v_mov_b32 v72, 0
    v_mov_b32 v73, 0
    v_mov_b32 v74, 0
    v_mov_b32 v75, 0
    v_mov_b32 v76, 0
    v_mov_b32 v77, 0
    v_mov_b32 v78, 0
    v_mov_b32 v79, 0
    s_add_u32 s20, s20, 8192
    s_add_u32 s21, s21, 8192
    s_add_u32 s31, s31, 8192
    s_add_u32 s22, s22, 10240
    s_add_u32 s19, s19, 1
    s_branch VA_LOOP0
VA_LOOP0_REDOB:
    s_nop 7
    v_mov_b32 v132, 0
    v_mov_b32 v133, 0
    v_mov_b32 v134, 0
    v_mov_b32 v135, 0
    v_mov_b32 v136, 0
    v_mov_b32 v137, 0
    v_mov_b32 v138, 0
    v_mov_b32 v139, 0
    s_branch VA_LOOP0_POLLB
.p2align 7
VA_LOOP1:
    ds_read_b128 v[140:143], v7 offset:0
    ds_read_b128 v[144:147], v7 offset:1024
    ds_read_b128 v[148:151], v7 offset:2048
    ds_read_b128 v[152:155], v7 offset:3072
    ds_read_b128 v[156:159], v7 offset:4096
    ds_read_b128 v[160:163], v7 offset:5120
    ds_read_b128 v[164:167], v7 offset:6144
    ds_read_b128 v[168:171], v7 offset:7168
    s_cmp_lg_u32 s19, 16
    s_cbranch_scc1 VA_LOOP1_NW
    v_mov_b32_e64 v6, 0
    s_mov_b32 s30, 85133440
    s_mov_b32 s27, 0
    s_nop 0
VA_LOOP1_WU2:
    buffer_load_dword v5, v6, s[8:11], s30 offen sc1
    s_add_u32 s27, s27, 1
    s_nop 0
    s_cmp_gt_u32 s27, 65536
    s_cbranch_scc1 CH_FAIL
    s_waitcnt vmcnt(0)
    v_cmp_le_u32 vcc, 168, v5
    s_cbranch_vccnz VA_LOOP1_WU2_OK
    s_nop 0
    s_sleep 4
    s_branch VA_LOOP1_WU2
VA_LOOP1_WU2_OK:
VA_LOOP1_NW:
    s_mov_b32 s27, 0
    s_nop 0
    buffer_load_dwordx4 v[20:23], v17, s[8:11], s20 offen sc1
    buffer_load_dwordx4 v[24:27], v18, s[8:11], s20 offen sc1
    s_nop 15
    s_nop 7
VA_LOOP1_POLL:
    buffer_load_dwordx4 v[20:23], v17, s[8:11], s20 offen sc1
    buffer_load_dwordx4 v[24:27], v18, s[8:11], s20 offen sc1
    s_add_u32 s27, s27, 1
    s_nop 0
    s_cmp_gt_u32 s27, 65536
    s_cbranch_scc1 CH_FAIL
    s_waitcnt vmcnt(2)
VA_LOOP1_CHK:
    v_max3_u32 v5, v20, v21, v22
    v_max3_u32 v5, v5, v23, v24
    v_max3_u32 v5, v5, v25, v26
    v_max_u32_e64 v5, v5, v27
    v_cmp_eq_u32 vcc, -1, v5
    s_cbranch_vccnz VA_LOOP1_POLL
    ds_write_b128 v17, v[20:23] offset:4096
    ds_write_b128 v18, v[24:27] offset:4096
    v_smfmac_f32_16x16x64_bf16 v[48:51], v[20:23], a[0:7], v4
    s_add_u32 s29, s24, 0
    s_nop 0
    buffer_load_dwordx4 v[80:83], v2, s[8:11], s29 offen offset:0 sc1
    v_smfmac_f32_16x16x64_bf16 v[52:55], v[20:23], a[8:15], v4
    buffer_load_dwordx4 v[88:91], v2, s[8:11], s29 offen offset:1024 sc1
    v_smfmac_f32_16x16x64_bf16 v[56:59], v[20:23], a[16:23], v4
    s_add_u32 s29, s24, 28672
    buffer_load_dwordx4 v[84:87], v2, s[8:11], s29 offen offset:0 sc1
    s_nop 0
    s_waitcnt lgkmcnt(8)
    v_smfmac_f32_16x16x64_bf16 v[60:63], v[20:23], v[140:147], v4
    ds_read_b128 v[140:143], v7 offset:8192
    buffer_load_dwordx4 v[92:95], v2, s[8:11], s29 offen offset:1024 sc1
    v_smfmac_f32_16x16x64_bf16 v[64:67], v[20:23], a[24:31], v4
    ds_read_b128 v[144:147], v7 offset:9216
    s_add_u32 s29, s24, 57344
    buffer_load_dwordx4 v[96:99], v2, s[8:11], s29 offen offset:0 sc1
    v_smfmac_f32_16x16x64_bf16 v[68:71], v[20:23], a[32:39], v4
    buffer_load_dwordx4 v[104:107], v2, s[8:11], s29 offen offset:1024 sc1
    s_nop 0
    s_waitcnt lgkmcnt(8)
    v_smfmac_f32_16x16x64_bf16 v[72:75], v[20:23], v[148:155], v4
    ds_read_b128 v[148:151], v7 offset:10240
    s_add_u32 s29, s24, 86016
    buffer_load_dwordx4 v[100:103], v2, s[8:11], s29 offen offset:0 sc1
    s_waitcnt lgkmcnt(0)
    s_barrier
    ds_read_b128 v[28:31], v15 offset:4096
    ds_read_b128 v[32:35], v16 offset:4096
    ds_read_b128 v[36:39], v252 offset:4096
    ds_read_b128 v[40:43], v253 offset:4096
    ds_read_b128 v[44:47], v254 offset:4096
    v_smfmac_f32_16x16x64_bf16 v[76:79], v[20:23], a[40:47], v4
    ds_read_b128 v[152:155], v7 offset:11264
    buffer_load_dwordx4 v[108:111], v2, s[8:11], s29 offen offset:1024 sc1
    v_smfmac_f32_16x16x64_bf16 v[48:51], v[24:27], a[48:55], v4
    v_smfmac_f32_16x16x64_bf16 v[52:55], v[24:27], v[156:163], v4
    ds_read_b128 v[156:159], v7 offset:12288
    v_smfmac_f32_16x16x64_bf16 v[56:59], v[24:27], a[56:63], v4
    ds_read_b128 v[160:163], v7 offset:13312
    buffer_store_dwordx4 v[112:115], v2, s[8:11], s23 offen offset:0 sc1
    v_smfmac_f32_16x16x64_bf16 v[60:63], v[24:27], a[64:71], v4
    v_smfmac_f32_16x16x64_bf16 v[64:67], v[24:27], v[164:171], v4
    ds_read_b128 v[164:167], v7 offset:14336
    v_smfmac_f32_16x16x64_bf16 v[68:71], v[24:27], a[72:79], v4
    ds_read_b128 v[168:171], v7 offset:15360
    buffer_store_dwordx4 v[116:119], v2, s[8:11], s23 offen offset:1024 sc1
    s_add_u32 s23, s23, 114688
    v_smfmac_f32_16x16x64_bf16 v[72:75], v[24:27], a[80:87], v4
    v_smfmac_f32_16x16x64_bf16 v[76:79], v[24:27], v[140:147], v4
    ds_read_b128 v[140:143], v7 offset:16384
    s_nop 0
    s_waitcnt lgkmcnt(10)
    v_smfmac_f32_16x16x64_bf16 v[48:51], v[28:31], a[88:95], v4
    ds_read_b128 v[144:147], v7 offset:17408
    v_smfmac_f32_16x16x64_bf16 v[52:55], v[28:31], a[96:103], v4
    s_waitcnt lgkmcnt(10)
    s_waitcnt lgkmcnt(6)
    v_smfmac_f32_16x16x64_bf16 v[48:51], v[32:35], v[148:155], v4
    ds_read_b128 v[148:151], v7 offset:18432
    v_smfmac_f32_16x16x64_bf16 v[52:55], v[32:35], a[104:111], v4
    ds_read_b128 v[152:155], v7 offset:19456
    v_smfmac_f32_16x16x64_bf16 v[48:51], v[36:39], a[112:119], v4
    s_nop 0
    s_waitcnt lgkmcnt(6)
    v_smfmac_f32_16x16x64_bf16 v[52:55], v[36:39], v[156:163], v4
    ds_read_b128 v[156:159], v7 offset:20480
    v_smfmac_f32_16x16x64_bf16 v[48:51], v[40:43], a[120:127], v4
    ds_read_b128 v[160:163], v7 offset:21504
    v_smfmac_f32_16x16x64_bf16 v[52:55], v[40:43], a[128:135], v4
    s_nop 0
    s_waitcnt lgkmcnt(6)
    v_smfmac_f32_16x16x64_bf16 v[48:51], v[44:47], v[164:171], v4
    ds_read_b128 v[164:167], v7 offset:22528
    v_smfmac_f32_16x16x64_bf16 v[52:55], v[44:47], a[136:143], v4
    ds_read_b128 v[168:171], v7 offset:23552
    v_smfmac_f32_16x16x64_bf16 v[56:59], v[28:31], a[144:151], v4
    s_nop 0
    s_waitcnt lgkmcnt(6)
    v_smfmac_f32_16x16x64_bf16 v[60:63], v[28:31], v[140:147], v4
    ds_read_b128 v[140:143], v7 offset:24576
    v_smfmac_f32_16x16x64_bf16 v[56:59], v[32:35], a[152:159], v4
    ds_read_b128 v[144:147], v7 offset:25600
    v_smfmac_f32_16x16x64_bf16 v[60:63], v[32:35], a[160:167], v4
    s_nop 0
    s_waitcnt lgkmcnt(6)
    v_smfmac_f32_16x16x64_bf16 v[56:59], v[36:39], v[148:155], v4
    ds_read_b128 v[148:151], v7 offset:26624
    v_smfmac_f32_16x16x64_bf16 v[60:63], v[36:39], a[168:175], v4
    ds_read_b128 v[152:155], v7 offset:27648
    v_smfmac_f32_16x16x64_bf16 v[56:59], v[40:43], a[176:183], v4
    v_permlane32_swap_b32 v48, v50
    s_nop 0
    v_smfmac_f32_16x16x64_bf16 v[60:63], v[40:43], a[184:191], v4
    v_permlane32_swap_b32 v49, v51
    s_waitcnt lgkmcnt(6)
    v_smfmac_f32_16x16x64_bf16 v[56:59], v[44:47], v[156:163], v4
    v_permlane32_swap_b32 v52, v54
    s_nop 0
    v_smfmac_f32_16x16x64_bf16 v[60:63], v[44:47], a[192:199], v4
    v_permlane32_swap_b32 v53, v55
    s_nop 0
    v_smfmac_f32_16x16x64_bf16 v[64:67], v[28:31], a[200:207], v4
    v_add_f32 v48, v48, v50
    v_add_f32 v49, v49, v51
    v_smfmac_f32_16x16x64_bf16 v[68:71], v[28:31], a[208:215], v4
    v_add_f32 v52, v52, v54
    v_add_f32 v53, v53, v55
    v_smfmac_f32_16x16x64_bf16 v[64:67], v[32:35], a[216:223], v4
    v_cvt_pk_bf16_f32 v112, v48, v49
    v_smfmac_f32_16x16x64_bf16 v[68:71], v[32:35], a[224:231], v4
    v_cvt_pk_bf16_f32 v116, v52, v53
    s_nop 0
    s_waitcnt lgkmcnt(4)
    v_smfmac_f32_16x16x64_bf16 v[64:67], v[36:39], v[164:171], v4
    v_smfmac_f32_16x16x64_bf16 v[68:71], v[36:39], a[232:239], v4
    v_smfmac_f32_16x16x64_bf16 v[64:67], v[40:43], a[240:247], v4
    v_permlane32_swap_b32 v56, v58
    s_nop 0
    v_smfmac_f32_16x16x64_bf16 v[68:71], v[40:43], a[248:255], v4
    v_permlane32_swap_b32 v57, v59
    s_nop 0
    v_smfmac_f32_16x16x64_bf16 v[64:67], v[44:47], v[172:179], v4
    v_permlane32_swap_b32 v60, v62
    s_nop 0
    v_smfmac_f32_16x16x64_bf16 v[68:71], v[44:47], v[180:187], v4
    v_permlane32_swap_b32 v61, v63
    s_waitcnt lgkmcnt(2)
    v_smfmac_f32_16x16x64_bf16 v[72:75], v[28:31], v[140:147], v4
    v_add_f32 v56, v56, v58
    v_add_f32 v57, v57, v59
    v_smfmac_f32_16x16x64_bf16 v[76:79], v[28:31], v[188:195], v4
    v_add_f32 v60, v60, v62
    v_add_f32 v61, v61, v63
    v_smfmac_f32_16x16x64_bf16 v[72:75], v[32:35], v[196:203], v4
    v_cvt_pk_bf16_f32 v113, v56, v57
    v_smfmac_f32_16x16x64_bf16 v[76:79], v[32:35], v[204:211], v4
    v_cvt_pk_bf16_f32 v117, v60, v61
    v_smfmac_f32_16x16x64_bf16 v[72:75], v[36:39], v[212:219], v4
    v_smfmac_f32_16x16x64_bf16 v[76:79], v[36:39], v[220:227], v4
    s_nop 0
    s_waitcnt lgkmcnt(0)
    v_smfmac_f32_16x16x64_bf16 v[72:75], v[40:43], v[148:155], v4
    v_permlane32_swap_b32 v64, v66
    s_nop 0
    v_smfmac_f32_16x16x64_bf16 v[76:79], v[40:43], v[228:235], v4
    v_permlane32_swap_b32 v65, v67
    s_nop 0
    v_smfmac_f32_16x16x64_bf16 v[72:75], v[44:47], v[236:243], v4
    v_permlane32_swap_b32 v68, v70
    s_nop 0
    v_smfmac_f32_16x16x64_bf16 v[76:79], v[44:47], v[244:251], v4
    v_permlane32_swap_b32 v69, v71
    s_nop 0
    s_add_u32 s24, s24, 458752
    v_add_f32 v64, v64, v66
    v_add_f32 v65, v65, v67
    v_add_f32 v68, v68, v70
    v_add_f32 v69, v69, v71
    v_cvt_pk_bf16_f32 v114, v64, v65
    v_cvt_pk_bf16_f32 v118, v68, v69
    v_mov_b32 v132, 0
    v_mov_b32 v133, 0
    v_mov_b32 v134, 0
    v_mov_b32 v135, 0
    v_mov_b32 v136, 0
    v_mov_b32 v137, 0
    v_mov_b32 v138, 0
    v_mov_b32 v139, 0
    v_permlane32_swap_b32 v72, v74
    v_permlane32_swap_b32 v73, v75
    v_permlane32_swap_b32 v76, v78
    v_permlane32_swap_b32 v77, v79
    v_add_f32 v72, v72, v74
    v_add_f32 v73, v73, v75
    v_add_f32 v76, v76, v78
    v_add_f32 v77, v77, v79
    v_cvt_pk_bf16_f32 v115, v72, v73
    v_cvt_pk_bf16_f32 v119, v76, v77
    s_cmp_eq_u32 s19, 63
    s_cbranch_scc1 VA_DONE
    s_mov_b32 s27, 0
    s_sleep 4
    buffer_load_dwordx4 v[120:123], v2, s[8:11], s22 offen sc1
    buffer_load_dwordx4 v[124:127], v2, s[8:11], s22 offen offset:1024 sc1
    buffer_load_dwordx2 v[128:129], v3, s[8:11], s22 offen offset:2048 sc1
    s_nop 15
    s_nop 15
VA_LOOP1_POLLB:
    buffer_load_dwordx4 v[120:123], v2, s[8:11], s22 offen sc1
    buffer_load_dwordx4 v[124:127], v2, s[8:11], s22 offen offset:1024 sc1
    buffer_load_dwordx2 v[128:129], v3, s[8:11], s22 offen offset:2048 sc1
    s_add_u32 s27, s27, 1
    s_nop 0
    s_cmp_gt_u32 s27, 65536
    s_cbranch_scc1 CH_FAIL
    s_waitcnt vmcnt(3)
    v_max3_u32 v5, v120, v121, v122
    v_max3_u32 v5, v5, v123, v124
    v_max3_u32 v5, v5, v125, v126
    v_max3_u32 v5, v5, v127, v128
    v_max_u32_e64 v5, v5, v129
    v_cmp_eq_u32 vcc, -1, v5
    s_cbranch_vccnz VA_LOOP1_POLLB
    v_smfmac_f32_16x16x64_bf16 v[132:135], v[120:123], v[80:87], v4
    v_smfmac_f32_16x16x64_bf16 v[136:139], v[120:123], v[88:95], v4
    v_smfmac_f32_16x16x64_bf16 v[132:135], v[124:127], v[96:103], v4
    v_smfmac_f32_16x16x64_bf16 v[136:139], v[124:127], v[104:111], v4
    s_nop 3
    s_nop 0
    v_smfmac_f32_16x16x32_bf16 v[132:135], v[128:129], v[112:115], v4
    v_smfmac_f32_16x16x32_bf16 v[136:139], v[128:129], v[116:119], v4
    s_nop 6
    v_permlane32_swap_b32 v132, v134
    v_permlane32_swap_b32 v133, v135
    v_permlane32_swap_b32 v136, v138
    v_add_f32_e64 v132, v132, v134
    v_add_f32 v133, v133, v135
    v_permlane32_swap_b32 v137, v139
    ds_write2_b32 v8, v132, v133 offset0:0 offset1:32
    v_add_f32 v136, v136, v138
    v_add_f32 v137, v137, v139
    ds_write2_b32 v12, v136, v137 offset0:0 offset1:32
    s_waitcnt lgkmcnt(0)
    s_barrier
    s_cmp_gt_u32 s16, 1
    s_cbranch_scc1 VA_LOOP1_NOPUB
    ds_read_b128 v[132:135], v9
    ds_read_b128 v[136:139], v9 offset:16
    s_nop 0
    s_waitcnt lgkmcnt(0)
    v_pk_add_f32 v[132:133], v[132:133], v[134:135]
    v_pk_add_f32 v[136:137], v[136:137], v[138:139]
    v_pk_add_f32 v[132:133], v[132:133], v[136:137]
    v_cvt_pk_bf16_f32 v14, v132, v133
    v_min_u32_e64 v14, 0xfffffffe, v14
    buffer_store_dword v14, v10, s[8:11], s31 offen sc1
    s_cmp_lg_u32 s19, 62
    s_cbranch_scc1 VA_LOOP1_NOPUB
    s_add_u32 s29, s31, 8192
    buffer_store_dword v14, v10, s[8:11], s29 offen sc1
VA_LOOP1_NOPUB:
    v_mov_b32 v48, 0
    v_mov_b32 v49, 0
    v_mov_b32 v50, 0
    v_mov_b32 v51, 0
    v_mov_b32 v52, 0
    v_mov_b32 v53, 0
    v_mov_b32 v54, 0
    v_mov_b32 v55, 0
    v_mov_b32 v56, 0
    v_mov_b32 v57, 0
    v_mov_b32 v58, 0
    v_mov_b32 v59, 0
    v_mov_b32 v60, 0
    v_mov_b32 v61, 0
    v_mov_b32 v62, 0
    v_mov_b32 v63, 0
    v_mov_b32 v64, 0
    v_mov_b32 v65, 0
    v_mov_b32 v66, 0
    v_mov_b32 v67, 0
    v_mov_b32 v68, 0
    v_mov_b32 v69, 0
    v_mov_b32 v70, 0
    v_mov_b32 v71, 0
    v_mov_b32 v72, 0
    v_mov_b32 v73, 0
    v_mov_b32 v74, 0
    v_mov_b32 v75, 0
    v_mov_b32 v76, 0
    v_mov_b32 v77, 0
    v_mov_b32 v78, 0
    v_mov_b32 v79, 0
    s_add_u32 s20, s20, 8192
    s_add_u32 s21, s21, 8192
    s_add_u32 s31, s31, 8192
    s_add_u32 s22, s22, 10240
    s_add_u32 s19, s19, 1
    s_branch VA_LOOP1
VA_LOOP1_REDOB:
    s_nop 7
    v_mov_b32 v132, 0
    v_mov_b32 v133, 0
    v_mov_b32 v134, 0
    v_mov_b32 v135, 0
    v_mov_b32 v136, 0
    v_mov_b32 v137, 0
    v_mov_b32 v138, 0
    v_mov_b32 v139, 0
    s_branch VA_LOOP1_POLLB
VA_DONE:
    buffer_store_dwordx4 v[112:115], v2, s[8:11], s23 offen offset:0 sc1
    buffer_store_dwordx4 v[116:119], v2, s[8:11], s23 offen offset:1024 sc1
    s_add_u32 s23, s23, 114688
    s_waitcnt vmcnt(0)
    v_mov_b32 v5, 1
    s_mov_b32 s26, 85134080
    buffer_store_dword v5, v11, s[8:11], s26 offen sc1
    s_branch CH_DONE
    s_nop 0
SPR:
    v_and_b32 v1, 63, v0
    v_lshlrev_b32 v2, 7, v1
    v_lshlrev_b32 v6, 4, v1
    s_mov_b32 s19, 0
    v_mov_b32_e64 v3, 0
    s_mov_b32 s30, 85133824
    s_mov_b32 s27, 0
    s_nop 0
SPR_WX:
    buffer_load_dword v5, v3, s[8:11], s30 offen sc1
    s_add_u32 s27, s27, 1
    s_nop 0
    s_cmp_gt_u32 s27, 65536
    s_cbranch_scc1 CH_FAIL
    s_waitcnt vmcnt(0)
    v_cmp_le_u32 vcc, 32, v5
    s_cbranch_vccnz SPR_WX_OK
    s_sleep 4
    s_branch SPR_WX
SPR_WX_OK:
    s_cmp_eq_u32 s17, 31
    s_cbranch_scc1 EXP
    s_mov_b32 s20, 83886080
    s_mov_b32 s22, 84463616
    s_mov_b32 s23, 86016
    s_mul_i32 s24, s16, 114688
    s_add_u32 s24, s24, 51335168
    s_mul_i32 s30, s16, 8192
    s_add_u32 s30, s30, 83886080
    buffer_load_dword v4, v2, s[8:11], s30 offen sc1
    s_add_u32 s29, s30, 557056
    buffer_load_dword v4, v2, s[8:11], s29 offen sc1
    s_add_u32 s29, s30, 4211109888
    buffer_load_dword v4, v2, s[8:11], s29 offen sc1
    s_add_u32 s29, s30, 4211142656
    buffer_load_dword v4, v2, s[8:11], s29 offen sc1
    s_cmp_lg_u32 s18, 0
    s_cbranch_scc1 SPR_CF_OK
    v_mov_b32 v3, 124
    s_mov_b32 s27, 0
    s_nop 0
SPR_CF:
    buffer_load_dword v5, v3, s[12:15], 0 offen sc1
    s_add_u32 s27, s27, 1
    s_waitcnt vmcnt(0)
    v_readfirstlane_b32 s30, v5
    s_nop 3
    s_cmp_eq_u32 s30, 0xffff
    s_cbranch_scc1 CH_REDO
    s_cmp_lg_u32 s30, 0
    s_cbranch_scc1 SPR_CF_OK
    s_sleep 2
    s_cmp_lt_u32 s27, 400
    s_cbranch_scc1 SPR_CF
    s_mov_b64 exec, 1
    v_mov_b32 v44, 0xffff
    v_mov_b32_e64 v45, 0
    buffer_atomic_cmpswap v[44:45], v3, s[12:15], 0 offen
    s_mov_b64 exec, -1
    s_mov_b32 s27, 0
    s_branch SPR_CF
    s_nop 0
SPR_CF_OK:
    v_mov_b32_e64 v3, 0
    s_mov_b32 s30, 85131264
    s_mov_b32 s27, 0
    s_nop 0
SPR_WU:
    buffer_load_dword v5, v3, s[8:11], s30 offen sc1
    s_add_u32 s27, s27, 1
    s_nop 0
    s_cmp_gt_u32 s27, 65536
    s_cbranch_scc1 CH_FAIL
    s_waitcnt vmcnt(0)
    v_cmp_le_u32 vcc, 224, v5
    s_cbranch_vccnz SPR_WU_OK
    s_nop 0
    s_sleep 4
    s_branch SPR_WU
SPR_WU_OK:
    v_mov_b32_e64 v3, 0
SPR_LOOP:
    s_mov_b32 s27, 0
    s_nop 0
SPR_POLL:
    buffer_load_dword v5, v3, s[8:11], s20 offen sc1
    s_add_u32 s27, s27, 1
    s_nop 0
    s_cmp_gt_u32 s27, 65536
    s_cbranch_scc1 CH_FAIL
    s_waitcnt vmcnt(0)
    v_cmp_eq_u32 vcc, -1, v5
    s_cbranch_vccz SPR_GO
    s_sleep 4
    s_branch SPR_POLL
SPR_GO:
    s_cmp_lg_u32 s19, 14
    s_cbranch_scc1 SPR_NW
    v_mov_b32_e64 v3, 0
    s_mov_b32 s30, 85133440
    s_mov_b32 s27, 0
    s_nop 0
SPR_WU2:
    buffer_load_dword v5, v3, s[8:11], s30 offen sc1
    s_add_u32 s27, s27, 1
    s_nop 0
    s_cmp_gt_u32 s27, 65536
    s_cbranch_scc1 CH_FAIL
    s_waitcnt vmcnt(0)
    v_cmp_le_u32 vcc, 168, v5
    s_cbranch_vccnz SPR_WU2_OK
    s_nop 0
    s_sleep 4
    s_branch SPR_WU2
SPR_WU2_OK:
SPR_NW:
    s_cmp_lg_u32 s16, 0
    s_cbranch_scc1 SPR_N0
    s_add_u32 s29, s20, 24576
    buffer_load_dword v4, v2, s[8:11], s29 offen sc1
    buffer_load_dword v4, v2, s[8:11], s22 offen sc1
    s_add_u32 s29, s22, 2048
    buffer_load_dword v4, v2, s[8:11], s29 offen sc1
    s_lshl_b32 s30, s19, 9
    s_nop 0
    s_min_u32 s30, s30, 24576
    s_add_u32 s30, s30, 85098496
    buffer_load_dword v4, v2, s[8:11], s30 offen sc1
SPR_N0:
    s_cmp_lg_u32 s16, 1
    s_cbranch_scc1 SPR_N1
    buffer_load_dword v4, v2, s[8:11], s23 offen sc1
    s_add_u32 s29, s23, 8192
    buffer_load_dword v4, v2, s[8:11], s29 offen sc1
    s_add_u32 s29, s23, 16384
    buffer_load_dword v4, v2, s[8:11], s29 offen sc1
    s_add_u32 s29, s23, 20480
    buffer_load_dword v4, v2, s[8:11], s29 offen sc1
SPR_N1:
    s_add_u32 s20, s20, 8192
    s_add_u32 s22, s22, 10240
    s_add_u32 s23, s23, 28672
    s_add_u32 s24, s24, 458752
    s_add_u32 s19, s19, 1
    s_cmp_lt_u32 s19, 61
    s_cbranch_scc1 SPR_LOOP
    s_branch CH_DONE
EXP:
    s_cmp_lg_u32 s18, 0
    s_cbranch_scc1 EXP_CF_OK
    v_mov_b32 v3, 124
    s_mov_b32 s27, 0
    s_nop 0
EXP_CF:
    buffer_load_dword v5, v3, s[12:15], 0 offen sc1
    s_add_u32 s27, s27, 1
    s_waitcnt vmcnt(0)
    v_readfirstlane_b32 s30, v5
    s_nop 3
    s_cmp_eq_u32 s30, 0xffff
    s_cbranch_scc1 CH_REDO
    s_cmp_lg_u32 s30, 0
    s_cbranch_scc1 EXP_CF_OK
    s_sleep 2
    s_cmp_lt_u32 s27, 400
    s_cbranch_scc1 EXP_CF
    s_mov_b64 exec, 1
    v_mov_b32 v44, 0xffff
    v_mov_b32_e64 v45, 0
    buffer_atomic_cmpswap v[44:45], v3, s[12:15], 0 offen
    s_mov_b64 exec, -1
    s_mov_b32 s27, 0
    s_branch EXP_CF
    s_nop 0
EXP_CF_OK:
    s_lshl_b32 s29, s16, 2
    v_mov_b32 v8, 0x40000000
    v_mov_b32 v5, s29
    v_cmp_eq_u32 vcc, 0, v1
    s_nop 1
    v_cndmask_b32 v8, v8, v5, vcc
    s_mov_b32 s26, 85133568
    s_lshl_b32 s20, s16, 11
    s_nop 0
    s_min_u32 s20, s20, 5120
    s_add_u32 s20, s20, 83886080
EXP_LOOP:
    s_mov_b32 s27, 0
    s_nop 0
EXP_POLL:
    buffer_load_dwordx4 v[16:19], v6, s[8:11], s20 offen sc1
    buffer_load_dwordx4 v[20:23], v6, s[8:11], s20 offen offset:1024 sc1
    s_add_u32 s27, s27, 1
    s_nop 0
    s_cmp_gt_u32 s27, 65536
    s_cbranch_scc1 CH_FAIL
    s_waitcnt vmcnt(0)
    v_max3_u32 v5, v16, v17, v18
    v_max3_u32 v5, v5, v19, v20
    v_max3_u32 v5, v5, v21, v22
    v_max_u32 v5, v5, v23
    v_cmp_eq_u32 vcc, -1, v5
    s_cbranch_vccnz EXP_NO
    v_mov_b32 v10, s19
    buffer_store_dword v10, v8, s[8:11], s26 offen sc1
    s_add_u32 s29, s20, 2097152
    buffer_store_dwordx4 v[16:19], v6, s[8:11], s29 offen sc1
    buffer_store_dwordx4 v[20:23], v6, s[8:11], s29 offen offset:1024 sc1
    s_waitcnt vmcnt(0)
    s_cmp_lg_u32 s19, 63
    s_cbranch_scc1 EXP_NX
    v_mov_b32 v10, 64
    buffer_store_dword v10, v8, s[8:11], s26 offen sc1
    s_branch CH_DONE
    s_nop 0
EXP_NX:
    s_add_u32 s20, s20, 8192
    s_add_u32 s19, s19, 1
    s_branch EXP_LOOP
EXP_NO:
    s_sleep 4
    s_branch EXP_POLL
WORKER:
    s_sub_u32 s64, s17, 32
    s_nop 0
    s_cmp_ge_u32 s64, 224
    s_cbranch_scc1 CH_DONE
    s_nop 0
    s_load_dwordx2 s[4:5], s[0:1], 0
    s_load_dwordx2 s[6:7], s[0:1], 88
    s_waitcnt lgkmcnt(0)
    s_mov_b32 s56, s4
    s_and_b32 s57, s5, 0xffff
    s_mov_b32 s58, 1835008
    s_mov_b32 s59, 0x00020000
    s_mov_b32 s60, s6
    s_nop 0
    s_and_b32 s61, s7, 0xffff
    s_mov_b32 s62, 1835008
    s_mov_b32 s63, 0x00020000
    s_and_b32 s65, s64, 7
    s_lshl_b32 s65, s65, 7
    s_lshr_b32 s67, s64, 3
    s_mov_b32 s69, 0
    s_and_b32 s17, s64, 1
    s_lshr_b32 s18, s64, 1
    s_mov_b32 s29, 280
    s_mov_b32 s31, 280
    v_mov_b32_e64 v253, 0
    s_mov_b32 s30, 85133952
    s_mov_b32 s27, 0
    s_nop 0
WK_WX:
    buffer_load_dword v254, v253, s[8:11], s30 offen sc1
    s_add_u32 s27, s27, 1
    s_nop 0
    s_cmp_gt_u32 s27, 65536
    s_cbranch_scc1 CH_FAIL
    s_waitcnt vmcnt(0)
    v_cmp_le_u32 vcc, 32, v254
    s_cbranch_vccnz WK_WX_OK
    s_sleep 4
    s_branch WK_WX
WK_WX_OK:
    s_mul_hi_u32 s70, s18, 613566757
    s_lshl_b32 s70, s70, 7
    v_mov_b32 v253, 0
    s_add_u32 s30, s70, 85135360
    s_mov_b32 s27, 0
    s_nop 0
WK_WB:
    buffer_load_dword v254, v253, s[8:11], s30 offen sc1
    s_add_u32 s27, s27, 1
    s_nop 0
    s_cmp_gt_u32 s27, 65536
    s_cbranch_scc1 CH_FAIL
    s_waitcnt vmcnt(0)
    v_cmp_le_u32 vcc, 7, v254
    s_cbranch_vccnz WK_WB_OK
    s_sleep 2
    s_branch WK_WB
WK_WB_OK:
WK_PASS:
    v_and_b32_e64 v1, 63, v0
    v_lshlrev_b32 v1, 4, v1
    s_lshl_b32 s21, s16, 11
    s_mul_i32 s19, s18, 57344
    s_mov_b32 s22, 9437184
    s_cmp_ge_u32 s18, 112
    s_cselect_b32 s22, 4290641920, s22
    s_cmp_ge_u32 s18, 224
    s_cselect_b32 s22, 79429632, s22
    s_add_u32 s19, s19, s22
    s_nop 0
    s_mul_i32 s22, s16, 14336
    s_add_u32 s19, s19, s22
    s_add_u32 m0, s21, 0
    s_add_u32 s22, s19, 0
    s_nop 0
    buffer_load_dwordx4 v1, s[8:11], s22 offen sc1 lds
    buffer_load_dwordx4 v1, s[8:11], s22 offen offset:1024 sc1 lds
    s_add_u32 m0, s21, 8192
    s_add_u32 s22, s19, 2048
    buffer_load_dwordx4 v1, s[8:11], s22 offen sc1 lds
    buffer_load_dwordx4 v1, s[8:11], s22 offen offset:1024 sc1 lds
    s_add_u32 m0, s21, 16384
    s_add_u32 s22, s19, 4096
    buffer_load_dwordx4 v1, s[8:11], s22 offen sc1 lds
    buffer_load_dwordx4 v1, s[8:11], s22 offen offset:1024 sc1 lds
    s_lshl_b32 s23, s17, 4
    s_lshl_b32 s22, s16, 2
    s_add_u32 s23, s23, s22
    s_lshr_b32 s28, s23, 1
    s_mul_i32 s23, s23, 14336
    s_add_u32 s23, s23, 0
    s_nop 0
    buffer_load_dwordx4 a[0:3], v1, s[8:11], s23 offen offset:0 sc1
    buffer_load_dwordx4 a[4:7], v1, s[8:11], s23 offen offset:1024 sc1
    buffer_load_dwordx4 a[8:11], v1, s[8:11], s23 offen offset:2048 sc1
    buffer_load_dwordx4 a[12:15], v1, s[8:11], s23 offen offset:3072 sc1
    s_add_u32 s23, s23, 4096
    buffer_load_dwordx4 a[16:19], v1, s[8:11], s23 offen offset:0 sc1
    buffer_load_dwordx4 a[20:23], v1, s[8:11], s23 offen offset:1024 sc1
    buffer_load_dwordx4 a[24:27], v1, s[8:11], s23 offen offset:2048 sc1
    buffer_load_dwordx4 a[28:31], v1, s[8:11], s23 offen offset:3072 sc1
    s_add_u32 s23, s23, 4096
    buffer_load_dwordx4 a[32:35], v1, s[8:11], s23 offen offset:0 sc1
    buffer_load_dwordx4 a[36:39], v1, s[8:11], s23 offen offset:1024 sc1
    buffer_load_dwordx4 a[40:43], v1, s[8:11], s23 offen offset:2048 sc1
    buffer_load_dwordx4 a[44:47], v1, s[8:11], s23 offen offset:3072 sc1
    s_add_u32 s23, s23, 4096
    buffer_load_dwordx4 a[48:51], v1, s[8:11], s23 offen offset:0 sc1
    buffer_load_dwordx4 a[52:55], v1, s[8:11], s23 offen offset:1024 sc1
    buffer_load_dwordx4 a[56:59], v1, s[8:11], s23 offen offset:2048 sc1
    buffer_load_dwordx4 a[60:63], v1, s[8:11], s23 offen offset:3072 sc1
    s_add_u32 s23, s23, 4096
    buffer_load_dwordx4 a[64:67], v1, s[8:11], s23 offen offset:0 sc1
    buffer_load_dwordx4 a[68:71], v1, s[8:11], s23 offen offset:1024 sc1
    buffer_load_dwordx4 a[72:75], v1, s[8:11], s23 offen offset:2048 sc1
    buffer_load_dwordx4 a[76:79], v1, s[8:11], s23 offen offset:3072 sc1
    s_add_u32 s23, s23, 4096
    buffer_load_dwordx4 a[80:83], v1, s[8:11], s23 offen offset:0 sc1
    buffer_load_dwordx4 a[84:87], v1, s[8:11], s23 offen offset:1024 sc1
    buffer_load_dwordx4 a[88:91], v1, s[8:11], s23 offen offset:2048 sc1
    buffer_load_dwordx4 a[92:95], v1, s[8:11], s23 offen offset:3072 sc1
    s_add_u32 s23, s23, 4096
    buffer_load_dwordx4 a[96:99], v1, s[8:11], s23 offen offset:0 sc1
    buffer_load_dwordx4 a[100:103], v1, s[8:11], s23 offen offset:1024 sc1
    buffer_load_dwordx4 a[104:107], v1, s[8:11], s23 offen offset:2048 sc1
    buffer_load_dwordx4 a[108:111], v1, s[8:11], s23 offen offset:3072 sc1
    s_add_u32 s23, s23, 4096
    buffer_load_dwordx4 a[112:115], v1, s[8:11], s23 offen offset:0 sc1
    buffer_load_dwordx4 a[116:119], v1, s[8:11], s23 offen offset:1024 sc1
    buffer_load_dwordx4 a[120:123], v1, s[8:11], s23 offen offset:2048 sc1
    buffer_load_dwordx4 a[124:127], v1, s[8:11], s23 offen offset:3072 sc1
    s_add_u32 s23, s23, 4096
    buffer_load_dwordx4 a[128:131], v1, s[8:11], s23 offen offset:0 sc1
    buffer_load_dwordx4 a[132:135], v1, s[8:11], s23 offen offset:1024 sc1
    buffer_load_dwordx4 a[136:139], v1, s[8:11], s23 offen offset:2048 sc1
    buffer_load_dwordx4 a[140:143], v1, s[8:11], s23 offen offset:3072 sc1
    s_add_u32 s23, s23, 4096
    buffer_load_dwordx4 a[144:147], v1, s[8:11], s23 offen offset:0 sc1
    buffer_load_dwordx4 a[148:151], v1, s[8:11], s23 offen offset:1024 sc1
    buffer_load_dwordx4 a[152:155], v1, s[8:11], s23 offen offset:2048 sc1
    buffer_load_dwordx4 a[156:159], v1, s[8:11], s23 offen offset:3072 sc1
    s_add_u32 s23, s23, 4096
    buffer_load_dwordx4 a[160:163], v1, s[8:11], s23 offen offset:0 sc1
    s_nop 0
    s_waitcnt vmcnt(20)
    buffer_load_dwordx4 a[164:167], v1, s[8:11], s23 offen offset:1024 sc1
    buffer_load_dwordx4 a[168:171], v1, s[8:11], s23 offen offset:2048 sc1
    buffer_load_dwordx4 a[172:175], v1, s[8:11], s23 offen offset:3072 sc1
    s_add_u32 s23, s23, 4096
    buffer_load_dwordx4 a[176:179], v1, s[8:11], s23 offen offset:0 sc1
    buffer_load_dwordx4 a[180:183], v1, s[8:11], s23 offen offset:1024 sc1
    buffer_load_dwordx4 a[184:187], v1, s[8:11], s23 offen offset:2048 sc1
    buffer_load_dwordx4 a[188:191], v1, s[8:11], s23 offen offset:3072 sc1
    s_add_u32 s23, s23, 4096
    buffer_load_dwordx4 a[192:195], v1, s[8:11], s23 offen offset:0 sc1
    buffer_load_dwordx4 a[196:199], v1, s[8:11], s23 offen offset:1024 sc1
    buffer_load_dwordx4 a[200:203], v1, s[8:11], s23 offen offset:2048 sc1
    buffer_load_dwordx4 a[204:207], v1, s[8:11], s23 offen offset:3072 sc1
    s_add_u32 s23, s23, 4096
    buffer_load_dwordx4 a[208:211], v1, s[8:11], s23 offen offset:0 sc1
    buffer_load_dwordx4 a[212:215], v1, s[8:11], s23 offen offset:1024 sc1
    buffer_load_dwordx4 a[216:219], v1, s[8:11], s23 offen offset:2048 sc1
    buffer_load_dwordx4 a[220:223], v1, s[8:11], s23 offen offset:3072 sc1
    s_waitcnt vmcnt(0)
    s_barrier
    ds_read_b128 v[80:83], v1 offset:0
    ds_read_b128 v[84:87], v1 offset:2048
    ds_read_b128 v[88:91], v1 offset:4096
    ds_read_b128 v[92:95], v1 offset:6144
WG_UNIT:
    s_add_u32 s27, s18, s29
    s_nop 0
    s_cmp_lt_u32 s27, 224
    s_cbranch_scc1 WK_NOGW
    s_nop 0
    s_cmp_ge_u32 s18, 224
    s_cbranch_scc1 WK_NOGW
    s_cmp_eq_u32 s69, 0
    s_cbranch_scc1 WK_NOGW
    s_mov_b32 s70, s27
    v_mov_b32_e64 v253, 0
    s_mov_b32 s30, 85133696
    s_mov_b32 s27, 0
    s_nop 0
WK_W0:
    buffer_load_dword v254, v253, s[8:11], s30 offen sc1
    s_add_u32 s27, s27, 1
    s_nop 0
    s_cmp_gt_u32 s27, 65536
    s_cbranch_scc1 CH_FAIL
    s_waitcnt vmcnt(0)
    v_cmp_le_u32 vcc, 84, v254
    s_cbranch_vccnz WK_W0_OK
    s_nop 0
    s_sleep 4
    s_branch WK_W0
WK_W0_OK:
    s_mov_b32 s27, s70
    s_nop 0
WK_NOGW:
    s_cmp_lt_u32 s27, s31
    s_cselect_b32 s23, s27, s18
    s_mul_i32 s20, s23, 57344
    s_mov_b32 s22, 9437184
    s_cmp_ge_u32 s23, 112
    s_cselect_b32 s22, 4290641920, s22
    s_cmp_ge_u32 s23, 224
    s_cselect_b32 s22, 79429632, s22
    s_add_u32 s20, s20, s22
    s_nop 0
    s_mul_i32 s22, s16, 14336
    s_add_u32 s20, s20, s22
    s_nop 0
    s_cmp_lt_u32 s18, 112
    s_cbranch_scc1 WG_LOOPU
    s_nop 0
WG_LOOPW:
    s_waitcnt vmcnt(6)
    s_barrier
    s_add_u32 m0, s21, 24576
    s_add_u32 s22, s19, 6144
    buffer_load_dwordx4 v1, s[8:11], s22 offen sc1 lds
    buffer_load_dwordx4 v1, s[8:11], s22 offen offset:1024 sc1 lds
    ds_read_b128 v[96:99], v1 offset:1024
    ds_read_b128 v[100:103], v1 offset:3072
    ds_read_b128 v[104:107], v1 offset:5120
    ds_read_b128 v[108:111], v1 offset:7168
    s_nop 0
    s_waitcnt lgkmcnt(4)
    v_mfma_f32_16x16x32_bf16 v[16:19], v[80:83], a[0:3], 0
    v_mfma_f32_16x16x32_bf16 v[32:35], v[80:83], a[56:59], 0
    v_mfma_f32_16x16x32_bf16 v[48:51], v[80:83], a[112:115], 0
    v_mfma_f32_16x16x32_bf16 v[64:67], v[80:83], a[168:171], 0
    v_mfma_f32_16x16x32_bf16 v[20:23], v[84:87], a[0:3], 0
    v_mfma_f32_16x16x32_bf16 v[36:39], v[84:87], a[56:59], 0
    v_mfma_f32_16x16x32_bf16 v[52:55], v[84:87], a[112:115], 0
    v_mfma_f32_16x16x32_bf16 v[68:71], v[84:87], a[168:171], 0
    v_mfma_f32_16x16x32_bf16 v[24:27], v[88:91], a[0:3], 0
    v_mfma_f32_16x16x32_bf16 v[40:43], v[88:91], a[56:59], 0
    v_mfma_f32_16x16x32_bf16 v[56:59], v[88:91], a[112:115], 0
    v_mfma_f32_16x16x32_bf16 v[72:75], v[88:91], a[168:171], 0
    v_mfma_f32_16x16x32_bf16 v[28:31], v[92:95], a[0:3], 0
    v_mfma_f32_16x16x32_bf16 v[44:47], v[92:95], a[56:59], 0
    v_mfma_f32_16x16x32_bf16 v[60:63], v[92:95], a[112:115], 0
    v_mfma_f32_16x16x32_bf16 v[76:79], v[92:95], a[168:171], 0
    ds_read_b128 v[80:83], v1 offset:8192
    ds_read_b128 v[84:87], v1 offset:10240
    ds_read_b128 v[88:91], v1 offset:12288
    ds_read_b128 v[92:95], v1 offset:14336
    s_nop 0
    s_waitcnt lgkmcnt(4)
    v_mfma_f32_16x16x32_bf16 v[16:19], v[96:99], a[4:7], v[16:19]
    v_mfma_f32_16x16x32_bf16 v[32:35], v[96:99], a[60:63], v[32:35]
    v_mfma_f32_16x16x32_bf16 v[48:51], v[96:99], a[116:119], v[48:51]
    v_mfma_f32_16x16x32_bf16 v[64:67], v[96:99], a[172:175], v[64:67]
    v_mfma_f32_16x16x32_bf16 v[20:23], v[100:103], a[4:7], v[20:23]
    v_mfma_f32_16x16x32_bf16 v[36:39], v[100:103], a[60:63], v[36:39]
    v_mfma_f32_16x16x32_bf16 v[52:55], v[100:103], a[116:119], v[52:55]
    v_mfma_f32_16x16x32_bf16 v[68:71], v[100:103], a[172:175], v[68:71]
    v_mfma_f32_16x16x32_bf16 v[24:27], v[104:107], a[4:7], v[24:27]
    v_mfma_f32_16x16x32_bf16 v[40:43], v[104:107], a[60:63], v[40:43]
    v_mfma_f32_16x16x32_bf16 v[56:59], v[104:107], a[116:119], v[56:59]
    v_mfma_f32_16x16x32_bf16 v[72:75], v[104:107], a[172:175], v[72:75]
    v_mfma_f32_16x16x32_bf16 v[28:31], v[108:111], a[4:7], v[28:31]
    v_mfma_f32_16x16x32_bf16 v[44:47], v[108:111], a[60:63], v[44:47]
    v_mfma_f32_16x16x32_bf16 v[60:63], v[108:111], a[116:119], v[60:63]
    v_mfma_f32_16x16x32_bf16 v[76:79], v[108:111], a[172:175], v[76:79]
    s_waitcnt vmcnt(6)
    s_barrier
    s_add_u32 m0, s21, 32768
    s_add_u32 s22, s19, 8192
    buffer_load_dwordx4 v1, s[8:11], s22 offen sc1 lds
    buffer_load_dwordx4 v1, s[8:11], s22 offen offset:1024 sc1 lds
    ds_read_b128 v[96:99], v1 offset:9216
    ds_read_b128 v[100:103], v1 offset:11264
    ds_read_b128 v[104:107], v1 offset:13312
    ds_read_b128 v[108:111], v1 offset:15360
    s_nop 0
    s_waitcnt lgkmcnt(4)
    v_mfma_f32_16x16x32_bf16 v[16:19], v[80:83], a[8:11], v[16:19]
    v_mfma_f32_16x16x32_bf16 v[32:35], v[80:83], a[64:67], v[32:35]
    v_mfma_f32_16x16x32_bf16 v[48:51], v[80:83], a[120:123], v[48:51]
    v_mfma_f32_16x16x32_bf16 v[64:67], v[80:83], a[176:179], v[64:67]
    v_mfma_f32_16x16x32_bf16 v[20:23], v[84:87], a[8:11], v[20:23]
    v_mfma_f32_16x16x32_bf16 v[36:39], v[84:87], a[64:67], v[36:39]
    v_mfma_f32_16x16x32_bf16 v[52:55], v[84:87], a[120:123], v[52:55]
    v_mfma_f32_16x16x32_bf16 v[68:71], v[84:87], a[176:179], v[68:71]
    v_mfma_f32_16x16x32_bf16 v[24:27], v[88:91], a[8:11], v[24:27]
    v_mfma_f32_16x16x32_bf16 v[40:43], v[88:91], a[64:67], v[40:43]
    v_mfma_f32_16x16x32_bf16 v[56:59], v[88:91], a[120:123], v[56:59]
    v_mfma_f32_16x16x32_bf16 v[72:75], v[88:91], a[176:179], v[72:75]
    v_mfma_f32_16x16x32_bf16 v[28:31], v[92:95], a[8:11], v[28:31]
    v_mfma_f32_16x16x32_bf16 v[44:47], v[92:95], a[64:67], v[44:47]
    v_mfma_f32_16x16x32_bf16 v[60:63], v[92:95], a[120:123], v[60:63]
    v_mfma_f32_16x16x32_bf16 v[76:79], v[92:95], a[176:179], v[76:79]
    ds_read_b128 v[80:83], v1 offset:16384
    ds_read_b128 v[84:87], v1 offset:18432
    ds_read_b128 v[88:91], v1 offset:20480
    ds_read_b128 v[92:95], v1 offset:22528
    s_nop 0
    s_waitcnt lgkmcnt(4)
    v_mfma_f32_16x16x32_bf16 v[16:19], v[96:99], a[12:15], v[16:19]
    v_mfma_f32_16x16x32_bf16 v[32:35], v[96:99], a[68:71], v[32:35]
    v_mfma_f32_16x16x32_bf16 v[48:51], v[96:99], a[124:127], v[48:51]
    v_mfma_f32_16x16x32_bf16 v[64:67], v[96:99], a[180:183], v[64:67]
    v_mfma_f32_16x16x32_bf16 v[20:23], v[100:103], a[12:15], v[20:23]
    v_mfma_f32_16x16x32_bf16 v[36:39], v[100:103], a[68:71], v[36:39]
    v_mfma_f32_16x16x32_bf16 v[52:55], v[100:103], a[124:127], v[52:55]
    v_mfma_f32_16x16x32_bf16 v[68:71], v[100:103], a[180:183], v[68:71]
    v_mfma_f32_16x16x32_bf16 v[24:27], v[104:107], a[12:15], v[24:27]
    v_mfma_f32_16x16x32_bf16 v[40:43], v[104:107], a[68:71], v[40:43]
    v_mfma_f32_16x16x32_bf16 v[56:59], v[104:107], a[124:127], v[56:59]
    v_mfma_f32_16x16x32_bf16 v[72:75], v[104:107], a[180:183], v[72:75]
    v_mfma_f32_16x16x32_bf16 v[28:31], v[108:111], a[12:15], v[28:31]
    v_mfma_f32_16x16x32_bf16 v[44:47], v[108:111], a[68:71], v[44:47]
    v_mfma_f32_16x16x32_bf16 v[60:63], v[108:111], a[124:127], v[60:63]
    v_mfma_f32_16x16x32_bf16 v[76:79], v[108:111], a[180:183], v[76:79]
    s_waitcnt vmcnt(2)
    s_barrier
    s_add_u32 m0, s21, 40960
    s_add_u32 s22, s19, 10240
    buffer_load_dwordx4 v1, s[8:11], s22 offen sc1 lds
    buffer_load_dwordx4 v1, s[8:11], s22 offen offset:1024 sc1 lds
    ds_read_b128 v[96:99], v1 offset:17408
    ds_read_b128 v[100:103], v1 offset:19456
    ds_read_b128 v[104:107], v1 offset:21504
    ds_read_b128 v[108:111], v1 offset:23552
    s_nop 0
    s_waitcnt lgkmcnt(4)
    v_mfma_f32_16x16x32_bf16 v[16:19], v[80:83], a[16:19], v[16:19]
    v_mfma_f32_16x16x32_bf16 v[32:35], v[80:83], a[72:75], v[32:35]
    v_mfma_f32_16x16x32_bf16 v[48:51], v[80:83], a[128:131], v[48:51]
    v_mfma_f32_16x16x32_bf16 v[64:67], v[80:83], a[184:187], v[64:67]
    v_mfma_f32_16x16x32_bf16 v[20:23], v[84:87], a[16:19], v[20:23]
    v_mfma_f32_16x16x32_bf16 v[36:39], v[84:87], a[72:75], v[36:39]
    v_mfma_f32_16x16x32_bf16 v[52:55], v[84:87], a[128:131], v[52:55]
    v_mfma_f32_16x16x32_bf16 v[68:71], v[84:87], a[184:187], v[68:71]
    v_mfma_f32_16x16x32_bf16 v[24:27], v[88:91], a[16:19], v[24:27]
    v_mfma_f32_16x16x32_bf16 v[40:43], v[88:91], a[72:75], v[40:43]
    v_mfma_f32_16x16x32_bf16 v[56:59], v[88:91], a[128:131], v[56:59]
    v_mfma_f32_16x16x32_bf16 v[72:75], v[88:91], a[184:187], v[72:75]
    v_mfma_f32_16x16x32_bf16 v[28:31], v[92:95], a[16:19], v[28:31]
    v_mfma_f32_16x16x32_bf16 v[44:47], v[92:95], a[72:75], v[44:47]
    v_mfma_f32_16x16x32_bf16 v[60:63], v[92:95], a[128:131], v[60:63]
    v_mfma_f32_16x16x32_bf16 v[76:79], v[92:95], a[184:187], v[76:79]
    ds_read_b128 v[80:83], v1 offset:24576
    ds_read_b128 v[84:87], v1 offset:26624
    ds_read_b128 v[88:91], v1 offset:28672
    ds_read_b128 v[92:95], v1 offset:30720
    s_nop 0
    s_waitcnt lgkmcnt(4)
    v_mfma_f32_16x16x32_bf16 v[16:19], v[96:99], a[20:23], v[16:19]
    v_mfma_f32_16x16x32_bf16 v[32:35], v[96:99], a[76:79], v[32:35]
    v_mfma_f32_16x16x32_bf16 v[48:51], v[96:99], a[132:135], v[48:51]
    v_mfma_f32_16x16x32_bf16 v[64:67], v[96:99], a[188:191], v[64:67]
    v_mfma_f32_16x16x32_bf16 v[20:23], v[100:103], a[20:23], v[20:23]
    v_mfma_f32_16x16x32_bf16 v[36:39], v[100:103], a[76:79], v[36:39]
    v_mfma_f32_16x16x32_bf16 v[52:55], v[100:103], a[132:135], v[52:55]
    v_mfma_f32_16x16x32_bf16 v[68:71], v[100:103], a[188:191], v[68:71]
    v_mfma_f32_16x16x32_bf16 v[24:27], v[104:107], a[20:23], v[24:27]
    v_mfma_f32_16x16x32_bf16 v[40:43], v[104:107], a[76:79], v[40:43]
    v_mfma_f32_16x16x32_bf16 v[56:59], v[104:107], a[132:135], v[56:59]
    v_mfma_f32_16x16x32_bf16 v[72:75], v[104:107], a[188:191], v[72:75]
    v_mfma_f32_16x16x32_bf16 v[28:31], v[108:111], a[20:23], v[28:31]
    v_mfma_f32_16x16x32_bf16 v[44:47], v[108:111], a[76:79], v[44:47]
    v_mfma_f32_16x16x32_bf16 v[60:63], v[108:111], a[132:135], v[60:63]
    v_mfma_f32_16x16x32_bf16 v[76:79], v[108:111], a[188:191], v[76:79]
    s_waitcnt vmcnt(2)
    s_barrier
    s_add_u32 m0, s21, 49152
    s_add_u32 s22, s19, 12288
    buffer_load_dwordx4 v1, s[8:11], s22 offen sc1 lds
    buffer_load_dwordx4 v1, s[8:11], s22 offen offset:1024 sc1 lds
    ds_read_b128 v[96:99], v1 offset:25600
    ds_read_b128 v[100:103], v1 offset:27648
    ds_read_b128 v[104:107], v1 offset:29696
    ds_read_b128 v[108:111], v1 offset:31744
    s_nop 0
    s_waitcnt lgkmcnt(4)
    v_mfma_f32_16x16x32_bf16 v[16:19], v[80:83], a[24:27], v[16:19]
    v_mfma_f32_16x16x32_bf16 v[32:35], v[80:83], a[80:83], v[32:35]
    v_mfma_f32_16x16x32_bf16 v[48:51], v[80:83], a[136:139], v[48:51]
    v_mfma_f32_16x16x32_bf16 v[64:67], v[80:83], a[192:195], v[64:67]
    v_mfma_f32_16x16x32_bf16 v[20:23], v[84:87], a[24:27], v[20:23]
    v_mfma_f32_16x16x32_bf16 v[36:39], v[84:87], a[80:83], v[36:39]
    v_mfma_f32_16x16x32_bf16 v[52:55], v[84:87], a[136:139], v[52:55]
    v_mfma_f32_16x16x32_bf16 v[68:71], v[84:87], a[192:195], v[68:71]
    v_mfma_f32_16x16x32_bf16 v[24:27], v[88:91], a[24:27], v[24:27]
    v_mfma_f32_16x16x32_bf16 v[40:43], v[88:91], a[80:83], v[40:43]
    v_mfma_f32_16x16x32_bf16 v[56:59], v[88:91], a[136:139], v[56:59]
    v_mfma_f32_16x16x32_bf16 v[72:75], v[88:91], a[192:195], v[72:75]
    v_mfma_f32_16x16x32_bf16 v[28:31], v[92:95], a[24:27], v[28:31]
    v_mfma_f32_16x16x32_bf16 v[44:47], v[92:95], a[80:83], v[44:47]
    v_mfma_f32_16x16x32_bf16 v[60:63], v[92:95], a[136:139], v[60:63]
    v_mfma_f32_16x16x32_bf16 v[76:79], v[92:95], a[192:195], v[76:79]
    ds_read_b128 v[80:83], v1 offset:32768
    ds_read_b128 v[84:87], v1 offset:34816
    ds_read_b128 v[88:91], v1 offset:36864
    ds_read_b128 v[92:95], v1 offset:38912
    s_nop 0
    s_waitcnt lgkmcnt(4)
    v_mfma_f32_16x16x32_bf16 v[16:19], v[96:99], a[28:31], v[16:19]
    v_mfma_f32_16x16x32_bf16 v[32:35], v[96:99], a[84:87], v[32:35]
    v_mfma_f32_16x16x32_bf16 v[48:51], v[96:99], a[140:143], v[48:51]
    v_mfma_f32_16x16x32_bf16 v[64:67], v[96:99], a[196:199], v[64:67]
    v_mfma_f32_16x16x32_bf16 v[20:23], v[100:103], a[28:31], v[20:23]
    v_mfma_f32_16x16x32_bf16 v[36:39], v[100:103], a[84:87], v[36:39]
    v_mfma_f32_16x16x32_bf16 v[52:55], v[100:103], a[140:143], v[52:55]
    v_mfma_f32_16x16x32_bf16 v[68:71], v[100:103], a[196:199], v[68:71]
    v_mfma_f32_16x16x32_bf16 v[24:27], v[104:107], a[28:31], v[24:27]
    v_mfma_f32_16x16x32_bf16 v[40:43], v[104:107], a[84:87], v[40:43]
    v_mfma_f32_16x16x32_bf16 v[56:59], v[104:107], a[140:143], v[56:59]
    v_mfma_f32_16x16x32_bf16 v[72:75], v[104:107], a[196:199], v[72:75]
    v_mfma_f32_16x16x32_bf16 v[28:31], v[108:111], a[28:31], v[28:31]
    v_mfma_f32_16x16x32_bf16 v[44:47], v[108:111], a[84:87], v[44:47]
    v_mfma_f32_16x16x32_bf16 v[60:63], v[108:111], a[140:143], v[60:63]
    v_mfma_f32_16x16x32_bf16 v[76:79], v[108:111], a[196:199], v[76:79]
    s_waitcnt vmcnt(2)
    s_barrier
    s_add_u32 m0, s21, 0
    s_add_u32 s22, s20, 0
    buffer_load_dwordx4 v1, s[8:11], s22 offen sc1 lds
    buffer_load_dwordx4 v1, s[8:11], s22 offen offset:1024 sc1 lds
    ds_read_b128 v[96:99], v1 offset:33792
    ds_read_b128 v[100:103], v1 offset:35840
    ds_read_b128 v[104:107], v1 offset:37888
    ds_read_b128 v[108:111], v1 offset:39936
    s_nop 0
    s_waitcnt lgkmcnt(4)
    v_mfma_f32_16x16x32_bf16 v[16:19], v[80:83], a[32:35], v[16:19]
    v_mfma_f32_16x16x32_bf16 v[32:35], v[80:83], a[88:91], v[32:35]
    v_mfma_f32_16x16x32_bf16 v[48:51], v[80:83], a[144:147], v[48:51]
    v_mfma_f32_16x16x32_bf16 v[64:67], v[80:83], a[200:203], v[64:67]
    v_mfma_f32_16x16x32_bf16 v[20:23], v[84:87], a[32:35], v[20:23]
    v_mfma_f32_16x16x32_bf16 v[36:39], v[84:87], a[88:91], v[36:39]
    v_mfma_f32_16x16x32_bf16 v[52:55], v[84:87], a[144:147], v[52:55]
    v_mfma_f32_16x16x32_bf16 v[68:71], v[84:87], a[200:203], v[68:71]
    v_mfma_f32_16x16x32_bf16 v[24:27], v[88:91], a[32:35], v[24:27]
    v_mfma_f32_16x16x32_bf16 v[40:43], v[88:91], a[88:91], v[40:43]
    v_mfma_f32_16x16x32_bf16 v[56:59], v[88:91], a[144:147], v[56:59]
    v_mfma_f32_16x16x32_bf16 v[72:75], v[88:91], a[200:203], v[72:75]
    v_mfma_f32_16x16x32_bf16 v[28:31], v[92:95], a[32:35], v[28:31]
    v_mfma_f32_16x16x32_bf16 v[44:47], v[92:95], a[88:91], v[44:47]
    v_mfma_f32_16x16x32_bf16 v[60:63], v[92:95], a[144:147], v[60:63]
    v_mfma_f32_16x16x32_bf16 v[76:79], v[92:95], a[200:203], v[76:79]
    ds_read_b128 v[80:83], v1 offset:40960
    ds_read_b128 v[84:87], v1 offset:43008
    ds_read_b128 v[88:91], v1 offset:45056
    ds_read_b128 v[92:95], v1 offset:47104
    s_nop 0
    s_waitcnt lgkmcnt(4)
    v_mfma_f32_16x16x32_bf16 v[16:19], v[96:99], a[36:39], v[16:19]
    v_mfma_f32_16x16x32_bf16 v[32:35], v[96:99], a[92:95], v[32:35]
    v_mfma_f32_16x16x32_bf16 v[48:51], v[96:99], a[148:151], v[48:51]
    v_mfma_f32_16x16x32_bf16 v[64:67], v[96:99], a[204:207], v[64:67]
    v_mfma_f32_16x16x32_bf16 v[20:23], v[100:103], a[36:39], v[20:23]
    v_mfma_f32_16x16x32_bf16 v[36:39], v[100:103], a[92:95], v[36:39]
    v_mfma_f32_16x16x32_bf16 v[52:55], v[100:103], a[148:151], v[52:55]
    v_mfma_f32_16x16x32_bf16 v[68:71], v[100:103], a[204:207], v[68:71]
    v_mfma_f32_16x16x32_bf16 v[24:27], v[104:107], a[36:39], v[24:27]
    v_mfma_f32_16x16x32_bf16 v[40:43], v[104:107], a[92:95], v[40:43]
    v_mfma_f32_16x16x32_bf16 v[56:59], v[104:107], a[148:151], v[56:59]
    v_mfma_f32_16x16x32_bf16 v[72:75], v[104:107], a[204:207], v[72:75]
    v_mfma_f32_16x16x32_bf16 v[28:31], v[108:111], a[36:39], v[28:31]
    v_mfma_f32_16x16x32_bf16 v[44:47], v[108:111], a[92:95], v[44:47]
    v_mfma_f32_16x16x32_bf16 v[60:63], v[108:111], a[148:151], v[60:63]
    v_mfma_f32_16x16x32_bf16 v[76:79], v[108:111], a[204:207], v[76:79]
    s_waitcnt vmcnt(2)
    s_barrier
    s_add_u32 m0, s21, 8192
    s_add_u32 s22, s20, 2048
    buffer_load_dwordx4 v1, s[8:11], s22 offen sc1 lds
    buffer_load_dwordx4 v1, s[8:11], s22 offen offset:1024 sc1 lds
    ds_read_b128 v[96:99], v1 offset:41984
    ds_read_b128 v[100:103], v1 offset:44032
    ds_read_b128 v[104:107], v1 offset:46080
    ds_read_b128 v[108:111], v1 offset:48128
    s_nop 0
    s_waitcnt lgkmcnt(4)
    v_mfma_f32_16x16x32_bf16 v[16:19], v[80:83], a[40:43], v[16:19]
    v_mfma_f32_16x16x32_bf16 v[32:35], v[80:83], a[96:99], v[32:35]
    v_mfma_f32_16x16x32_bf16 v[48:51], v[80:83], a[152:155], v[48:51]
    v_mfma_f32_16x16x32_bf16 v[64:67], v[80:83], a[208:211], v[64:67]
    v_mfma_f32_16x16x32_bf16 v[20:23], v[84:87], a[40:43], v[20:23]
    v_mfma_f32_16x16x32_bf16 v[36:39], v[84:87], a[96:99], v[36:39]
    v_mfma_f32_16x16x32_bf16 v[52:55], v[84:87], a[152:155], v[52:55]
    v_mfma_f32_16x16x32_bf16 v[68:71], v[84:87], a[208:211], v[68:71]
    v_mfma_f32_16x16x32_bf16 v[24:27], v[88:91], a[40:43], v[24:27]
    v_mfma_f32_16x16x32_bf16 v[40:43], v[88:91], a[96:99], v[40:43]
    v_mfma_f32_16x16x32_bf16 v[56:59], v[88:91], a[152:155], v[56:59]
    v_mfma_f32_16x16x32_bf16 v[72:75], v[88:91], a[208:211], v[72:75]
    v_mfma_f32_16x16x32_bf16 v[28:31], v[92:95], a[40:43], v[28:31]
    v_mfma_f32_16x16x32_bf16 v[44:47], v[92:95], a[96:99], v[44:47]
    v_mfma_f32_16x16x32_bf16 v[60:63], v[92:95], a[152:155], v[60:63]
    v_mfma_f32_16x16x32_bf16 v[76:79], v[92:95], a[208:211], v[76:79]
    ds_read_b128 v[80:83], v1 offset:49152
    ds_read_b128 v[84:87], v1 offset:51200
    ds_read_b128 v[88:91], v1 offset:53248
    ds_read_b128 v[92:95], v1 offset:55296
    s_nop 0
    s_waitcnt lgkmcnt(4)
    v_mfma_f32_16x16x32_bf16 v[16:19], v[96:99], a[44:47], v[16:19]
    v_mfma_f32_16x16x32_bf16 v[32:35], v[96:99], a[100:103], v[32:35]
    v_mfma_f32_16x16x32_bf16 v[48:51], v[96:99], a[156:159], v[48:51]
    v_mfma_f32_16x16x32_bf16 v[64:67], v[96:99], a[212:215], v[64:67]
    v_mfma_f32_16x16x32_bf16 v[20:23], v[100:103], a[44:47], v[20:23]
    v_mfma_f32_16x16x32_bf16 v[36:39], v[100:103], a[100:103], v[36:39]
    v_mfma_f32_16x16x32_bf16 v[52:55], v[100:103], a[156:159], v[52:55]
    v_mfma_f32_16x16x32_bf16 v[68:71], v[100:103], a[212:215], v[68:71]
    v_mfma_f32_16x16x32_bf16 v[24:27], v[104:107], a[44:47], v[24:27]
    v_mfma_f32_16x16x32_bf16 v[40:43], v[104:107], a[100:103], v[40:43]
    v_mfma_f32_16x16x32_bf16 v[56:59], v[104:107], a[156:159], v[56:59]
    v_mfma_f32_16x16x32_bf16 v[72:75], v[104:107], a[212:215], v[72:75]
    v_mfma_f32_16x16x32_bf16 v[28:31], v[108:111], a[44:47], v[28:31]
    v_mfma_f32_16x16x32_bf16 v[44:47], v[108:111], a[100:103], v[44:47]
    v_mfma_f32_16x16x32_bf16 v[60:63], v[108:111], a[156:159], v[60:63]
    v_mfma_f32_16x16x32_bf16 v[76:79], v[108:111], a[212:215], v[76:79]
    s_waitcnt vmcnt(2)
    s_barrier
    s_add_u32 m0, s21, 16384
    s_add_u32 s22, s20, 4096
    buffer_load_dwordx4 v1, s[8:11], s22 offen sc1 lds
    buffer_load_dwordx4 v1, s[8:11], s22 offen offset:1024 sc1 lds
    ds_read_b128 v[96:99], v1 offset:50176
    ds_read_b128 v[100:103], v1 offset:52224
    ds_read_b128 v[104:107], v1 offset:54272
    ds_read_b128 v[108:111], v1 offset:56320
    s_nop 0
    s_waitcnt lgkmcnt(4)
    v_mfma_f32_16x16x32_bf16 v[16:19], v[80:83], a[48:51], v[16:19]
    v_mfma_f32_16x16x32_bf16 v[32:35], v[80:83], a[104:107], v[32:35]
    v_mfma_f32_16x16x32_bf16 v[48:51], v[80:83], a[160:163], v[48:51]
    v_mfma_f32_16x16x32_bf16 v[64:67], v[80:83], a[216:219], v[64:67]
    v_mfma_f32_16x16x32_bf16 v[20:23], v[84:87], a[48:51], v[20:23]
    v_mfma_f32_16x16x32_bf16 v[36:39], v[84:87], a[104:107], v[36:39]
    v_mfma_f32_16x16x32_bf16 v[52:55], v[84:87], a[160:163], v[52:55]
    v_mfma_f32_16x16x32_bf16 v[68:71], v[84:87], a[216:219], v[68:71]
    v_mfma_f32_16x16x32_bf16 v[24:27], v[88:91], a[48:51], v[24:27]
    v_mfma_f32_16x16x32_bf16 v[40:43], v[88:91], a[104:107], v[40:43]
    v_mfma_f32_16x16x32_bf16 v[56:59], v[88:91], a[160:163], v[56:59]
    v_mfma_f32_16x16x32_bf16 v[72:75], v[88:91], a[216:219], v[72:75]
    v_mfma_f32_16x16x32_bf16 v[28:31], v[92:95], a[48:51], v[28:31]
    v_mfma_f32_16x16x32_bf16 v[44:47], v[92:95], a[104:107], v[44:47]
    v_mfma_f32_16x16x32_bf16 v[60:63], v[92:95], a[160:163], v[60:63]
    v_mfma_f32_16x16x32_bf16 v[76:79], v[92:95], a[216:219], v[76:79]
    ds_read_b128 v[80:83], v1 offset:0
    ds_read_b128 v[84:87], v1 offset:2048
    ds_read_b128 v[88:91], v1 offset:4096
    ds_read_b128 v[92:95], v1 offset:6144
    s_nop 0
    s_waitcnt lgkmcnt(4)
    v_mfma_f32_16x16x32_bf16 v[16:19], v[96:99], a[52:55], v[16:19]
    v_mfma_f32_16x16x32_bf16 v[32:35], v[96:99], a[108:111], v[32:35]
    v_mfma_f32_16x16x32_bf16 v[48:51], v[96:99], a[164:167], v[48:51]
    v_mfma_f32_16x16x32_bf16 v[64:67], v[96:99], a[220:223], v[64:67]
    v_mfma_f32_16x16x32_bf16 v[20:23], v[100:103], a[52:55], v[20:23]
    v_mfma_f32_16x16x32_bf16 v[36:39], v[100:103], a[108:111], v[36:39]
    v_mfma_f32_16x16x32_bf16 v[52:55], v[100:103], a[164:167], v[52:55]
    v_mfma_f32_16x16x32_bf16 v[68:71], v[100:103], a[220:223], v[68:71]
    v_mfma_f32_16x16x32_bf16 v[24:27], v[104:107], a[52:55], v[24:27]
    v_mfma_f32_16x16x32_bf16 v[40:43], v[104:107], a[108:111], v[40:43]
    v_mfma_f32_16x16x32_bf16 v[56:59], v[104:107], a[164:167], v[56:59]
    v_mfma_f32_16x16x32_bf16 v[72:75], v[104:107], a[220:223], v[72:75]
    v_mfma_f32_16x16x32_bf16 v[28:31], v[108:111], a[52:55], v[28:31]
    v_mfma_f32_16x16x32_bf16 v[44:47], v[108:111], a[108:111], v[44:47]
    v_mfma_f32_16x16x32_bf16 v[60:63], v[108:111], a[164:167], v[60:63]
    v_mfma_f32_16x16x32_bf16 v[76:79], v[108:111], a[220:223], v[76:79]
    s_cmp_ge_u32 s18, 224
    s_cbranch_scc1 WG_EPH
    s_nop 0
    s_sub_u32 s23, s18, 112
    s_mul_hi_u32 s24, s23, 613566757
    s_mul_i32 s22, s24, 7
    s_sub_u32 s25, s23, s22
    s_lshl_b32 s26, s28, 4
    s_add_u32 s26, s26, s24
    s_mul_i32 s26, s26, 28672
    s_lshl_b32 s22, s25, 11
    s_add_u32 s26, s26, s22
    s_add_u32 s26, s26, 16777216
    s_add_u32 s22, s26, 0
    s_nop 0
    v_cvt_pk_bf16_f32 v112, v16, v17
    v_cvt_pk_bf16_f32 v113, v18, v19
    v_cvt_pk_bf16_f32 v114, v20, v21
    v_cvt_pk_bf16_f32 v115, v22, v23
    buffer_store_dwordx4 v[112:115], v1, s[8:11], s22 offen offset:0 sc1
    v_cvt_pk_bf16_f32 v116, v24, v25
    v_cvt_pk_bf16_f32 v117, v26, v27
    v_cvt_pk_bf16_f32 v118, v28, v29
    v_cvt_pk_bf16_f32 v119, v30, v31
    buffer_store_dwordx4 v[116:119], v1, s[8:11], s22 offen offset:1024 sc1
    s_add_u32 s22, s26, 14336
    v_cvt_pk_bf16_f32 v120, v32, v33
    v_cvt_pk_bf16_f32 v121, v34, v35
    v_cvt_pk_bf16_f32 v122, v36, v37
    v_cvt_pk_bf16_f32 v123, v38, v39
    buffer_store_dwordx4 v[120:123], v1, s[8:11], s22 offen offset:0 sc1
    v_cvt_pk_bf16_f32 v124, v40, v41
    v_cvt_pk_bf16_f32 v125, v42, v43
    v_cvt_pk_bf16_f32 v126, v44, v45
    v_cvt_pk_bf16_f32 v127, v46, v47
    buffer_store_dwordx4 v[124:127], v1, s[8:11], s22 offen offset:1024 sc1
    s_add_u32 s22, s26, 458752
    v_cvt_pk_bf16_f32 v112, v48, v49
    v_cvt_pk_bf16_f32 v113, v50, v51
    v_cvt_pk_bf16_f32 v114, v52, v53
    v_cvt_pk_bf16_f32 v115, v54, v55
    buffer_store_dwordx4 v[112:115], v1, s[8:11], s22 offen offset:0 sc1
    v_cvt_pk_bf16_f32 v116, v56, v57
    v_cvt_pk_bf16_f32 v117, v58, v59
    v_cvt_pk_bf16_f32 v118, v60, v61
    v_cvt_pk_bf16_f32 v119, v62, v63
    buffer_store_dwordx4 v[116:119], v1, s[8:11], s22 offen offset:1024 sc1
    s_add_u32 s22, s26, 473088
    v_cvt_pk_bf16_f32 v120, v64, v65
    v_cvt_pk_bf16_f32 v121, v66, v67
    v_cvt_pk_bf16_f32 v122, v68, v69
    v_cvt_pk_bf16_f32 v123, v70, v71
    buffer_store_dwordx4 v[120:123], v1, s[8:11], s22 offen offset:0 sc1
    v_cvt_pk_bf16_f32 v124, v72, v73
    v_cvt_pk_bf16_f32 v125, v74, v75
    v_cvt_pk_bf16_f32 v126, v76, v77
    v_cvt_pk_bf16_f32 v127, v78, v79
    buffer_store_dwordx4 v[124:127], v1, s[8:11], s22 offen offset:1024 sc1
    s_branch WG_NEXT
    s_nop 0
WG_EPH:
    s_sub_u32 s23, s18, 224
    s_mul_i32 s26, s28, 112
    s_add_u32 s26, s26, s23
    s_lshl_b32 s26, s26, 10
    s_add_u32 s26, s26, 100663296
    s_nop 2
    s_nop 0
    v_cvt_pk_bf16_f32 v128, v16, v17
    v_cvt_pk_bf16_f32 v129, v24, v25
    v_lshlrev_b32 v130, 16, v128
    v_lshlrev_b32 v131, 16, v129
    v_and_b32 v128, 0xffff0000, v128
    v_and_b32 v129, 0xffff0000, v129
    v_mul_f32 v130, v130, v131
    v_mul_f32 v128, v128, v129
    v_cvt_pk_bf16_f32 v112, v130, v128
    v_cvt_pk_bf16_f32 v128, v18, v19
    v_cvt_pk_bf16_f32 v129, v26, v27
    v_lshlrev_b32 v130, 16, v128
    v_lshlrev_b32 v131, 16, v129
    v_and_b32 v128, 0xffff0000, v128
    v_and_b32 v129, 0xffff0000, v129
    v_mul_f32 v130, v130, v131
    v_mul_f32 v128, v128, v129
    v_cvt_pk_bf16_f32 v113, v130, v128
    v_cvt_pk_bf16_f32 v128, v20, v21
    v_cvt_pk_bf16_f32 v129, v28, v29
    v_lshlrev_b32 v130, 16, v128
    v_lshlrev_b32 v131, 16, v129
    v_and_b32 v128, 0xffff0000, v128
    v_and_b32 v129, 0xffff0000, v129
    v_mul_f32 v130, v130, v131
    v_mul_f32 v128, v128, v129
    v_cvt_pk_bf16_f32 v114, v130, v128
    v_cvt_pk_bf16_f32 v128, v22, v23
    v_cvt_pk_bf16_f32 v129, v30, v31
    v_lshlrev_b32 v130, 16, v128
    v_lshlrev_b32 v131, 16, v129
    v_and_b32 v128, 0xffff0000, v128
    v_and_b32 v129, 0xffff0000, v129
    v_mul_f32 v130, v130, v131
    v_mul_f32 v128, v128, v129
    v_cvt_pk_bf16_f32 v115, v130, v128
    s_add_u32 s22, s26, 0
    s_nop 0
    buffer_store_dwordx4 v[112:115], v1, s[8:11], s22 offen sc1
    v_cvt_pk_bf16_f32 v128, v32, v33
    v_cvt_pk_bf16_f32 v129, v40, v41
    v_lshlrev_b32 v130, 16, v128
    v_lshlrev_b32 v131, 16, v129
    v_and_b32 v128, 0xffff0000, v128
    v_and_b32 v129, 0xffff0000, v129
    v_mul_f32 v130, v130, v131
    v_mul_f32 v128, v128, v129
    v_cvt_pk_bf16_f32 v116, v130, v128
    v_cvt_pk_bf16_f32 v128, v34, v35
    v_cvt_pk_bf16_f32 v129, v42, v43
    v_lshlrev_b32 v130, 16, v128
    v_lshlrev_b32 v131, 16, v129
    v_and_b32 v128, 0xffff0000, v128
    v_and_b32 v129, 0xffff0000, v129
    v_mul_f32 v130, v130, v131
    v_mul_f32 v128, v128, v129
    v_cvt_pk_bf16_f32 v117, v130, v128
    v_cvt_pk_bf16_f32 v128, v36, v37
    v_cvt_pk_bf16_f32 v129, v44, v45
    v_lshlrev_b32 v130, 16, v128
    v_lshlrev_b32 v131, 16, v129
    v_and_b32 v128, 0xffff0000, v128
    v_and_b32 v129, 0xffff0000, v129
    v_mul_f32 v130, v130, v131
    v_mul_f32 v128, v128, v129
    v_cvt_pk_bf16_f32 v118, v130, v128
    v_cvt_pk_bf16_f32 v128, v38, v39
    v_cvt_pk_bf16_f32 v129, v46, v47
    v_lshlrev_b32 v130, 16, v128
    v_lshlrev_b32 v131, 16, v129
    v_and_b32 v128, 0xffff0000, v128
    v_and_b32 v129, 0xffff0000, v129
    v_mul_f32 v130, v130, v131
    v_mul_f32 v128, v128, v129
    v_cvt_pk_bf16_f32 v119, v130, v128
    s_add_u32 s22, s26, 57344
    buffer_store_dwordx4 v[116:119], v1, s[8:11], s22 offen sc1
    v_cvt_pk_bf16_f32 v128, v48, v49
    v_cvt_pk_bf16_f32 v129, v56, v57
    v_lshlrev_b32 v130, 16, v128
    v_lshlrev_b32 v131, 16, v129
    v_and_b32 v128, 0xffff0000, v128
    v_and_b32 v129, 0xffff0000, v129
    v_mul_f32 v130, v130, v131
    v_mul_f32 v128, v128, v129
    v_cvt_pk_bf16_f32 v120, v130, v128
    v_cvt_pk_bf16_f32 v128, v50, v51
    v_cvt_pk_bf16_f32 v129, v58, v59
    v_lshlrev_b32 v130, 16, v128
    v_lshlrev_b32 v131, 16, v129
    v_and_b32 v128, 0xffff0000, v128
    v_and_b32 v129, 0xffff0000, v129
    v_mul_f32 v130, v130, v131
    v_mul_f32 v128, v128, v129
    v_cvt_pk_bf16_f32 v121, v130, v128
    v_cvt_pk_bf16_f32 v128, v52, v53
    v_cvt_pk_bf16_f32 v129, v60, v61
    v_lshlrev_b32 v130, 16, v128
    v_lshlrev_b32 v131, 16, v129
    v_and_b32 v128, 0xffff0000, v128
    v_and_b32 v129, 0xffff0000, v129
    v_mul_f32 v130, v130, v131
    v_mul_f32 v128, v128, v129
    v_cvt_pk_bf16_f32 v122, v130, v128
    v_cvt_pk_bf16_f32 v128, v54, v55
    v_cvt_pk_bf16_f32 v129, v62, v63
    v_lshlrev_b32 v130, 16, v128
    v_lshlrev_b32 v131, 16, v129
    v_and_b32 v128, 0xffff0000, v128
    v_and_b32 v129, 0xffff0000, v129
    v_mul_f32 v130, v130, v131
    v_mul_f32 v128, v128, v129
    v_cvt_pk_bf16_f32 v123, v130, v128
    s_add_u32 s22, s26, 114688
    buffer_store_dwordx4 v[120:123], v1, s[8:11], s22 offen sc1
    v_cvt_pk_bf16_f32 v128, v64, v65
    v_cvt_pk_bf16_f32 v129, v72, v73
    v_lshlrev_b32 v130, 16, v128
    v_lshlrev_b32 v131, 16, v129
    v_and_b32 v128, 0xffff0000, v128
    v_and_b32 v129, 0xffff0000, v129
    v_mul_f32 v130, v130, v131
    v_mul_f32 v128, v128, v129
    v_cvt_pk_bf16_f32 v124, v130, v128
    v_cvt_pk_bf16_f32 v128, v66, v67
    v_cvt_pk_bf16_f32 v129, v74, v75
    v_lshlrev_b32 v130, 16, v128
    v_lshlrev_b32 v131, 16, v129
    v_and_b32 v128, 0xffff0000, v128
    v_and_b32 v129, 0xffff0000, v129
    v_mul_f32 v130, v130, v131
    v_mul_f32 v128, v128, v129
    v_cvt_pk_bf16_f32 v125, v130, v128
    v_cvt_pk_bf16_f32 v128, v68, v69
    v_cvt_pk_bf16_f32 v129, v76, v77
    v_lshlrev_b32 v130, 16, v128
    v_lshlrev_b32 v131, 16, v129
    v_and_b32 v128, 0xffff0000, v128
    v_and_b32 v129, 0xffff0000, v129
    v_mul_f32 v130, v130, v131
    v_mul_f32 v128, v128, v129
    v_cvt_pk_bf16_f32 v126, v130, v128
    v_cvt_pk_bf16_f32 v128, v70, v71
    v_cvt_pk_bf16_f32 v129, v78, v79
    v_lshlrev_b32 v130, 16, v128
    v_lshlrev_b32 v131, 16, v129
    v_and_b32 v128, 0xffff0000, v128
    v_and_b32 v129, 0xffff0000, v129
    v_mul_f32 v130, v130, v131
    v_mul_f32 v128, v128, v129
    v_cvt_pk_bf16_f32 v127, v130, v128
    s_add_u32 s22, s26, 172032
    buffer_store_dwordx4 v[124:127], v1, s[8:11], s22 offen sc1
    s_branch WG_NEXT
    s_nop 0
WG_LOOPU:
    s_waitcnt vmcnt(6)
    s_barrier
    s_add_u32 m0, s21, 24576
    s_add_u32 s22, s19, 6144
    buffer_load_dwordx4 v1, s[8:11], s22 offen sc1 lds
    buffer_load_dwordx4 v1, s[8:11], s22 offen offset:1024 sc1 lds
    ds_read_b128 v[96:99], v1 offset:1024
    ds_read_b128 v[100:103], v1 offset:3072
    ds_read_b128 v[104:107], v1 offset:5120
    ds_read_b128 v[108:111], v1 offset:7168
    s_nop 0
    s_waitcnt lgkmcnt(4)
    v_mfma_f32_16x16x32_bf16 v[16:19], a[0:3], v[80:83], 0
    v_mfma_f32_16x16x32_bf16 v[32:35], a[56:59], v[80:83], 0
    v_mfma_f32_16x16x32_bf16 v[48:51], a[112:115], v[80:83], 0
    v_mfma_f32_16x16x32_bf16 v[64:67], a[168:171], v[80:83], 0
    v_mfma_f32_16x16x32_bf16 v[20:23], a[0:3], v[84:87], 0
    v_mfma_f32_16x16x32_bf16 v[36:39], a[56:59], v[84:87], 0
    v_mfma_f32_16x16x32_bf16 v[52:55], a[112:115], v[84:87], 0
    v_mfma_f32_16x16x32_bf16 v[68:71], a[168:171], v[84:87], 0
    v_mfma_f32_16x16x32_bf16 v[24:27], a[0:3], v[88:91], 0
    v_mfma_f32_16x16x32_bf16 v[40:43], a[56:59], v[88:91], 0
    v_mfma_f32_16x16x32_bf16 v[56:59], a[112:115], v[88:91], 0
    v_mfma_f32_16x16x32_bf16 v[72:75], a[168:171], v[88:91], 0
    v_mfma_f32_16x16x32_bf16 v[28:31], a[0:3], v[92:95], 0
    v_mfma_f32_16x16x32_bf16 v[44:47], a[56:59], v[92:95], 0
    v_mfma_f32_16x16x32_bf16 v[60:63], a[112:115], v[92:95], 0
    v_mfma_f32_16x16x32_bf16 v[76:79], a[168:171], v[92:95], 0
    ds_read_b128 v[80:83], v1 offset:8192
    ds_read_b128 v[84:87], v1 offset:10240
    ds_read_b128 v[88:91], v1 offset:12288
    ds_read_b128 v[92:95], v1 offset:14336
    s_nop 0
    s_waitcnt lgkmcnt(4)
    v_mfma_f32_16x16x32_bf16 v[16:19], a[4:7], v[96:99], v[16:19]
    v_mfma_f32_16x16x32_bf16 v[32:35], a[60:63], v[96:99], v[32:35]
    v_mfma_f32_16x16x32_bf16 v[48:51], a[116:119], v[96:99], v[48:51]
    v_mfma_f32_16x16x32_bf16 v[64:67], a[172:175], v[96:99], v[64:67]
    v_mfma_f32_16x16x32_bf16 v[20:23], a[4:7], v[100:103], v[20:23]
    v_mfma_f32_16x16x32_bf16 v[36:39], a[60:63], v[100:103], v[36:39]
    v_mfma_f32_16x16x32_bf16 v[52:55], a[116:119], v[100:103], v[52:55]
    v_mfma_f32_16x16x32_bf16 v[68:71], a[172:175], v[100:103], v[68:71]
    v_mfma_f32_16x16x32_bf16 v[24:27], a[4:7], v[104:107], v[24:27]
    v_mfma_f32_16x16x32_bf16 v[40:43], a[60:63], v[104:107], v[40:43]
    v_mfma_f32_16x16x32_bf16 v[56:59], a[116:119], v[104:107], v[56:59]
    v_mfma_f32_16x16x32_bf16 v[72:75], a[172:175], v[104:107], v[72:75]
    v_mfma_f32_16x16x32_bf16 v[28:31], a[4:7], v[108:111], v[28:31]
    v_mfma_f32_16x16x32_bf16 v[44:47], a[60:63], v[108:111], v[44:47]
    v_mfma_f32_16x16x32_bf16 v[60:63], a[116:119], v[108:111], v[60:63]
    v_mfma_f32_16x16x32_bf16 v[76:79], a[172:175], v[108:111], v[76:79]
    s_waitcnt vmcnt(6)
    s_barrier
    s_add_u32 m0, s21, 32768
    s_add_u32 s22, s19, 8192
    buffer_load_dwordx4 v1, s[8:11], s22 offen sc1 lds
    buffer_load_dwordx4 v1, s[8:11], s22 offen offset:1024 sc1 lds
    ds_read_b128 v[96:99], v1 offset:9216
    ds_read_b128 v[100:103], v1 offset:11264
    ds_read_b128 v[104:107], v1 offset:13312
    ds_read_b128 v[108:111], v1 offset:15360
    s_nop 0
    s_waitcnt lgkmcnt(4)
    v_mfma_f32_16x16x32_bf16 v[16:19], a[8:11], v[80:83], v[16:19]
    v_mfma_f32_16x16x32_bf16 v[32:35], a[64:67], v[80:83], v[32:35]
    v_mfma_f32_16x16x32_bf16 v[48:51], a[120:123], v[80:83], v[48:51]
    v_mfma_f32_16x16x32_bf16 v[64:67], a[176:179], v[80:83], v[64:67]
    v_mfma_f32_16x16x32_bf16 v[20:23], a[8:11], v[84:87], v[20:23]
    v_mfma_f32_16x16x32_bf16 v[36:39], a[64:67], v[84:87], v[36:39]
    v_mfma_f32_16x16x32_bf16 v[52:55], a[120:123], v[84:87], v[52:55]
    v_mfma_f32_16x16x32_bf16 v[68:71], a[176:179], v[84:87], v[68:71]
    v_mfma_f32_16x16x32_bf16 v[24:27], a[8:11], v[88:91], v[24:27]
    v_mfma_f32_16x16x32_bf16 v[40:43], a[64:67], v[88:91], v[40:43]
    v_mfma_f32_16x16x32_bf16 v[56:59], a[120:123], v[88:91], v[56:59]
    v_mfma_f32_16x16x32_bf16 v[72:75], a[176:179], v[88:91], v[72:75]
    v_mfma_f32_16x16x32_bf16 v[28:31], a[8:11], v[92:95], v[28:31]
    v_mfma_f32_16x16x32_bf16 v[44:47], a[64:67], v[92:95], v[44:47]
    v_mfma_f32_16x16x32_bf16 v[60:63], a[120:123], v[92:95], v[60:63]
    v_mfma_f32_16x16x32_bf16 v[76:79], a[176:179], v[92:95], v[76:79]
    ds_read_b128 v[80:83], v1 offset:16384
    ds_read_b128 v[84:87], v1 offset:18432
    ds_read_b128 v[88:91], v1 offset:20480
    ds_read_b128 v[92:95], v1 offset:22528
    s_nop 0
    s_waitcnt lgkmcnt(4)
    v_mfma_f32_16x16x32_bf16 v[16:19], a[12:15], v[96:99], v[16:19]
    v_mfma_f32_16x16x32_bf16 v[32:35], a[68:71], v[96:99], v[32:35]
    v_mfma_f32_16x16x32_bf16 v[48:51], a[124:127], v[96:99], v[48:51]
    v_mfma_f32_16x16x32_bf16 v[64:67], a[180:183], v[96:99], v[64:67]
    v_mfma_f32_16x16x32_bf16 v[20:23], a[12:15], v[100:103], v[20:23]
    v_mfma_f32_16x16x32_bf16 v[36:39], a[68:71], v[100:103], v[36:39]
    v_mfma_f32_16x16x32_bf16 v[52:55], a[124:127], v[100:103], v[52:55]
    v_mfma_f32_16x16x32_bf16 v[68:71], a[180:183], v[100:103], v[68:71]
    v_mfma_f32_16x16x32_bf16 v[24:27], a[12:15], v[104:107], v[24:27]
    v_mfma_f32_16x16x32_bf16 v[40:43], a[68:71], v[104:107], v[40:43]
    v_mfma_f32_16x16x32_bf16 v[56:59], a[124:127], v[104:107], v[56:59]
    v_mfma_f32_16x16x32_bf16 v[72:75], a[180:183], v[104:107], v[72:75]
    v_mfma_f32_16x16x32_bf16 v[28:31], a[12:15], v[108:111], v[28:31]
    v_mfma_f32_16x16x32_bf16 v[44:47], a[68:71], v[108:111], v[44:47]
    v_mfma_f32_16x16x32_bf16 v[60:63], a[124:127], v[108:111], v[60:63]
    v_mfma_f32_16x16x32_bf16 v[76:79], a[180:183], v[108:111], v[76:79]
    s_waitcnt vmcnt(2)
    s_barrier
    s_add_u32 m0, s21, 40960
    s_add_u32 s22, s19, 10240
    buffer_load_dwordx4 v1, s[8:11], s22 offen sc1 lds
    buffer_load_dwordx4 v1, s[8:11], s22 offen offset:1024 sc1 lds
    ds_read_b128 v[96:99], v1 offset:17408
    ds_read_b128 v[100:103], v1 offset:19456
    ds_read_b128 v[104:107], v1 offset:21504
    ds_read_b128 v[108:111], v1 offset:23552
    s_nop 0
    s_waitcnt lgkmcnt(4)
    v_mfma_f32_16x16x32_bf16 v[16:19], a[16:19], v[80:83], v[16:19]
    v_mfma_f32_16x16x32_bf16 v[32:35], a[72:75], v[80:83], v[32:35]
    v_mfma_f32_16x16x32_bf16 v[48:51], a[128:131], v[80:83], v[48:51]
    v_mfma_f32_16x16x32_bf16 v[64:67], a[184:187], v[80:83], v[64:67]
    v_mfma_f32_16x16x32_bf16 v[20:23], a[16:19], v[84:87], v[20:23]
    v_mfma_f32_16x16x32_bf16 v[36:39], a[72:75], v[84:87], v[36:39]
    v_mfma_f32_16x16x32_bf16 v[52:55], a[128:131], v[84:87], v[52:55]
    v_mfma_f32_16x16x32_bf16 v[68:71], a[184:187], v[84:87], v[68:71]
    v_mfma_f32_16x16x32_bf16 v[24:27], a[16:19], v[88:91], v[24:27]
    v_mfma_f32_16x16x32_bf16 v[40:43], a[72:75], v[88:91], v[40:43]
    v_mfma_f32_16x16x32_bf16 v[56:59], a[128:131], v[88:91], v[56:59]
    v_mfma_f32_16x16x32_bf16 v[72:75], a[184:187], v[88:91], v[72:75]
    v_mfma_f32_16x16x32_bf16 v[28:31], a[16:19], v[92:95], v[28:31]
    v_mfma_f32_16x16x32_bf16 v[44:47], a[72:75], v[92:95], v[44:47]
    v_mfma_f32_16x16x32_bf16 v[60:63], a[128:131], v[92:95], v[60:63]
    v_mfma_f32_16x16x32_bf16 v[76:79], a[184:187], v[92:95], v[76:79]
    ds_read_b128 v[80:83], v1 offset:24576
    ds_read_b128 v[84:87], v1 offset:26624
    ds_read_b128 v[88:91], v1 offset:28672
    ds_read_b128 v[92:95], v1 offset:30720
    s_nop 0
    s_waitcnt lgkmcnt(4)
    v_mfma_f32_16x16x32_bf16 v[16:19], a[20:23], v[96:99], v[16:19]
    v_mfma_f32_16x16x32_bf16 v[32:35], a[76:79], v[96:99], v[32:35]
    v_mfma_f32_16x16x32_bf16 v[48:51], a[132:135], v[96:99], v[48:51]
    v_mfma_f32_16x16x32_bf16 v[64:67], a[188:191], v[96:99], v[64:67]
    v_mfma_f32_16x16x32_bf16 v[20:23], a[20:23], v[100:103], v[20:23]
    v_mfma_f32_16x16x32_bf16 v[36:39], a[76:79], v[100:103], v[36:39]
    v_mfma_f32_16x16x32_bf16 v[52:55], a[132:135], v[100:103], v[52:55]
    v_mfma_f32_16x16x32_bf16 v[68:71], a[188:191], v[100:103], v[68:71]
    v_mfma_f32_16x16x32_bf16 v[24:27], a[20:23], v[104:107], v[24:27]
    v_mfma_f32_16x16x32_bf16 v[40:43], a[76:79], v[104:107], v[40:43]
    v_mfma_f32_16x16x32_bf16 v[56:59], a[132:135], v[104:107], v[56:59]
    v_mfma_f32_16x16x32_bf16 v[72:75], a[188:191], v[104:107], v[72:75]
    v_mfma_f32_16x16x32_bf16 v[28:31], a[20:23], v[108:111], v[28:31]
    v_mfma_f32_16x16x32_bf16 v[44:47], a[76:79], v[108:111], v[44:47]
    v_mfma_f32_16x16x32_bf16 v[60:63], a[132:135], v[108:111], v[60:63]
    v_mfma_f32_16x16x32_bf16 v[76:79], a[188:191], v[108:111], v[76:79]
    s_waitcnt vmcnt(2)
    s_barrier
    s_add_u32 m0, s21, 49152
    s_add_u32 s22, s19, 12288
    buffer_load_dwordx4 v1, s[8:11], s22 offen sc1 lds
    buffer_load_dwordx4 v1, s[8:11], s22 offen offset:1024 sc1 lds
    ds_read_b128 v[96:99], v1 offset:25600
    ds_read_b128 v[100:103], v1 offset:27648
    ds_read_b128 v[104:107], v1 offset:29696
    ds_read_b128 v[108:111], v1 offset:31744
    s_nop 0
    s_waitcnt lgkmcnt(4)
    v_mfma_f32_16x16x32_bf16 v[16:19], a[24:27], v[80:83], v[16:19]
    v_mfma_f32_16x16x32_bf16 v[32:35], a[80:83], v[80:83], v[32:35]
    v_mfma_f32_16x16x32_bf16 v[48:51], a[136:139], v[80:83], v[48:51]
    v_mfma_f32_16x16x32_bf16 v[64:67], a[192:195], v[80:83], v[64:67]
    v_mfma_f32_16x16x32_bf16 v[20:23], a[24:27], v[84:87], v[20:23]
    v_mfma_f32_16x16x32_bf16 v[36:39], a[80:83], v[84:87], v[36:39]
    v_mfma_f32_16x16x32_bf16 v[52:55], a[136:139], v[84:87], v[52:55]
    v_mfma_f32_16x16x32_bf16 v[68:71], a[192:195], v[84:87], v[68:71]
    v_mfma_f32_16x16x32_bf16 v[24:27], a[24:27], v[88:91], v[24:27]
    v_mfma_f32_16x16x32_bf16 v[40:43], a[80:83], v[88:91], v[40:43]
    v_mfma_f32_16x16x32_bf16 v[56:59], a[136:139], v[88:91], v[56:59]
    v_mfma_f32_16x16x32_bf16 v[72:75], a[192:195], v[88:91], v[72:75]
    v_mfma_f32_16x16x32_bf16 v[28:31], a[24:27], v[92:95], v[28:31]
    v_mfma_f32_16x16x32_bf16 v[44:47], a[80:83], v[92:95], v[44:47]
    v_mfma_f32_16x16x32_bf16 v[60:63], a[136:139], v[92:95], v[60:63]
    v_mfma_f32_16x16x32_bf16 v[76:79], a[192:195], v[92:95], v[76:79]
    ds_read_b128 v[80:83], v1 offset:32768
    ds_read_b128 v[84:87], v1 offset:34816
    ds_read_b128 v[88:91], v1 offset:36864
    ds_read_b128 v[92:95], v1 offset:38912
    s_nop 0
    s_waitcnt lgkmcnt(4)
    v_mfma_f32_16x16x32_bf16 v[16:19], a[28:31], v[96:99], v[16:19]
    v_mfma_f32_16x16x32_bf16 v[32:35], a[84:87], v[96:99], v[32:35]
    v_mfma_f32_16x16x32_bf16 v[48:51], a[140:143], v[96:99], v[48:51]
    v_mfma_f32_16x16x32_bf16 v[64:67], a[196:199], v[96:99], v[64:67]
    v_mfma_f32_16x16x32_bf16 v[20:23], a[28:31], v[100:103], v[20:23]
    v_mfma_f32_16x16x32_bf16 v[36:39], a[84:87], v[100:103], v[36:39]
    v_mfma_f32_16x16x32_bf16 v[52:55], a[140:143], v[100:103], v[52:55]
    v_mfma_f32_16x16x32_bf16 v[68:71], a[196:199], v[100:103], v[68:71]
    v_mfma_f32_16x16x32_bf16 v[24:27], a[28:31], v[104:107], v[24:27]
    v_mfma_f32_16x16x32_bf16 v[40:43], a[84:87], v[104:107], v[40:43]
    v_mfma_f32_16x16x32_bf16 v[56:59], a[140:143], v[104:107], v[56:59]
    v_mfma_f32_16x16x32_bf16 v[72:75], a[196:199], v[104:107], v[72:75]
    v_mfma_f32_16x16x32_bf16 v[28:31], a[28:31], v[108:111], v[28:31]
    v_mfma_f32_16x16x32_bf16 v[44:47], a[84:87], v[108:111], v[44:47]
    v_mfma_f32_16x16x32_bf16 v[60:63], a[140:143], v[108:111], v[60:63]
    v_mfma_f32_16x16x32_bf16 v[76:79], a[196:199], v[108:111], v[76:79]
    s_waitcnt vmcnt(2)
    s_barrier
    s_add_u32 m0, s21, 0
    s_add_u32 s22, s20, 0
    buffer_load_dwordx4 v1, s[8:11], s22 offen sc1 lds
    buffer_load_dwordx4 v1, s[8:11], s22 offen offset:1024 sc1 lds
    ds_read_b128 v[96:99], v1 offset:33792
    ds_read_b128 v[100:103], v1 offset:35840
    ds_read_b128 v[104:107], v1 offset:37888
    ds_read_b128 v[108:111], v1 offset:39936
    s_nop 0
    s_waitcnt lgkmcnt(4)
    v_mfma_f32_16x16x32_bf16 v[16:19], a[32:35], v[80:83], v[16:19]
    v_mfma_f32_16x16x32_bf16 v[32:35], a[88:91], v[80:83], v[32:35]
    v_mfma_f32_16x16x32_bf16 v[48:51], a[144:147], v[80:83], v[48:51]
    v_mfma_f32_16x16x32_bf16 v[64:67], a[200:203], v[80:83], v[64:67]
    v_mfma_f32_16x16x32_bf16 v[20:23], a[32:35], v[84:87], v[20:23]
    v_mfma_f32_16x16x32_bf16 v[36:39], a[88:91], v[84:87], v[36:39]
    v_mfma_f32_16x16x32_bf16 v[52:55], a[144:147], v[84:87], v[52:55]
    v_mfma_f32_16x16x32_bf16 v[68:71], a[200:203], v[84:87], v[68:71]
    v_mfma_f32_16x16x32_bf16 v[24:27], a[32:35], v[88:91], v[24:27]
    v_mfma_f32_16x16x32_bf16 v[40:43], a[88:91], v[88:91], v[40:43]
    v_mfma_f32_16x16x32_bf16 v[56:59], a[144:147], v[88:91], v[56:59]
    v_mfma_f32_16x16x32_bf16 v[72:75], a[200:203], v[88:91], v[72:75]
    v_mfma_f32_16x16x32_bf16 v[28:31], a[32:35], v[92:95], v[28:31]
    v_mfma_f32_16x16x32_bf16 v[44:47], a[88:91], v[92:95], v[44:47]
    v_mfma_f32_16x16x32_bf16 v[60:63], a[144:147], v[92:95], v[60:63]
    v_mfma_f32_16x16x32_bf16 v[76:79], a[200:203], v[92:95], v[76:79]
    ds_read_b128 v[80:83], v1 offset:40960
    ds_read_b128 v[84:87], v1 offset:43008
    ds_read_b128 v[88:91], v1 offset:45056
    ds_read_b128 v[92:95], v1 offset:47104
    s_nop 0
    s_waitcnt lgkmcnt(4)
    v_mfma_f32_16x16x32_bf16 v[16:19], a[36:39], v[96:99], v[16:19]
    v_mfma_f32_16x16x32_bf16 v[32:35], a[92:95], v[96:99], v[32:35]
    v_mfma_f32_16x16x32_bf16 v[48:51], a[148:151], v[96:99], v[48:51]
    v_mfma_f32_16x16x32_bf16 v[64:67], a[204:207], v[96:99], v[64:67]
    v_mfma_f32_16x16x32_bf16 v[20:23], a[36:39], v[100:103], v[20:23]
    v_mfma_f32_16x16x32_bf16 v[36:39], a[92:95], v[100:103], v[36:39]
    v_mfma_f32_16x16x32_bf16 v[52:55], a[148:151], v[100:103], v[52:55]
    v_mfma_f32_16x16x32_bf16 v[68:71], a[204:207], v[100:103], v[68:71]
    v_mfma_f32_16x16x32_bf16 v[24:27], a[36:39], v[104:107], v[24:27]
    v_mfma_f32_16x16x32_bf16 v[40:43], a[92:95], v[104:107], v[40:43]
    v_mfma_f32_16x16x32_bf16 v[56:59], a[148:151], v[104:107], v[56:59]
    v_mfma_f32_16x16x32_bf16 v[72:75], a[204:207], v[104:107], v[72:75]
    v_mfma_f32_16x16x32_bf16 v[28:31], a[36:39], v[108:111], v[28:31]
    v_mfma_f32_16x16x32_bf16 v[44:47], a[92:95], v[108:111], v[44:47]
    v_mfma_f32_16x16x32_bf16 v[60:63], a[148:151], v[108:111], v[60:63]
    v_mfma_f32_16x16x32_bf16 v[76:79], a[204:207], v[108:111], v[76:79]
    s_waitcnt vmcnt(2)
    s_barrier
    s_add_u32 m0, s21, 8192
    s_add_u32 s22, s20, 2048
    buffer_load_dwordx4 v1, s[8:11], s22 offen sc1 lds
    buffer_load_dwordx4 v1, s[8:11], s22 offen offset:1024 sc1 lds
    ds_read_b128 v[96:99], v1 offset:41984
    ds_read_b128 v[100:103], v1 offset:44032
    ds_read_b128 v[104:107], v1 offset:46080
    ds_read_b128 v[108:111], v1 offset:48128
    s_nop 0
    s_waitcnt lgkmcnt(4)
    v_mfma_f32_16x16x32_bf16 v[16:19], a[40:43], v[80:83], v[16:19]
    v_mfma_f32_16x16x32_bf16 v[32:35], a[96:99], v[80:83], v[32:35]
    v_mfma_f32_16x16x32_bf16 v[48:51], a[152:155], v[80:83], v[48:51]
    v_mfma_f32_16x16x32_bf16 v[64:67], a[208:211], v[80:83], v[64:67]
    v_mfma_f32_16x16x32_bf16 v[20:23], a[40:43], v[84:87], v[20:23]
    v_mfma_f32_16x16x32_bf16 v[36:39], a[96:99], v[84:87], v[36:39]
    v_mfma_f32_16x16x32_bf16 v[52:55], a[152:155], v[84:87], v[52:55]
    v_mfma_f32_16x16x32_bf16 v[68:71], a[208:211], v[84:87], v[68:71]
    v_mfma_f32_16x16x32_bf16 v[24:27], a[40:43], v[88:91], v[24:27]
    v_mfma_f32_16x16x32_bf16 v[40:43], a[96:99], v[88:91], v[40:43]
    v_mfma_f32_16x16x32_bf16 v[56:59], a[152:155], v[88:91], v[56:59]
    v_mfma_f32_16x16x32_bf16 v[72:75], a[208:211], v[88:91], v[72:75]
    v_mfma_f32_16x16x32_bf16 v[28:31], a[40:43], v[92:95], v[28:31]
    v_mfma_f32_16x16x32_bf16 v[44:47], a[96:99], v[92:95], v[44:47]
    v_mfma_f32_16x16x32_bf16 v[60:63], a[152:155], v[92:95], v[60:63]
    v_mfma_f32_16x16x32_bf16 v[76:79], a[208:211], v[92:95], v[76:79]
    ds_read_b128 v[80:83], v1 offset:49152
    ds_read_b128 v[84:87], v1 offset:51200
    ds_read_b128 v[88:91], v1 offset:53248
    ds_read_b128 v[92:95], v1 offset:55296
    s_nop 0
    s_waitcnt lgkmcnt(4)
    v_mfma_f32_16x16x32_bf16 v[16:19], a[44:47], v[96:99], v[16:19]
    v_mfma_f32_16x16x32_bf16 v[32:35], a[100:103], v[96:99], v[32:35]
    v_mfma_f32_16x16x32_bf16 v[48:51], a[156:159], v[96:99], v[48:51]
    v_mfma_f32_16x16x32_bf16 v[64:67], a[212:215], v[96:99], v[64:67]
    v_mfma_f32_16x16x32_bf16 v[20:23], a[44:47], v[100:103], v[20:23]
    v_mfma_f32_16x16x32_bf16 v[36:39], a[100:103], v[100:103], v[36:39]
    v_mfma_f32_16x16x32_bf16 v[52:55], a[156:159], v[100:103], v[52:55]
    v_mfma_f32_16x16x32_bf16 v[68:71], a[212:215], v[100:103], v[68:71]
    v_mfma_f32_16x16x32_bf16 v[24:27], a[44:47], v[104:107], v[24:27]
    v_mfma_f32_16x16x32_bf16 v[40:43], a[100:103], v[104:107], v[40:43]
    v_mfma_f32_16x16x32_bf16 v[56:59], a[156:159], v[104:107], v[56:59]
    v_mfma_f32_16x16x32_bf16 v[72:75], a[212:215], v[104:107], v[72:75]
    v_mfma_f32_16x16x32_bf16 v[28:31], a[44:47], v[108:111], v[28:31]
    v_mfma_f32_16x16x32_bf16 v[44:47], a[100:103], v[108:111], v[44:47]
    v_mfma_f32_16x16x32_bf16 v[60:63], a[156:159], v[108:111], v[60:63]
    v_mfma_f32_16x16x32_bf16 v[76:79], a[212:215], v[108:111], v[76:79]
    s_waitcnt vmcnt(2)
    s_barrier
    s_add_u32 m0, s21, 16384
    s_add_u32 s22, s20, 4096
    buffer_load_dwordx4 v1, s[8:11], s22 offen sc1 lds
    buffer_load_dwordx4 v1, s[8:11], s22 offen offset:1024 sc1 lds
    ds_read_b128 v[96:99], v1 offset:50176
    ds_read_b128 v[100:103], v1 offset:52224
    ds_read_b128 v[104:107], v1 offset:54272
    ds_read_b128 v[108:111], v1 offset:56320
    s_nop 0
    s_waitcnt lgkmcnt(4)
    v_mfma_f32_16x16x32_bf16 v[16:19], a[48:51], v[80:83], v[16:19]
    v_mfma_f32_16x16x32_bf16 v[32:35], a[104:107], v[80:83], v[32:35]
    v_mfma_f32_16x16x32_bf16 v[48:51], a[160:163], v[80:83], v[48:51]
    v_mfma_f32_16x16x32_bf16 v[64:67], a[216:219], v[80:83], v[64:67]
    v_mfma_f32_16x16x32_bf16 v[20:23], a[48:51], v[84:87], v[20:23]
    v_mfma_f32_16x16x32_bf16 v[36:39], a[104:107], v[84:87], v[36:39]
    v_mfma_f32_16x16x32_bf16 v[52:55], a[160:163], v[84:87], v[52:55]
    v_mfma_f32_16x16x32_bf16 v[68:71], a[216:219], v[84:87], v[68:71]
    v_mfma_f32_16x16x32_bf16 v[24:27], a[48:51], v[88:91], v[24:27]
    v_mfma_f32_16x16x32_bf16 v[40:43], a[104:107], v[88:91], v[40:43]
    v_mfma_f32_16x16x32_bf16 v[56:59], a[160:163], v[88:91], v[56:59]
    v_mfma_f32_16x16x32_bf16 v[72:75], a[216:219], v[88:91], v[72:75]
    v_mfma_f32_16x16x32_bf16 v[28:31], a[48:51], v[92:95], v[28:31]
    v_mfma_f32_16x16x32_bf16 v[44:47], a[104:107], v[92:95], v[44:47]
    v_mfma_f32_16x16x32_bf16 v[60:63], a[160:163], v[92:95], v[60:63]
    v_mfma_f32_16x16x32_bf16 v[76:79], a[216:219], v[92:95], v[76:79]
    ds_read_b128 v[80:83], v1 offset:0
    ds_read_b128 v[84:87], v1 offset:2048
    ds_read_b128 v[88:91], v1 offset:4096
    ds_read_b128 v[92:95], v1 offset:6144
    s_nop 0
    s_waitcnt lgkmcnt(4)
    v_mfma_f32_16x16x32_bf16 v[16:19], a[52:55], v[96:99], v[16:19]
    v_mfma_f32_16x16x32_bf16 v[32:35], a[108:111], v[96:99], v[32:35]
    v_mfma_f32_16x16x32_bf16 v[48:51], a[164:167], v[96:99], v[48:51]
    v_mfma_f32_16x16x32_bf16 v[64:67], a[220:223], v[96:99], v[64:67]
    v_mfma_f32_16x16x32_bf16 v[20:23], a[52:55], v[100:103], v[20:23]
    v_mfma_f32_16x16x32_bf16 v[36:39], a[108:111], v[100:103], v[36:39]
    v_mfma_f32_16x16x32_bf16 v[52:55], a[164:167], v[100:103], v[52:55]
    v_mfma_f32_16x16x32_bf16 v[68:71], a[220:223], v[100:103], v[68:71]
    v_mfma_f32_16x16x32_bf16 v[24:27], a[52:55], v[104:107], v[24:27]
    v_mfma_f32_16x16x32_bf16 v[40:43], a[108:111], v[104:107], v[40:43]
    v_mfma_f32_16x16x32_bf16 v[56:59], a[164:167], v[104:107], v[56:59]
    v_mfma_f32_16x16x32_bf16 v[72:75], a[220:223], v[104:107], v[72:75]
    v_mfma_f32_16x16x32_bf16 v[28:31], a[52:55], v[108:111], v[28:31]
    v_mfma_f32_16x16x32_bf16 v[44:47], a[108:111], v[108:111], v[44:47]
    v_mfma_f32_16x16x32_bf16 v[60:63], a[164:167], v[108:111], v[60:63]
    v_mfma_f32_16x16x32_bf16 v[76:79], a[220:223], v[108:111], v[76:79]
    s_mul_hi_u32 s24, s18, 613566757
    s_mul_i32 s22, s24, 7
    s_sub_u32 s25, s18, s22
    s_lshl_b32 s26, s28, 4
    s_add_u32 s26, s26, s24
    s_mul_i32 s26, s26, 28672
    s_lshl_b32 s22, s25, 12
    s_add_u32 s26, s26, s22
    s_add_u32 s26, s26, 50331648
    s_add_u32 s22, s26, 0
    s_nop 0
    v_cvt_pk_bf16_f32 v112, v16, v17
    v_cvt_pk_bf16_f32 v113, v18, v19
    v_cvt_pk_bf16_f32 v114, v32, v33
    v_cvt_pk_bf16_f32 v115, v34, v35
    buffer_store_dwordx4 v[112:115], v1, s[8:11], s22 offen offset:0 sc1
    v_cvt_pk_bf16_f32 v116, v20, v21
    v_cvt_pk_bf16_f32 v117, v22, v23
    v_cvt_pk_bf16_f32 v118, v36, v37
    v_cvt_pk_bf16_f32 v119, v38, v39
    buffer_store_dwordx4 v[116:119], v1, s[8:11], s22 offen offset:1024 sc1
    v_cvt_pk_bf16_f32 v120, v24, v25
    v_cvt_pk_bf16_f32 v121, v26, v27
    v_cvt_pk_bf16_f32 v122, v40, v41
    v_cvt_pk_bf16_f32 v123, v42, v43
    buffer_store_dwordx4 v[120:123], v1, s[8:11], s22 offen offset:2048 sc1
    v_cvt_pk_bf16_f32 v124, v28, v29
    v_cvt_pk_bf16_f32 v125, v30, v31
    v_cvt_pk_bf16_f32 v126, v44, v45
    v_cvt_pk_bf16_f32 v127, v46, v47
    buffer_store_dwordx4 v[124:127], v1, s[8:11], s22 offen offset:3072 sc1
    s_add_u32 s22, s26, 458752
    v_cvt_pk_bf16_f32 v112, v48, v49
    v_cvt_pk_bf16_f32 v113, v50, v51
    v_cvt_pk_bf16_f32 v114, v64, v65
    v_cvt_pk_bf16_f32 v115, v66, v67
    buffer_store_dwordx4 v[112:115], v1, s[8:11], s22 offen offset:0 sc1
    v_cvt_pk_bf16_f32 v116, v52, v53
    v_cvt_pk_bf16_f32 v117, v54, v55
    v_cvt_pk_bf16_f32 v118, v68, v69
    v_cvt_pk_bf16_f32 v119, v70, v71
    buffer_store_dwordx4 v[116:119], v1, s[8:11], s22 offen offset:1024 sc1
    v_cvt_pk_bf16_f32 v120, v56, v57
    v_cvt_pk_bf16_f32 v121, v58, v59
    v_cvt_pk_bf16_f32 v122, v72, v73
    v_cvt_pk_bf16_f32 v123, v74, v75
    buffer_store_dwordx4 v[120:123], v1, s[8:11], s22 offen offset:2048 sc1
    v_cvt_pk_bf16_f32 v124, v60, v61
    v_cvt_pk_bf16_f32 v125, v62, v63
    v_cvt_pk_bf16_f32 v126, v76, v77
    v_cvt_pk_bf16_f32 v127, v78, v79
    buffer_store_dwordx4 v[124:127], v1, s[8:11], s22 offen offset:3072 sc1
    s_cmp_lt_u32 s27, 112
    s_cbranch_scc1 WG_NEXT
    s_nop 0
    s_mul_i32 s66, s69, 2176
    s_waitcnt vmcnt(0)
    s_barrier
    s_cmp_lg_u32 s16, 0
    s_cbranch_scc1 SIG_5
    s_add_u32 s68, s66, 85131264
    s_mov_b64 exec, 1
    v_mov_b32 v254, 0
    v_mov_b32_e64 v255, 1
    buffer_atomic_add v255, v254, s[8:11], s68 offen
    s_mov_b64 exec, -1
    s_nop 0
SIG_5:
WG_NEXT:
    s_mov_b32 s18, s27
    s_mov_b32 s19, s20
    s_cmp_lt_u32 s18, s31
    s_cbranch_scc1 WG_UNIT
    s_waitcnt vmcnt(0) lgkmcnt(0)
    s_barrier
    s_cmp_lg_u32 s69, 0
    s_cbranch_scc1 WK_GDONE
    s_cmp_ge_u32 s64, 84
    s_cbranch_scc1 WK_NOGF
    s_nop 0
    s_load_dwordx4 s[20:23], s[0:1], 64
    s_load_dwordx2 s[24:25], s[0:1], 80
    v_and_b32 v1, 63, v0
    v_and_b32 v3, 15, v1
    v_lshrrev_b32 v4, 4, v1
    v_lshlrev_b32 v5, 4, v1
    s_waitcnt lgkmcnt(0)
    s_cmp_ge_u32 s64, 56
    s_cbranch_scc1 GF_TD
    s_cmp_ge_u32 s64, 28
    s_cselect_b32 s6, s22, s20
    s_cselect_b32 s7, s23, s21
    s_cselect_b32 s22, 2, 0
    s_cselect_b32 s23, 28, 0
    s_sub_u32 s23, s64, s23
    s_mov_b32 s32, s6
    s_and_b32 s33, s7, 0xffff
    s_mov_b32 s34, 1605632
    s_mov_b32 s35, 0x00020000
    s_lshl_b32 s25, s23, 7
    v_lshrrev_b32 v6, 3, v0
    v_and_b32_e64 v7, 7, v0
    v_mul_u32_u24 v9, 3584, v6
    v_lshl_add_u32 v9, v7, 4, v9
    v_mul_u32_u24 v10, 144, v6
    v_lshl_add_u32 v10, v7, 4, v10
    s_add_u32 s5, s25, 0
    s_nop 0
    buffer_load_dwordx4 v[64:67], v9, s[32:35], s5 offen
    s_add_u32 s5, s25, 114688
    buffer_load_dwordx4 v[68:71], v9, s[32:35], s5 offen
    s_add_u32 s5, s25, 229376
    buffer_load_dwordx4 v[72:75], v9, s[32:35], s5 offen
    s_add_u32 s5, s25, 344064
    buffer_load_dwordx4 v[76:79], v9, s[32:35], s5 offen
    s_add_u32 s5, s25, 458752
    buffer_load_dwordx4 v[80:83], v9, s[32:35], s5 offen
    s_add_u32 s5, s25, 573440
    buffer_load_dwordx4 v[84:87], v9, s[32:35], s5 offen
    s_add_u32 s5, s25, 688128
    buffer_load_dwordx4 v[88:91], v9, s[32:35], s5 offen
    s_add_u32 s5, s25, 802816
    buffer_load_dwordx4 v[92:95], v9, s[32:35], s5 offen
    s_add_u32 s5, s25, 917504
    buffer_load_dwordx4 v[96:99], v9, s[32:35], s5 offen
    s_add_u32 s5, s25, 1032192
    buffer_load_dwordx4 v[100:103], v9, s[32:35], s5 offen
    s_add_u32 s5, s25, 1146880
    buffer_load_dwordx4 v[104:107], v9, s[32:35], s5 offen
    s_add_u32 s5, s25, 1261568
    buffer_load_dwordx4 v[108:111], v9, s[32:35], s5 offen
    s_add_u32 s5, s25, 1376256
    buffer_load_dwordx4 v[112:115], v9, s[32:35], s5 offen
    s_add_u32 s5, s25, 1490944
    buffer_load_dwordx4 v[116:119], v9, s[32:35], s5 offen
    s_nop 0
    s_waitcnt vmcnt(13)
    ds_write_b128 v10, v[64:67] offset:0
    s_nop 0
    s_waitcnt vmcnt(12)
    ds_write_b128 v10, v[68:71] offset:4608
    s_nop 0
    s_waitcnt vmcnt(11)
    ds_write_b128 v10, v[72:75] offset:9216
    s_nop 0
    s_waitcnt vmcnt(10)
    ds_write_b128 v10, v[76:79] offset:13824
    s_nop 0
    s_waitcnt vmcnt(9)
    ds_write_b128 v10, v[80:83] offset:18432
    s_nop 0
    s_waitcnt vmcnt(8)
    ds_write_b128 v10, v[84:87] offset:23040
    s_nop 0
    s_waitcnt vmcnt(7)
    ds_write_b128 v10, v[88:91] offset:27648
    s_nop 0
    s_waitcnt vmcnt(6)
    ds_write_b128 v10, v[92:95] offset:32256
    s_nop 0
    s_waitcnt vmcnt(5)
    ds_write_b128 v10, v[96:99] offset:36864
    s_nop 0
    s_waitcnt vmcnt(4)
    ds_write_b128 v10, v[100:103] offset:41472
    s_nop 0
    s_waitcnt vmcnt(3)
    ds_write_b128 v10, v[104:107] offset:46080
    s_nop 0
    s_waitcnt vmcnt(2)
    ds_write_b128 v10, v[108:111] offset:50688
    s_nop 0
    s_waitcnt vmcnt(1)
    ds_write_b128 v10, v[112:115] offset:55296
    s_nop 0
    s_waitcnt vmcnt(0)
    ds_write_b128 v10, v[116:119] offset:59904
    s_waitcnt lgkmcnt(0)
    s_barrier
    v_lshrrev_b32_e64 v6, 2, v3
    v_lshl_add_u32 v6, v4, 3, v6
    v_mul_u32_u24 v6, 144, v6
    v_and_b32_e64 v7, 3, v1
    v_lshl_add_u32 v11, v7, 3, v6
    s_lshl_b32 s5, s16, 5
    v_add_u32 v11, s5, v11
    s_lshl_b32 s26, s23, 1
    s_lshr_b32 s5, s16, 1
    s_add_u32 s26, s26, s5
    s_lshl_b32 s26, s26, 2
    s_add_u32 s26, s26, s22
    s_and_b32 s5, s16, 1
    s_add_u32 s26, s26, s5
    s_nop 0
    s_mul_i32 s26, s26, 14336
    s_add_u32 s26, s26, 92274688
    ds_read_b64_tr_b16 v[64:65], v11 offset:0
    ds_read_b64_tr_b16 v[66:67], v11 offset:576
    ds_read_b64_tr_b16 v[68:69], v11 offset:4608
    ds_read_b64_tr_b16 v[70:71], v11 offset:5184
    ds_read_b64_tr_b16 v[72:73], v11 offset:9216
    ds_read_b64_tr_b16 v[74:75], v11 offset:9792
    ds_read_b64_tr_b16 v[76:77], v11 offset:13824
    ds_read_b64_tr_b16 v[78:79], v11 offset:14400
    ds_read_b64_tr_b16 v[80:81], v11 offset:18432
    ds_read_b64_tr_b16 v[82:83], v11 offset:19008
    ds_read_b64_tr_b16 v[84:85], v11 offset:23040
    ds_read_b64_tr_b16 v[86:87], v11 offset:23616
    ds_read_b64_tr_b16 v[88:89], v11 offset:27648
    ds_read_b64_tr_b16 v[90:91], v11 offset:28224
    s_nop 0
    s_waitcnt lgkmcnt(0)
    ds_read_b64_tr_b16 v[92:93], v11 offset:32256
    ds_read_b64_tr_b16 v[94:95], v11 offset:32832
    ds_read_b64_tr_b16 v[96:97], v11 offset:36864
    ds_read_b64_tr_b16 v[98:99], v11 offset:37440
    ds_read_b64_tr_b16 v[100:101], v11 offset:41472
    ds_read_b64_tr_b16 v[102:103], v11 offset:42048
    ds_read_b64_tr_b16 v[104:105], v11 offset:46080
    ds_read_b64_tr_b16 v[106:107], v11 offset:46656
    ds_read_b64_tr_b16 v[108:109], v11 offset:50688
    ds_read_b64_tr_b16 v[110:111], v11 offset:51264
    ds_read_b64_tr_b16 v[112:113], v11 offset:55296
    ds_read_b64_tr_b16 v[114:115], v11 offset:55872
    ds_read_b64_tr_b16 v[116:117], v11 offset:59904
    ds_read_b64_tr_b16 v[118:119], v11 offset:60480
    s_branch GF_ST
    s_nop 0
GF_TD:
    s_mov_b32 s32, s24
    s_nop 0
    s_and_b32 s33, s25, 0xffff
    s_mov_b32 s34, 1605632
    s_mov_b32 s35, 0x00020000
    s_sub_u32 s4, s64, 56
    s_nop 0
    s_mul_hi_u32 s20, s4, 613566757
    s_mul_i32 s5, s20, 7
    s_sub_u32 s23, s4, s5
    s_mul_i32 s25, s20, 401408
    s_lshl_b32 s5, s23, 7
    s_add_u32 s25, s25, s5
    v_lshrrev_b32 v6, 3, v0
    v_and_b32 v7, 7, v0
    v_mul_u32_u24 v9, 896, v6
    v_lshl_add_u32 v9, v7, 4, v9
    v_mul_u32_u24 v10, 144, v6
    v_lshl_add_u32 v10, v7, 4, v10
    s_add_u32 s5, s25, 0
    s_nop 0
    buffer_load_dwordx4 v[64:67], v9, s[32:35], s5 offen
    s_add_u32 s5, s25, 28672
    buffer_load_dwordx4 v[68:71], v9, s[32:35], s5 offen
    s_add_u32 s5, s25, 57344
    buffer_load_dwordx4 v[72:75], v9, s[32:35], s5 offen
    s_add_u32 s5, s25, 86016
    buffer_load_dwordx4 v[76:79], v9, s[32:35], s5 offen
    s_add_u32 s5, s25, 114688
    buffer_load_dwordx4 v[80:83], v9, s[32:35], s5 offen
    s_add_u32 s5, s25, 143360
    buffer_load_dwordx4 v[84:87], v9, s[32:35], s5 offen
    s_add_u32 s5, s25, 172032
    buffer_load_dwordx4 v[88:91], v9, s[32:35], s5 offen
    s_add_u32 s5, s25, 200704
    buffer_load_dwordx4 v[92:95], v9, s[32:35], s5 offen
    s_add_u32 s5, s25, 229376
    buffer_load_dwordx4 v[96:99], v9, s[32:35], s5 offen
    s_add_u32 s5, s25, 258048
    buffer_load_dwordx4 v[100:103], v9, s[32:35], s5 offen
    s_add_u32 s5, s25, 286720
    buffer_load_dwordx4 v[104:107], v9, s[32:35], s5 offen
    s_add_u32 s5, s25, 315392
    buffer_load_dwordx4 v[108:111], v9, s[32:35], s5 offen
    s_add_u32 s5, s25, 344064
    buffer_load_dwordx4 v[112:115], v9, s[32:35], s5 offen
    s_add_u32 s5, s25, 372736
    buffer_load_dwordx4 v[116:119], v9, s[32:35], s5 offen
    s_nop 0
    s_waitcnt vmcnt(13)
    ds_write_b128 v10, v[64:67] offset:0
    s_nop 0
    s_waitcnt vmcnt(12)
    ds_write_b128 v10, v[68:71] offset:4608
    s_nop 0
    s_waitcnt vmcnt(11)
    ds_write_b128 v10, v[72:75] offset:9216
    s_nop 0
    s_waitcnt vmcnt(10)
    ds_write_b128 v10, v[76:79] offset:13824
    s_nop 0
    s_waitcnt vmcnt(9)
    ds_write_b128 v10, v[80:83] offset:18432
    s_nop 0
    s_waitcnt vmcnt(8)
    ds_write_b128 v10, v[84:87] offset:23040
    s_nop 0
    s_waitcnt vmcnt(7)
    ds_write_b128 v10, v[88:91] offset:27648
    s_nop 0
    s_waitcnt vmcnt(6)
    ds_write_b128 v10, v[92:95] offset:32256
    s_nop 0
    s_waitcnt vmcnt(5)
    ds_write_b128 v10, v[96:99] offset:36864
    s_nop 0
    s_waitcnt vmcnt(4)
    ds_write_b128 v10, v[100:103] offset:41472
    s_nop 0
    s_waitcnt vmcnt(3)
    ds_write_b128 v10, v[104:107] offset:46080
    s_nop 0
    s_waitcnt vmcnt(2)
    ds_write_b128 v10, v[108:111] offset:50688
    s_nop 0
    s_waitcnt vmcnt(1)
    ds_write_b128 v10, v[112:115] offset:55296
    s_nop 0
    s_waitcnt vmcnt(0)
    ds_write_b128 v10, v[116:119] offset:59904
    s_waitcnt lgkmcnt(0)
    s_barrier
    v_lshrrev_b32_e64 v6, 2, v3
    v_lshl_add_u32 v6, v4, 2, v6
    v_mul_u32_u24 v6, 144, v6
    v_and_b32_e64 v7, 3, v1
    v_lshl_add_u32 v11, v7, 3, v6
    s_lshl_b32 s5, s16, 5
    v_add_u32 v11, s5, v11
    s_lshl_b32 s26, s23, 2
    s_add_u32 s26, s26, s16
    s_mul_i32 s26, s26, 56
    s_mul_i32 s5, s20, 14
    s_add_u32 s26, s26, s5
    s_lshl_b32 s26, s26, 10
    s_add_u32 s26, s26, 96468992
    ds_read_b64_tr_b16 v[64:65], v11 offset:0
    ds_read_b64_tr_b16 v[66:67], v11 offset:2304
    ds_read_b64_tr_b16 v[68:69], v11 offset:4608
    ds_read_b64_tr_b16 v[70:71], v11 offset:6912
    ds_read_b64_tr_b16 v[72:73], v11 offset:9216
    ds_read_b64_tr_b16 v[74:75], v11 offset:11520
    ds_read_b64_tr_b16 v[76:77], v11 offset:13824
    ds_read_b64_tr_b16 v[78:79], v11 offset:16128
    ds_read_b64_tr_b16 v[80:81], v11 offset:18432
    ds_read_b64_tr_b16 v[82:83], v11 offset:20736
    ds_read_b64_tr_b16 v[84:85], v11 offset:23040
    ds_read_b64_tr_b16 v[86:87], v11 offset:25344
    ds_read_b64_tr_b16 v[88:89], v11 offset:27648
    ds_read_b64_tr_b16 v[90:91], v11 offset:29952
    s_nop 0
    s_waitcnt lgkmcnt(0)
    ds_read_b64_tr_b16 v[92:93], v11 offset:32256
    ds_read_b64_tr_b16 v[94:95], v11 offset:34560
    ds_read_b64_tr_b16 v[96:97], v11 offset:36864
    ds_read_b64_tr_b16 v[98:99], v11 offset:39168
    ds_read_b64_tr_b16 v[100:101], v11 offset:41472
    ds_read_b64_tr_b16 v[102:103], v11 offset:43776
    ds_read_b64_tr_b16 v[104:105], v11 offset:46080
    ds_read_b64_tr_b16 v[106:107], v11 offset:48384
    ds_read_b64_tr_b16 v[108:109], v11 offset:50688
    ds_read_b64_tr_b16 v[110:111], v11 offset:52992
    ds_read_b64_tr_b16 v[112:113], v11 offset:55296
    ds_read_b64_tr_b16 v[114:115], v11 offset:57600
    ds_read_b64_tr_b16 v[116:117], v11 offset:59904
    ds_read_b64_tr_b16 v[118:119], v11 offset:62208
GF_ST:
    s_nop 0
    s_waitcnt lgkmcnt(0)
    buffer_store_dwordx4 v[64:67], v5, s[8:11], s26 offen offset:0 sc1
    buffer_store_dwordx4 v[68:71], v5, s[8:11], s26 offen offset:1024 sc1
    buffer_store_dwordx4 v[72:75], v5, s[8:11], s26 offen offset:2048 sc1
    buffer_store_dwordx4 v[76:79], v5, s[8:11], s26 offen offset:3072 sc1
    s_add_u32 s26, s26, 4096
    buffer_store_dwordx4 v[80:83], v5, s[8:11], s26 offen offset:0 sc1
    buffer_store_dwordx4 v[84:87], v5, s[8:11], s26 offen offset:1024 sc1
    buffer_store_dwordx4 v[88:91], v5, s[8:11], s26 offen offset:2048 sc1
    buffer_store_dwordx4 v[92:95], v5, s[8:11], s26 offen offset:3072 sc1
    s_add_u32 s26, s26, 4096
    buffer_store_dwordx4 v[96:99], v5, s[8:11], s26 offen offset:0 sc1
    buffer_store_dwordx4 v[100:103], v5, s[8:11], s26 offen offset:1024 sc1
    buffer_store_dwordx4 v[104:107], v5, s[8:11], s26 offen offset:2048 sc1
    buffer_store_dwordx4 v[108:111], v5, s[8:11], s26 offen offset:3072 sc1
    s_add_u32 s26, s26, 4096
    buffer_store_dwordx4 v[112:115], v5, s[8:11], s26 offen offset:0 sc1
    buffer_store_dwordx4 v[116:119], v5, s[8:11], s26 offen offset:1024 sc1
    s_waitcnt vmcnt(0)
    s_barrier
    s_cmp_lg_u32 s16, 0
    s_cbranch_scc1 SIG_6
    s_mov_b32 s68, 85133696
    s_mov_b64 exec, 1
    v_mov_b32 v254, 0
    v_mov_b32_e64 v255, 1
    buffer_atomic_add v255, v254, s[8:11], s68 offen
    s_mov_b64 exec, -1
    s_nop 0
SIG_6:
WK_NOGF:
    v_mov_b32_e64 v253, 0
    s_mov_b32 s30, 85133824
    s_mov_b32 s27, 0
    s_nop 0
WK_WX2:
    buffer_load_dword v254, v253, s[8:11], s30 offen sc1
    s_add_u32 s27, s27, 1
    s_nop 0
    s_cmp_gt_u32 s27, 65536
    s_cbranch_scc1 CH_FAIL
    s_waitcnt vmcnt(0)
    v_cmp_le_u32 vcc, 32, v254
    s_cbranch_vccnz WK_WX2_OK
    s_sleep 4
    s_branch WK_WX2
WK_WX2_OK:
    v_and_b32 v252, 63, v0
    v_min_u32 v253, 31, v252
    v_lshlrev_b32_e64 v253, 7, v253
    s_mov_b32 s30, 85135360
    s_mov_b32 s27, 0
    s_nop 0
WK_WALL:
    buffer_load_dword v254, v253, s[8:11], s30 offen sc1
    s_add_u32 s27, s27, 1
    s_nop 0
    s_cmp_gt_u32 s27, 65536
    s_cbranch_scc1 CH_FAIL
    s_waitcnt vmcnt(0)
    v_cmp_gt_u32 vcc, 7, v254
    s_cbranch_vccz WK_WALL_OK
    s_sleep 2
    s_branch WK_WALL
WK_WALL_OK:
    s_mov_b32 s69, 1
    s_and_b32 s17, s64, 7
    s_add_u32 s18, s67, 112
    s_cmp_lt_u32 s17, 2
    s_cselect_b32 s18, s18, s67
    s_mov_b32 s29, 28
    s_branch WK_PASS
WK_GDONE:
    s_waitcnt vmcnt(0)
    s_barrier
    s_cmp_lg_u32 s16, 0
    s_cbranch_scc1 SIG_7
    s_add_u32 s68, s65, 85131392
    s_mov_b64 exec, 1
    v_mov_b32 v254, 0
    v_mov_b32_e64 v255, 1
    buffer_atomic_add v255, v254, s[8:11], s68 offen
    s_mov_b64 exec, -1
    s_nop 0
SIG_7:
    v_mov_b32_e64 v253, 0
    s_add_u32 s30, s65, 85131392
    s_mov_b32 s27, 0
    s_nop 0
WK_W1:
    buffer_load_dword v254, v253, s[8:11], s30 offen sc1
    s_add_u32 s27, s27, 1
    s_nop 0
    s_cmp_gt_u32 s27, 65536
    s_cbranch_scc1 CH_FAIL
    s_waitcnt vmcnt(0)
    v_cmp_le_u32 vcc, 28, v254
    s_cbranch_vccnz WK_W1_OK
    s_sleep 4
    s_branch WK_W1
WK_W1_OK:
    s_lshr_b32 s66, s65, 7
    s_mul_i32 s66, s66, 28
    s_add_u32 s66, s66, s67
    v_and_b32 v2, 63, v0
    v_lshlrev_b32_e64 v1, 4, v2
    s_mul_hi_u32 s20, s66, 613566757
    s_mul_i32 s22, s20, 7
    s_sub_u32 s21, s66, s22
    s_mul_i32 s22, s16, 14336
    s_mul_i32 s23, s20, 229376
    s_add_u32 s23, s23, s22
    s_nop 0
    s_add_u32 s23, s23, 100663296
    s_mul_i32 s24, s21, 229376
    s_add_u32 s24, s24, s22
    s_nop 0
    s_add_u32 s24, s24, 96468992
    s_add_u32 s22, s23, 0
    s_nop 0
    buffer_load_dwordx4 v[80:83], v1, s[8:11], s22 offen offset:0 sc1
    s_add_u32 s22, s24, 0
    s_nop 0
    buffer_load_dwordx4 v[96:99], v1, s[8:11], s22 offen offset:0 sc1
    s_add_u32 s22, s23, 57344
    buffer_load_dwordx4 v[84:87], v1, s[8:11], s22 offen offset:0 sc1
    s_add_u32 s22, s24, 57344
    buffer_load_dwordx4 v[100:103], v1, s[8:11], s22 offen offset:0 sc1
    s_add_u32 s22, s23, 114688
    buffer_load_dwordx4 v[88:91], v1, s[8:11], s22 offen offset:0 sc1
    s_add_u32 s22, s24, 114688
    buffer_load_dwordx4 v[104:107], v1, s[8:11], s22 offen offset:0 sc1
    s_add_u32 s22, s23, 172032
    buffer_load_dwordx4 v[92:95], v1, s[8:11], s22 offen offset:0 sc1
    s_add_u32 s22, s24, 172032
    buffer_load_dwordx4 v[108:111], v1, s[8:11], s22 offen offset:0 sc1
    s_add_u32 s22, s23, 0
    s_nop 0
    buffer_load_dwordx4 v[112:115], v1, s[8:11], s22 offen offset:1024 sc1
    s_add_u32 s22, s24, 0
    s_nop 0
    buffer_load_dwordx4 v[128:131], v1, s[8:11], s22 offen offset:1024 sc1
    s_add_u32 s22, s23, 57344
    buffer_load_dwordx4 v[116:119], v1, s[8:11], s22 offen offset:1024 sc1
    s_add_u32 s22, s24, 57344
    buffer_load_dwordx4 v[132:135], v1, s[8:11], s22 offen offset:1024 sc1
    s_add_u32 s22, s23, 114688
    buffer_load_dwordx4 v[120:123], v1, s[8:11], s22 offen offset:1024 sc1
    s_add_u32 s22, s24, 114688
    buffer_load_dwordx4 v[136:139], v1, s[8:11], s22 offen offset:1024 sc1
    s_add_u32 s22, s23, 172032
    buffer_load_dwordx4 v[124:127], v1, s[8:11], s22 offen offset:1024 sc1
    s_add_u32 s22, s24, 172032
    buffer_load_dwordx4 v[140:143], v1, s[8:11], s22 offen offset:1024 sc1
    s_nop 0
    s_waitcnt vmcnt(8)
    v_mfma_f32_16x16x32_bf16 v[16:19], v[96:99], v[80:83], 0
    v_mfma_f32_16x16x32_bf16 v[20:23], v[100:103], v[80:83], 0
    v_mfma_f32_16x16x32_bf16 v[24:27], v[104:107], v[80:83], 0
    v_mfma_f32_16x16x32_bf16 v[28:31], v[108:111], v[80:83], 0
    v_mfma_f32_16x16x32_bf16 v[32:35], v[96:99], v[84:87], 0
    v_mfma_f32_16x16x32_bf16 v[36:39], v[100:103], v[84:87], 0
    v_mfma_f32_16x16x32_bf16 v[40:43], v[104:107], v[84:87], 0
    v_mfma_f32_16x16x32_bf16 v[44:47], v[108:111], v[84:87], 0
    v_mfma_f32_16x16x32_bf16 v[48:51], v[96:99], v[88:91], 0
    v_mfma_f32_16x16x32_bf16 v[52:55], v[100:103], v[88:91], 0
    v_mfma_f32_16x16x32_bf16 v[56:59], v[104:107], v[88:91], 0
    v_mfma_f32_16x16x32_bf16 v[60:63], v[108:111], v[88:91], 0
    v_mfma_f32_16x16x32_bf16 v[64:67], v[96:99], v[92:95], 0
    v_mfma_f32_16x16x32_bf16 v[68:71], v[100:103], v[92:95], 0
    v_mfma_f32_16x16x32_bf16 v[72:75], v[104:107], v[92:95], 0
    v_mfma_f32_16x16x32_bf16 v[76:79], v[108:111], v[92:95], 0
    s_add_u32 s22, s23, 0
    s_nop 0
    buffer_load_dwordx4 v[80:83], v1, s[8:11], s22 offen offset:2048 sc1
    s_add_u32 s22, s24, 0
    s_nop 0
    buffer_load_dwordx4 v[96:99], v1, s[8:11], s22 offen offset:2048 sc1
    s_add_u32 s22, s23, 57344
    buffer_load_dwordx4 v[84:87], v1, s[8:11], s22 offen offset:2048 sc1
    s_add_u32 s22, s24, 57344
    buffer_load_dwordx4 v[100:103], v1, s[8:11], s22 offen offset:2048 sc1
    s_add_u32 s22, s23, 114688
    buffer_load_dwordx4 v[88:91], v1, s[8:11], s22 offen offset:2048 sc1
    s_add_u32 s22, s24, 114688
    buffer_load_dwordx4 v[104:107], v1, s[8:11], s22 offen offset:2048 sc1
    s_add_u32 s22, s23, 172032
    buffer_load_dwordx4 v[92:95], v1, s[8:11], s22 offen offset:2048 sc1
    s_add_u32 s22, s24, 172032
    buffer_load_dwordx4 v[108:111], v1, s[8:11], s22 offen offset:2048 sc1
    s_nop 0
    s_waitcnt vmcnt(8)
    v_mfma_f32_16x16x32_bf16 v[16:19], v[128:131], v[112:115], v[16:19]
    v_mfma_f32_16x16x32_bf16 v[20:23], v[132:135], v[112:115], v[20:23]
    v_mfma_f32_16x16x32_bf16 v[24:27], v[136:139], v[112:115], v[24:27]
    v_mfma_f32_16x16x32_bf16 v[28:31], v[140:143], v[112:115], v[28:31]
    v_mfma_f32_16x16x32_bf16 v[32:35], v[128:131], v[116:119], v[32:35]
    v_mfma_f32_16x16x32_bf16 v[36:39], v[132:135], v[116:119], v[36:39]
    v_mfma_f32_16x16x32_bf16 v[40:43], v[136:139], v[116:119], v[40:43]
    v_mfma_f32_16x16x32_bf16 v[44:47], v[140:143], v[116:119], v[44:47]
    v_mfma_f32_16x16x32_bf16 v[48:51], v[128:131], v[120:123], v[48:51]
    v_mfma_f32_16x16x32_bf16 v[52:55], v[132:135], v[120:123], v[52:55]
    v_mfma_f32_16x16x32_bf16 v[56:59], v[136:139], v[120:123], v[56:59]
    v_mfma_f32_16x16x32_bf16 v[60:63], v[140:143], v[120:123], v[60:63]
    v_mfma_f32_16x16x32_bf16 v[64:67], v[128:131], v[124:127], v[64:67]
    v_mfma_f32_16x16x32_bf16 v[68:71], v[132:135], v[124:127], v[68:71]
    v_mfma_f32_16x16x32_bf16 v[72:75], v[136:139], v[124:127], v[72:75]
    v_mfma_f32_16x16x32_bf16 v[76:79], v[140:143], v[124:127], v[76:79]
    s_add_u32 s22, s23, 0
    s_nop 0
    buffer_load_dwordx4 v[112:115], v1, s[8:11], s22 offen offset:3072 sc1
    s_add_u32 s22, s24, 0
    s_nop 0
    buffer_load_dwordx4 v[128:131], v1, s[8:11], s22 offen offset:3072 sc1
    s_add_u32 s22, s23, 57344
    buffer_load_dwordx4 v[116:119], v1, s[8:11], s22 offen offset:3072 sc1
    s_add_u32 s22, s24, 57344
    buffer_load_dwordx4 v[132:135], v1, s[8:11], s22 offen offset:3072 sc1
    s_add_u32 s22, s23, 114688
    buffer_load_dwordx4 v[120:123], v1, s[8:11], s22 offen offset:3072 sc1
    s_add_u32 s22, s24, 114688
    buffer_load_dwordx4 v[136:139], v1, s[8:11], s22 offen offset:3072 sc1
    s_add_u32 s22, s23, 172032
    buffer_load_dwordx4 v[124:127], v1, s[8:11], s22 offen offset:3072 sc1
    s_add_u32 s22, s24, 172032
    buffer_load_dwordx4 v[140:143], v1, s[8:11], s22 offen offset:3072 sc1
    s_nop 0
    s_waitcnt vmcnt(8)
    v_mfma_f32_16x16x32_bf16 v[16:19], v[96:99], v[80:83], v[16:19]
    v_mfma_f32_16x16x32_bf16 v[20:23], v[100:103], v[80:83], v[20:23]
    v_mfma_f32_16x16x32_bf16 v[24:27], v[104:107], v[80:83], v[24:27]
    v_mfma_f32_16x16x32_bf16 v[28:31], v[108:111], v[80:83], v[28:31]
    v_mfma_f32_16x16x32_bf16 v[32:35], v[96:99], v[84:87], v[32:35]
    v_mfma_f32_16x16x32_bf16 v[36:39], v[100:103], v[84:87], v[36:39]
    v_mfma_f32_16x16x32_bf16 v[40:43], v[104:107], v[84:87], v[40:43]
    v_mfma_f32_16x16x32_bf16 v[44:47], v[108:111], v[84:87], v[44:47]
    v_mfma_f32_16x16x32_bf16 v[48:51], v[96:99], v[88:91], v[48:51]
    v_mfma_f32_16x16x32_bf16 v[52:55], v[100:103], v[88:91], v[52:55]
    v_mfma_f32_16x16x32_bf16 v[56:59], v[104:107], v[88:91], v[56:59]
    v_mfma_f32_16x16x32_bf16 v[60:63], v[108:111], v[88:91], v[60:63]
    v_mfma_f32_16x16x32_bf16 v[64:67], v[96:99], v[92:95], v[64:67]
    v_mfma_f32_16x16x32_bf16 v[68:71], v[100:103], v[92:95], v[68:71]
    v_mfma_f32_16x16x32_bf16 v[72:75], v[104:107], v[92:95], v[72:75]
    v_mfma_f32_16x16x32_bf16 v[76:79], v[108:111], v[92:95], v[76:79]
    s_add_u32 s22, s23, 4096
    buffer_load_dwordx4 v[80:83], v1, s[8:11], s22 offen offset:0 sc1
    s_add_u32 s22, s24, 4096
    buffer_load_dwordx4 v[96:99], v1, s[8:11], s22 offen offset:0 sc1
    s_add_u32 s22, s23, 61440
    buffer_load_dwordx4 v[84:87], v1, s[8:11], s22 offen offset:0 sc1
    s_add_u32 s22, s24, 61440
    buffer_load_dwordx4 v[100:103], v1, s[8:11], s22 offen offset:0 sc1
    s_add_u32 s22, s23, 118784
    buffer_load_dwordx4 v[88:91], v1, s[8:11], s22 offen offset:0 sc1
    s_add_u32 s22, s24, 118784
    buffer_load_dwordx4 v[104:107], v1, s[8:11], s22 offen offset:0 sc1
    s_add_u32 s22, s23, 176128
    buffer_load_dwordx4 v[92:95], v1, s[8:11], s22 offen offset:0 sc1
    s_add_u32 s22, s24, 176128
    buffer_load_dwordx4 v[108:111], v1, s[8:11], s22 offen offset:0 sc1
    s_nop 0
    s_waitcnt vmcnt(8)
    v_mfma_f32_16x16x32_bf16 v[16:19], v[128:131], v[112:115], v[16:19]
    v_mfma_f32_16x16x32_bf16 v[20:23], v[132:135], v[112:115], v[20:23]
    v_mfma_f32_16x16x32_bf16 v[24:27], v[136:139], v[112:115], v[24:27]
    v_mfma_f32_16x16x32_bf16 v[28:31], v[140:143], v[112:115], v[28:31]
    v_mfma_f32_16x16x32_bf16 v[32:35], v[128:131], v[116:119], v[32:35]
    v_mfma_f32_16x16x32_bf16 v[36:39], v[132:135], v[116:119], v[36:39]
    v_mfma_f32_16x16x32_bf16 v[40:43], v[136:139], v[116:119], v[40:43]
    v_mfma_f32_16x16x32_bf16 v[44:47], v[140:143], v[116:119], v[44:47]
    v_mfma_f32_16x16x32_bf16 v[48:51], v[128:131], v[120:123], v[48:51]
    v_mfma_f32_16x16x32_bf16 v[52:55], v[132:135], v[120:123], v[52:55]
    v_mfma_f32_16x16x32_bf16 v[56:59], v[136:139], v[120:123], v[56:59]
    v_mfma_f32_16x16x32_bf16 v[60:63], v[140:143], v[120:123], v[60:63]
    v_mfma_f32_16x16x32_bf16 v[64:67], v[128:131], v[124:127], v[64:67]
    v_mfma_f32_16x16x32_bf16 v[68:71], v[132:135], v[124:127], v[68:71]
    v_mfma_f32_16x16x32_bf16 v[72:75], v[136:139], v[124:127], v[72:75]
    v_mfma_f32_16x16x32_bf16 v[76:79], v[140:143], v[124:127], v[76:79]
    s_add_u32 s22, s23, 4096
    buffer_load_dwordx4 v[112:115], v1, s[8:11], s22 offen offset:1024 sc1
    s_add_u32 s22, s24, 4096
    buffer_load_dwordx4 v[128:131], v1, s[8:11], s22 offen offset:1024 sc1
    s_add_u32 s22, s23, 61440
    buffer_load_dwordx4 v[116:119], v1, s[8:11], s22 offen offset:1024 sc1
    s_add_u32 s22, s24, 61440
    buffer_load_dwordx4 v[132:135], v1, s[8:11], s22 offen offset:1024 sc1
    s_add_u32 s22, s23, 118784
    buffer_load_dwordx4 v[120:123], v1, s[8:11], s22 offen offset:1024 sc1
    s_add_u32 s22, s24, 118784
    buffer_load_dwordx4 v[136:139], v1, s[8:11], s22 offen offset:1024 sc1
    s_add_u32 s22, s23, 176128
    buffer_load_dwordx4 v[124:127], v1, s[8:11], s22 offen offset:1024 sc1
    s_add_u32 s22, s24, 176128
    buffer_load_dwordx4 v[140:143], v1, s[8:11], s22 offen offset:1024 sc1
    s_nop 0
    s_waitcnt vmcnt(8)
    v_mfma_f32_16x16x32_bf16 v[16:19], v[96:99], v[80:83], v[16:19]
    v_mfma_f32_16x16x32_bf16 v[20:23], v[100:103], v[80:83], v[20:23]
    v_mfma_f32_16x16x32_bf16 v[24:27], v[104:107], v[80:83], v[24:27]
    v_mfma_f32_16x16x32_bf16 v[28:31], v[108:111], v[80:83], v[28:31]
    v_mfma_f32_16x16x32_bf16 v[32:35], v[96:99], v[84:87], v[32:35]
    v_mfma_f32_16x16x32_bf16 v[36:39], v[100:103], v[84:87], v[36:39]
    v_mfma_f32_16x16x32_bf16 v[40:43], v[104:107], v[84:87], v[40:43]
    v_mfma_f32_16x16x32_bf16 v[44:47], v[108:111], v[84:87], v[44:47]
    v_mfma_f32_16x16x32_bf16 v[48:51], v[96:99], v[88:91], v[48:51]
    v_mfma_f32_16x16x32_bf16 v[52:55], v[100:103], v[88:91], v[52:55]
    v_mfma_f32_16x16x32_bf16 v[56:59], v[104:107], v[88:91], v[56:59]
    v_mfma_f32_16x16x32_bf16 v[60:63], v[108:111], v[88:91], v[60:63]
    v_mfma_f32_16x16x32_bf16 v[64:67], v[96:99], v[92:95], v[64:67]
    v_mfma_f32_16x16x32_bf16 v[68:71], v[100:103], v[92:95], v[68:71]
    v_mfma_f32_16x16x32_bf16 v[72:75], v[104:107], v[92:95], v[72:75]
    v_mfma_f32_16x16x32_bf16 v[76:79], v[108:111], v[92:95], v[76:79]
    s_add_u32 s22, s23, 4096
    buffer_load_dwordx4 v[80:83], v1, s[8:11], s22 offen offset:2048 sc1
    s_add_u32 s22, s24, 4096
    buffer_load_dwordx4 v[96:99], v1, s[8:11], s22 offen offset:2048 sc1
    s_add_u32 s22, s23, 61440
    buffer_load_dwordx4 v[84:87], v1, s[8:11], s22 offen offset:2048 sc1
    s_add_u32 s22, s24, 61440
    buffer_load_dwordx4 v[100:103], v1, s[8:11], s22 offen offset:2048 sc1
    s_add_u32 s22, s23, 118784
    buffer_load_dwordx4 v[88:91], v1, s[8:11], s22 offen offset:2048 sc1
    s_add_u32 s22, s24, 118784
    buffer_load_dwordx4 v[104:107], v1, s[8:11], s22 offen offset:2048 sc1
    s_add_u32 s22, s23, 176128
    buffer_load_dwordx4 v[92:95], v1, s[8:11], s22 offen offset:2048 sc1
    s_add_u32 s22, s24, 176128
    buffer_load_dwordx4 v[108:111], v1, s[8:11], s22 offen offset:2048 sc1
    s_nop 0
    s_waitcnt vmcnt(8)
    v_mfma_f32_16x16x32_bf16 v[16:19], v[128:131], v[112:115], v[16:19]
    v_mfma_f32_16x16x32_bf16 v[20:23], v[132:135], v[112:115], v[20:23]
    v_mfma_f32_16x16x32_bf16 v[24:27], v[136:139], v[112:115], v[24:27]
    v_mfma_f32_16x16x32_bf16 v[28:31], v[140:143], v[112:115], v[28:31]
    v_mfma_f32_16x16x32_bf16 v[32:35], v[128:131], v[116:119], v[32:35]
    v_mfma_f32_16x16x32_bf16 v[36:39], v[132:135], v[116:119], v[36:39]
    v_mfma_f32_16x16x32_bf16 v[40:43], v[136:139], v[116:119], v[40:43]
    v_mfma_f32_16x16x32_bf16 v[44:47], v[140:143], v[116:119], v[44:47]
    v_mfma_f32_16x16x32_bf16 v[48:51], v[128:131], v[120:123], v[48:51]
    v_mfma_f32_16x16x32_bf16 v[52:55], v[132:135], v[120:123], v[52:55]
    v_mfma_f32_16x16x32_bf16 v[56:59], v[136:139], v[120:123], v[56:59]
    v_mfma_f32_16x16x32_bf16 v[60:63], v[140:143], v[120:123], v[60:63]
    v_mfma_f32_16x16x32_bf16 v[64:67], v[128:131], v[124:127], v[64:67]
    v_mfma_f32_16x16x32_bf16 v[68:71], v[132:135], v[124:127], v[68:71]
    v_mfma_f32_16x16x32_bf16 v[72:75], v[136:139], v[124:127], v[72:75]
    v_mfma_f32_16x16x32_bf16 v[76:79], v[140:143], v[124:127], v[76:79]
    s_add_u32 s22, s23, 4096
    buffer_load_dwordx4 v[112:115], v1, s[8:11], s22 offen offset:3072 sc1
    s_add_u32 s22, s24, 4096
    buffer_load_dwordx4 v[128:131], v1, s[8:11], s22 offen offset:3072 sc1
    s_add_u32 s22, s23, 61440
    buffer_load_dwordx4 v[116:119], v1, s[8:11], s22 offen offset:3072 sc1
    s_add_u32 s22, s24, 61440
    buffer_load_dwordx4 v[132:135], v1, s[8:11], s22 offen offset:3072 sc1
    s_add_u32 s22, s23, 118784
    buffer_load_dwordx4 v[120:123], v1, s[8:11], s22 offen offset:3072 sc1
    s_add_u32 s22, s24, 118784
    buffer_load_dwordx4 v[136:139], v1, s[8:11], s22 offen offset:3072 sc1
    s_add_u32 s22, s23, 176128
    buffer_load_dwordx4 v[124:127], v1, s[8:11], s22 offen offset:3072 sc1
    s_add_u32 s22, s24, 176128
    buffer_load_dwordx4 v[140:143], v1, s[8:11], s22 offen offset:3072 sc1
    s_nop 0
    s_waitcnt vmcnt(8)
    v_mfma_f32_16x16x32_bf16 v[16:19], v[96:99], v[80:83], v[16:19]
    v_mfma_f32_16x16x32_bf16 v[20:23], v[100:103], v[80:83], v[20:23]
    v_mfma_f32_16x16x32_bf16 v[24:27], v[104:107], v[80:83], v[24:27]
    v_mfma_f32_16x16x32_bf16 v[28:31], v[108:111], v[80:83], v[28:31]
    v_mfma_f32_16x16x32_bf16 v[32:35], v[96:99], v[84:87], v[32:35]
    v_mfma_f32_16x16x32_bf16 v[36:39], v[100:103], v[84:87], v[36:39]
    v_mfma_f32_16x16x32_bf16 v[40:43], v[104:107], v[84:87], v[40:43]
    v_mfma_f32_16x16x32_bf16 v[44:47], v[108:111], v[84:87], v[44:47]
    v_mfma_f32_16x16x32_bf16 v[48:51], v[96:99], v[88:91], v[48:51]
    v_mfma_f32_16x16x32_bf16 v[52:55], v[100:103], v[88:91], v[52:55]
    v_mfma_f32_16x16x32_bf16 v[56:59], v[104:107], v[88:91], v[56:59]
    v_mfma_f32_16x16x32_bf16 v[60:63], v[108:111], v[88:91], v[60:63]
    v_mfma_f32_16x16x32_bf16 v[64:67], v[96:99], v[92:95], v[64:67]
    v_mfma_f32_16x16x32_bf16 v[68:71], v[100:103], v[92:95], v[68:71]
    v_mfma_f32_16x16x32_bf16 v[72:75], v[104:107], v[92:95], v[72:75]
    v_mfma_f32_16x16x32_bf16 v[76:79], v[108:111], v[92:95], v[76:79]
    s_add_u32 s22, s23, 8192
    buffer_load_dwordx4 v[80:83], v1, s[8:11], s22 offen offset:0 sc1
    s_add_u32 s22, s24, 8192
    buffer_load_dwordx4 v[96:99], v1, s[8:11], s22 offen offset:0 sc1
    s_add_u32 s22, s23, 65536
    buffer_load_dwordx4 v[84:87], v1, s[8:11], s22 offen offset:0 sc1
    s_add_u32 s22, s24, 65536
    buffer_load_dwordx4 v[100:103], v1, s[8:11], s22 offen offset:0 sc1
    s_add_u32 s22, s23, 122880
    buffer_load_dwordx4 v[88:91], v1, s[8:11], s22 offen offset:0 sc1
    s_add_u32 s22, s24, 122880
    buffer_load_dwordx4 v[104:107], v1, s[8:11], s22 offen offset:0 sc1
    s_add_u32 s22, s23, 180224
    buffer_load_dwordx4 v[92:95], v1, s[8:11], s22 offen offset:0 sc1
    s_add_u32 s22, s24, 180224
    buffer_load_dwordx4 v[108:111], v1, s[8:11], s22 offen offset:0 sc1
    s_nop 0
    s_waitcnt vmcnt(8)
    v_mfma_f32_16x16x32_bf16 v[16:19], v[128:131], v[112:115], v[16:19]
    v_mfma_f32_16x16x32_bf16 v[20:23], v[132:135], v[112:115], v[20:23]
    v_mfma_f32_16x16x32_bf16 v[24:27], v[136:139], v[112:115], v[24:27]
    v_mfma_f32_16x16x32_bf16 v[28:31], v[140:143], v[112:115], v[28:31]
    v_mfma_f32_16x16x32_bf16 v[32:35], v[128:131], v[116:119], v[32:35]
    v_mfma_f32_16x16x32_bf16 v[36:39], v[132:135], v[116:119], v[36:39]
    v_mfma_f32_16x16x32_bf16 v[40:43], v[136:139], v[116:119], v[40:43]
    v_mfma_f32_16x16x32_bf16 v[44:47], v[140:143], v[116:119], v[44:47]
    v_mfma_f32_16x16x32_bf16 v[48:51], v[128:131], v[120:123], v[48:51]
    v_mfma_f32_16x16x32_bf16 v[52:55], v[132:135], v[120:123], v[52:55]
    v_mfma_f32_16x16x32_bf16 v[56:59], v[136:139], v[120:123], v[56:59]
    v_mfma_f32_16x16x32_bf16 v[60:63], v[140:143], v[120:123], v[60:63]
    v_mfma_f32_16x16x32_bf16 v[64:67], v[128:131], v[124:127], v[64:67]
    v_mfma_f32_16x16x32_bf16 v[68:71], v[132:135], v[124:127], v[68:71]
    v_mfma_f32_16x16x32_bf16 v[72:75], v[136:139], v[124:127], v[72:75]
    v_mfma_f32_16x16x32_bf16 v[76:79], v[140:143], v[124:127], v[76:79]
    s_add_u32 s22, s23, 8192
    buffer_load_dwordx4 v[112:115], v1, s[8:11], s22 offen offset:1024 sc1
    s_add_u32 s22, s24, 8192
    buffer_load_dwordx4 v[128:131], v1, s[8:11], s22 offen offset:1024 sc1
    s_add_u32 s22, s23, 65536
    buffer_load_dwordx4 v[116:119], v1, s[8:11], s22 offen offset:1024 sc1
    s_add_u32 s22, s24, 65536
    buffer_load_dwordx4 v[132:135], v1, s[8:11], s22 offen offset:1024 sc1
    s_add_u32 s22, s23, 122880
    buffer_load_dwordx4 v[120:123], v1, s[8:11], s22 offen offset:1024 sc1
    s_add_u32 s22, s24, 122880
    buffer_load_dwordx4 v[136:139], v1, s[8:11], s22 offen offset:1024 sc1
    s_add_u32 s22, s23, 180224
    buffer_load_dwordx4 v[124:127], v1, s[8:11], s22 offen offset:1024 sc1
    s_add_u32 s22, s24, 180224
    buffer_load_dwordx4 v[140:143], v1, s[8:11], s22 offen offset:1024 sc1
    s_nop 0
    s_waitcnt vmcnt(8)
    v_mfma_f32_16x16x32_bf16 v[16:19], v[96:99], v[80:83], v[16:19]
    v_mfma_f32_16x16x32_bf16 v[20:23], v[100:103], v[80:83], v[20:23]
    v_mfma_f32_16x16x32_bf16 v[24:27], v[104:107], v[80:83], v[24:27]
    v_mfma_f32_16x16x32_bf16 v[28:31], v[108:111], v[80:83], v[28:31]
    v_mfma_f32_16x16x32_bf16 v[32:35], v[96:99], v[84:87], v[32:35]
    v_mfma_f32_16x16x32_bf16 v[36:39], v[100:103], v[84:87], v[36:39]
    v_mfma_f32_16x16x32_bf16 v[40:43], v[104:107], v[84:87], v[40:43]
    v_mfma_f32_16x16x32_bf16 v[44:47], v[108:111], v[84:87], v[44:47]
    v_mfma_f32_16x16x32_bf16 v[48:51], v[96:99], v[88:91], v[48:51]
    v_mfma_f32_16x16x32_bf16 v[52:55], v[100:103], v[88:91], v[52:55]
    v_mfma_f32_16x16x32_bf16 v[56:59], v[104:107], v[88:91], v[56:59]
    v_mfma_f32_16x16x32_bf16 v[60:63], v[108:111], v[88:91], v[60:63]
    v_mfma_f32_16x16x32_bf16 v[64:67], v[96:99], v[92:95], v[64:67]
    v_mfma_f32_16x16x32_bf16 v[68:71], v[100:103], v[92:95], v[68:71]
    v_mfma_f32_16x16x32_bf16 v[72:75], v[104:107], v[92:95], v[72:75]
    v_mfma_f32_16x16x32_bf16 v[76:79], v[108:111], v[92:95], v[76:79]
    s_add_u32 s22, s23, 8192
    buffer_load_dwordx4 v[80:83], v1, s[8:11], s22 offen offset:2048 sc1
    s_add_u32 s22, s24, 8192
    buffer_load_dwordx4 v[96:99], v1, s[8:11], s22 offen offset:2048 sc1
    s_add_u32 s22, s23, 65536
    buffer_load_dwordx4 v[84:87], v1, s[8:11], s22 offen offset:2048 sc1
    s_add_u32 s22, s24, 65536
    buffer_load_dwordx4 v[100:103], v1, s[8:11], s22 offen offset:2048 sc1
    s_add_u32 s22, s23, 122880
    buffer_load_dwordx4 v[88:91], v1, s[8:11], s22 offen offset:2048 sc1
    s_add_u32 s22, s24, 122880
    buffer_load_dwordx4 v[104:107], v1, s[8:11], s22 offen offset:2048 sc1
    s_add_u32 s22, s23, 180224
    buffer_load_dwordx4 v[92:95], v1, s[8:11], s22 offen offset:2048 sc1
    s_add_u32 s22, s24, 180224
    buffer_load_dwordx4 v[108:111], v1, s[8:11], s22 offen offset:2048 sc1
    s_nop 0
    s_waitcnt vmcnt(8)
    v_mfma_f32_16x16x32_bf16 v[16:19], v[128:131], v[112:115], v[16:19]
    v_mfma_f32_16x16x32_bf16 v[20:23], v[132:135], v[112:115], v[20:23]
    v_mfma_f32_16x16x32_bf16 v[24:27], v[136:139], v[112:115], v[24:27]
    v_mfma_f32_16x16x32_bf16 v[28:31], v[140:143], v[112:115], v[28:31]
    v_mfma_f32_16x16x32_bf16 v[32:35], v[128:131], v[116:119], v[32:35]
    v_mfma_f32_16x16x32_bf16 v[36:39], v[132:135], v[116:119], v[36:39]
    v_mfma_f32_16x16x32_bf16 v[40:43], v[136:139], v[116:119], v[40:43]
    v_mfma_f32_16x16x32_bf16 v[44:47], v[140:143], v[116:119], v[44:47]
    v_mfma_f32_16x16x32_bf16 v[48:51], v[128:131], v[120:123], v[48:51]
    v_mfma_f32_16x16x32_bf16 v[52:55], v[132:135], v[120:123], v[52:55]
    v_mfma_f32_16x16x32_bf16 v[56:59], v[136:139], v[120:123], v[56:59]
    v_mfma_f32_16x16x32_bf16 v[60:63], v[140:143], v[120:123], v[60:63]
    v_mfma_f32_16x16x32_bf16 v[64:67], v[128:131], v[124:127], v[64:67]
    v_mfma_f32_16x16x32_bf16 v[68:71], v[132:135], v[124:127], v[68:71]
    v_mfma_f32_16x16x32_bf16 v[72:75], v[136:139], v[124:127], v[72:75]
    v_mfma_f32_16x16x32_bf16 v[76:79], v[140:143], v[124:127], v[76:79]
    s_add_u32 s22, s23, 8192
    buffer_load_dwordx4 v[112:115], v1, s[8:11], s22 offen offset:3072 sc1
    s_add_u32 s22, s24, 8192
    buffer_load_dwordx4 v[128:131], v1, s[8:11], s22 offen offset:3072 sc1
    s_add_u32 s22, s23, 65536
    buffer_load_dwordx4 v[116:119], v1, s[8:11], s22 offen offset:3072 sc1
    s_add_u32 s22, s24, 65536
    buffer_load_dwordx4 v[132:135], v1, s[8:11], s22 offen offset:3072 sc1
    s_add_u32 s22, s23, 122880
    buffer_load_dwordx4 v[120:123], v1, s[8:11], s22 offen offset:3072 sc1
    s_add_u32 s22, s24, 122880
    buffer_load_dwordx4 v[136:139], v1, s[8:11], s22 offen offset:3072 sc1
    s_add_u32 s22, s23, 180224
    buffer_load_dwordx4 v[124:127], v1, s[8:11], s22 offen offset:3072 sc1
    s_add_u32 s22, s24, 180224
    buffer_load_dwordx4 v[140:143], v1, s[8:11], s22 offen offset:3072 sc1
    s_nop 0
    s_waitcnt vmcnt(8)
    v_mfma_f32_16x16x32_bf16 v[16:19], v[96:99], v[80:83], v[16:19]
    v_mfma_f32_16x16x32_bf16 v[20:23], v[100:103], v[80:83], v[20:23]
    v_mfma_f32_16x16x32_bf16 v[24:27], v[104:107], v[80:83], v[24:27]
    v_mfma_f32_16x16x32_bf16 v[28:31], v[108:111], v[80:83], v[28:31]
    v_mfma_f32_16x16x32_bf16 v[32:35], v[96:99], v[84:87], v[32:35]
    v_mfma_f32_16x16x32_bf16 v[36:39], v[100:103], v[84:87], v[36:39]
    v_mfma_f32_16x16x32_bf16 v[40:43], v[104:107], v[84:87], v[40:43]
    v_mfma_f32_16x16x32_bf16 v[44:47], v[108:111], v[84:87], v[44:47]
    v_mfma_f32_16x16x32_bf16 v[48:51], v[96:99], v[88:91], v[48:51]
    v_mfma_f32_16x16x32_bf16 v[52:55], v[100:103], v[88:91], v[52:55]
    v_mfma_f32_16x16x32_bf16 v[56:59], v[104:107], v[88:91], v[56:59]
    v_mfma_f32_16x16x32_bf16 v[60:63], v[108:111], v[88:91], v[60:63]
    v_mfma_f32_16x16x32_bf16 v[64:67], v[96:99], v[92:95], v[64:67]
    v_mfma_f32_16x16x32_bf16 v[68:71], v[100:103], v[92:95], v[68:71]
    v_mfma_f32_16x16x32_bf16 v[72:75], v[104:107], v[92:95], v[72:75]
    v_mfma_f32_16x16x32_bf16 v[76:79], v[108:111], v[92:95], v[76:79]
    s_add_u32 s22, s23, 12288
    buffer_load_dwordx4 v[80:83], v1, s[8:11], s22 offen offset:0 sc1
    s_add_u32 s22, s24, 12288
    buffer_load_dwordx4 v[96:99], v1, s[8:11], s22 offen offset:0 sc1
    s_add_u32 s22, s23, 69632
    buffer_load_dwordx4 v[84:87], v1, s[8:11], s22 offen offset:0 sc1
    s_add_u32 s22, s24, 69632
    buffer_load_dwordx4 v[100:103], v1, s[8:11], s22 offen offset:0 sc1
    s_add_u32 s22, s23, 126976
    buffer_load_dwordx4 v[88:91], v1, s[8:11], s22 offen offset:0 sc1
    s_add_u32 s22, s24, 126976
    buffer_load_dwordx4 v[104:107], v1, s[8:11], s22 offen offset:0 sc1
    s_add_u32 s22, s23, 184320
    buffer_load_dwordx4 v[92:95], v1, s[8:11], s22 offen offset:0 sc1
    s_add_u32 s22, s24, 184320
    buffer_load_dwordx4 v[108:111], v1, s[8:11], s22 offen offset:0 sc1
    s_nop 0
    s_waitcnt vmcnt(8)
    v_mfma_f32_16x16x32_bf16 v[16:19], v[128:131], v[112:115], v[16:19]
    v_mfma_f32_16x16x32_bf16 v[20:23], v[132:135], v[112:115], v[20:23]
    v_mfma_f32_16x16x32_bf16 v[24:27], v[136:139], v[112:115], v[24:27]
    v_mfma_f32_16x16x32_bf16 v[28:31], v[140:143], v[112:115], v[28:31]
    v_mfma_f32_16x16x32_bf16 v[32:35], v[128:131], v[116:119], v[32:35]
    v_mfma_f32_16x16x32_bf16 v[36:39], v[132:135], v[116:119], v[36:39]
    v_mfma_f32_16x16x32_bf16 v[40:43], v[136:139], v[116:119], v[40:43]
    v_mfma_f32_16x16x32_bf16 v[44:47], v[140:143], v[116:119], v[44:47]
    v_mfma_f32_16x16x32_bf16 v[48:51], v[128:131], v[120:123], v[48:51]
    v_mfma_f32_16x16x32_bf16 v[52:55], v[132:135], v[120:123], v[52:55]
    v_mfma_f32_16x16x32_bf16 v[56:59], v[136:139], v[120:123], v[56:59]
    v_mfma_f32_16x16x32_bf16 v[60:63], v[140:143], v[120:123], v[60:63]
    v_mfma_f32_16x16x32_bf16 v[64:67], v[128:131], v[124:127], v[64:67]
    v_mfma_f32_16x16x32_bf16 v[68:71], v[132:135], v[124:127], v[68:71]
    v_mfma_f32_16x16x32_bf16 v[72:75], v[136:139], v[124:127], v[72:75]
    v_mfma_f32_16x16x32_bf16 v[76:79], v[140:143], v[124:127], v[76:79]
    s_add_u32 s22, s23, 12288
    buffer_load_dwordx4 v[112:115], v1, s[8:11], s22 offen offset:1024 sc1
    s_add_u32 s22, s24, 12288
    buffer_load_dwordx4 v[128:131], v1, s[8:11], s22 offen offset:1024 sc1
    s_add_u32 s22, s23, 69632
    buffer_load_dwordx4 v[116:119], v1, s[8:11], s22 offen offset:1024 sc1
    s_add_u32 s22, s24, 69632
    buffer_load_dwordx4 v[132:135], v1, s[8:11], s22 offen offset:1024 sc1
    s_add_u32 s22, s23, 126976
    buffer_load_dwordx4 v[120:123], v1, s[8:11], s22 offen offset:1024 sc1
    s_add_u32 s22, s24, 126976
    buffer_load_dwordx4 v[136:139], v1, s[8:11], s22 offen offset:1024 sc1
    s_add_u32 s22, s23, 184320
    buffer_load_dwordx4 v[124:127], v1, s[8:11], s22 offen offset:1024 sc1
    s_add_u32 s22, s24, 184320
    buffer_load_dwordx4 v[140:143], v1, s[8:11], s22 offen offset:1024 sc1
    s_nop 0
    s_waitcnt vmcnt(8)
    v_mfma_f32_16x16x32_bf16 v[16:19], v[96:99], v[80:83], v[16:19]
    v_mfma_f32_16x16x32_bf16 v[20:23], v[100:103], v[80:83], v[20:23]
    v_mfma_f32_16x16x32_bf16 v[24:27], v[104:107], v[80:83], v[24:27]
    v_mfma_f32_16x16x32_bf16 v[28:31], v[108:111], v[80:83], v[28:31]
    v_mfma_f32_16x16x32_bf16 v[32:35], v[96:99], v[84:87], v[32:35]
    v_mfma_f32_16x16x32_bf16 v[36:39], v[100:103], v[84:87], v[36:39]
    v_mfma_f32_16x16x32_bf16 v[40:43], v[104:107], v[84:87], v[40:43]
    v_mfma_f32_16x16x32_bf16 v[44:47], v[108:111], v[84:87], v[44:47]
    v_mfma_f32_16x16x32_bf16 v[48:51], v[96:99], v[88:91], v[48:51]
    v_mfma_f32_16x16x32_bf16 v[52:55], v[100:103], v[88:91], v[52:55]
    v_mfma_f32_16x16x32_bf16 v[56:59], v[104:107], v[88:91], v[56:59]
    v_mfma_f32_16x16x32_bf16 v[60:63], v[108:111], v[88:91], v[60:63]
    v_mfma_f32_16x16x32_bf16 v[64:67], v[96:99], v[92:95], v[64:67]
    v_mfma_f32_16x16x32_bf16 v[68:71], v[100:103], v[92:95], v[68:71]
    v_mfma_f32_16x16x32_bf16 v[72:75], v[104:107], v[92:95], v[72:75]
    v_mfma_f32_16x16x32_bf16 v[76:79], v[108:111], v[92:95], v[76:79]
    s_nop 0
    s_waitcnt vmcnt(0)
    v_mfma_f32_16x16x32_bf16 v[16:19], v[128:131], v[112:115], v[16:19]
    v_mfma_f32_16x16x32_bf16 v[20:23], v[132:135], v[112:115], v[20:23]
    v_mfma_f32_16x16x32_bf16 v[24:27], v[136:139], v[112:115], v[24:27]
    v_mfma_f32_16x16x32_bf16 v[28:31], v[140:143], v[112:115], v[28:31]
    v_mfma_f32_16x16x32_bf16 v[32:35], v[128:131], v[116:119], v[32:35]
    v_mfma_f32_16x16x32_bf16 v[36:39], v[132:135], v[116:119], v[36:39]
    v_mfma_f32_16x16x32_bf16 v[40:43], v[136:139], v[116:119], v[40:43]
    v_mfma_f32_16x16x32_bf16 v[44:47], v[140:143], v[116:119], v[44:47]
    v_mfma_f32_16x16x32_bf16 v[48:51], v[128:131], v[120:123], v[48:51]
    v_mfma_f32_16x16x32_bf16 v[52:55], v[132:135], v[120:123], v[52:55]
    v_mfma_f32_16x16x32_bf16 v[56:59], v[136:139], v[120:123], v[56:59]
    v_mfma_f32_16x16x32_bf16 v[60:63], v[140:143], v[120:123], v[60:63]
    v_mfma_f32_16x16x32_bf16 v[64:67], v[128:131], v[124:127], v[64:67]
    v_mfma_f32_16x16x32_bf16 v[68:71], v[132:135], v[124:127], v[68:71]
    v_mfma_f32_16x16x32_bf16 v[72:75], v[136:139], v[124:127], v[72:75]
    v_mfma_f32_16x16x32_bf16 v[76:79], v[140:143], v[124:127], v[76:79]
    v_and_b32 v3, 15, v2
    v_lshrrev_b32 v4, 4, v2
    v_mul_u32_u24 v5, 272, v3
    v_lshl_add_u32 v5, v4, 4, v5
    s_mul_i32 s22, s16, 17408
    v_add_u32 v5, s22, v5
    s_nop 3
    ds_write_b128 v5, v[16:19] offset:0
    ds_write_b128 v5, v[20:23] offset:64
    ds_write_b128 v5, v[24:27] offset:128
    ds_write_b128 v5, v[28:31] offset:192
    ds_write_b128 v5, v[32:35] offset:4352
    ds_write_b128 v5, v[36:39] offset:4416
    ds_write_b128 v5, v[40:43] offset:4480
    ds_write_b128 v5, v[44:47] offset:4544
    ds_write_b128 v5, v[48:51] offset:8704
    ds_write_b128 v5, v[52:55] offset:8768
    ds_write_b128 v5, v[56:59] offset:8832
    ds_write_b128 v5, v[60:63] offset:8896
    ds_write_b128 v5, v[64:67] offset:13056
    ds_write_b128 v5, v[68:71] offset:13120
    ds_write_b128 v5, v[72:75] offset:13184
    ds_write_b128 v5, v[76:79] offset:13248
    s_waitcnt lgkmcnt(0)
    s_barrier
    v_lshrrev_b32 v3, 3, v0
    v_and_b32 v4, 7, v0
    v_mul_u32_u24 v5, 272, v3
    v_lshl_add_u32 v5, v4, 5, v5
    v_mul_u32_u24 v6, 896, v3
    v_lshl_add_u32 v6, v4, 4, v6
    s_mul_i32 s22, s20, 57344
    s_lshl_b32 s23, s21, 7
    s_add_u32 s22, s22, s23
    s_add_u32 s22, s22, 125829120
    ds_read_b128 v[16:19], v5 offset:0
    ds_read_b128 v[20:23], v5 offset:16
    ds_read_b128 v[24:27], v5 offset:17408
    ds_read_b128 v[28:31], v5 offset:17424
    ds_read_b128 v[32:35], v5 offset:34816
    ds_read_b128 v[36:39], v5 offset:34832
    ds_read_b128 v[40:43], v5 offset:52224
    ds_read_b128 v[44:47], v5 offset:52240
    ds_read_b128 v[48:51], v5 offset:8704
    ds_read_b128 v[52:55], v5 offset:8720
    ds_read_b128 v[56:59], v5 offset:26112
    ds_read_b128 v[60:63], v5 offset:26128
    ds_read_b128 v[64:67], v5 offset:43520
    ds_read_b128 v[68:71], v5 offset:43536
    ds_read_b128 v[72:75], v5 offset:60928
    ds_read_b128 v[76:79], v5 offset:60944
    s_nop 0
    s_waitcnt lgkmcnt(8)
    v_pk_add_f32 v[16:17], v[16:17], v[24:25]
    v_pk_add_f32 v[32:33], v[32:33], v[40:41]
    v_pk_add_f32 v[16:17], v[16:17], v[32:33]
    v_pk_add_f32 v[18:19], v[18:19], v[26:27]
    v_pk_add_f32 v[34:35], v[34:35], v[42:43]
    v_pk_add_f32 v[18:19], v[18:19], v[34:35]
    v_pk_add_f32 v[20:21], v[20:21], v[28:29]
    v_pk_add_f32 v[36:37], v[36:37], v[44:45]
    v_pk_add_f32 v[20:21], v[20:21], v[36:37]
    v_pk_add_f32 v[22:23], v[22:23], v[30:31]
    v_pk_add_f32 v[38:39], v[38:39], v[46:47]
    v_pk_add_f32 v[22:23], v[22:23], v[38:39]
    v_cvt_pk_bf16_f32 v8, v16, v17
    v_cvt_pk_bf16_f32 v9, v18, v19
    v_cvt_pk_bf16_f32 v10, v20, v21
    v_cvt_pk_bf16_f32 v11, v22, v23
    s_add_u32 s23, s22, 0
    s_nop 0
    buffer_store_dwordx4 v[8:11], v6, s[8:11], s23 offen sc1
    s_nop 0
    s_waitcnt lgkmcnt(0)
    v_pk_add_f32 v[48:49], v[48:49], v[56:57]
    v_pk_add_f32 v[64:65], v[64:65], v[72:73]
    v_pk_add_f32 v[48:49], v[48:49], v[64:65]
    v_pk_add_f32 v[50:51], v[50:51], v[58:59]
    v_pk_add_f32 v[66:67], v[66:67], v[74:75]
    v_pk_add_f32 v[50:51], v[50:51], v[66:67]
    v_pk_add_f32 v[52:53], v[52:53], v[60:61]
    v_pk_add_f32 v[68:69], v[68:69], v[76:77]
    v_pk_add_f32 v[52:53], v[52:53], v[68:69]
    v_pk_add_f32 v[54:55], v[54:55], v[62:63]
    v_pk_add_f32 v[70:71], v[70:71], v[78:79]
    v_pk_add_f32 v[54:55], v[54:55], v[70:71]
    v_cvt_pk_bf16_f32 v12, v48, v49
    v_cvt_pk_bf16_f32 v13, v50, v51
    v_cvt_pk_bf16_f32 v14, v52, v53
    v_cvt_pk_bf16_f32 v15, v54, v55
    s_add_u32 s23, s22, 28672
    buffer_store_dwordx4 v[12:15], v6, s[8:11], s23 offen sc1
    s_waitcnt vmcnt(0)
    s_barrier
    s_cmp_lg_u32 s16, 0
    s_cbranch_scc1 SIG_8
    s_add_u32 s68, s65, 85132416
    s_mov_b64 exec, 1
    v_mov_b32 v254, 0
    v_mov_b32_e64 v255, 1
    buffer_atomic_add v255, v254, s[8:11], s68 offen
    s_mov_b64 exec, -1
    s_nop 0
SIG_8:
    s_cmp_ge_u32 s64, 200
    s_cbranch_scc1 CH_DONE
    s_lshr_b32 s17, s64, 1
    s_and_b32 s18, s64, 1
    s_mov_b32 s19, 0
    s_mov_b32 s28, 4
    s_mul_i32 s71, s17, 0
    s_lshr_b32 s71, s71, 4
    s_add_u32 s71, s71, 0
    s_cmp_lt_u32 s64, 104
    s_cbranch_scc1 WK_FIN
    s_nop 0
    s_sub_u32 s66, s64, 104
    s_lshr_b32 s17, s66, 3
    s_add_u32 s17, s17, 52
    s_bfe_u32 s18, s66, 0x10002
    s_and_b32 s19, s66, 3
    s_add_u32 s28, s19, 1
    s_sub_u32 s71, s17, 8
    s_nop 0
WK_FIN:
    s_lshr_b32 s65, s17, 3
    s_lshl_b32 s65, s65, 7
    v_mov_b32_e64 v253, 0
    s_add_u32 s30, s65, 85132416
    s_mov_b32 s27, 0
    s_nop 0
WK_W2:
    buffer_load_dword v254, v253, s[8:11], s30 offen sc1
    s_add_u32 s27, s27, 1
    s_nop 0
    s_cmp_gt_u32 s27, 65536
    s_cbranch_scc1 CH_FAIL
    s_waitcnt vmcnt(0)
    v_cmp_le_u32 vcc, 28, v254
    s_cbranch_vccnz WK_W2_OK
    s_sleep 4
    s_branch WK_W2
WK_W2_OK:
    v_mov_b32_e64 v253, 0
    s_mov_b32 s68, 85133568
    s_mov_b32 s27, 0
    s_nop 0
WK_WT:
    buffer_load_dword v254, v253, s[8:11], s68 offen sc1
    s_add_u32 s27, s27, 1
    s_nop 0
    s_cmp_gt_u32 s27, 65536
    s_cbranch_scc1 CH_FAIL
    s_waitcnt vmcnt(0)
    v_cmp_le_u32 vcc, s71, v254
    s_cbranch_vccnz WK_WT_OK
    s_sleep 100
    s_branch WK_WT
WK_WT_OK:
    v_and_b32 v2, 63, v0
    v_lshlrev_b32 v1, 4, v2
    v_and_b32 v3, 15, v2
    v_lshrrev_b32 v4, 4, v2
    v_mov_b32 v5, 0x4444
    v_mov_b32 v6, 0xeeee
    v_and_b32 v7, 8, v2
    v_cmp_ne_u32 vcc, 0, v7
    s_nop 1
    v_cndmask_b32 v5, v5, v6, vcc
    s_mul_i32 s20, s17, 28672
    s_add_u32 s20, s20, 0
    s_nop 0
    buffer_load_dwordx4 v[24:27], v1, s[8:11], s20 offen offset:0 sc1
    buffer_load_dwordx4 v[28:31], v1, s[8:11], s20 offen offset:1024 sc1
    buffer_load_dwordx4 v[32:35], v1, s[8:11], s20 offen offset:2048 sc1
    buffer_load_dwordx4 v[36:39], v1, s[8:11], s20 offen offset:3072 sc1
    s_add_u32 s20, s20, 4096
    buffer_load_dwordx4 v[40:43], v1, s[8:11], s20 offen offset:0 sc1
    buffer_load_dwordx4 v[44:47], v1, s[8:11], s20 offen offset:1024 sc1
    buffer_load_dwordx4 v[48:51], v1, s[8:11], s20 offen offset:2048 sc1
    buffer_load_dwordx4 v[52:55], v1, s[8:11], s20 offen offset:3072 sc1
    s_add_u32 s20, s20, 4096
    buffer_load_dwordx4 v[56:59], v1, s[8:11], s20 offen offset:0 sc1
    buffer_load_dwordx4 v[60:63], v1, s[8:11], s20 offen offset:1024 sc1
    buffer_load_dwordx4 v[64:67], v1, s[8:11], s20 offen offset:2048 sc1
    buffer_load_dwordx4 v[68:71], v1, s[8:11], s20 offen offset:3072 sc1
    s_add_u32 s20, s20, 4096
    buffer_load_dwordx4 v[72:75], v1, s[8:11], s20 offen offset:0 sc1
    buffer_load_dwordx4 v[76:79], v1, s[8:11], s20 offen offset:1024 sc1
    buffer_load_dwordx4 v[80:83], v1, s[8:11], s20 offen offset:2048 sc1
    buffer_load_dwordx4 v[84:87], v1, s[8:11], s20 offen offset:3072 sc1
    s_add_u32 s20, s20, 4096
    buffer_load_dwordx4 v[88:91], v1, s[8:11], s20 offen offset:0 sc1
    buffer_load_dwordx4 v[92:95], v1, s[8:11], s20 offen offset:1024 sc1
    buffer_load_dwordx4 v[96:99], v1, s[8:11], s20 offen offset:2048 sc1
    buffer_load_dwordx4 v[100:103], v1, s[8:11], s20 offen offset:3072 sc1
    s_add_u32 s20, s20, 4096
    buffer_load_dwordx4 v[104:107], v1, s[8:11], s20 offen offset:0 sc1
    buffer_load_dwordx4 v[108:111], v1, s[8:11], s20 offen offset:1024 sc1
    buffer_load_dwordx4 v[112:115], v1, s[8:11], s20 offen offset:2048 sc1
    buffer_load_dwordx4 v[116:119], v1, s[8:11], s20 offen offset:3072 sc1
    s_add_u32 s20, s20, 4096
    buffer_load_dwordx4 v[120:123], v1, s[8:11], s20 offen offset:0 sc1
    buffer_load_dwordx4 v[124:127], v1, s[8:11], s20 offen offset:1024 sc1
    buffer_load_dwordx4 v[128:131], v1, s[8:11], s20 offen offset:2048 sc1
    buffer_load_dwordx4 v[132:135], v1, s[8:11], s20 offen offset:3072 sc1
    s_lshl_b32 s21, s17, 4
    s_lshl_b32 s22, s16, 2
    s_add_u32 s21, s21, s22
    s_lshl_b32 s22, s21, 1
    s_add_u32 s22, s22, s18
    s_nop 0
    s_mul_i32 s22, s22, 14336
    s_add_u32 s22, s22, 16777216
    s_add_u32 s20, s22, 0
    s_nop 0
    buffer_load_dwordx4 a[0:3], v1, s[8:11], s20 offen offset:0 sc1
    buffer_load_dwordx4 a[4:7], v1, s[8:11], s20 offen offset:1024 sc1
    buffer_load_dwordx4 a[8:11], v1, s[8:11], s20 offen offset:2048 sc1
    buffer_load_dwordx4 a[12:15], v1, s[8:11], s20 offen offset:3072 sc1
    s_add_u32 s20, s22, 4096
    buffer_load_dwordx4 a[16:19], v1, s[8:11], s20 offen offset:0 sc1
    buffer_load_dwordx4 a[20:23], v1, s[8:11], s20 offen offset:1024 sc1
    buffer_load_dwordx4 a[24:27], v1, s[8:11], s20 offen offset:2048 sc1
    buffer_load_dwordx4 a[28:31], v1, s[8:11], s20 offen offset:3072 sc1
    s_add_u32 s20, s22, 8192
    buffer_load_dwordx4 a[32:35], v1, s[8:11], s20 offen offset:0 sc1
    buffer_load_dwordx4 a[36:39], v1, s[8:11], s20 offen offset:1024 sc1
    buffer_load_dwordx4 a[40:43], v1, s[8:11], s20 offen offset:2048 sc1
    buffer_load_dwordx4 a[44:47], v1, s[8:11], s20 offen offset:3072 sc1
    s_add_u32 s20, s22, 12288
    buffer_load_dwordx4 a[48:51], v1, s[8:11], s20 offen offset:0 sc1
    buffer_load_dwordx4 a[52:55], v1, s[8:11], s20 offen offset:1024 sc1
    s_add_u32 s20, s22, 28672
    buffer_load_dwordx4 a[56:59], v1, s[8:11], s20 offen offset:0 sc1
    buffer_load_dwordx4 a[60:63], v1, s[8:11], s20 offen offset:1024 sc1
    buffer_load_dwordx4 a[64:67], v1, s[8:11], s20 offen offset:2048 sc1
    buffer_load_dwordx4 a[68:71], v1, s[8:11], s20 offen offset:3072 sc1
    s_add_u32 s20, s22, 32768
    buffer_load_dwordx4 a[72:75], v1, s[8:11], s20 offen offset:0 sc1
    buffer_load_dwordx4 a[76:79], v1, s[8:11], s20 offen offset:1024 sc1
    buffer_load_dwordx4 a[80:83], v1, s[8:11], s20 offen offset:2048 sc1
    buffer_load_dwordx4 a[84:87], v1, s[8:11], s20 offen offset:3072 sc1
    s_add_u32 s20, s22, 36864
    buffer_load_dwordx4 a[88:91], v1, s[8:11], s20 offen offset:0 sc1
    buffer_load_dwordx4 a[92:95], v1, s[8:11], s20 offen offset:1024 sc1
    buffer_load_dwordx4 a[96:99], v1, s[8:11], s20 offen offset:2048 sc1
    buffer_load_dwordx4 a[100:103], v1, s[8:11], s20 offen offset:3072 sc1
    s_add_u32 s20, s22, 40960
    buffer_load_dwordx4 a[104:107], v1, s[8:11], s20 offen offset:0 sc1
    buffer_load_dwordx4 a[108:111], v1, s[8:11], s20 offen offset:1024 sc1
    s_lshl_b32 s20, s18, 4
    v_add_u32 v6, s20, v3
    v_lshlrev_b32 v7, 2, v4
    v_add_u32 v8, 0, v7
    v_cmp_le_u32 s[40:41], v8, v6
    v_add_u32_e64 v8, 1, v7
    v_cmp_le_u32 s[42:43], v8, v6
    v_add_u32_e64 v8, 2, v7
    v_cmp_le_u32 s[44:45], v8, v6
    v_add_u32_e64 v8, 3, v7
    v_cmp_le_u32 s[46:47], v8, v6
    v_add_u32_e64 v8, 16, v7
    v_cmp_le_u32 s[48:49], v8, v6
    v_add_u32_e64 v8, 17, v7
    v_cmp_le_u32 s[50:51], v8, v6
    v_add_u32_e64 v8, 18, v7
    v_cmp_le_u32 s[52:53], v8, v6
    v_add_u32_e64 v8, 19, v7
    v_cmp_le_u32 s[54:55], v8, v6
    v_mov_b32 v10, 0xf149f2ca
    v_mov_b32 v196, 0
    v_mov_b32 v197, 0
    v_mov_b32 v198, 0
    v_mov_b32 v199, 0
    v_mov_b32 v200, 0
    v_mov_b32 v201, 0
    v_mov_b32 v202, 0
    v_mov_b32 v203, 0
    v_mov_b32 v204, 0
    v_mov_b32 v205, 0
    v_mov_b32 v206, 0
    v_mov_b32 v207, 0
    v_mov_b32 v208, 0
    v_mov_b32 v209, 0
    v_mov_b32_e64 v210, 0
    v_mov_b32 v211, 0
    s_waitcnt vmcnt(14)
    s_add_u32 s20, s22, 57344
    buffer_load_dwordx4 a[112:115], v1, s[8:11], s20 offen offset:0 sc1
    buffer_load_dwordx4 a[116:119], v1, s[8:11], s20 offen offset:1024 sc1
    buffer_load_dwordx4 a[120:123], v1, s[8:11], s20 offen offset:2048 sc1
    buffer_load_dwordx4 a[124:127], v1, s[8:11], s20 offen offset:3072 sc1
    s_add_u32 s20, s22, 61440
    buffer_load_dwordx4 a[128:131], v1, s[8:11], s20 offen offset:0 sc1
    buffer_load_dwordx4 a[132:135], v1, s[8:11], s20 offen offset:1024 sc1
    buffer_load_dwordx4 a[136:139], v1, s[8:11], s20 offen offset:2048 sc1
    buffer_load_dwordx4 a[140:143], v1, s[8:11], s20 offen offset:3072 sc1
    s_add_u32 s20, s22, 65536
    buffer_load_dwordx4 a[144:147], v1, s[8:11], s20 offen offset:0 sc1
    buffer_load_dwordx4 a[148:151], v1, s[8:11], s20 offen offset:1024 sc1
    buffer_load_dwordx4 a[152:155], v1, s[8:11], s20 offen offset:2048 sc1
    buffer_load_dwordx4 a[156:159], v1, s[8:11], s20 offen offset:3072 sc1
    s_add_u32 s20, s22, 69632
    buffer_load_dwordx4 a[160:163], v1, s[8:11], s20 offen offset:0 sc1
    buffer_load_dwordx4 a[164:167], v1, s[8:11], s20 offen offset:1024 sc1
    v_mfma_f32_16x16x32_bf16 v[136:139], v[24:27], a[0:3], 0
    v_mfma_f32_16x16x32_bf16 v[140:143], v[80:83], a[0:3], 0
    v_mfma_f32_16x16x32_bf16 v[136:139], v[28:31], a[4:7], v[136:139]
    v_mfma_f32_16x16x32_bf16 v[140:143], v[84:87], a[4:7], v[140:143]
    v_mfma_f32_16x16x32_bf16 v[136:139], v[32:35], a[8:11], v[136:139]
    v_mfma_f32_16x16x32_bf16 v[140:143], v[88:91], a[8:11], v[140:143]
    v_mfma_f32_16x16x32_bf16 v[136:139], v[36:39], a[12:15], v[136:139]
    v_mfma_f32_16x16x32_bf16 v[140:143], v[92:95], a[12:15], v[140:143]
    v_mfma_f32_16x16x32_bf16 v[136:139], v[40:43], a[16:19], v[136:139]
    v_mfma_f32_16x16x32_bf16 v[140:143], v[96:99], a[16:19], v[140:143]
    v_mfma_f32_16x16x32_bf16 v[136:139], v[44:47], a[20:23], v[136:139]
    v_mfma_f32_16x16x32_bf16 v[140:143], v[100:103], a[20:23], v[140:143]
    v_mfma_f32_16x16x32_bf16 v[136:139], v[48:51], a[24:27], v[136:139]
    v_mfma_f32_16x16x32_bf16 v[140:143], v[104:107], a[24:27], v[140:143]
    v_mfma_f32_16x16x32_bf16 v[136:139], v[52:55], a[28:31], v[136:139]
    v_mfma_f32_16x16x32_bf16 v[140:143], v[108:111], a[28:31], v[140:143]
    v_mfma_f32_16x16x32_bf16 v[136:139], v[56:59], a[32:35], v[136:139]
    v_mfma_f32_16x16x32_bf16 v[140:143], v[112:115], a[32:35], v[140:143]
    v_mfma_f32_16x16x32_bf16 v[136:139], v[60:63], a[36:39], v[136:139]
    v_mfma_f32_16x16x32_bf16 v[140:143], v[116:119], a[36:39], v[140:143]
    v_mfma_f32_16x16x32_bf16 v[136:139], v[64:67], a[40:43], v[136:139]
    v_mfma_f32_16x16x32_bf16 v[140:143], v[120:123], a[40:43], v[140:143]
    v_mfma_f32_16x16x32_bf16 v[136:139], v[68:71], a[44:47], v[136:139]
    v_mfma_f32_16x16x32_bf16 v[140:143], v[124:127], a[44:47], v[140:143]
    v_mfma_f32_16x16x32_bf16 v[136:139], v[72:75], a[48:51], v[136:139]
    v_mfma_f32_16x16x32_bf16 v[140:143], v[128:131], a[48:51], v[140:143]
    v_mfma_f32_16x16x32_bf16 v[136:139], v[76:79], a[52:55], v[136:139]
    v_mfma_f32_16x16x32_bf16 v[140:143], v[132:135], a[52:55], v[140:143]
    s_nop 0
    s_waitcnt vmcnt(14)
    s_add_u32 s20, s22, 86016
    buffer_load_dwordx4 a[168:171], v1, s[8:11], s20 offen offset:0 sc1
    buffer_load_dwordx4 a[172:175], v1, s[8:11], s20 offen offset:1024 sc1
    buffer_load_dwordx4 a[176:179], v1, s[8:11], s20 offen offset:2048 sc1
    buffer_load_dwordx4 a[180:183], v1, s[8:11], s20 offen offset:3072 sc1
    s_add_u32 s20, s22, 90112
    buffer_load_dwordx4 a[184:187], v1, s[8:11], s20 offen offset:0 sc1
    buffer_load_dwordx4 a[188:191], v1, s[8:11], s20 offen offset:1024 sc1
    buffer_load_dwordx4 a[192:195], v1, s[8:11], s20 offen offset:2048 sc1
    buffer_load_dwordx4 a[196:199], v1, s[8:11], s20 offen offset:3072 sc1
    s_add_u32 s20, s22, 94208
    buffer_load_dwordx4 a[200:203], v1, s[8:11], s20 offen offset:0 sc1
    buffer_load_dwordx4 a[204:207], v1, s[8:11], s20 offen offset:1024 sc1
    buffer_load_dwordx4 a[208:211], v1, s[8:11], s20 offen offset:2048 sc1
    buffer_load_dwordx4 a[212:215], v1, s[8:11], s20 offen offset:3072 sc1
    s_add_u32 s20, s22, 98304
    buffer_load_dwordx4 a[216:219], v1, s[8:11], s20 offen offset:0 sc1
    buffer_load_dwordx4 a[220:223], v1, s[8:11], s20 offen offset:1024 sc1
    v_mfma_f32_16x16x32_bf16 v[144:147], v[24:27], a[56:59], 0
    v_mfma_f32_16x16x32_bf16 v[148:151], v[80:83], a[56:59], 0
    v_mfma_f32_16x16x32_bf16 v[144:147], v[28:31], a[60:63], v[144:147]
    v_mfma_f32_16x16x32_bf16 v[148:151], v[84:87], a[60:63], v[148:151]
    v_mfma_f32_16x16x32_bf16 v[144:147], v[32:35], a[64:67], v[144:147]
    v_mfma_f32_16x16x32_bf16 v[148:151], v[88:91], a[64:67], v[148:151]
    v_mfma_f32_16x16x32_bf16 v[144:147], v[36:39], a[68:71], v[144:147]
    v_mfma_f32_16x16x32_bf16 v[148:151], v[92:95], a[68:71], v[148:151]
    v_mfma_f32_16x16x32_bf16 v[144:147], v[40:43], a[72:75], v[144:147]
    v_mfma_f32_16x16x32_bf16 v[148:151], v[96:99], a[72:75], v[148:151]
    v_mfma_f32_16x16x32_bf16 v[144:147], v[44:47], a[76:79], v[144:147]
    v_mfma_f32_16x16x32_bf16 v[148:151], v[100:103], a[76:79], v[148:151]
    v_mfma_f32_16x16x32_bf16 v[144:147], v[48:51], a[80:83], v[144:147]
    v_mfma_f32_16x16x32_bf16 v[148:151], v[104:107], a[80:83], v[148:151]
    v_mfma_f32_16x16x32_bf16 v[144:147], v[52:55], a[84:87], v[144:147]
    v_mfma_f32_16x16x32_bf16 v[148:151], v[108:111], a[84:87], v[148:151]
    v_mfma_f32_16x16x32_bf16 v[144:147], v[56:59], a[88:91], v[144:147]
    v_mfma_f32_16x16x32_bf16 v[148:151], v[112:115], a[88:91], v[148:151]
    v_mfma_f32_16x16x32_bf16 v[144:147], v[60:63], a[92:95], v[144:147]
    v_mfma_f32_16x16x32_bf16 v[148:151], v[116:119], a[92:95], v[148:151]
    v_mfma_f32_16x16x32_bf16 v[144:147], v[64:67], a[96:99], v[144:147]
    v_mfma_f32_16x16x32_bf16 v[148:151], v[120:123], a[96:99], v[148:151]
    v_mfma_f32_16x16x32_bf16 v[144:147], v[68:71], a[100:103], v[144:147]
    v_mfma_f32_16x16x32_bf16 v[148:151], v[124:127], a[100:103], v[148:151]
    v_mfma_f32_16x16x32_bf16 v[144:147], v[72:75], a[104:107], v[144:147]
    v_mfma_f32_16x16x32_bf16 v[148:151], v[128:131], a[104:107], v[148:151]
    v_mfma_f32_16x16x32_bf16 v[144:147], v[76:79], a[108:111], v[144:147]
    v_mfma_f32_16x16x32_bf16 v[148:151], v[132:135], a[108:111], v[148:151]
    s_nop 0
    s_waitcnt vmcnt(14)
    v_mfma_f32_16x16x32_bf16 v[152:155], v[24:27], a[112:115], 0
    v_mfma_f32_16x16x32_bf16 v[156:159], v[80:83], a[112:115], 0
    v_mfma_f32_16x16x32_bf16 v[152:155], v[28:31], a[116:119], v[152:155]
    v_mfma_f32_16x16x32_bf16 v[156:159], v[84:87], a[116:119], v[156:159]
    v_mfma_f32_16x16x32_bf16 v[152:155], v[32:35], a[120:123], v[152:155]
    v_mfma_f32_16x16x32_bf16 v[156:159], v[88:91], a[120:123], v[156:159]
    v_mfma_f32_16x16x32_bf16 v[152:155], v[36:39], a[124:127], v[152:155]
    v_mfma_f32_16x16x32_bf16 v[156:159], v[92:95], a[124:127], v[156:159]
    v_mfma_f32_16x16x32_bf16 v[152:155], v[40:43], a[128:131], v[152:155]
    v_mfma_f32_16x16x32_bf16 v[156:159], v[96:99], a[128:131], v[156:159]
    v_mfma_f32_16x16x32_bf16 v[152:155], v[44:47], a[132:135], v[152:155]
    v_mfma_f32_16x16x32_bf16 v[156:159], v[100:103], a[132:135], v[156:159]
    v_mfma_f32_16x16x32_bf16 v[152:155], v[48:51], a[136:139], v[152:155]
    v_mfma_f32_16x16x32_bf16 v[156:159], v[104:107], a[136:139], v[156:159]
    v_mfma_f32_16x16x32_bf16 v[152:155], v[52:55], a[140:143], v[152:155]
    v_mfma_f32_16x16x32_bf16 v[156:159], v[108:111], a[140:143], v[156:159]
    v_mfma_f32_16x16x32_bf16 v[152:155], v[56:59], a[144:147], v[152:155]
    v_mfma_f32_16x16x32_bf16 v[156:159], v[112:115], a[144:147], v[156:159]
    v_mfma_f32_16x16x32_bf16 v[152:155], v[60:63], a[148:151], v[152:155]
    v_mfma_f32_16x16x32_bf16 v[156:159], v[116:119], a[148:151], v[156:159]
    v_mfma_f32_16x16x32_bf16 v[152:155], v[64:67], a[152:155], v[152:155]
    v_mfma_f32_16x16x32_bf16 v[156:159], v[120:123], a[152:155], v[156:159]
    v_mfma_f32_16x16x32_bf16 v[152:155], v[68:71], a[156:159], v[152:155]
    v_mfma_f32_16x16x32_bf16 v[156:159], v[124:127], a[156:159], v[156:159]
    v_mfma_f32_16x16x32_bf16 v[152:155], v[72:75], a[160:163], v[152:155]
    v_mfma_f32_16x16x32_bf16 v[156:159], v[128:131], a[160:163], v[156:159]
    v_mfma_f32_16x16x32_bf16 v[152:155], v[76:79], a[164:167], v[152:155]
    v_mfma_f32_16x16x32_bf16 v[156:159], v[132:135], a[164:167], v[156:159]
    s_nop 0
    s_waitcnt vmcnt(0)
    v_mfma_f32_16x16x32_bf16 v[160:163], v[24:27], a[168:171], 0
    v_mfma_f32_16x16x32_bf16 v[164:167], v[80:83], a[168:171], 0
    v_mfma_f32_16x16x32_bf16 v[160:163], v[28:31], a[172:175], v[160:163]
    v_mfma_f32_16x16x32_bf16 v[164:167], v[84:87], a[172:175], v[164:167]
    v_mfma_f32_16x16x32_bf16 v[160:163], v[32:35], a[176:179], v[160:163]
    v_mfma_f32_16x16x32_bf16 v[164:167], v[88:91], a[176:179], v[164:167]
    v_mfma_f32_16x16x32_bf16 v[160:163], v[36:39], a[180:183], v[160:163]
    v_mfma_f32_16x16x32_bf16 v[164:167], v[92:95], a[180:183], v[164:167]
    v_mfma_f32_16x16x32_bf16 v[160:163], v[40:43], a[184:187], v[160:163]
    v_mfma_f32_16x16x32_bf16 v[164:167], v[96:99], a[184:187], v[164:167]
    v_mfma_f32_16x16x32_bf16 v[160:163], v[44:47], a[188:191], v[160:163]
    v_mfma_f32_16x16x32_bf16 v[164:167], v[100:103], a[188:191], v[164:167]
    v_mfma_f32_16x16x32_bf16 v[160:163], v[48:51], a[192:195], v[160:163]
    v_mfma_f32_16x16x32_bf16 v[164:167], v[104:107], a[192:195], v[164:167]
    v_mfma_f32_16x16x32_bf16 v[160:163], v[52:55], a[196:199], v[160:163]
    v_mfma_f32_16x16x32_bf16 v[164:167], v[108:111], a[196:199], v[164:167]
    v_mfma_f32_16x16x32_bf16 v[160:163], v[56:59], a[200:203], v[160:163]
    v_mfma_f32_16x16x32_bf16 v[164:167], v[112:115], a[200:203], v[164:167]
    v_mfma_f32_16x16x32_bf16 v[160:163], v[60:63], a[204:207], v[160:163]
    v_mfma_f32_16x16x32_bf16 v[164:167], v[116:119], a[204:207], v[164:167]
    v_mfma_f32_16x16x32_bf16 v[160:163], v[64:67], a[208:211], v[160:163]
    v_mfma_f32_16x16x32_bf16 v[164:167], v[120:123], a[208:211], v[164:167]
    v_mfma_f32_16x16x32_bf16 v[160:163], v[68:71], a[212:215], v[160:163]
    v_mfma_f32_16x16x32_bf16 v[164:167], v[124:127], a[212:215], v[164:167]
    v_mfma_f32_16x16x32_bf16 v[160:163], v[72:75], a[216:219], v[160:163]
    v_mfma_f32_16x16x32_bf16 v[164:167], v[128:131], a[216:219], v[164:167]
    v_mfma_f32_16x16x32_bf16 v[160:163], v[76:79], a[220:223], v[160:163]
    v_mfma_f32_16x16x32_bf16 v[164:167], v[132:135], a[220:223], v[164:167]
    s_mov_b32 s23, 306783379
    v_min_u32 v6, 223, v0
    v_mul_hi_u32 v7, v6, s23
    v_mul_u32_u24 v8, 14, v7
    v_sub_u32 v6, v6, v8
    v_mul_u32_u24 v11, 464, v7
    v_lshl_add_u32 v11, v6, 5, v11
    v_mul_u32_u24 v12, 896, v7
    v_lshl_add_u32 v12, v6, 4, v12
    s_mul_i32 s23, s19, 7168
    s_mul_i32 s24, s21, 28672
    s_add_u32 s24, s24, s23
    s_nop 0
    s_add_u32 s24, s24, 50331648
    s_lshl_b32 s25, s17, 2
    s_add_u32 s25, s25, s16
    s_mul_i32 s25, s25, 28672
    s_add_u32 s25, s25, s23
    s_nop 0
    s_add_u32 s25, s25, 117571584
    s_add_u32 s20, s24, 0
    s_nop 0
    buffer_load_dwordx4 v[24:27], v1, s[8:11], s20 offen offset:0 sc1
    buffer_load_dwordx4 v[40:43], v1, s[8:11], s20 offen offset:1024 sc1
    buffer_load_dwordx4 v[56:59], v1, s[8:11], s20 offen offset:2048 sc1
    buffer_load_dwordx4 v[72:75], v1, s[8:11], s20 offen offset:3072 sc1
    s_add_u32 s20, s24, 4096
    buffer_load_dwordx4 v[88:91], v1, s[8:11], s20 offen offset:0 sc1
    buffer_load_dwordx4 v[104:107], v1, s[8:11], s20 offen offset:1024 sc1
    buffer_load_dwordx4 v[120:123], v1, s[8:11], s20 offen offset:2048 sc1
    s_add_u32 s20, s24, 28672
    buffer_load_dwordx4 v[28:31], v1, s[8:11], s20 offen offset:0 sc1
    buffer_load_dwordx4 v[44:47], v1, s[8:11], s20 offen offset:1024 sc1
    buffer_load_dwordx4 v[60:63], v1, s[8:11], s20 offen offset:2048 sc1
    buffer_load_dwordx4 v[76:79], v1, s[8:11], s20 offen offset:3072 sc1
    s_add_u32 s20, s24, 32768
    buffer_load_dwordx4 v[92:95], v1, s[8:11], s20 offen offset:0 sc1
    buffer_load_dwordx4 v[108:111], v1, s[8:11], s20 offen offset:1024 sc1
    buffer_load_dwordx4 v[124:127], v1, s[8:11], s20 offen offset:2048 sc1
    s_add_u32 s20, s24, 57344
    buffer_load_dwordx4 v[32:35], v1, s[8:11], s20 offen offset:0 sc1
    buffer_load_dwordx4 v[48:51], v1, s[8:11], s20 offen offset:1024 sc1
    buffer_load_dwordx4 v[64:67], v1, s[8:11], s20 offen offset:2048 sc1
    buffer_load_dwordx4 v[80:83], v1, s[8:11], s20 offen offset:3072 sc1
    s_add_u32 s20, s24, 61440
    buffer_load_dwordx4 v[96:99], v1, s[8:11], s20 offen offset:0 sc1
    buffer_load_dwordx4 v[112:115], v1, s[8:11], s20 offen offset:1024 sc1
    buffer_load_dwordx4 v[128:131], v1, s[8:11], s20 offen offset:2048 sc1
    s_add_u32 s20, s24, 86016
    buffer_load_dwordx4 v[36:39], v1, s[8:11], s20 offen offset:0 sc1
    buffer_load_dwordx4 v[52:55], v1, s[8:11], s20 offen offset:1024 sc1
    buffer_load_dwordx4 v[68:71], v1, s[8:11], s20 offen offset:2048 sc1
    buffer_load_dwordx4 v[84:87], v1, s[8:11], s20 offen offset:3072 sc1
    s_add_u32 s20, s24, 90112
    buffer_load_dwordx4 v[100:103], v1, s[8:11], s20 offen offset:0 sc1
    buffer_load_dwordx4 v[116:119], v1, s[8:11], s20 offen offset:1024 sc1
    buffer_load_dwordx4 v[132:135], v1, s[8:11], s20 offen offset:2048 sc1
    s_lshl_b32 s26, s17, 5
    s_lshl_b32 s20, s18, 4
    s_add_u32 s26, s26, s20
    s_nop 0
    s_mul_i32 s26, s26, 896
    s_mul_i32 s20, s19, 224
    s_add_u32 s26, s26, s20
    s_nop 0
    s_add_u32 s20, s26, 125829120
    buffer_load_dwordx4 v[16:19], v12, s[56:59], s26 offen
    buffer_load_dwordx4 v[20:23], v12, s[8:11], s20 offen sc1
    v_cndmask_b32 v136, v10, v136, s[40:41]
    v_cndmask_b32 v137, v10, v137, s[42:43]
    v_cndmask_b32 v138, v10, v138, s[44:45]
    v_cndmask_b32 v139, v10, v139, s[46:47]
    v_cndmask_b32 v140, v10, v140, s[48:49]
    v_cndmask_b32 v141, v10, v141, s[50:51]
    v_cndmask_b32 v142, v10, v142, s[52:53]
    v_cndmask_b32 v143, v10, v143, s[54:55]
    v_cndmask_b32 v144, v10, v144, s[40:41]
    v_cndmask_b32 v145, v10, v145, s[42:43]
    v_cndmask_b32 v146, v10, v146, s[44:45]
    v_cndmask_b32 v147, v10, v147, s[46:47]
    v_cndmask_b32 v148, v10, v148, s[48:49]
    v_cndmask_b32 v149, v10, v149, s[50:51]
    v_cndmask_b32 v150, v10, v150, s[52:53]
    v_cndmask_b32 v151, v10, v151, s[54:55]
    v_cndmask_b32 v152, v10, v152, s[40:41]
    v_cndmask_b32 v153, v10, v153, s[42:43]
    v_cndmask_b32 v154, v10, v154, s[44:45]
    v_cndmask_b32 v155, v10, v155, s[46:47]
    v_cndmask_b32 v156, v10, v156, s[48:49]
    v_cndmask_b32 v157, v10, v157, s[50:51]
    v_cndmask_b32 v158, v10, v158, s[52:53]
    v_cndmask_b32 v159, v10, v159, s[54:55]
    v_cndmask_b32 v160, v10, v160, s[40:41]
    v_cndmask_b32 v161, v10, v161, s[42:43]
    v_cndmask_b32 v162, v10, v162, s[44:45]
    v_cndmask_b32 v163, v10, v163, s[46:47]
    v_cndmask_b32 v164, v10, v164, s[48:49]
    v_cndmask_b32 v165, v10, v165, s[50:51]
    v_cndmask_b32 v166, v10, v166, s[52:53]
    v_cndmask_b32 v167, v10, v167, s[54:55]
    v_and_b32 v253, 3, v0
    v_lshlrev_b32 v253, 2, v253
    s_mov_b32 s68, 85133568
    s_add_u32 s70, s17, 0
    s_cmp_eq_u32 s17, 63
    s_cselect_b32 s70, 61, s70
    s_mov_b32 s27, 0
WK_W3:
    buffer_load_dword v254, v253, s[8:11], s68 offen sc1
    s_add_u32 s27, s27, 1
    s_nop 0
    s_cmp_gt_u32 s27, 65536
    s_cbranch_scc1 CH_FAIL
    s_waitcnt vmcnt(0)
    v_cmp_ge_u32 vcc, s70, v254
    s_cbranch_vccz WK_W3_OK
    s_sleep 3
    v_cmp_lt_u32 vcc, 60, v254
    s_cbranch_vccnz WK_W3
    s_sleep 16
    v_add_u32_e64 v254, 4, v254
    v_cmp_lt_u32 vcc, s70, v254
    s_cbranch_vccnz WK_W3
    s_sleep 100
    s_branch WK_W3
WK_W3_OK:
    s_lshl_b32 s20, s17, 13
    s_nop 0
    s_add_u32 s20, s20, 85983232
    s_cmp_eq_u32 s17, 63
    s_nop 0
    s_cselect_b32 s20, 84410368, s20
    s_add_u32 s29, s20, 4096
    s_mov_b32 s27, 0
    s_nop 0
WF_MP:
    buffer_load_dwordx4 v[168:171], v1, s[8:11], s20 offen offset:0 sc1
    buffer_load_dwordx4 v[172:175], v1, s[8:11], s20 offen offset:1024 sc1
    buffer_load_dwordx4 v[176:179], v1, s[8:11], s20 offen offset:2048 sc1
    buffer_load_dwordx4 v[180:183], v1, s[8:11], s20 offen offset:3072 sc1
    buffer_load_dwordx4 v[184:187], v1, s[8:11], s29 offen offset:0 sc1
    buffer_load_dwordx4 v[188:191], v1, s[8:11], s29 offen offset:1024 sc1
    buffer_load_dwordx4 v[192:195], v1, s[8:11], s29 offen offset:2048 sc1
    s_add_u32 s27, s27, 1
    s_nop 0
    s_cmp_gt_u32 s27, 65536
    s_cbranch_scc1 CH_FAIL
    s_waitcnt vmcnt(0)
    v_max3_u32 v6, v168, v169, v170
    v_max3_u32 v6, v6, v171, v172
    v_max3_u32 v6, v6, v173, v174
    v_max3_u32 v6, v6, v175, v176
    v_max3_u32 v6, v6, v177, v178
    v_max3_u32 v6, v6, v179, v180
    v_max3_u32 v6, v6, v181, v182
    v_max3_u32 v6, v6, v183, v184
    v_max3_u32 v6, v6, v185, v186
    v_max3_u32 v6, v6, v187, v188
    v_max3_u32 v6, v6, v189, v190
    v_max3_u32 v6, v6, v191, v192
    v_max3_u32 v6, v6, v193, v194
    v_max_u32_e64 v6, v6, v195
    v_cmp_eq_u32 vcc, -1, v6
    s_cbranch_vccnz WF_MP
    v_smfmac_f32_16x16x64_bf16 v[196:199], v[168:171], a[0:7], v5
    v_smfmac_f32_16x16x64_bf16 v[200:203], v[168:171], a[56:63], v5
    v_smfmac_f32_16x16x64_bf16 v[204:207], v[168:171], a[112:119], v5
    v_smfmac_f32_16x16x64_bf16 v[208:211], v[168:171], a[168:175], v5
    v_smfmac_f32_16x16x64_bf16 v[196:199], v[172:175], a[8:15], v5
    v_smfmac_f32_16x16x64_bf16 v[200:203], v[172:175], a[64:71], v5
    v_smfmac_f32_16x16x64_bf16 v[204:207], v[172:175], a[120:127], v5
    v_smfmac_f32_16x16x64_bf16 v[208:211], v[172:175], a[176:183], v5
    v_smfmac_f32_16x16x64_bf16 v[196:199], v[176:179], a[16:23], v5
    v_smfmac_f32_16x16x64_bf16 v[200:203], v[176:179], a[72:79], v5
    v_smfmac_f32_16x16x64_bf16 v[204:207], v[176:179], a[128:135], v5
    v_smfmac_f32_16x16x64_bf16 v[208:211], v[176:179], a[184:191], v5
    v_smfmac_f32_16x16x64_bf16 v[196:199], v[180:183], a[24:31], v5
    v_smfmac_f32_16x16x64_bf16 v[200:203], v[180:183], a[80:87], v5
    v_smfmac_f32_16x16x64_bf16 v[204:207], v[180:183], a[136:143], v5
    v_smfmac_f32_16x16x64_bf16 v[208:211], v[180:183], a[192:199], v5
    v_smfmac_f32_16x16x64_bf16 v[196:199], v[184:187], a[32:39], v5
    v_smfmac_f32_16x16x64_bf16 v[200:203], v[184:187], a[88:95], v5
    v_smfmac_f32_16x16x64_bf16 v[204:207], v[184:187], a[144:151], v5
    v_smfmac_f32_16x16x64_bf16 v[208:211], v[184:187], a[200:207], v5
    v_smfmac_f32_16x16x64_bf16 v[196:199], v[188:191], a[40:47], v5
    v_smfmac_f32_16x16x64_bf16 v[200:203], v[188:191], a[96:103], v5
    v_smfmac_f32_16x16x64_bf16 v[204:207], v[188:191], a[152:159], v5
    v_smfmac_f32_16x16x64_bf16 v[208:211], v[188:191], a[208:215], v5
    v_smfmac_f32_16x16x64_bf16 v[196:199], v[192:195], a[48:55], v5
    v_smfmac_f32_16x16x64_bf16 v[200:203], v[192:195], a[104:111], v5
    v_smfmac_f32_16x16x64_bf16 v[204:207], v[192:195], a[160:167], v5
    v_smfmac_f32_16x16x64_bf16 v[208:211], v[192:195], a[216:223], v5
    s_nop 4
    v_permlane32_swap_b32 v196, v198
    v_permlane32_swap_b32 v197, v199
    v_permlane32_swap_b32 v200, v202
    v_permlane32_swap_b32 v201, v203
    v_permlane32_swap_b32 v204, v206
    v_permlane32_swap_b32 v205, v207
    v_permlane32_swap_b32 v208, v210
    v_permlane32_swap_b32 v209, v211
    v_add_f32 v196, v196, v198
    v_add_f32 v197, v197, v199
    v_add_f32 v200, v200, v202
    v_add_f32 v201, v201, v203
    v_add_f32 v204, v204, v206
    v_add_f32 v205, v205, v207
    v_add_f32 v208, v208, v210
    v_add_f32_e64 v209, v209, v211
    v_max3_f32 v198, v136, v137, v138
    v_max3_f32 v198, v198, v139, v140
    v_max3_f32 v198, v198, v141, v142
    v_max3_f32 v198, v198, v143, v196
    v_max_f32_e64 v198, v198, v197
    v_max3_f32 v202, v144, v145, v146
    v_max3_f32 v202, v202, v147, v148
    v_max3_f32 v202, v202, v149, v150
    v_max3_f32 v202, v202, v151, v200
    v_max_f32_e64 v202, v202, v201
    v_max3_f32 v206, v152, v153, v154
    v_max3_f32 v206, v206, v155, v156
    v_max3_f32 v206, v206, v157, v158
    v_max3_f32 v206, v206, v159, v204
    v_max_f32_e64 v206, v206, v205
    v_max3_f32 v210, v160, v161, v162
    v_max3_f32 v210, v210, v163, v164
    v_max3_f32 v210, v210, v165, v166
    v_max3_f32 v210, v210, v167, v208
    v_max_f32 v210, v210, v209
    v_mov_b32 v199, v198
    v_mov_b32 v203, v202
    v_mov_b32 v207, v206
    v_mov_b32 v211, v210
    s_nop 0
    v_permlane16_swap_b32 v198, v199
    v_permlane16_swap_b32 v202, v203
    v_permlane16_swap_b32 v206, v207
    v_permlane16_swap_b32 v210, v211
    v_max_f32 v198, v198, v199
    v_max_f32 v202, v202, v203
    v_max_f32 v206, v206, v207
    v_max_f32 v210, v210, v211
    v_mov_b32 v199, v198
    v_mov_b32 v203, v202
    v_mov_b32 v207, v206
    v_mov_b32 v211, v210
    s_nop 0
    v_permlane32_swap_b32 v198, v199
    v_permlane32_swap_b32 v202, v203
    v_permlane32_swap_b32 v206, v207
    v_permlane32_swap_b32 v210, v211
    v_max_f32 v198, v198, v199
    v_max_f32 v202, v202, v203
    v_max_f32 v206, v206, v207
    v_max_f32 v210, v210, v211
    v_sub_f32 v136, v136, v198
    v_sub_f32 v137, v137, v198
    v_sub_f32 v138, v138, v198
    v_sub_f32 v139, v139, v198
    v_sub_f32 v140, v140, v198
    v_sub_f32 v141, v141, v198
    v_sub_f32 v142, v142, v198
    v_sub_f32 v143, v143, v198
    v_sub_f32 v196, v196, v198
    v_sub_f32 v197, v197, v198
    v_exp_f32 v136, v136
    v_exp_f32 v137, v137
    v_exp_f32 v138, v138
    v_exp_f32 v139, v139
    v_exp_f32 v140, v140
    v_exp_f32 v141, v141
    v_exp_f32 v142, v142
    v_exp_f32 v143, v143
    v_exp_f32 v196, v196
    v_exp_f32 v197, v197
    v_sub_f32 v144, v144, v202
    v_sub_f32 v145, v145, v202
    v_sub_f32 v146, v146, v202
    v_sub_f32 v147, v147, v202
    v_sub_f32 v148, v148, v202
    v_sub_f32 v149, v149, v202
    v_sub_f32 v150, v150, v202
    v_sub_f32 v151, v151, v202
    v_sub_f32 v200, v200, v202
    v_sub_f32 v201, v201, v202
    v_exp_f32 v144, v144
    v_exp_f32 v145, v145
    v_exp_f32 v146, v146
    v_exp_f32 v147, v147
    v_exp_f32 v148, v148
    v_exp_f32 v149, v149
    v_exp_f32 v150, v150
    v_exp_f32 v151, v151
    v_exp_f32 v200, v200
    v_exp_f32 v201, v201
    v_sub_f32 v152, v152, v206
    v_sub_f32 v153, v153, v206
    v_sub_f32 v154, v154, v206
    v_sub_f32 v155, v155, v206
    v_sub_f32 v156, v156, v206
    v_sub_f32 v157, v157, v206
    v_sub_f32 v158, v158, v206
    v_sub_f32 v159, v159, v206
    v_sub_f32 v204, v204, v206
    v_sub_f32 v205, v205, v206
    v_exp_f32 v152, v152
    v_exp_f32 v153, v153
    v_exp_f32 v154, v154
    v_exp_f32 v155, v155
    v_exp_f32 v156, v156
    v_exp_f32 v157, v157
    v_exp_f32 v158, v158
    v_exp_f32 v159, v159
    v_exp_f32 v204, v204
    v_exp_f32 v205, v205
    v_sub_f32 v160, v160, v210
    v_sub_f32 v161, v161, v210
    v_sub_f32 v162, v162, v210
    v_sub_f32 v163, v163, v210
    v_sub_f32 v164, v164, v210
    v_sub_f32 v165, v165, v210
    v_sub_f32 v166, v166, v210
    v_sub_f32 v167, v167, v210
    v_sub_f32 v208, v208, v210
    v_sub_f32 v209, v209, v210
    v_exp_f32 v160, v160
    v_exp_f32 v161, v161
    v_exp_f32 v162, v162
    v_exp_f32 v163, v163
    v_exp_f32 v164, v164
    v_exp_f32 v165, v165
    v_exp_f32 v166, v166
    v_exp_f32 v167, v167
    v_exp_f32 v208, v208
    v_exp_f32 v209, v209
    v_add_f32 v198, v136, v137
    v_add_f32 v198, v198, v138
    v_add_f32 v198, v198, v139
    v_add_f32 v198, v198, v140
    v_add_f32 v198, v198, v141
    v_add_f32 v198, v198, v142
    v_add_f32 v198, v198, v143
    v_add_f32 v198, v198, v196
    v_add_f32 v198, v198, v197
    v_add_f32 v202, v144, v145
    v_add_f32 v202, v202, v146
    v_add_f32 v202, v202, v147
    v_add_f32 v202, v202, v148
    v_add_f32 v202, v202, v149
    v_add_f32 v202, v202, v150
    v_add_f32 v202, v202, v151
    v_add_f32 v202, v202, v200
    v_add_f32 v202, v202, v201
    v_add_f32 v206, v152, v153
    v_add_f32 v206, v206, v154
    v_add_f32 v206, v206, v155
    v_add_f32 v206, v206, v156
    v_add_f32 v206, v206, v157
    v_add_f32 v206, v206, v158
    v_add_f32 v206, v206, v159
    v_add_f32 v206, v206, v204
    v_add_f32 v206, v206, v205
    v_add_f32 v210, v160, v161
    v_add_f32 v210, v210, v162
    v_add_f32 v210, v210, v163
    v_add_f32 v210, v210, v164
    v_add_f32 v210, v210, v165
    v_add_f32 v210, v210, v166
    v_add_f32 v210, v210, v167
    v_add_f32 v210, v210, v208
    v_add_f32 v210, v210, v209
    v_mov_b32 v199, v198
    v_mov_b32 v203, v202
    v_mov_b32 v207, v206
    v_mov_b32 v211, v210
    s_nop 0
    v_permlane16_swap_b32 v198, v199
    v_permlane16_swap_b32 v202, v203
    v_permlane16_swap_b32 v206, v207
    v_permlane16_swap_b32 v210, v211
    v_add_f32 v198, v198, v199
    v_add_f32 v202, v202, v203
    v_add_f32 v206, v206, v207
    v_add_f32 v210, v210, v211
    v_mov_b32 v199, v198
    v_mov_b32 v203, v202
    v_mov_b32 v207, v206
    v_mov_b32 v211, v210
    s_nop 0
    v_permlane32_swap_b32 v198, v199
    v_permlane32_swap_b32 v202, v203
    v_permlane32_swap_b32 v206, v207
    v_permlane32_swap_b32 v210, v211
    v_add_f32 v198, v198, v199
    v_add_f32 v202, v202, v203
    v_add_f32 v206, v206, v207
    v_add_f32 v210, v210, v211
    v_rcp_f32 v198, v198
    v_rcp_f32 v202, v202
    v_rcp_f32 v206, v206
    v_rcp_f32 v210, v210
    s_nop 0
    v_mul_f32 v136, v136, v198
    v_mul_f32 v137, v137, v198
    v_mul_f32 v138, v138, v198
    v_mul_f32 v139, v139, v198
    v_mul_f32 v140, v140, v198
    v_mul_f32 v141, v141, v198
    v_mul_f32 v142, v142, v198
    v_mul_f32 v143, v143, v198
    v_mul_f32 v196, v196, v198
    v_mul_f32 v197, v197, v198
    v_cvt_pk_bf16_f32 v212, v136, v137
    v_cvt_pk_bf16_f32 v213, v138, v139
    v_cvt_pk_bf16_f32 v214, v140, v141
    v_cvt_pk_bf16_f32 v215, v142, v143
    v_cvt_pk_bf16_f32 v228, v196, v197
    v_mul_f32 v144, v144, v202
    v_mul_f32 v145, v145, v202
    v_mul_f32 v146, v146, v202
    v_mul_f32 v147, v147, v202
    v_mul_f32 v148, v148, v202
    v_mul_f32 v149, v149, v202
    v_mul_f32 v150, v150, v202
    v_mul_f32 v151, v151, v202
    v_mul_f32 v200, v200, v202
    v_mul_f32 v201, v201, v202
    v_cvt_pk_bf16_f32 v216, v144, v145
    v_cvt_pk_bf16_f32 v217, v146, v147
    v_cvt_pk_bf16_f32 v218, v148, v149
    v_cvt_pk_bf16_f32 v219, v150, v151
    v_cvt_pk_bf16_f32 v229, v200, v201
    v_mul_f32 v152, v152, v206
    v_mul_f32 v153, v153, v206
    v_mul_f32 v154, v154, v206
    v_mul_f32 v155, v155, v206
    v_mul_f32 v156, v156, v206
    v_mul_f32 v157, v157, v206
    v_mul_f32 v158, v158, v206
    v_mul_f32 v159, v159, v206
    v_mul_f32 v204, v204, v206
    v_mul_f32 v205, v205, v206
    v_cvt_pk_bf16_f32 v220, v152, v153
    v_cvt_pk_bf16_f32 v221, v154, v155
    v_cvt_pk_bf16_f32 v222, v156, v157
    v_cvt_pk_bf16_f32 v223, v158, v159
    v_cvt_pk_bf16_f32 v230, v204, v205
    v_mul_f32 v160, v160, v210
    v_mul_f32 v161, v161, v210
    v_mul_f32 v162, v162, v210
    v_mul_f32 v163, v163, v210
    v_mul_f32 v164, v164, v210
    v_mul_f32 v165, v165, v210
    v_mul_f32 v166, v166, v210
    v_mul_f32 v167, v167, v210
    v_mul_f32 v208, v208, v210
    v_mul_f32 v209, v209, v210
    v_cvt_pk_bf16_f32 v224, v160, v161
    v_cvt_pk_bf16_f32 v225, v162, v163
    v_cvt_pk_bf16_f32 v226, v164, v165
    v_cvt_pk_bf16_f32 v227, v166, v167
    v_cvt_pk_bf16_f32 v231, v208, v209
    s_nop 0
    s_nop 0
WF_Q:
    v_mfma_f32_16x16x32_bf16 v[136:139], v[24:27], v[212:215], 0
    v_mfma_f32_16x16x32_bf16 v[140:143], v[40:43], v[212:215], 0
    v_mfma_f32_16x16x32_bf16 v[144:147], v[56:59], v[212:215], 0
    v_mfma_f32_16x16x32_bf16 v[148:151], v[72:75], v[212:215], 0
    v_mfma_f32_16x16x32_bf16 v[152:155], v[88:91], v[212:215], 0
    v_mfma_f32_16x16x32_bf16 v[156:159], v[104:107], v[212:215], 0
    v_mfma_f32_16x16x32_bf16 v[160:163], v[120:123], v[212:215], 0
    v_mfma_f32_16x16x32_bf16 v[136:139], v[28:31], v[216:219], v[136:139]
    v_mfma_f32_16x16x32_bf16 v[140:143], v[44:47], v[216:219], v[140:143]
    v_mfma_f32_16x16x32_bf16 v[144:147], v[60:63], v[216:219], v[144:147]
    v_mfma_f32_16x16x32_bf16 v[148:151], v[76:79], v[216:219], v[148:151]
    v_mfma_f32_16x16x32_bf16 v[152:155], v[92:95], v[216:219], v[152:155]
    v_mfma_f32_16x16x32_bf16 v[156:159], v[108:111], v[216:219], v[156:159]
    v_mfma_f32_16x16x32_bf16 v[160:163], v[124:127], v[216:219], v[160:163]
    v_mfma_f32_16x16x32_bf16 v[136:139], v[32:35], v[220:223], v[136:139]
    v_mfma_f32_16x16x32_bf16 v[140:143], v[48:51], v[220:223], v[140:143]
    v_mfma_f32_16x16x32_bf16 v[144:147], v[64:67], v[220:223], v[144:147]
    v_mfma_f32_16x16x32_bf16 v[148:151], v[80:83], v[220:223], v[148:151]
    v_mfma_f32_16x16x32_bf16 v[152:155], v[96:99], v[220:223], v[152:155]
    v_mfma_f32_16x16x32_bf16 v[156:159], v[112:115], v[220:223], v[156:159]
    v_mfma_f32_16x16x32_bf16 v[160:163], v[128:131], v[220:223], v[160:163]
    v_mfma_f32_16x16x32_bf16 v[136:139], v[36:39], v[224:227], v[136:139]
    v_mfma_f32_16x16x32_bf16 v[140:143], v[52:55], v[224:227], v[140:143]
    v_mfma_f32_16x16x32_bf16 v[144:147], v[68:71], v[224:227], v[144:147]
    v_mfma_f32_16x16x32_bf16 v[148:151], v[84:87], v[224:227], v[148:151]
    v_mfma_f32_16x16x32_bf16 v[152:155], v[100:103], v[224:227], v[152:155]
    v_mfma_f32_16x16x32_bf16 v[156:159], v[116:119], v[224:227], v[156:159]
    v_mfma_f32_16x16x32_bf16 v[160:163], v[132:135], v[224:227], v[160:163]
    v_mul_u32_u24 v6, 464, v3
    v_lshl_add_u32 v6, v4, 4, v6
    s_mul_i32 s20, s16, 7424
    v_add_u32 v6, s20, v6
    v_and_b32 v253, 3, v0
    v_lshlrev_b32_e64 v253, 2, v253
    s_mov_b32 s68, 85133568
    s_add_u32 s70, s17, 2
    s_cmp_lt_u32 s70, 63
    s_cbranch_scc1 WK_W4_N
    v_and_b32 v253, 63, v0
    v_min_u32 v253, 55, v253
    v_lshlrev_b32 v253, 2, v253
    s_mov_b32 s68, 85134080
    s_mov_b32 s70, 0
    s_nop 0
WK_W4_N:
    s_mov_b32 s27, 0
    s_nop 0
WK_W4:
    buffer_load_dword v254, v253, s[8:11], s68 offen sc1
    s_add_u32 s27, s27, 1
    s_nop 0
    s_cmp_gt_u32 s27, 65536
    s_cbranch_scc1 CH_FAIL
    s_waitcnt vmcnt(0)
    v_cmp_ge_u32 vcc, s70, v254
    s_cbranch_vccz WK_W4_OK
    s_sleep 3
    s_cmp_gt_u32 s17, 60
    s_cbranch_scc1 WK_W4
    s_sleep 16
    v_add_u32_e64 v254, 4, v254
    v_cmp_lt_u32 vcc, s70, v254
    s_cbranch_vccnz WK_W4
    s_sleep 100
    s_branch WK_W4
WK_W4_OK:
    buffer_load_dwordx4 v[168:171], v1, s[8:11], s25 offen offset:0 sc1
    buffer_load_dwordx4 v[172:175], v1, s[8:11], s25 offen offset:1024 sc1
    buffer_load_dwordx4 v[176:179], v1, s[8:11], s25 offen offset:2048 sc1
    buffer_load_dwordx4 v[180:183], v1, s[8:11], s25 offen offset:3072 sc1
    s_add_u32 s25, s25, 4096
    buffer_load_dwordx4 v[184:187], v1, s[8:11], s25 offen offset:0 sc1
    buffer_load_dwordx4 v[188:191], v1, s[8:11], s25 offen offset:1024 sc1
    buffer_load_dwordx4 v[192:195], v1, s[8:11], s25 offen offset:2048 sc1
    s_nop 0
    s_waitcnt vmcnt(6)
    v_mfma_f32_16x16x32_bf16 v[136:139], v[168:171], v[228:231], v[136:139]
    s_nop 0
    s_waitcnt vmcnt(5)
    v_mfma_f32_16x16x32_bf16 v[140:143], v[172:175], v[228:231], v[140:143]
    s_nop 0
    s_waitcnt vmcnt(4)
    v_mfma_f32_16x16x32_bf16 v[144:147], v[176:179], v[228:231], v[144:147]
    s_nop 0
    s_waitcnt vmcnt(3)
    v_mfma_f32_16x16x32_bf16 v[148:151], v[180:183], v[228:231], v[148:151]
    s_nop 0
    s_waitcnt vmcnt(2)
    v_mfma_f32_16x16x32_bf16 v[152:155], v[184:187], v[228:231], v[152:155]
    s_nop 0
    s_waitcnt vmcnt(1)
    v_mfma_f32_16x16x32_bf16 v[156:159], v[188:191], v[228:231], v[156:159]
    s_nop 0
    s_waitcnt vmcnt(0)
    v_mfma_f32_16x16x32_bf16 v[160:163], v[192:195], v[228:231], v[160:163]
    s_nop 0
    s_nop 0
    ds_write_b128 v6, v[136:139] offset:0
    ds_write_b128 v6, v[140:143] offset:64
    ds_write_b128 v6, v[144:147] offset:128
    ds_write_b128 v6, v[148:151] offset:192
    ds_write_b128 v6, v[152:155] offset:256
    ds_write_b128 v6, v[156:159] offset:320
    s_nop 0
    s_nop 0
    ds_write_b128 v6, v[160:163] offset:384
    s_waitcnt lgkmcnt(0)
    s_barrier
    ds_read_b128 v[168:171], v11 offset:0
    ds_read_b128 v[172:175], v11 offset:16
    ds_read_b128 v[176:179], v11 offset:7424
    ds_read_b128 v[180:183], v11 offset:7440
    ds_read_b128 v[184:187], v11 offset:14848
    ds_read_b128 v[188:191], v11 offset:14864
    ds_read_b128 v[192:195], v11 offset:22272
    ds_read_b128 v[196:199], v11 offset:22288
    s_nop 0
    s_waitcnt lgkmcnt(0)
    v_pk_add_f32 v[168:169], v[168:169], v[176:177]
    v_pk_add_f32 v[184:185], v[184:185], v[192:193]
    v_pk_add_f32 v[168:169], v[168:169], v[184:185]
    v_pk_add_f32 v[170:171], v[170:171], v[178:179]
    v_pk_add_f32 v[186:187], v[186:187], v[194:195]
    v_pk_add_f32 v[170:171], v[170:171], v[186:187]
    v_pk_add_f32 v[172:173], v[172:173], v[180:181]
    v_pk_add_f32 v[188:189], v[188:189], v[196:197]
    v_pk_add_f32 v[172:173], v[172:173], v[188:189]
    v_pk_add_f32 v[174:175], v[174:175], v[182:183]
    v_pk_add_f32 v[190:191], v[190:191], v[198:199]
    v_pk_add_f32 v[174:175], v[174:175], v[190:191]
    v_cvt_pk_bf16_f32 v176, v168, v169
    v_lshlrev_b32_e64 v177, 16, v176
    v_and_b32 v178, 0xffff0000, v176
    v_lshlrev_b32_e64 v179, 16, v16
    v_and_b32 v180, 0xffff0000, v16
    v_add_f32 v177, v177, v179
    v_add_f32 v178, v178, v180
    v_cvt_pk_bf16_f32 v176, v177, v178
    v_lshlrev_b32_e64 v177, 16, v176
    v_and_b32 v178, 0xffff0000, v176
    v_lshlrev_b32_e64 v179, 16, v20
    v_and_b32 v180, 0xffff0000, v20
    v_add_f32 v177, v177, v179
    v_add_f32 v178, v178, v180
    v_cvt_pk_bf16_f32 v196, v177, v178
    v_cvt_pk_bf16_f32 v176, v170, v171
    v_lshlrev_b32_e64 v177, 16, v176
    v_and_b32 v178, 0xffff0000, v176
    v_lshlrev_b32_e64 v179, 16, v17
    v_and_b32 v180, 0xffff0000, v17
    v_add_f32 v177, v177, v179
    v_add_f32 v178, v178, v180
    v_cvt_pk_bf16_f32 v176, v177, v178
    v_lshlrev_b32_e64 v177, 16, v176
    v_and_b32 v178, 0xffff0000, v176
    v_lshlrev_b32_e64 v179, 16, v21
    v_and_b32 v180, 0xffff0000, v21
    v_add_f32 v177, v177, v179
    v_add_f32 v178, v178, v180
    v_cvt_pk_bf16_f32 v197, v177, v178
    v_cvt_pk_bf16_f32 v176, v172, v173
    v_lshlrev_b32_e64 v177, 16, v176
    v_and_b32 v178, 0xffff0000, v176
    v_lshlrev_b32_e64 v179, 16, v18
    v_and_b32 v180, 0xffff0000, v18
    v_add_f32 v177, v177, v179
    v_add_f32 v178, v178, v180
    v_cvt_pk_bf16_f32 v176, v177, v178
    v_lshlrev_b32_e64 v177, 16, v176
    v_and_b32 v178, 0xffff0000, v176
    v_lshlrev_b32_e64 v179, 16, v22
    v_and_b32 v180, 0xffff0000, v22
    v_add_f32 v177, v177, v179
    v_add_f32 v178, v178, v180
    v_cvt_pk_bf16_f32 v198, v177, v178
    v_cvt_pk_bf16_f32 v176, v174, v175
    v_lshlrev_b32_e64 v177, 16, v176
    v_and_b32 v178, 0xffff0000, v176
    v_lshlrev_b32_e64 v179, 16, v19
    v_and_b32 v180, 0xffff0000, v19
    v_add_f32 v177, v177, v179
    v_add_f32 v178, v178, v180
    v_cvt_pk_bf16_f32 v176, v177, v178
    v_lshlrev_b32_e64 v177, 16, v176
    v_and_b32 v178, 0xffff0000, v176
    v_lshlrev_b32_e64 v179, 16, v23
    v_and_b32 v180, 0xffff0000, v23
    v_add_f32 v177, v177, v179
    v_add_f32 v178, v178, v180
    v_cvt_pk_bf16_f32 v199, v177, v178
    buffer_store_dwordx4 v[196:199], v12, s[60:63], s26 offen
    s_add_u32 s19, s19, 1
    s_cmp_ge_u32 s19, s28
    s_cbranch_scc1 WF_E
    s_nop 0
    s_mul_i32 s23, s19, 7168
    s_mul_i32 s24, s21, 28672
    s_add_u32 s24, s24, s23
    s_nop 0
    s_add_u32 s24, s24, 50331648
    s_lshl_b32 s25, s17, 2
    s_add_u32 s25, s25, s16
    s_mul_i32 s25, s25, 28672
    s_add_u32 s25, s25, s23
    s_nop 0
    s_add_u32 s25, s25, 117571584
    s_add_u32 s20, s24, 0
    s_nop 0
    buffer_load_dwordx4 v[24:27], v1, s[8:11], s20 offen offset:0 sc1
    buffer_load_dwordx4 v[40:43], v1, s[8:11], s20 offen offset:1024 sc1
    buffer_load_dwordx4 v[56:59], v1, s[8:11], s20 offen offset:2048 sc1
    buffer_load_dwordx4 v[72:75], v1, s[8:11], s20 offen offset:3072 sc1
    s_add_u32 s20, s24, 4096
    buffer_load_dwordx4 v[88:91], v1, s[8:11], s20 offen offset:0 sc1
    buffer_load_dwordx4 v[104:107], v1, s[8:11], s20 offen offset:1024 sc1
    buffer_load_dwordx4 v[120:123], v1, s[8:11], s20 offen offset:2048 sc1
    s_add_u32 s20, s24, 28672
    buffer_load_dwordx4 v[28:31], v1, s[8:11], s20 offen offset:0 sc1
    buffer_load_dwordx4 v[44:47], v1, s[8:11], s20 offen offset:1024 sc1
    buffer_load_dwordx4 v[60:63], v1, s[8:11], s20 offen offset:2048 sc1
    buffer_load_dwordx4 v[76:79], v1, s[8:11], s20 offen offset:3072 sc1
    s_add_u32 s20, s24, 32768
    buffer_load_dwordx4 v[92:95], v1, s[8:11], s20 offen offset:0 sc1
    buffer_load_dwordx4 v[108:111], v1, s[8:11], s20 offen offset:1024 sc1
    buffer_load_dwordx4 v[124:127], v1, s[8:11], s20 offen offset:2048 sc1
    s_add_u32 s20, s24, 57344
    buffer_load_dwordx4 v[32:35], v1, s[8:11], s20 offen offset:0 sc1
    buffer_load_dwordx4 v[48:51], v1, s[8:11], s20 offen offset:1024 sc1
    buffer_load_dwordx4 v[64:67], v1, s[8:11], s20 offen offset:2048 sc1
    buffer_load_dwordx4 v[80:83], v1, s[8:11], s20 offen offset:3072 sc1
    s_add_u32 s20, s24, 61440
    buffer_load_dwordx4 v[96:99], v1, s[8:11], s20 offen offset:0 sc1
    buffer_load_dwordx4 v[112:115], v1, s[8:11], s20 offen offset:1024 sc1
    buffer_load_dwordx4 v[128:131], v1, s[8:11], s20 offen offset:2048 sc1
    s_add_u32 s20, s24, 86016
    buffer_load_dwordx4 v[36:39], v1, s[8:11], s20 offen offset:0 sc1
    buffer_load_dwordx4 v[52:55], v1, s[8:11], s20 offen offset:1024 sc1
    buffer_load_dwordx4 v[68:71], v1, s[8:11], s20 offen offset:2048 sc1
    buffer_load_dwordx4 v[84:87], v1, s[8:11], s20 offen offset:3072 sc1
    s_add_u32 s20, s24, 90112
    buffer_load_dwordx4 v[100:103], v1, s[8:11], s20 offen offset:0 sc1
    buffer_load_dwordx4 v[116:119], v1, s[8:11], s20 offen offset:1024 sc1
    buffer_load_dwordx4 v[132:135], v1, s[8:11], s20 offen offset:2048 sc1
    s_lshl_b32 s26, s17, 5
    s_lshl_b32 s20, s18, 4
    s_add_u32 s26, s26, s20
    s_nop 0
    s_mul_i32 s26, s26, 896
    s_mul_i32 s20, s19, 224
    s_add_u32 s26, s26, s20
    s_nop 0
    s_add_u32 s20, s26, 125829120
    buffer_load_dwordx4 v[16:19], v12, s[56:59], s26 offen
    buffer_load_dwordx4 v[20:23], v12, s[8:11], s20 offen sc1
    s_nop 0
    s_waitcnt vmcnt(0)
    s_barrier
    s_branch WF_Q
WF_E:
    s_waitcnt vmcnt(0)
    s_branch CH_DONE
CH_REDO:
    s_waitcnt vmcnt(0) lgkmcnt(0)
    s_barrier
    s_mov_b32 s17, s2
    s_mov_b32 s93, s2
    s_mov_b32 s18, 1
    s_branch CH_DISPATCH
CH_FAIL:
    v_mov_b32 v1, 0xdead
    v_mov_b32 v2, 228
    buffer_store_dword v1, v2, s[12:15], 0 offen
CH_DONE:
    s_endpgm
.section .rodata,"a"
.p2align 6
.amdhsa_kernel parallel_sum__memory_aug_recurrent_mem_tr__glu_gated_bilinear__prompt_kernel
  .amdhsa_next_free_vgpr 512
  .amdhsa_next_free_sgpr 102
  .amdhsa_accum_offset 256
  .amdhsa_group_segment_fixed_size 0
  .amdhsa_kernarg_size 112
  .amdhsa_user_sgpr_count 2
  .amdhsa_user_sgpr_kernarg_segment_ptr 1
  .amdhsa_system_sgpr_workgroup_id_x 1
.end_amdhsa_kernel
```
